```python
import torch

def _softmax(x, axis=-1):
    return torch.softmax(x, dim=axis)
def _gelu(x):
    return torch.nn.functional.gelu(x, approximate="tanh")
def _silu(x):
    return torch.nn.functional.silu(x)
def _sigmoid(x):
    return torch.sigmoid(x)
def _layernorm(x, axis=-1, eps=1e-5):
    m = x.mean(dim=axis, keepdim=True)
    v = x.var(dim=axis, keepdim=True, unbiased=False)
    return (x - m) / torch.sqrt(v + eps)
def _scatter_add(tgt, idx, src, axis=0):
    return tgt.clone().index_add_(axis, idx, src)
def _segment_sum(src, seg, n):
    out = torch.zeros((n,) + src.shape[1:], dtype=src.dtype)
    return out.index_add_(0, seg, src)
def _pad(x, pw):
    flat = tuple(v for pair in reversed(pw) for v in pair)
    return torch.nn.functional.pad(x, flat)

kernel_name = 'concat_heads__mha_block_cached__gqa_block_cached__near_ridge'

def setup_inputs():

    _w = (lambda a: (lambda t: t.to(torch.bfloat16) if t.is_floating_point() else t)(torch.as_tensor(a)))
    def _A_setup():
        B, Sq, D = 16, 240, 448
        H, Sk, Dh = 16, 512, 256
        return {
            "x": _w((lambda *s: torch.randn(*s, dtype=torch.bfloat16) * 0.8)(B, Sq, D)),
            "k_cache": _w((lambda *s: torch.randn(*s, dtype=torch.bfloat16) * 0.8)(B, H, Sk, Dh)),
            "v_cache": _w((lambda *s: torch.randn(*s, dtype=torch.bfloat16) * 0.05)(B, H, Sk, Dh)),
            "wq": _w((lambda *s: torch.randn(*s, dtype=torch.bfloat16) * 0.8)(D, H * Dh) * (D ** -0.5)),
            "wo": _w((lambda *s: torch.randn(*s, dtype=torch.bfloat16) * 0.05)(H * Dh, D) * ((H * Dh) ** -0.5)),
        }
    _A_in = _A_setup()

    def _B_setup():
        B, Sq, D = 16, 240, 448
        Hq, Hkv, Sk, Dh = 16, 16, 512, 256
        assert Hq % Hkv == 0, (Hq, Hkv)
        return {
            "x": _w((lambda *s: torch.randn(*s, dtype=torch.bfloat16) * 0.8)(B, Sq, D)),
            "k_cache": _w((lambda *s: torch.randn(*s, dtype=torch.bfloat16) * 0.8)(B, Hkv, Sk, Dh)),
            "v_cache": _w((lambda *s: torch.randn(*s, dtype=torch.bfloat16) * 0.05)(B, Hkv, Sk, Dh)),
            "wq": _w((lambda *s: torch.randn(*s, dtype=torch.bfloat16) * 0.8)(D, Hq * Dh) * (D ** -0.5)),
            "wo": _w((lambda *s: torch.randn(*s, dtype=torch.bfloat16) * 0.05)(Hq * Dh, D) * ((Hq * Dh) ** -0.5)),
        }
    _B_in = _B_setup()

    return {
        "A_x": _A_in["x"],
        "A_k_cache": _A_in["k_cache"],
        "A_v_cache": _A_in["v_cache"],
        "A_wq": _A_in["wq"],
        "A_wo": _A_in["wo"],
        "B_x": _B_in["x"],
        "B_k_cache": _B_in["k_cache"],
        "B_v_cache": _B_in["v_cache"],
        "B_wq": _B_in["wq"],
        "B_wo": _B_in["wo"],
    }

def reference(A_x, A_k_cache, A_v_cache, A_wq, A_wo, B_x, B_k_cache, B_v_cache, B_wq, B_wo):
    def _A_ref(x, k_cache, v_cache, wq, wo):
        B, Sq, D = x.shape
        H, Dh = 16, 256
        q = (lambda x, *d: x.permute(*d))((x @ wq).reshape(B, Sq, H, Dh), 0, 2, 1, 3)
        scores = torch.einsum("bhqd,bhkd->bhqk", q, k_cache) * (Dh ** -0.5)
        p = _softmax(scores, axis=-1)
        o = torch.einsum("bhqk,bhkd->bhqd", p, v_cache)
        return (lambda x, *d: x.permute(*d))(o, 0, 2, 1, 3).reshape(B, Sq, H * Dh) @ wo

    def _B_ref(x, k_cache, v_cache, wq, wo):
        B, Sq, D = x.shape
        Hq, Dh = 16, 256
        Hkv = k_cache.shape[1]
        rep = Hq // Hkv
        q = (lambda x, *d: x.permute(*d))((x @ wq).reshape(B, Sq, Hq, Dh), 0, 2, 1, 3)
        k = (lambda x, n, axis: torch.repeat_interleave(x, n, dim=axis))(k_cache, rep, axis=1)
        v = (lambda x, n, axis: torch.repeat_interleave(x, n, dim=axis))(v_cache, rep, axis=1)
        scores = torch.einsum("bhqd,bhkd->bhqk", q, k) * (Dh ** -0.5)
        p = _softmax(scores, axis=-1)
        o = torch.einsum("bhqk,bhkd->bhqd", p, v)
        return (lambda x, *d: x.permute(*d))(o, 0, 2, 1, 3).reshape(B, Sq, Hq * Dh) @ wo

    a = _A_ref(A_x, A_k_cache, A_v_cache, A_wq, A_wo)
    b = _B_ref(B_x, B_k_cache, B_v_cache, B_wq, B_wo)
    return torch.concatenate([a, b], axis=-1)
```

```asm
; @launch grid=(256,1,1) block=(256,1,1) lds=163840
.amdgcn_target "amdgcn-amd-amdhsa--gfx950"
.macro mf d, a, b
v_mfma_f32_16x16x32_bf16 \d, \a, \b, \d
.endm
.macro mz d, a, b, c
v_mfma_f32_16x16x32_bf16 \d, \a, \b, \c
.endm
.macro cv d, a, b
v_cvt_pk_bf16_f32 \d, \a, \b
.endm
.macro ar d, a
v_accvgpr_read_b32 \d, \a
.endm
.macro aw d, a
v_accvgpr_write_b32 \d, \a
.endm
.macro wl
s_waitcnt lgkmcnt(0)
.endm
.macro tr d, a, o
ds_read_b64_tr_b16 \d, \a offset:\o
.endm
.text
.globl concat_heads__mha_block_cached__gqa_block_cached__near_ridge_kernel
.p2align 8
.type concat_heads__mha_block_cached__gqa_block_cached__near_ridge_kernel,@function
concat_heads__mha_block_cached__gqa_block_cached__near_ridge_kernel:
s_cmp_ge_u32 s2, 256
s_cbranch_scc1 L_exit
s_bfe_u32 s78, s2, 0x10002
s_mul_i32 s72, s78, 40
s_add_u32 s72, s0, s72
s_addc_u32 s73, s1, 0
s_load_dwordx8 s[60:67], s[72:73], 0
s_getpc_b64 s[58:59]
s_lshr_b32 s3, s2, 3
s_and_b32 s77, s3, 7
s_lshl_b32 s3, s3, 13
v_lshrrev_b32 v39, 6, v0
v_lshrrev_b32 v41, 2, v0
v_readfirstlane_b32 s32, v39
v_lshl_add_u32 v41, v41, 7, s3
v_min_u32 v41, L_end-L_main4, v41
global_load_dword v20, v41, s[58:59]
v_bfe_u32 v24, v0, 3, 3
v_and_b32 v25, 7, v0
v_bfe_u32 v26, v0, 4, 2
v_and_b32 v27, 1, v26
v_lshlrev_b32 v27, 2, v27
v_xor_b32 v27, v27, v25
v_lshlrev_b32 v27, 4, v27
v_lshl_add_u32 v13, v24, 13, v27
s_lshl_b32 s46, s32, 11
s_lshl_b32 s47, s32, 17
s_cmp_eq_u32 s77, 7
s_cselect_b32 s54, 0, s77
s_lshl_b32 s54, s54, 19
s_add_u32 s47, s47, s54
s_lshl_b32 s75, s77, 10
s_sub_u32 s10, 3670016, s75
s_mov_b32 s11, 0x20000
s_waitcnt lgkmcnt(0)
s_add_u32 s8, s66, s75
s_addc_u32 s9, s67, 0
s_and_b32 s9, s9, 0xffff
s_add_u32 m0, s46, 0
s_add_u32 s39, s47, 0
buffer_load_dwordx4 v13, s[8:11], s39 offen lds
s_add_u32 m0, s46, 1024
s_add_u32 s39, s47, 65536
buffer_load_dwordx4 v13, s[8:11], s39 offen lds
s_load_dwordx2 s[68:69], s[72:73], 32
s_load_dwordx2 s[70:71], s[0:1], 96
s_load_dwordx4 s[84:87], s[0:1], 80
s_and_b32 s76, s2, 7
s_lshr_b32 s74, s2, 6
s_lshl2_add_u32 s76, s76, s74
s_and_b32 s79, s76, 15
s_mul_i32 s74, s79, 215040
s_add_u32 s4, s60, s74
s_addc_u32 s5, s61, 0
s_and_b32 s5, s5, 0xffff
s_mov_b32 s6, 215040
s_mov_b32 s7, 0x20000
s_mul_i32 s50, s32, 24576
s_add_u32 s50, s50, 65536
v_lshlrev_b32 v37, 1, v26
v_xor_b32 v37, v37, v25
v_lshlrev_b32 v37, 4, v37
v_lshl_add_u32 v36, v39, 6, v24
v_mul_u32_u24 v36, 896, v36
v_add_u32 v14, v36, v37
s_lshr_b32 s38, s54, 12
s_add_u32 m0, s50, 0
s_add_u32 s39, s38, 0
buffer_load_dwordx4 v14, s[4:7], s39 offen lds
s_add_u32 m0, s50, 1024
s_add_u32 s39, s38, 7168
buffer_load_dwordx4 v14, s[4:7], s39 offen lds
s_add_u32 m0, s50, 2048
s_add_u32 s39, s38, 14336
buffer_load_dwordx4 v14, s[4:7], s39 offen lds
s_add_u32 m0, s50, 3072
s_add_u32 s39, s38, 21504
buffer_load_dwordx4 v14, s[4:7], s39 offen lds
s_add_u32 m0, s50, 4096
s_add_u32 s39, s38, 28672
buffer_load_dwordx4 v14, s[4:7], s39 offen lds
s_add_u32 m0, s50, 5120
s_add_u32 s39, s38, 35840
buffer_load_dwordx4 v14, s[4:7], s39 offen lds
s_cmp_eq_u32 s32, 3
s_cbranch_scc1 L_main3
L_main4:
s_add_u32 m0, s50, 6144
s_add_u32 s39, s38, 43008
buffer_load_dwordx4 v14, s[4:7], s39 offen lds
s_add_u32 m0, s50, 7168
s_add_u32 s39, s38, 50176
buffer_load_dwordx4 v14, s[4:7], s39 offen lds
s_add_u32 m0, s46, 16384
s_add_u32 s39, s47, 128
buffer_load_dwordx4 v13, s[8:11], s39 offen lds
s_add_u32 m0, s46, 17408
s_add_u32 s39, s47, 65664
buffer_load_dwordx4 v13, s[8:11], s39 offen lds
v_and_b32 v0, 63, v0
v_lshlrev_b32 v1, 4, v0
v_lshl_add_u32 v2, v24, 9, v37
s_lshl_b32 s33, s32, 12
v_mul_u32_u24 v28, 896, v24
v_add_u32 v3, v28, v27
v_and_b32 v28, 15, v0
v_bfe_u32 v29, v0, 2, 2
v_and_b32 v30, 3, v0
v_lshrrev_b32 v31, 3, v28
v_and_b32 v32, 7, v28
v_lshlrev_b32 v32, 7, v32
v_and_b32 v33, 6, v28
v_xor_b32 v33, v33, v26
v_lshl_add_u32 v32, v33, 4, v32
v_lshl_add_u32 v5, v31, 12, v32
v_xor_b32 v6, 64, v5
v_lshl_add_u32 v32, v31, 10, v32
v_add_u32 v21, s50, v32
v_xor_b32 v22, 64, v21
v_lshrrev_b32 v31, 1, v26
v_and_b32 v32, 1, v26
v_lshl_add_u32 v33, v32, 2, v29
v_lshlrev_b32 v34, 12, v31
v_lshl_add_u32 v34, v33, 7, v34
v_lshl_add_u32 v34, v30, 3, v34
v_lshrrev_b32 v35, 1, v33
v_lshl_add_u32 v7, v35, 5, v34
v_xor_b32 v8, 32, v7
v_xor_b32 v9, 64, v7
v_xor_b32 v10, 96, v7
v_lshrrev_b32 v35, 1, v29
v_lshl_add_u32 v35, v35, 2, v30
v_lshlrev_b32 v35, 4, v35
v_lshl_add_u32 v36, v26, 10, v35
v_lshl_add_u32 v11, v29, 7, v36
v_xor_b32 v12, 64, v11
v_lshl_add_u32 v36, v31, 10, v35
v_lshl_add_u32 v36, v33, 7, v36
s_and_b32 s74, s77, 1
v_lshl_add_u32 v15, s74, 3, v36
v_xor_b32 v16, 64, v15
v_lshl_add_u32 v36, v39, 15, v1
v_add_u32 v4, 65536, v36
s_mul_i32 s45, s32, 28672
s_mov_b32 s34, -4096
s_mov_b32 s35, -4096
s_mov_b32 s43, 0
s_mov_b32 s36, 0x53800000
s_mov_b32 s55, 0x2b800000
s_mov_b32 s37, 0x3db8aa3b
s_lshl_b32 s40, s32, 16
s_add_u32 s40, s40, s75
s_mov_b32 s41, 0
s_mov_b32 s42, 0
s_mov_b32 s24, s33
s_add_u32 s25, s33, 0x10000
s_mov_b32 s53, 0x40000000
s_mov_b32 s49, 0x40000
s_add_u32 s51, s54, 524288
s_cmp_eq_u32 s51, 3670016
s_cselect_b32 s51, 0, s51
wl
s_lshl_b32 s72, s79, 22
s_lshl_b32 s73, s77, 19
s_add_u32 s72, s72, s73
s_add_u32 s12, s62, s72
s_addc_u32 s13, s63, 0
s_and_b32 s13, s13, 0xffff
s_mov_b32 s14, 524288
s_mov_b32 s15, 0x20000
s_add_u32 s16, s64, s72
s_addc_u32 s17, s65, 0
s_and_b32 s17, s17, 0xffff
s_mov_b32 s18, 524288
s_mov_b32 s19, 0x20000
s_mul_i32 s72, s77, 458752
s_add_u32 s20, s68, s72
s_addc_u32 s21, s69, 0
s_and_b32 s21, s21, 0xffff
s_mov_b32 s22, 458752
s_mov_b32 s23, 0x20000
s_mul_i32 s72, s76, 2658304
s_add_u32 s28, s70, s72
s_addc_u32 s29, s71, 0
s_and_b32 s29, s29, 0xffff
s_mov_b32 s30, 2621440
s_mov_b32 s31, 0x20000
s_add_u32 s92, s84, 0
s_addc_u32 s93, s85, 0
s_and_b32 s93, s93, 0xffff
s_mov_b32 s94, 6881280
s_mov_b32 s95, 0x20000
s_add_u32 s96, s86, 0
s_addc_u32 s97, s87, 0
s_and_b32 s97, s97, 0xffff
s_mov_b32 s98, 256
s_mov_b32 s99, 0x20000
s_lshl_b32 s72, s77, 2
s_add_u32 s72, s72, s32
s_lshl_b32 s26, s72, 13
s_lshr_b32 s73, s72, 1
s_mul_i32 s74, s79, 15
s_add_u32 s73, s73, s74
s_mul_i32 s73, s73, 28672
s_mul_i32 s74, s78, 896
s_add_u32 s73, s73, s74
s_and_b32 s74, s72, 1
s_lshl_b32 s74, s74, 6
s_add_u32 s27, s73, s74
s_cmp_lt_u32 s72, 30
s_cselect_b32 s26, s26, 0x40000000
s_cselect_b32 s27, s27, 0x40000000
s_lshl_b32 s72, s72, 2
s_add_u32 s72, s72, 2359296
v_min_u32 v41, 1, v0
v_lshl_add_u32 v17, v41, 30, s72
s_mul_i32 s56, s79, 28672
s_lshl_b32 s68, s77, 15
s_lshl_b32 s57, s77, 4
s_add_u32 s57, s57, 2359296
s_lshl_b32 s90, s76, 2
s_getreg_b32 s72, hwreg(HW_REG_XCC_ID, 0, 3)
s_lshl_b32 s72, s72, 2
s_lshl_b32 s91, 1, s72
s_add_u32 s52, s51, 524288
s_cmp_eq_u32 s52, 3670016
s_cselect_b32 s52, 0, s52
s_add_u32 s48, s52, 524288
s_cmp_eq_u32 s48, 3670016
s_cselect_b32 s48, 0, s48
s_add_u32 s69, s48, 524288
s_cmp_eq_u32 s69, 3670016
s_cselect_b32 s69, 0, s69
s_add_u32 s70, s69, 524288
s_cmp_eq_u32 s70, 3670016
s_cselect_b32 s70, 0, s70
s_add_u32 s71, s70, 524288
s_cmp_eq_u32 s71, 3670016
s_cselect_b32 s71, 0, s71
s_and_b32 s72, s32, 1
s_lshl_b32 s72, s72, 18
s_cmp_lt_u32 s32, 2
s_cselect_b32 s44, s51, s52
s_cselect_b32 s86, s48, s69
s_cselect_b32 s87, s70, s71
s_cselect_b32 s85, s54, s51
s_add_u32 s85, s85, s72
s_add_u32 s44, s44, s72
s_add_u32 s86, s86, s72
s_add_u32 s87, s87, s72
s_lshr_b32 s38, s51, 12
s_add_u32 m0, s50, 8192
s_add_u32 s39, s38, 0
buffer_load_dwordx4 v14, s[4:7], s39 offen lds
s_add_u32 m0, s50, 9216
s_add_u32 s39, s38, 7168
buffer_load_dwordx4 v14, s[4:7], s39 offen lds
s_add_u32 m0, s50, 10240
s_add_u32 s39, s38, 14336
buffer_load_dwordx4 v14, s[4:7], s39 offen lds
s_add_u32 m0, s50, 11264
s_add_u32 s39, s38, 21504
buffer_load_dwordx4 v14, s[4:7], s39 offen lds
s_waitcnt vmcnt(14)
s_barrier
tr a[128:129],v11,0
tr a[130:131],v11,512
tr a[132:133],v11,4096
tr a[134:135],v11,4608
tr a[136:137],v11,4104
tr a[138:139],v11,4616
tr a[140:141],v11,8
tr a[142:143],v11,520
s_waitcnt vmcnt(6)
ds_read_b128 v[96:99], v21 offset:0
ds_read_b128 v[112:115], v22 offset:0
ds_read_b128 v[100:103], v21 offset:2048
ds_read_b128 v[116:119], v22 offset:2048
ds_read_b128 v[104:107], v21 offset:4096
ds_read_b128 v[120:123], v22 offset:4096
ds_read_b128 v[108:111], v21 offset:6144
ds_read_b128 v[124:127], v22 offset:6144
wl
mz v[32:35],a[128:131],v[96:99],0
s_add_u32 m0, s50, 12288
s_add_u32 s39, s38, 28672
buffer_load_dwordx4 v14, s[4:7], s39 offen lds
mf v[32:35],a[132:135],v[112:115]
s_add_u32 m0, s50, 13312
s_add_u32 s39, s38, 35840
buffer_load_dwordx4 v14, s[4:7], s39 offen lds
mz v[48:51],a[136:139],v[112:115],0
s_add_u32 m0, s50, 14336
tr a[144:145],v12,0
mf v[48:51],a[140:143],v[96:99]
s_add_u32 s39, s38, 43008
buffer_load_dwordx4 v14, s[4:7], s39 offen lds
mz v[52:55],a[140:143],v[100:103],0
s_add_u32 m0, s50, 15360
s_add_u32 s39, s38, 50176
buffer_load_dwordx4 v14, s[4:7], s39 offen lds
mf v[52:55],a[136:139],v[116:119]
s_lshr_b32 s38, s52, 12
s_add_u32 m0, s50, 16384
tr a[146:147],v12,512
mz v[36:39],a[132:135],v[116:119],0
s_add_u32 s39, s38, 0
buffer_load_dwordx4 v14, s[4:7], s39 offen lds
mf v[36:39],a[128:131],v[100:103]
s_add_u32 m0, s50, 17408
s_add_u32 s39, s38, 7168
buffer_load_dwordx4 v14, s[4:7], s39 offen lds
mz v[40:43],a[128:131],v[104:107],0
s_add_u32 m0, s50, 18432
tr a[148:149],v12,4096
mf v[40:43],a[132:135],v[120:123]
s_add_u32 s39, s38, 14336
buffer_load_dwordx4 v14, s[4:7], s39 offen lds
mz v[56:59],a[136:139],v[120:123],0
s_add_u32 m0, s50, 19456
s_add_u32 s39, s38, 21504
buffer_load_dwordx4 v14, s[4:7], s39 offen lds
mf v[56:59],a[140:143],v[104:107]
s_add_u32 m0, s50, 20480
tr a[150:151],v12,4608
mz v[60:63],a[140:143],v[108:111],0
s_add_u32 s39, s38, 28672
buffer_load_dwordx4 v14, s[4:7], s39 offen lds
mf v[60:63],a[136:139],v[124:127]
s_add_u32 m0, s50, 21504
s_add_u32 s39, s38, 35840
buffer_load_dwordx4 v14, s[4:7], s39 offen lds
tr a[152:153],v12,4104
tr a[154:155],v12,4616
tr a[156:157],v12,8
tr a[158:159],v12,520
mz v[44:47],a[132:135],v[124:127],0
s_add_u32 m0, s50, 22528
mf v[44:47],a[128:131],v[108:111]
s_add_u32 s39, s38, 43008
buffer_load_dwordx4 v14, s[4:7], s39 offen lds
wl
mz v[76:79],a[144:147],v[108:111],0
s_add_u32 m0, s50, 23552
s_add_u32 s39, s38, 50176
buffer_load_dwordx4 v14, s[4:7], s39 offen lds
s_waitcnt vmcnt(16)
s_barrier
mf v[76:79],a[148:151],v[124:127]
s_add_u32 m0, s33, 32768
tr a[128:129],v11,16384
mz v[92:95],a[152:155],v[124:127],0
s_add_u32 s39, s44, 0
buffer_load_dwordx4 v13, s[8:11], s39 offen lds
mf v[92:95],a[156:159],v[108:111]
s_add_u32 m0, s33, 33792
s_add_u32 s39, s44, 65536
buffer_load_dwordx4 v13, s[8:11], s39 offen lds
mz v[88:91],a[156:159],v[104:107],0
s_add_u32 m0, s33, 34816
tr a[130:131],v11,16896
mf v[88:91],a[152:155],v[120:123]
s_add_u32 s39, s44, 131072
buffer_load_dwordx4 v13, s[8:11], s39 offen lds
mz v[72:75],a[148:151],v[120:123],0
s_add_u32 m0, s33, 35840
s_add_u32 s39, s44, 196608
buffer_load_dwordx4 v13, s[8:11], s39 offen lds
mf v[72:75],a[144:147],v[104:107]
s_add_u32 m0, s33, 49152
tr a[132:133],v11,20480
mz v[68:71],a[144:147],v[100:103],0
s_add_u32 s39, s44, 128
buffer_load_dwordx4 v13, s[8:11], s39 offen lds
mf v[68:71],a[148:151],v[116:119]
s_add_u32 m0, s33, 50176
tr a[134:135],v11,20992
mz v[84:87],a[152:155],v[116:119],0
s_add_u32 s39, s44, 65664
buffer_load_dwordx4 v13, s[8:11], s39 offen lds
mf v[84:87],a[156:159],v[100:103]
s_add_u32 m0, s33, 51200
tr a[136:137],v11,20488
mz v[80:83],a[156:159],v[96:99],0
tr a[138:139],v11,21000
mf v[80:83],a[152:155],v[112:115]
s_add_u32 s39, s44, 131200
buffer_load_dwordx4 v13, s[8:11], s39 offen lds
tr a[140:141],v11,16392
tr a[142:143],v11,16904
mz v[64:67],a[148:151],v[112:115],0
s_add_u32 m0, s33, 52224
mf v[64:67],a[144:147],v[96:99]
wl
mz a[64:67],a[128:131],v[96:99],0
s_add_u32 s39, s44, 196736
buffer_load_dwordx4 v13, s[8:11], s39 offen lds
mf a[64:67],a[132:135],v[112:115]
s_lshr_b32 s38, s48, 12
s_add_u32 m0, s50, 0
tr a[144:145],v12,16384
mz a[80:83],a[136:139],v[112:115],0
s_add_u32 s39, s38, 0
buffer_load_dwordx4 v14, s[4:7], s39 offen lds
mf a[80:83],a[140:143],v[96:99]
s_add_u32 m0, s50, 1024
tr a[146:147],v12,16896
mz a[84:87],a[140:143],v[100:103],0
tr a[148:149],v12,20480
mf a[84:87],a[136:139],v[116:119]
s_add_u32 s39, s38, 7168
buffer_load_dwordx4 v14, s[4:7], s39 offen lds
mz a[68:71],a[132:135],v[116:119],0
s_add_u32 m0, s50, 2048
tr a[150:151],v12,20992
mf a[68:71],a[128:131],v[100:103]
tr a[152:153],v12,20488
mz a[72:75],a[128:131],v[104:107],0
s_add_u32 s39, s38, 14336
buffer_load_dwordx4 v14, s[4:7], s39 offen lds
mf a[72:75],a[132:135],v[120:123]
s_add_u32 m0, s50, 3072
tr a[154:155],v12,21000
mz a[88:91],a[136:139],v[120:123],0
s_add_u32 s39, s38, 21504
buffer_load_dwordx4 v14, s[4:7], s39 offen lds
mf a[88:91],a[140:143],v[104:107]
s_add_u32 m0, s50, 4096
tr a[156:157],v12,16392
mz a[92:95],a[140:143],v[108:111],0
tr a[158:159],v12,16904
s_waitcnt vmcnt(20)
mf a[92:95],a[136:139],v[124:127]
s_add_u32 s39, s38, 28672
buffer_load_dwordx4 v14, s[4:7], s39 offen lds
ds_read_b128 v[128:131], v21 offset:8192
ds_read_b128 v[144:147], v22 offset:8192
ds_read_b128 v[132:135], v21 offset:10240
ds_read_b128 v[148:151], v22 offset:10240
ds_read_b128 v[136:139], v21 offset:12288
ds_read_b128 v[152:155], v22 offset:12288
ds_read_b128 v[140:143], v21 offset:14336
ds_read_b128 v[156:159], v22 offset:14336
mz a[76:79],a[132:135],v[124:127],0
s_add_u32 m0, s50, 5120
mf a[76:79],a[128:131],v[108:111]
wl
mz a[108:111],a[144:147],v[108:111],0
s_add_u32 s39, s38, 35840
buffer_load_dwordx4 v14, s[4:7], s39 offen lds
s_waitcnt vmcnt(10)
s_barrier
mf a[108:111],a[148:151],v[124:127]
s_add_u32 m0, s50, 6144
tr a[128:129],v11,32768
mz a[124:127],a[152:155],v[124:127],0
s_add_u32 s39, s38, 43008
buffer_load_dwordx4 v14, s[4:7], s39 offen lds
mf a[124:127],a[156:159],v[108:111]
s_add_u32 m0, s50, 7168
tr a[130:131],v11,33280
mz a[120:123],a[156:159],v[104:107],0
tr a[132:133],v11,36864
mf a[120:123],a[152:155],v[120:123]
s_add_u32 s39, s38, 50176
buffer_load_dwordx4 v14, s[4:7], s39 offen lds
mz a[104:107],a[148:151],v[120:123],0
tr a[134:135],v11,37376
mf a[104:107],a[144:147],v[104:107]
tr a[136:137],v11,40960
mz a[100:103],a[144:147],v[100:103],0
tr a[138:139],v11,41472
mf a[100:103],a[148:151],v[116:119]
tr a[140:141],v11,45056
mz a[116:119],a[152:155],v[116:119],0
tr a[142:143],v11,45568
s_waitcnt vmcnt(16)
mf a[116:119],a[156:159],v[100:103]
ds_read_b128 v[160:163], v21 offset:16384
mz a[112:115],a[156:159],v[96:99],0
ds_read_b128 v[176:179], v22 offset:16384
mf a[112:115],a[152:155],v[112:115]
ds_read_b128 v[164:167], v21 offset:18432
ds_read_b128 v[180:183], v22 offset:18432
ds_read_b128 v[168:171], v21 offset:20480
ds_read_b128 v[184:187], v22 offset:20480
ds_read_b128 v[172:175], v21 offset:22528
ds_read_b128 v[188:191], v22 offset:22528
mz a[96:99],a[148:151],v[112:115],0
s_add_u32 m0, s33, 0
mf a[96:99],a[144:147],v[96:99]
wl
mf v[32:35],a[128:131],v[128:131]
s_add_u32 s39, s86, 0
buffer_load_dwordx4 v13, s[8:11], s39 offen lds
mf v[32:35],a[132:135],v[144:147]
s_add_u32 m0, s33, 1024
tr a[144:145],v11,32776
mf v[32:35],a[136:139],v[160:163]
tr a[146:147],v11,33288
mf v[32:35],a[140:143],v[176:179]
s_add_u32 s39, s86, 65536
buffer_load_dwordx4 v13, s[8:11], s39 offen lds
mf v[36:39],a[140:143],v[180:183]
s_add_u32 m0, s33, 2048
tr a[148:149],v11,36872
mf v[36:39],a[136:139],v[164:167]
tr a[150:151],v11,37384
mf v[36:39],a[132:135],v[148:151]
s_add_u32 s39, s86, 131072
buffer_load_dwordx4 v13, s[8:11], s39 offen lds
mf v[36:39],a[128:131],v[132:135]
s_add_u32 m0, s33, 3072
tr a[152:153],v11,40968
mf v[40:43],a[128:131],v[136:139]
tr a[154:155],v11,41480
mf v[40:43],a[132:135],v[152:155]
s_add_u32 s39, s86, 196608
buffer_load_dwordx4 v13, s[8:11], s39 offen lds
mf v[40:43],a[136:139],v[168:171]
s_lshr_b32 s38, s69, 12
s_add_u32 m0, s50, 8192
tr a[156:157],v11,45064
mf v[40:43],a[140:143],v[184:187]
tr a[158:159],v11,45576
mf v[44:47],a[140:143],v[188:191]
s_add_u32 s39, s38, 0
buffer_load_dwordx4 v14, s[4:7], s39 offen lds
mf v[44:47],a[136:139],v[172:175]
s_add_u32 m0, s50, 9216
mf v[44:47],a[132:135],v[156:159]
mf v[44:47],a[128:131],v[140:143]
s_add_u32 s39, s38, 7168
buffer_load_dwordx4 v14, s[4:7], s39 offen lds
wl
mf v[60:63],a[144:147],v[140:143]
s_add_u32 m0, s50, 10240
tr a[128:129],v12,32768
mf v[60:63],a[148:151],v[156:159]
tr a[130:131],v12,33280
mf v[60:63],a[152:155],v[172:175]
s_add_u32 s39, s38, 14336
buffer_load_dwordx4 v14, s[4:7], s39 offen lds
mf v[60:63],a[156:159],v[188:191]
s_add_u32 m0, s50, 11264
tr a[132:133],v12,36864
mf v[56:59],a[156:159],v[184:187]
tr a[134:135],v12,37376
mf v[56:59],a[152:155],v[168:171]
s_add_u32 s39, s38, 21504
buffer_load_dwordx4 v14, s[4:7], s39 offen lds
mf v[56:59],a[148:151],v[152:155]
s_add_u32 m0, s50, 12288
tr a[136:137],v12,40960
mf v[56:59],a[144:147],v[136:139]
tr a[138:139],v12,41472
mf v[52:55],a[144:147],v[132:135]
s_add_u32 s39, s38, 28672
buffer_load_dwordx4 v14, s[4:7], s39 offen lds
mf v[52:55],a[148:151],v[148:151]
s_add_u32 m0, s50, 13312
tr a[140:141],v12,45056
mf v[52:55],a[152:155],v[164:167]
tr a[142:143],v12,45568
mf v[52:55],a[156:159],v[180:183]
s_add_u32 s39, s38, 35840
buffer_load_dwordx4 v14, s[4:7], s39 offen lds
mf v[48:51],a[156:159],v[176:179]
s_add_u32 m0, s50, 14336
mf v[48:51],a[152:155],v[160:163]
mf v[48:51],a[148:151],v[144:147]
s_add_u32 s39, s38, 43008
buffer_load_dwordx4 v14, s[4:7], s39 offen lds
mf v[48:51],a[144:147],v[128:131]
s_add_u32 m0, s50, 15360
wl
mf v[64:67],a[128:131],v[128:131]
tr a[144:145],v12,32776
mf v[64:67],a[132:135],v[144:147]
s_add_u32 s39, s38, 50176
buffer_load_dwordx4 v14, s[4:7], s39 offen lds
mf v[64:67],a[136:139],v[160:163]
s_add_u32 m0, s33, 16384
tr a[146:147],v12,33288
mf v[64:67],a[140:143],v[176:179]
tr a[148:149],v12,36872
mf v[68:71],a[140:143],v[180:183]
s_add_u32 s39, s86, 128
buffer_load_dwordx4 v13, s[8:11], s39 offen lds
mf v[68:71],a[136:139],v[164:167]
s_add_u32 m0, s33, 17408
tr a[150:151],v12,37384
mf v[68:71],a[132:135],v[148:151]
tr a[152:153],v12,40968
mf v[68:71],a[128:131],v[132:135]
s_add_u32 s39, s86, 65664
buffer_load_dwordx4 v13, s[8:11], s39 offen lds
mf v[72:75],a[128:131],v[136:139]
s_add_u32 m0, s33, 18432
tr a[154:155],v12,41480
mf v[72:75],a[132:135],v[152:155]
tr a[156:157],v12,45064
mf v[72:75],a[136:139],v[168:171]
s_add_u32 s39, s86, 131200
buffer_load_dwordx4 v13, s[8:11], s39 offen lds
mf v[72:75],a[140:143],v[184:187]
s_add_u32 m0, s33, 19456
tr a[158:159],v12,45576
mf v[76:79],a[140:143],v[188:191]
mf v[76:79],a[136:139],v[172:175]
s_add_u32 s39, s86, 196736
buffer_load_dwordx4 v13, s[8:11], s39 offen lds
mf v[76:79],a[132:135],v[156:159]
mf v[76:79],a[128:131],v[140:143]
s_add_u32 m0, s33, 32768
wl
mf v[92:95],a[144:147],v[140:143]
s_waitcnt vmcnt(24)
s_barrier
mf v[92:95],a[148:151],v[156:159]
s_add_u32 s39, s87, 0
buffer_load_dwordx4 v13, s[8:11], s39 offen lds
mf v[92:95],a[152:155],v[172:175]
s_add_u32 m0, s33, 33792
tr a[128:129],v11,49152
mf v[92:95],a[156:159],v[188:191]
tr a[130:131],v11,49664
mf v[88:91],a[156:159],v[184:187]
tr a[132:133],v11,53248
mf v[88:91],a[152:155],v[168:171]
tr a[134:135],v11,53760
mf v[88:91],a[148:151],v[152:155]
s_add_u32 s39, s87, 65536
buffer_load_dwordx4 v13, s[8:11], s39 offen lds
mf v[88:91],a[144:147],v[136:139]
s_add_u32 m0, s33, 34816
tr a[136:137],v11,57344
mf v[84:87],a[144:147],v[132:135]
tr a[138:139],v11,57856
mf v[84:87],a[148:151],v[148:151]
tr a[140:141],v11,61440
mf v[84:87],a[152:155],v[164:167]
tr a[142:143],v11,61952
mf v[84:87],a[156:159],v[180:183]
s_add_u32 s39, s87, 131072
buffer_load_dwordx4 v13, s[8:11], s39 offen lds
mf v[80:83],a[156:159],v[176:179]
s_add_u32 m0, s33, 35840
mf v[80:83],a[152:155],v[160:163]
mf v[80:83],a[148:151],v[144:147]
mf v[80:83],a[144:147],v[128:131]
wl
mf a[64:67],a[128:131],v[128:131]
s_add_u32 s39, s87, 196608
buffer_load_dwordx4 v13, s[8:11], s39 offen lds
mf a[64:67],a[132:135],v[144:147]
s_lshr_b32 s38, s70, 12
s_add_u32 m0, s50, 16384
tr a[144:145],v11,49160
mf a[64:67],a[136:139],v[160:163]
tr a[146:147],v11,49672
mf a[64:67],a[140:143],v[176:179]
tr a[148:149],v11,53256
mf a[68:71],a[140:143],v[180:183]
tr a[150:151],v11,53768
mf a[68:71],a[136:139],v[164:167]
tr a[152:153],v11,57352
mf a[68:71],a[132:135],v[148:151]
s_add_u32 s39, s38, 0
buffer_load_dwordx4 v14, s[4:7], s39 offen lds
mf a[68:71],a[128:131],v[132:135]
s_add_u32 m0, s50, 17408
tr a[154:155],v11,57864
mf a[72:75],a[128:131],v[136:139]
tr a[156:157],v11,61448
mf a[72:75],a[132:135],v[152:155]
tr a[158:159],v11,61960
s_waitcnt vmcnt(21)
mf a[72:75],a[136:139],v[168:171]
ds_read_b128 v[192:195], v21 offset:0
mf a[72:75],a[140:143],v[184:187]
s_add_u32 s39, s38, 7168
buffer_load_dwordx4 v14, s[4:7], s39 offen lds
mf a[76:79],a[140:143],v[188:191]
s_add_u32 m0, s50, 18432
ds_read_b128 v[208:211], v22 offset:0
mf a[76:79],a[136:139],v[172:175]
ds_read_b128 v[196:199], v21 offset:2048
ds_read_b128 v[212:215], v22 offset:2048
ds_read_b128 v[200:203], v21 offset:4096
ds_read_b128 v[216:219], v22 offset:4096
ds_read_b128 v[204:207], v21 offset:6144
ds_read_b128 v[220:223], v22 offset:6144
mf a[76:79],a[132:135],v[156:159]
mf a[76:79],a[128:131],v[140:143]
wl
mf a[92:95],a[144:147],v[140:143]
s_add_u32 s39, s38, 14336
buffer_load_dwordx4 v14, s[4:7], s39 offen lds
mf a[92:95],a[148:151],v[156:159]
s_add_u32 m0, s50, 19456
tr a[128:129],v12,49152
mf a[92:95],a[152:155],v[172:175]
tr a[130:131],v12,49664
mf a[92:95],a[156:159],v[188:191]
tr a[132:133],v12,53248
mf a[88:91],a[156:159],v[184:187]
tr a[134:135],v12,53760
mf a[88:91],a[152:155],v[168:171]
s_add_u32 s39, s38, 21504
buffer_load_dwordx4 v14, s[4:7], s39 offen lds
mf a[88:91],a[148:151],v[152:155]
s_add_u32 m0, s50, 20480
tr a[136:137],v12,57344
mf a[88:91],a[144:147],v[136:139]
tr a[138:139],v12,57856
mf a[84:87],a[144:147],v[132:135]
tr a[140:141],v12,61440
mf a[84:87],a[148:151],v[148:151]
tr a[142:143],v12,61952
mf a[84:87],a[152:155],v[164:167]
mf a[84:87],a[156:159],v[180:183]
s_add_u32 s39, s38, 28672
buffer_load_dwordx4 v14, s[4:7], s39 offen lds
mf a[80:83],a[156:159],v[176:179]
s_add_u32 m0, s50, 21504
mf a[80:83],a[152:155],v[160:163]
mf a[80:83],a[148:151],v[144:147]
mf a[80:83],a[144:147],v[128:131]
wl
mf a[96:99],a[128:131],v[128:131]
s_add_u32 s39, s38, 35840
buffer_load_dwordx4 v14, s[4:7], s39 offen lds
mf a[96:99],a[132:135],v[144:147]
s_add_u32 m0, s50, 22528
tr a[144:145],v12,49160
mf a[96:99],a[136:139],v[160:163]
tr a[146:147],v12,49672
mf a[96:99],a[140:143],v[176:179]
tr a[148:149],v12,53256
mf a[100:103],a[140:143],v[180:183]
tr a[150:151],v12,53768
mf a[100:103],a[136:139],v[164:167]
s_add_u32 s39, s38, 43008
buffer_load_dwordx4 v14, s[4:7], s39 offen lds
mf a[100:103],a[132:135],v[148:151]
s_add_u32 m0, s50, 23552
tr a[152:153],v12,57352
mf a[100:103],a[128:131],v[132:135]
tr a[154:155],v12,57864
mf a[104:107],a[128:131],v[136:139]
tr a[156:157],v12,61448
mf a[104:107],a[132:135],v[152:155]
tr a[158:159],v12,61960
s_waitcnt vmcnt(15)
mf a[104:107],a[136:139],v[168:171]
s_add_u32 s39, s38, 50176
buffer_load_dwordx4 v14, s[4:7], s39 offen lds
mf a[104:107],a[140:143],v[184:187]
ds_read_b128 v[224:227], v21 offset:8192
mf a[108:111],a[140:143],v[188:191]
ds_read_b128 v[240:243], v22 offset:8192
mf a[108:111],a[136:139],v[172:175]
ds_read_b128 v[228:231], v21 offset:10240
ds_read_b128 v[244:247], v22 offset:10240
ds_read_b128 v[232:235], v21 offset:12288
ds_read_b128 v[248:251], v22 offset:12288
ds_read_b128 v[236:239], v21 offset:14336
ds_read_b128 v[252:255], v22 offset:14336
mf a[108:111],a[132:135],v[156:159]
mf a[108:111],a[128:131],v[140:143]
s_add_u32 m0, s33, 49152
wl
mf a[124:127],a[144:147],v[140:143]
s_waitcnt vmcnt(24)
s_barrier
mf a[124:127],a[148:151],v[156:159]
s_add_u32 s39, s87, 128
buffer_load_dwordx4 v13, s[8:11], s39 offen lds
mf a[124:127],a[152:155],v[172:175]
s_add_u32 m0, s33, 50176
tr a[128:129],v11,0
mf a[124:127],a[156:159],v[188:191]
tr a[130:131],v11,512
mf a[120:123],a[156:159],v[184:187]
tr a[132:133],v11,4096
mf a[120:123],a[152:155],v[168:171]
tr a[134:135],v11,4608
mf a[120:123],a[148:151],v[152:155]
s_add_u32 s39, s87, 65664
buffer_load_dwordx4 v13, s[8:11], s39 offen lds
mf a[120:123],a[144:147],v[136:139]
s_add_u32 m0, s33, 51200
tr a[136:137],v11,8192
mf a[116:119],a[144:147],v[132:135]
tr a[138:139],v11,8704
mf a[116:119],a[148:151],v[148:151]
tr a[140:141],v11,12288
mf a[116:119],a[152:155],v[164:167]
tr a[142:143],v11,12800
mf a[116:119],a[156:159],v[180:183]
s_add_u32 s39, s87, 131200
buffer_load_dwordx4 v13, s[8:11], s39 offen lds
mf a[112:115],a[156:159],v[176:179]
s_add_u32 m0, s33, 52224
mf a[112:115],a[152:155],v[160:163]
mf a[112:115],a[148:151],v[144:147]
mf a[112:115],a[144:147],v[128:131]
wl
mf v[32:35],a[128:131],v[192:195]
s_add_u32 s39, s87, 196736
buffer_load_dwordx4 v13, s[8:11], s39 offen lds
mf v[32:35],a[132:135],v[208:211]
s_lshr_b32 s38, s71, 12
s_add_u32 m0, s50, 0
tr a[144:145],v11,8
mf v[32:35],a[136:139],v[224:227]
tr a[146:147],v11,520
mf v[32:35],a[140:143],v[240:243]
tr a[148:149],v11,4104
mf v[36:39],a[140:143],v[244:247]
tr a[150:151],v11,4616
mf v[36:39],a[136:139],v[228:231]
tr a[152:153],v11,8200
mf v[36:39],a[132:135],v[212:215]
s_add_u32 s39, s38, 0
buffer_load_dwordx4 v14, s[4:7], s39 offen lds
mf v[36:39],a[128:131],v[196:199]
s_add_u32 m0, s50, 1024
tr a[154:155],v11,8712
mf v[40:43],a[128:131],v[200:203]
tr a[156:157],v11,12296
mf v[40:43],a[132:135],v[216:219]
tr a[158:159],v11,12808
mf v[40:43],a[136:139],v[232:235]
mf v[40:43],a[140:143],v[248:251]
s_add_u32 s39, s38, 7168
buffer_load_dwordx4 v14, s[4:7], s39 offen lds
mf v[44:47],a[140:143],v[252:255]
s_add_u32 m0, s50, 2048
mf v[44:47],a[136:139],v[236:239]
mf v[44:47],a[132:135],v[220:223]
mf v[44:47],a[128:131],v[204:207]
wl
mf v[60:63],a[144:147],v[204:207]
s_add_u32 s39, s38, 14336
buffer_load_dwordx4 v14, s[4:7], s39 offen lds
mf v[60:63],a[148:151],v[220:223]
s_add_u32 m0, s50, 3072
tr a[128:129],v12,0
mf v[60:63],a[152:155],v[236:239]
tr a[130:131],v12,512
mf v[60:63],a[156:159],v[252:255]
tr a[132:133],v12,4096
mf v[56:59],a[156:159],v[248:251]
tr a[134:135],v12,4608
mf v[56:59],a[152:155],v[232:235]
s_add_u32 s39, s38, 21504
buffer_load_dwordx4 v14, s[4:7], s39 offen lds
mf v[56:59],a[148:151],v[216:219]
s_add_u32 m0, s50, 4096
tr a[136:137],v12,8192
mf v[56:59],a[144:147],v[200:203]
tr a[138:139],v12,8704
mf v[52:55],a[144:147],v[196:199]
tr a[140:141],v12,12288
mf v[52:55],a[148:151],v[212:215]
tr a[142:143],v12,12800
mf v[52:55],a[152:155],v[228:231]
mf v[52:55],a[156:159],v[244:247]
s_add_u32 s39, s38, 28672
buffer_load_dwordx4 v14, s[4:7], s39 offen lds
mf v[48:51],a[156:159],v[240:243]
s_add_u32 m0, s50, 5120
mf v[48:51],a[152:155],v[224:227]
mf v[48:51],a[148:151],v[208:211]
mf v[48:51],a[144:147],v[192:195]
wl
mf v[64:67],a[128:131],v[192:195]
s_add_u32 s39, s38, 35840
buffer_load_dwordx4 v14, s[4:7], s39 offen lds
mf v[64:67],a[132:135],v[208:211]
s_add_u32 m0, s50, 6144
tr a[144:145],v12,8
mf v[64:67],a[136:139],v[224:227]
tr a[146:147],v12,520
mf v[64:67],a[140:143],v[240:243]
tr a[148:149],v12,4104
mf v[68:71],a[140:143],v[244:247]
tr a[150:151],v12,4616
mf v[68:71],a[136:139],v[228:231]
s_add_u32 s39, s38, 43008
buffer_load_dwordx4 v14, s[4:7], s39 offen lds
mf v[68:71],a[132:135],v[212:215]
s_add_u32 m0, s50, 7168
tr a[152:153],v12,8200
mf v[68:71],a[128:131],v[196:199]
tr a[154:155],v12,8712
mf v[72:75],a[128:131],v[200:203]
tr a[156:157],v12,12296
mf v[72:75],a[132:135],v[216:219]
tr a[158:159],v12,12808
s_waitcnt vmcnt(11)
mf v[72:75],a[136:139],v[232:235]
s_add_u32 s39, s38, 50176
buffer_load_dwordx4 v14, s[4:7], s39 offen lds
mf v[72:75],a[140:143],v[248:251]
ds_read_b128 a[160:163], v21 offset:16384
mf v[76:79],a[140:143],v[252:255]
ds_read_b128 a[176:179], v22 offset:16384
mf v[76:79],a[136:139],v[236:239]
ds_read_b128 a[164:167], v21 offset:18432
ds_read_b128 a[180:183], v22 offset:18432
ds_read_b128 a[168:171], v21 offset:20480
ds_read_b128 a[184:187], v22 offset:20480
ds_read_b128 a[172:175], v21 offset:22528
ds_read_b128 a[188:191], v22 offset:22528
mf v[76:79],a[132:135],v[220:223]
mf v[76:79],a[128:131],v[204:207]
wl
mf v[92:95],a[144:147],v[204:207]
s_waitcnt vmcnt(24)
s_barrier
mf v[92:95],a[148:151],v[220:223]
tr a[128:129],v11,16384
mf v[92:95],a[152:155],v[236:239]
tr a[130:131],v11,16896
mf v[92:95],a[156:159],v[252:255]
tr a[132:133],v11,20480
mf v[88:91],a[156:159],v[248:251]
tr a[134:135],v11,20992
mf v[88:91],a[152:155],v[232:235]
tr a[136:137],v11,24576
mf v[88:91],a[148:151],v[216:219]
tr a[138:139],v11,25088
mf v[88:91],a[144:147],v[200:203]
tr a[140:141],v11,28672
mf v[84:87],a[144:147],v[196:199]
tr a[142:143],v11,29184
mf v[84:87],a[148:151],v[212:215]
mf v[84:87],a[152:155],v[228:231]
mf v[84:87],a[156:159],v[244:247]
mf v[80:83],a[156:159],v[240:243]
mf v[80:83],a[152:155],v[224:227]
mf v[80:83],a[148:151],v[208:211]
mf v[80:83],a[144:147],v[192:195]
wl
mf a[64:67],a[128:131],v[192:195]
tr a[144:145],v11,16392
mf a[64:67],a[132:135],v[208:211]
tr a[146:147],v11,16904
mf a[64:67],a[136:139],v[224:227]
tr a[148:149],v11,20488
mf a[64:67],a[140:143],v[240:243]
tr a[150:151],v11,21000
mf a[68:71],a[140:143],v[244:247]
tr a[152:153],v11,24584
mf a[68:71],a[136:139],v[228:231]
tr a[154:155],v11,25096
mf a[68:71],a[132:135],v[212:215]
tr a[156:157],v11,28680
mf a[68:71],a[128:131],v[196:199]
tr a[158:159],v11,29192
mf a[72:75],a[128:131],v[200:203]
mf a[72:75],a[132:135],v[216:219]
mf a[72:75],a[136:139],v[232:235]
mf a[72:75],a[140:143],v[248:251]
mf a[76:79],a[140:143],v[252:255]
mf a[76:79],a[136:139],v[236:239]
mf a[76:79],a[132:135],v[220:223]
mf a[76:79],a[128:131],v[204:207]
wl
mf a[92:95],a[144:147],v[204:207]
tr a[128:129],v12,16384
mf a[92:95],a[148:151],v[220:223]
tr a[130:131],v12,16896
mf a[92:95],a[152:155],v[236:239]
tr a[132:133],v12,20480
mf a[92:95],a[156:159],v[252:255]
tr a[134:135],v12,20992
mf a[88:91],a[156:159],v[248:251]
tr a[136:137],v12,24576
mf a[88:91],a[152:155],v[232:235]
tr a[138:139],v12,25088
mf a[88:91],a[148:151],v[216:219]
tr a[140:141],v12,28672
mf a[88:91],a[144:147],v[200:203]
tr a[142:143],v12,29184
mf a[84:87],a[144:147],v[196:199]
mf a[84:87],a[148:151],v[212:215]
mf a[84:87],a[152:155],v[228:231]
mf a[84:87],a[156:159],v[244:247]
mf a[80:83],a[156:159],v[240:243]
mf a[80:83],a[152:155],v[224:227]
mf a[80:83],a[148:151],v[208:211]
mf a[80:83],a[144:147],v[192:195]
wl
mf a[96:99],a[128:131],v[192:195]
tr a[144:145],v12,16392
mf a[96:99],a[132:135],v[208:211]
tr a[146:147],v12,16904
mf a[96:99],a[136:139],v[224:227]
tr a[148:149],v12,20488
mf a[96:99],a[140:143],v[240:243]
tr a[150:151],v12,21000
mf a[100:103],a[140:143],v[244:247]
tr a[152:153],v12,24584
mf a[100:103],a[136:139],v[228:231]
tr a[154:155],v12,25096
mf a[100:103],a[132:135],v[212:215]
tr a[156:157],v12,28680
mf a[100:103],a[128:131],v[196:199]
tr a[158:159],v12,29192
s_waitcnt vmcnt(0)
mf a[104:107],a[128:131],v[200:203]
ds_read_b128 a[192:195], v21 offset:0
mf a[104:107],a[132:135],v[216:219]
ds_read_b128 a[208:211], v22 offset:0
mf a[104:107],a[136:139],v[232:235]
ds_read_b128 a[196:199], v21 offset:2048
mf a[104:107],a[140:143],v[248:251]
ds_read_b128 a[212:215], v22 offset:2048
mf a[108:111],a[140:143],v[252:255]
ds_read_b128 a[200:203], v21 offset:4096
mf a[108:111],a[136:139],v[236:239]
ds_read_b128 a[216:219], v22 offset:4096
ds_read_b128 a[204:207], v21 offset:6144
ds_read_b128 a[220:223], v22 offset:6144
mf a[108:111],a[132:135],v[220:223]
mf a[108:111],a[128:131],v[204:207]
wl
mf a[124:127],a[144:147],v[204:207]
s_waitcnt vmcnt(20)
s_barrier
mf a[124:127],a[148:151],v[220:223]
tr a[128:129],v11,32768
mf a[124:127],a[152:155],v[236:239]
tr a[130:131],v11,33280
mf a[124:127],a[156:159],v[252:255]
tr a[132:133],v11,36864
mf a[120:123],a[156:159],v[248:251]
tr a[134:135],v11,37376
mf a[120:123],a[152:155],v[232:235]
tr a[136:137],v11,40960
mf a[120:123],a[148:151],v[216:219]
tr a[138:139],v11,41472
mf a[120:123],a[144:147],v[200:203]
tr a[140:141],v11,45056
mf a[116:119],a[144:147],v[196:199]
tr a[142:143],v11,45568
mf a[116:119],a[148:151],v[212:215]
mf a[116:119],a[152:155],v[228:231]
mf a[116:119],a[156:159],v[244:247]
mf a[112:115],a[156:159],v[240:243]
mf a[112:115],a[152:155],v[224:227]
mf a[112:115],a[148:151],v[208:211]
mf a[112:115],a[144:147],v[192:195]
wl
mf v[32:35],a[128:131],a[160:163]
tr a[144:145],v11,32776
mf v[32:35],a[132:135],a[176:179]
tr a[146:147],v11,33288
mf v[32:35],a[136:139],a[192:195]
tr a[148:149],v11,36872
mf v[32:35],a[140:143],a[208:211]
tr a[150:151],v11,37384
mf v[36:39],a[140:143],a[212:215]
tr a[152:153],v11,40968
mf v[36:39],a[136:139],a[196:199]
tr a[154:155],v11,41480
mf v[36:39],a[132:135],a[180:183]
tr a[156:157],v11,45064
mf v[36:39],a[128:131],a[164:167]
tr a[158:159],v11,45576
mf v[40:43],a[128:131],a[168:171]
mf v[40:43],a[132:135],a[184:187]
v_mul_f32 v32, s37, v32
v_mul_f32 v33, s37, v33
mf v[40:43],a[136:139],a[200:203]
v_mul_f32 v34, s37, v34
v_mul_f32 v35, s37, v35
mf v[40:43],a[140:143],a[216:219]
cv v32,v32,v33
cv v34,v34,v35
mf v[44:47],a[140:143],a[220:223]
aw a0,v32
aw a1,v34
mf v[44:47],a[136:139],a[204:207]
v_mul_f32 v36, s37, v36
v_mul_f32 v37, s37, v37
mf v[44:47],a[132:135],a[188:191]
v_mul_f32 v38, s37, v38
v_mul_f32 v39, s37, v39
mf v[44:47],a[128:131],a[172:175]
wl
cv v36,v36,v37
cv v38,v38,v39
mf v[60:63],a[144:147],a[172:175]
tr a[128:129],v12,32768
aw a4,v36
mf v[60:63],a[148:151],a[188:191]
tr a[130:131],v12,33280
aw a5,v38
mf v[60:63],a[152:155],a[204:207]
tr a[132:133],v12,36864
v_mul_f32 v40, s37, v40
mf v[60:63],a[156:159],a[220:223]
tr a[134:135],v12,37376
v_mul_f32 v41, s37, v41
mf v[56:59],a[156:159],a[216:219]
tr a[136:137],v12,40960
v_mul_f32 v42, s37, v42
mf v[56:59],a[152:155],a[200:203]
tr a[138:139],v12,41472
v_mul_f32 v43, s37, v43
mf v[56:59],a[148:151],a[184:187]
tr a[140:141],v12,45056
cv v40,v40,v41
mf v[56:59],a[144:147],a[168:171]
tr a[142:143],v12,45568
cv v42,v42,v43
mf v[52:55],a[144:147],a[164:167]
aw a8,v40
aw a9,v42
mf v[52:55],a[148:151],a[180:183]
v_mul_f32 v44, s37, v44
v_mul_f32 v45, s37, v45
mf v[52:55],a[152:155],a[196:199]
v_mul_f32 v46, s37, v46
v_mul_f32 v47, s37, v47
mf v[52:55],a[156:159],a[212:215]
cv v44,v44,v45
cv v46,v46,v47
mf v[48:51],a[156:159],a[208:211]
aw a12,v44
aw a13,v46
mf v[48:51],a[152:155],a[192:195]
v_mul_f32 v60, s37, v60
v_mul_f32 v61, s37, v61
mf v[48:51],a[148:151],a[176:179]
v_mul_f32 v62, s37, v62
v_mul_f32 v63, s37, v63
mf v[48:51],a[144:147],a[160:163]
wl
cv v60,v60,v61
cv v62,v62,v63
mf v[64:67],a[128:131],a[160:163]
tr a[144:145],v12,32776
aw a14,v60
mf v[64:67],a[132:135],a[176:179]
tr a[146:147],v12,33288
aw a15,v62
mf v[64:67],a[136:139],a[192:195]
tr a[148:149],v12,36872
v_mul_f32 v56, s37, v56
mf v[64:67],a[140:143],a[208:211]
tr a[150:151],v12,37384
v_mul_f32 v57, s37, v57
mf v[68:71],a[140:143],a[212:215]
tr a[152:153],v12,40968
v_mul_f32 v58, s37, v58
mf v[68:71],a[136:139],a[196:199]
tr a[154:155],v12,41480
v_mul_f32 v59, s37, v59
mf v[68:71],a[132:135],a[180:183]
tr a[156:157],v12,45064
cv v56,v56,v57
mf v[68:71],a[128:131],a[164:167]
tr a[158:159],v12,45576
cv v58,v58,v59
mf v[72:75],a[128:131],a[168:171]
aw a10,v56
aw a11,v58
mf v[72:75],a[132:135],a[184:187]
v_mul_f32 v52, s37, v52
v_mul_f32 v53, s37, v53
mf v[72:75],a[136:139],a[200:203]
v_mul_f32 v54, s37, v54
v_mul_f32 v55, s37, v55
mf v[72:75],a[140:143],a[216:219]
cv v52,v52,v53
cv v54,v54,v55
mf v[76:79],a[140:143],a[220:223]
aw a6,v52
aw a7,v54
mf v[76:79],a[136:139],a[204:207]
v_mul_f32 v48, s37, v48
v_mul_f32 v49, s37, v49
mf v[76:79],a[132:135],a[188:191]
v_mul_f32 v50, s37, v50
v_mul_f32 v51, s37, v51
mf v[76:79],a[128:131],a[172:175]
wl
cv v48,v48,v49
cv v50,v50,v51
mf v[92:95],a[144:147],a[172:175]
s_waitcnt vmcnt(8)
aw a2,v48
s_barrier
mf v[92:95],a[148:151],a[188:191]
tr a[128:129],v11,49152
aw a3,v50
mf v[92:95],a[152:155],a[204:207]
tr a[130:131],v11,49664
v_mul_f32 v64, s37, v64
mf v[92:95],a[156:159],a[220:223]
tr a[132:133],v11,53248
v_mul_f32 v65, s37, v65
mf v[88:91],a[156:159],a[216:219]
tr a[134:135],v11,53760
v_mul_f32 v66, s37, v66
mf v[88:91],a[152:155],a[200:203]
tr a[136:137],v11,57344
v_mul_f32 v67, s37, v67
mf v[88:91],a[148:151],a[184:187]
tr a[138:139],v11,57856
cv v64,v64,v65
mf v[88:91],a[144:147],a[168:171]
tr a[140:141],v11,61440
cv v66,v66,v67
mf v[84:87],a[144:147],a[164:167]
tr a[142:143],v11,61952
aw a16,v64
mf v[84:87],a[148:151],a[180:183]
aw a17,v66
v_mul_f32 v68, s37, v68
mf v[84:87],a[152:155],a[196:199]
v_mul_f32 v69, s37, v69
v_mul_f32 v70, s37, v70
mf v[84:87],a[156:159],a[212:215]
v_mul_f32 v71, s37, v71
cv v68,v68,v69
mf v[80:83],a[156:159],a[208:211]
cv v70,v70,v71
aw a20,v68
mf v[80:83],a[152:155],a[192:195]
aw a21,v70
v_mul_f32 v72, s37, v72
mf v[80:83],a[148:151],a[176:179]
v_mul_f32 v73, s37, v73
v_mul_f32 v74, s37, v74
mf v[80:83],a[144:147],a[160:163]
wl
v_mul_f32 v75, s37, v75
cv v72,v72,v73
mf a[64:67],a[128:131],a[160:163]
tr a[144:145],v11,49160
cv v74,v74,v75
mf a[64:67],a[132:135],a[176:179]
tr a[146:147],v11,49672
aw a24,v72
mf a[64:67],a[136:139],a[192:195]
tr a[148:149],v11,53256
aw a25,v74
mf a[64:67],a[140:143],a[208:211]
tr a[150:151],v11,53768
v_mul_f32 v76, s37, v76
mf a[68:71],a[140:143],a[212:215]
tr a[152:153],v11,57352
v_mul_f32 v77, s37, v77
mf a[68:71],a[136:139],a[196:199]
tr a[154:155],v11,57864
v_mul_f32 v78, s37, v78
mf a[68:71],a[132:135],a[180:183]
tr a[156:157],v11,61448
v_mul_f32 v79, s37, v79
mf a[68:71],a[128:131],a[164:167]
tr a[158:159],v11,61960
cv v76,v76,v77
mf a[72:75],a[128:131],a[168:171]
cv v78,v78,v79
aw a28,v76
mf a[72:75],a[132:135],a[184:187]
aw a29,v78
v_mul_f32 v92, s37, v92
mf a[72:75],a[136:139],a[200:203]
v_mul_f32 v93, s37, v93
v_mul_f32 v94, s37, v94
mf a[72:75],a[140:143],a[216:219]
v_mul_f32 v95, s37, v95
cv v92,v92,v93
mf a[76:79],a[140:143],a[220:223]
cv v94,v94,v95
aw a30,v92
mf a[76:79],a[136:139],a[204:207]
aw a31,v94
v_mul_f32 v88, s37, v88
mf a[76:79],a[132:135],a[188:191]
v_mul_f32 v89, s37, v89
v_mul_f32 v90, s37, v90
mf a[76:79],a[128:131],a[172:175]
wl
v_mul_f32 v91, s37, v91
cv v88,v88,v89
mf a[92:95],a[144:147],a[172:175]
tr a[128:129],v12,49152
cv v90,v90,v91
mf a[92:95],a[148:151],a[188:191]
tr a[130:131],v12,49664
aw a26,v88
mf a[92:95],a[152:155],a[204:207]
tr a[132:133],v12,53248
aw a27,v90
mf a[92:95],a[156:159],a[220:223]
tr a[134:135],v12,53760
v_mul_f32 v84, s37, v84
mf a[88:91],a[156:159],a[216:219]
tr a[136:137],v12,57344
v_mul_f32 v85, s37, v85
mf a[88:91],a[152:155],a[200:203]
tr a[138:139],v12,57856
v_mul_f32 v86, s37, v86
mf a[88:91],a[148:151],a[184:187]
tr a[140:141],v12,61440
v_mul_f32 v87, s37, v87
mf a[88:91],a[144:147],a[168:171]
tr a[142:143],v12,61952
cv v84,v84,v85
mf a[84:87],a[144:147],a[164:167]
cv v86,v86,v87
aw a22,v84
mf a[84:87],a[148:151],a[180:183]
aw a23,v86
v_mul_f32 v80, s37, v80
mf a[84:87],a[152:155],a[196:199]
v_mul_f32 v81, s37, v81
v_mul_f32 v82, s37, v82
mf a[84:87],a[156:159],a[212:215]
v_mul_f32 v83, s37, v83
cv v80,v80,v81
mf a[80:83],a[156:159],a[208:211]
cv v82,v82,v83
aw a18,v80
mf a[80:83],a[152:155],a[192:195]
aw a19,v82
ar v24,a64
mf a[80:83],a[148:151],a[176:179]
ar v25,a65
ar v26,a66
mf a[80:83],a[144:147],a[160:163]
wl
ar v27,a67
v_mul_f32 v24, s37, v24
mf a[96:99],a[128:131],a[160:163]
tr a[144:145],v12,49160
v_mul_f32 v25, s37, v25
mf a[96:99],a[132:135],a[176:179]
tr a[146:147],v12,49672
v_mul_f32 v26, s37, v26
mf a[96:99],a[136:139],a[192:195]
tr a[148:149],v12,53256
v_mul_f32 v27, s37, v27
mf a[96:99],a[140:143],a[208:211]
tr a[150:151],v12,53768
cv v24,v24,v25
mf a[100:103],a[140:143],a[212:215]
tr a[152:153],v12,57352
cv v26,v26,v27
mf a[100:103],a[136:139],a[196:199]
tr a[154:155],v12,57864
aw a32,v24
mf a[100:103],a[132:135],a[180:183]
tr a[156:157],v12,61448
aw a33,v26
mf a[100:103],a[128:131],a[164:167]
tr a[158:159],v12,61960
ar v28,a68
mf a[104:107],a[128:131],a[168:171]
ar v29,a69
ar v30,a70
mf a[104:107],a[132:135],a[184:187]
ar v31,a71
v_mul_f32 v28, s37, v28
mf a[104:107],a[136:139],a[200:203]
v_mul_f32 v29, s37, v29
v_mul_f32 v30, s37, v30
mf a[104:107],a[140:143],a[216:219]
v_mul_f32 v31, s37, v31
cv v28,v28,v29
mf a[108:111],a[140:143],a[220:223]
cv v30,v30,v31
aw a36,v28
mf a[108:111],a[136:139],a[204:207]
aw a37,v30
ar v24,a72
mf a[108:111],a[132:135],a[188:191]
ar v25,a73
ar v26,a74
mf a[108:111],a[128:131],a[172:175]
wl
ar v27,a75
v_mul_f32 v24, s37, v24
mf a[124:127],a[144:147],a[172:175]
s_barrier
v_mul_f32 v25, s37, v25
v_mul_f32 v26, s37, v26
mf a[124:127],a[148:151],a[188:191]
tr a[128:129],v11,0
v_mul_f32 v27, s37, v27
mf a[124:127],a[152:155],a[204:207]
tr a[130:131],v11,512
cv v24,v24,v25
mf a[124:127],a[156:159],a[220:223]
tr a[132:133],v11,4096
cv v26,v26,v27
mf a[120:123],a[156:159],a[216:219]
tr a[134:135],v11,4608
aw a40,v24
mf a[120:123],a[152:155],a[200:203]
tr a[136:137],v11,8192
aw a41,v26
mf a[120:123],a[148:151],a[184:187]
tr a[138:139],v11,8704
ar v28,a76
mf a[120:123],a[144:147],a[168:171]
tr a[140:141],v11,12288
ar v29,a77
mf a[116:119],a[144:147],a[164:167]
tr a[142:143],v11,12800
ar v30,a78
mf a[116:119],a[148:151],a[180:183]
ar v31,a79
v_mul_f32 v28, s37, v28
mf a[116:119],a[152:155],a[196:199]
v_mul_f32 v29, s37, v29
v_mul_f32 v30, s37, v30
mf a[116:119],a[156:159],a[212:215]
v_mul_f32 v31, s37, v31
cv v28,v28,v29
mf a[112:115],a[156:159],a[208:211]
cv v30,v30,v31
aw a44,v28
mf a[112:115],a[152:155],a[192:195]
aw a45,v30
ar v28,a92
mf a[112:115],a[148:151],a[176:179]
ar v29,a93
ar v30,a94
mf a[112:115],a[144:147],a[160:163]
wl
ar v31,a95
v_mul_f32 v28, s37, v28
mz v[32:35],a[128:131],v[96:99],0
tr a[144:145],v11,8
v_mul_f32 v29, s37, v29
mf v[32:35],a[132:135],v[112:115]
tr a[146:147],v11,520
v_mul_f32 v30, s37, v30
mf v[32:35],a[136:139],v[128:131]
tr a[148:149],v11,4104
v_mul_f32 v31, s37, v31
mf v[32:35],a[140:143],v[144:147]
tr a[150:151],v11,4616
cv v28,v28,v29
mz v[36:39],a[140:143],v[148:151],0
tr a[152:153],v11,8200
cv v30,v30,v31
mf v[36:39],a[136:139],v[132:135]
tr a[154:155],v11,8712
aw a46,v28
mf v[36:39],a[132:135],v[116:119]
tr a[156:157],v11,12296
aw a47,v30
mf v[36:39],a[128:131],v[100:103]
tr a[158:159],v11,12808
ar v24,a88
mz v[40:43],a[128:131],v[104:107],0
ar v25,a89
ar v26,a90
mf v[40:43],a[132:135],v[120:123]
ar v27,a91
v_mul_f32 v24, s37, v24
mf v[40:43],a[136:139],v[136:139]
v_mul_f32 v25, s37, v25
v_mul_f32 v26, s37, v26
mf v[40:43],a[140:143],v[152:155]
v_mul_f32 v27, s37, v27
cv v24,v24,v25
mz v[44:47],a[140:143],v[156:159],0
cv v26,v26,v27
aw a42,v24
mf v[44:47],a[136:139],v[140:143]
aw a43,v26
ar v28,a84
mf v[44:47],a[132:135],v[124:127]
ar v29,a85
ar v30,a86
mf v[44:47],a[128:131],v[108:111]
wl
ar v31,a87
v_mul_f32 v28, s37, v28
mz v[60:63],a[144:147],v[108:111],0
tr a[128:129],v12,0
v_mul_f32 v29, s37, v29
mf v[60:63],a[148:151],v[124:127]
tr a[130:131],v12,512
v_mul_f32 v30, s37, v30
mf v[60:63],a[152:155],v[140:143]
tr a[132:133],v12,4096
v_mul_f32 v31, s37, v31
mf v[60:63],a[156:159],v[156:159]
tr a[134:135],v12,4608
cv v28,v28,v29
mz v[56:59],a[156:159],v[152:155],0
tr a[136:137],v12,8192
cv v30,v30,v31
mf v[56:59],a[152:155],v[136:139]
tr a[138:139],v12,8704
aw a38,v28
mf v[56:59],a[148:151],v[120:123]
tr a[140:141],v12,12288
aw a39,v30
mf v[56:59],a[144:147],v[104:107]
tr a[142:143],v12,12800
ar v24,a80
mz v[52:55],a[144:147],v[100:103],0
ar v25,a81
ar v26,a82
mf v[52:55],a[148:151],v[116:119]
ar v27,a83
v_mul_f32 v24, s37, v24
mf v[52:55],a[152:155],v[132:135]
v_mul_f32 v25, s37, v25
v_mul_f32 v26, s37, v26
mf v[52:55],a[156:159],v[148:151]
v_mul_f32 v27, s37, v27
cv v24,v24,v25
mz v[48:51],a[156:159],v[144:147],0
cv v26,v26,v27
aw a34,v24
mf v[48:51],a[152:155],v[128:131]
aw a35,v26
ar v24,a96
mf v[48:51],a[148:151],v[112:115]
ar v25,a97
ar v26,a98
mf v[48:51],a[144:147],v[96:99]
wl
ar v27,a99
v_mul_f32 v24, s37, v24
mz v[64:67],a[128:131],v[96:99],0
tr a[144:145],v12,8
v_mul_f32 v25, s37, v25
mf v[64:67],a[132:135],v[112:115]
tr a[146:147],v12,520
v_mul_f32 v26, s37, v26
mf v[64:67],a[136:139],v[128:131]
tr a[148:149],v12,4104
v_mul_f32 v27, s37, v27
mf v[64:67],a[140:143],v[144:147]
tr a[150:151],v12,4616
cv v24,v24,v25
mz v[68:71],a[140:143],v[148:151],0
tr a[152:153],v12,8200
cv v26,v26,v27
mf v[68:71],a[136:139],v[132:135]
tr a[154:155],v12,8712
aw a48,v24
mf v[68:71],a[132:135],v[116:119]
tr a[156:157],v12,12296
aw a49,v26
mf v[68:71],a[128:131],v[100:103]
tr a[158:159],v12,12808
ar v28,a100
mz v[72:75],a[128:131],v[104:107],0
ar v29,a101
ar v30,a102
mf v[72:75],a[132:135],v[120:123]
ar v31,a103
v_mul_f32 v28, s37, v28
mf v[72:75],a[136:139],v[136:139]
v_mul_f32 v29, s37, v29
v_mul_f32 v30, s37, v30
mf v[72:75],a[140:143],v[152:155]
v_mul_f32 v31, s37, v31
cv v28,v28,v29
mz v[76:79],a[140:143],v[156:159],0
cv v30,v30,v31
aw a52,v28
mf v[76:79],a[136:139],v[140:143]
aw a53,v30
ar v24,a104
mf v[76:79],a[132:135],v[124:127]
ar v25,a105
ar v26,a106
mf v[76:79],a[128:131],v[108:111]
wl
ar v27,a107
v_mul_f32 v24, s37, v24
mz v[92:95],a[144:147],v[108:111],0
s_barrier
v_mul_f32 v25, s37, v25
v_mul_f32 v26, s37, v26
mf v[92:95],a[148:151],v[124:127]
tr a[128:129],v11,16384
v_mul_f32 v27, s37, v27
mf v[92:95],a[152:155],v[140:143]
tr a[130:131],v11,16896
cv v24,v24,v25
mf v[92:95],a[156:159],v[156:159]
tr a[132:133],v11,20480
cv v26,v26,v27
mz v[88:91],a[156:159],v[152:155],0
tr a[134:135],v11,20992
aw a56,v24
mf v[88:91],a[152:155],v[136:139]
tr a[136:137],v11,20488
aw a57,v26
mf v[88:91],a[148:151],v[120:123]
tr a[138:139],v11,21000
ar v28,a108
mf v[88:91],a[144:147],v[104:107]
tr a[140:141],v11,16392
ar v29,a109
mz v[84:87],a[144:147],v[100:103],0
tr a[142:143],v11,16904
ar v30,a110
mf v[84:87],a[148:151],v[116:119]
ar v31,a111
v_mul_f32 v28, s37, v28
mf v[84:87],a[152:155],v[132:135]
v_mul_f32 v29, s37, v29
v_mul_f32 v30, s37, v30
mf v[84:87],a[156:159],v[148:151]
v_mul_f32 v31, s37, v31
cv v28,v28,v29
mz v[80:83],a[156:159],v[144:147],0
cv v30,v30,v31
aw a60,v28
mf v[80:83],a[152:155],v[128:131]
aw a61,v30
ar v28,a124
mf v[80:83],a[148:151],v[112:115]
ar v29,a125
ar v30,a126
mf v[80:83],a[144:147],v[96:99]
wl
ar v31,a127
v_mul_f32 v28, s37, v28
mf v[32:35],a[128:131],v[160:163]
tr a[144:145],v12,16384
v_mul_f32 v29, s37, v29
mf v[32:35],a[132:135],v[176:179]
tr a[146:147],v12,16896
v_mul_f32 v30, s37, v30
mf v[48:51],a[136:139],v[176:179]
tr a[148:149],v12,20480
v_mul_f32 v31, s37, v31
mf v[48:51],a[140:143],v[160:163]
tr a[150:151],v12,20992
cv v28,v28,v29
mf v[52:55],a[140:143],v[164:167]
tr a[152:153],v12,20488
cv v30,v30,v31
mf v[52:55],a[136:139],v[180:183]
tr a[154:155],v12,21000
aw a62,v28
mf v[36:39],a[132:135],v[180:183]
tr a[156:157],v12,16392
aw a63,v30
mf v[36:39],a[128:131],v[164:167]
tr a[158:159],v12,16904
ar v24,a120
mf v[40:43],a[128:131],v[168:171]
ar v25,a121
ar v26,a122
mf v[40:43],a[132:135],v[184:187]
ar v27,a123
v_mul_f32 v24, s37, v24
mf v[56:59],a[136:139],v[184:187]
v_mul_f32 v25, s37, v25
v_mul_f32 v26, s37, v26
mf v[56:59],a[140:143],v[168:171]
v_mul_f32 v27, s37, v27
cv v24,v24,v25
mf v[60:63],a[140:143],v[172:175]
cv v26,v26,v27
aw a58,v24
mf v[60:63],a[136:139],v[188:191]
aw a59,v26
ar v28,a116
mf v[44:47],a[132:135],v[188:191]
ar v29,a117
ar v30,a118
mf v[44:47],a[128:131],v[172:175]
wl
ar v31,a119
v_mul_f32 v28, s37, v28
mf v[76:79],a[144:147],v[172:175]
s_barrier
v_mul_f32 v29, s37, v29
v_mul_f32 v30, s37, v30
mf v[76:79],a[148:151],v[188:191]
tr a[128:129],v11,32768
v_mul_f32 v31, s37, v31
mf v[92:95],a[152:155],v[188:191]
tr a[130:131],v11,33280
cv v28,v28,v29
mf v[92:95],a[156:159],v[172:175]
tr a[132:133],v11,36864
cv v30,v30,v31
mf v[88:91],a[156:159],v[168:171]
tr a[134:135],v11,37376
aw a54,v28
mf v[88:91],a[152:155],v[184:187]
tr a[136:137],v11,40960
aw a55,v30
mf v[72:75],a[148:151],v[184:187]
tr a[138:139],v11,41472
ar v24,a112
mf v[72:75],a[144:147],v[168:171]
tr a[140:141],v11,45056
ar v25,a113
mf v[68:71],a[144:147],v[164:167]
tr a[142:143],v11,45568
ar v26,a114
mf v[68:71],a[148:151],v[180:183]
ar v27,a115
v_mul_f32 v24, s37, v24
mf v[84:87],a[152:155],v[180:183]
v_mul_f32 v25, s37, v25
v_mul_f32 v26, s37, v26
mf v[84:87],a[156:159],v[164:167]
v_mul_f32 v27, s37, v27
cv v24,v24,v25
mf v[80:83],a[156:159],v[160:163]
cv v26,v26,v27
aw a50,v24
mf v[80:83],a[152:155],v[176:179]
aw a51,v26
mf v[64:67],a[148:151],v[176:179]
mf v[64:67],a[144:147],v[160:163]
wl
mf v[32:35],a[128:131],v[192:195]
tr a[144:145],v11,32776
mf v[32:35],a[132:135],v[208:211]
tr a[146:147],v11,33288
mf v[32:35],a[136:139],v[224:227]
tr a[148:149],v11,36872
mf v[32:35],a[140:143],v[240:243]
tr a[150:151],v11,37384
mf v[36:39],a[140:143],v[244:247]
tr a[152:153],v11,40968
mf v[36:39],a[136:139],v[228:231]
tr a[154:155],v11,41480
mf v[36:39],a[132:135],v[212:215]
tr a[156:157],v11,45064
mf v[36:39],a[128:131],v[196:199]
tr a[158:159],v11,45576
mf v[40:43],a[128:131],v[200:203]
mf v[40:43],a[132:135],v[216:219]
mf v[40:43],a[136:139],v[232:235]
mf v[40:43],a[140:143],v[248:251]
mf v[44:47],a[140:143],v[252:255]
mf v[44:47],a[136:139],v[236:239]
mf v[44:47],a[132:135],v[220:223]
mf v[44:47],a[128:131],v[204:207]
wl
mf v[60:63],a[144:147],v[204:207]
tr a[128:129],v12,32768
mf v[60:63],a[148:151],v[220:223]
tr a[130:131],v12,33280
mf v[60:63],a[152:155],v[236:239]
tr a[132:133],v12,36864
mf v[60:63],a[156:159],v[252:255]
tr a[134:135],v12,37376
mf v[56:59],a[156:159],v[248:251]
tr a[136:137],v12,40960
mf v[56:59],a[152:155],v[232:235]
tr a[138:139],v12,41472
mf v[56:59],a[148:151],v[216:219]
tr a[140:141],v12,45056
mf v[56:59],a[144:147],v[200:203]
tr a[142:143],v12,45568
mf v[52:55],a[144:147],v[196:199]
mf v[52:55],a[148:151],v[212:215]
mf v[52:55],a[152:155],v[228:231]
mf v[52:55],a[156:159],v[244:247]
mf v[48:51],a[156:159],v[240:243]
mf v[48:51],a[152:155],v[224:227]
mf v[48:51],a[148:151],v[208:211]
mf v[48:51],a[144:147],v[192:195]
wl
mf v[64:67],a[128:131],v[192:195]
tr a[144:145],v12,32776
mf v[64:67],a[132:135],v[208:211]
tr a[146:147],v12,33288
mf v[64:67],a[136:139],v[224:227]
tr a[148:149],v12,36872
mf v[64:67],a[140:143],v[240:243]
tr a[150:151],v12,37384
mf v[68:71],a[140:143],v[244:247]
tr a[152:153],v12,40968
mf v[68:71],a[136:139],v[228:231]
tr a[154:155],v12,41480
mf v[68:71],a[132:135],v[212:215]
tr a[156:157],v12,45064
mf v[68:71],a[128:131],v[196:199]
tr a[158:159],v12,45576
mf v[72:75],a[128:131],v[200:203]
mf v[72:75],a[132:135],v[216:219]
mf v[72:75],a[136:139],v[232:235]
mf v[72:75],a[140:143],v[248:251]
mf v[76:79],a[140:143],v[252:255]
mf v[76:79],a[136:139],v[236:239]
mf v[76:79],a[132:135],v[220:223]
mf v[76:79],a[128:131],v[204:207]
wl
mf v[92:95],a[144:147],v[204:207]
s_barrier
mf v[92:95],a[148:151],v[220:223]
tr a[128:129],v11,49152
mf v[92:95],a[152:155],v[236:239]
tr a[130:131],v11,49664
mf v[92:95],a[156:159],v[252:255]
tr a[132:133],v11,53248
mf v[88:91],a[156:159],v[248:251]
tr a[134:135],v11,53760
mf v[88:91],a[152:155],v[232:235]
tr a[136:137],v11,57344
mf v[88:91],a[148:151],v[216:219]
tr a[138:139],v11,57856
mf v[88:91],a[144:147],v[200:203]
tr a[140:141],v11,61440
mf v[84:87],a[144:147],v[196:199]
tr a[142:143],v11,61952
mf v[84:87],a[148:151],v[212:215]
mf v[84:87],a[152:155],v[228:231]
mf v[84:87],a[156:159],v[244:247]
mf v[80:83],a[156:159],v[240:243]
mf v[80:83],a[152:155],v[224:227]
mf v[80:83],a[148:151],v[208:211]
mf v[80:83],a[144:147],v[192:195]
wl
mf v[32:35],a[128:131],a[160:163]
tr a[144:145],v11,49160
mf v[32:35],a[132:135],a[176:179]
tr a[146:147],v11,49672
mf v[32:35],a[136:139],a[192:195]
tr a[148:149],v11,53256
mf v[32:35],a[140:143],a[208:211]
tr a[150:151],v11,53768
mf v[36:39],a[140:143],a[212:215]
tr a[152:153],v11,57352
mf v[36:39],a[136:139],a[196:199]
tr a[154:155],v11,57864
mf v[36:39],a[132:135],a[180:183]
tr a[156:157],v11,61448
mf v[36:39],a[128:131],a[164:167]
tr a[158:159],v11,61960
mf v[40:43],a[128:131],a[168:171]
mf v[40:43],a[132:135],a[184:187]
v_mul_f32 v32, s37, v32
v_mul_f32 v33, s37, v33
mf v[40:43],a[136:139],a[200:203]
v_mul_f32 v34, s37, v34
v_mul_f32 v35, s37, v35
mf v[40:43],a[140:143],a[216:219]
cv v32,v32,v33
cv v34,v34,v35
mf v[44:47],a[140:143],a[220:223]
aw a64,v32
aw a65,v34
mf v[44:47],a[136:139],a[204:207]
v_mul_f32 v36, s37, v36
v_mul_f32 v37, s37, v37
mf v[44:47],a[132:135],a[188:191]
v_mul_f32 v38, s37, v38
v_mul_f32 v39, s37, v39
mf v[44:47],a[128:131],a[172:175]
wl
cv v36,v36,v37
cv v38,v38,v39
mf v[60:63],a[144:147],a[172:175]
tr a[128:129],v12,49152
aw a68,v36
mf v[60:63],a[148:151],a[188:191]
tr a[130:131],v12,49664
aw a69,v38
mf v[60:63],a[152:155],a[204:207]
tr a[132:133],v12,53248
v_mul_f32 v40, s37, v40
mf v[60:63],a[156:159],a[220:223]
tr a[134:135],v12,53760
v_mul_f32 v41, s37, v41
mf v[56:59],a[156:159],a[216:219]
tr a[136:137],v12,57344
v_mul_f32 v42, s37, v42
mf v[56:59],a[152:155],a[200:203]
tr a[138:139],v12,57856
v_mul_f32 v43, s37, v43
mf v[56:59],a[148:151],a[184:187]
tr a[140:141],v12,61440
cv v40,v40,v41
mf v[56:59],a[144:147],a[168:171]
tr a[142:143],v12,61952
cv v42,v42,v43
mf v[52:55],a[144:147],a[164:167]
aw a72,v40
aw a73,v42
mf v[52:55],a[148:151],a[180:183]
v_mul_f32 v44, s37, v44
v_mul_f32 v45, s37, v45
mf v[52:55],a[152:155],a[196:199]
v_mul_f32 v46, s37, v46
v_mul_f32 v47, s37, v47
mf v[52:55],a[156:159],a[212:215]
cv v44,v44,v45
cv v46,v46,v47
mf v[48:51],a[156:159],a[208:211]
aw a76,v44
aw a77,v46
mf v[48:51],a[152:155],a[192:195]
v_mul_f32 v60, s37, v60
v_mul_f32 v61, s37, v61
mf v[48:51],a[148:151],a[176:179]
v_mul_f32 v62, s37, v62
v_mul_f32 v63, s37, v63
mf v[48:51],a[144:147],a[160:163]
wl
cv v60,v60,v61
cv v62,v62,v63
mf v[64:67],a[128:131],a[160:163]
tr a[144:145],v12,49160
aw a78,v60
mf v[64:67],a[132:135],a[176:179]
tr a[146:147],v12,49672
aw a79,v62
mf v[64:67],a[136:139],a[192:195]
tr a[148:149],v12,53256
v_mul_f32 v56, s37, v56
mf v[64:67],a[140:143],a[208:211]
tr a[150:151],v12,53768
v_mul_f32 v57, s37, v57
mf v[68:71],a[140:143],a[212:215]
tr a[152:153],v12,57352
v_mul_f32 v58, s37, v58
mf v[68:71],a[136:139],a[196:199]
tr a[154:155],v12,57864
v_mul_f32 v59, s37, v59
mf v[68:71],a[132:135],a[180:183]
tr a[156:157],v12,61448
cv v56,v56,v57
mf v[68:71],a[128:131],a[164:167]
tr a[158:159],v12,61960
cv v58,v58,v59
mf v[72:75],a[128:131],a[168:171]
aw a74,v56
aw a75,v58
mf v[72:75],a[132:135],a[184:187]
v_mul_f32 v52, s37, v52
v_mul_f32 v53, s37, v53
mf v[72:75],a[136:139],a[200:203]
v_mul_f32 v54, s37, v54
v_mul_f32 v55, s37, v55
mf v[72:75],a[140:143],a[216:219]
cv v52,v52,v53
cv v54,v54,v55
mf v[76:79],a[140:143],a[220:223]
aw a70,v52
aw a71,v54
mf v[76:79],a[136:139],a[204:207]
v_mul_f32 v48, s37, v48
v_mul_f32 v49, s37, v49
mf v[76:79],a[132:135],a[188:191]
v_mul_f32 v50, s37, v50
v_mul_f32 v51, s37, v51
mf v[76:79],a[128:131],a[172:175]
wl
cv v48,v48,v49
cv v50,v50,v51
mf v[92:95],a[144:147],a[172:175]
s_barrier
aw a66,v48
aw a67,v50
mf v[92:95],a[148:151],a[188:191]
tr a[128:129],v11,0
v_mul_f32 v64, s37, v64
mf v[92:95],a[152:155],a[204:207]
tr a[130:131],v11,512
v_mul_f32 v65, s37, v65
mf v[92:95],a[156:159],a[220:223]
tr a[132:133],v11,4096
v_mul_f32 v66, s37, v66
mf v[88:91],a[156:159],a[216:219]
tr a[134:135],v11,4608
v_mul_f32 v67, s37, v67
mf v[88:91],a[152:155],a[200:203]
tr a[136:137],v11,8192
cv v64,v64,v65
mf v[88:91],a[148:151],a[184:187]
tr a[138:139],v11,8704
cv v66,v66,v67
mf v[88:91],a[144:147],a[168:171]
tr a[140:141],v11,12288
aw a80,v64
mf v[84:87],a[144:147],a[164:167]
tr a[142:143],v11,12800
aw a81,v66
mf v[84:87],a[148:151],a[180:183]
v_mul_f32 v68, s37, v68
v_mul_f32 v69, s37, v69
mf v[84:87],a[152:155],a[196:199]
v_mul_f32 v70, s37, v70
v_mul_f32 v71, s37, v71
mf v[84:87],a[156:159],a[212:215]
cv v68,v68,v69
cv v70,v70,v71
mf v[80:83],a[156:159],a[208:211]
aw a84,v68
aw a85,v70
mf v[80:83],a[152:155],a[192:195]
v_mul_f32 v72, s37, v72
v_mul_f32 v73, s37, v73
mf v[80:83],a[148:151],a[176:179]
v_mul_f32 v74, s37, v74
v_mul_f32 v75, s37, v75
mf v[80:83],a[144:147],a[160:163]
wl
cv v72,v72,v73
cv v74,v74,v75
mz v[32:35],a[128:131],v[96:99],0
tr a[144:145],v11,8
aw a88,v72
mf v[32:35],a[132:135],v[112:115]
tr a[146:147],v11,520
aw a89,v74
mf v[32:35],a[136:139],v[128:131]
tr a[148:149],v11,4104
v_mul_f32 v76, s37, v76
mf v[32:35],a[140:143],v[144:147]
tr a[150:151],v11,4616
v_mul_f32 v77, s37, v77
mz v[36:39],a[140:143],v[148:151],0
tr a[152:153],v11,8200
v_mul_f32 v78, s37, v78
mf v[36:39],a[136:139],v[132:135]
tr a[154:155],v11,8712
v_mul_f32 v79, s37, v79
mf v[36:39],a[132:135],v[116:119]
tr a[156:157],v11,12296
cv v76,v76,v77
mf v[36:39],a[128:131],v[100:103]
tr a[158:159],v11,12808
cv v78,v78,v79
mz v[40:43],a[128:131],v[104:107],0
aw a92,v76
aw a93,v78
mf v[40:43],a[132:135],v[120:123]
v_mul_f32 v92, s37, v92
v_mul_f32 v93, s37, v93
mf v[40:43],a[136:139],v[136:139]
v_mul_f32 v94, s37, v94
v_mul_f32 v95, s37, v95
mf v[40:43],a[140:143],v[152:155]
cv v92,v92,v93
cv v94,v94,v95
mz v[44:47],a[140:143],v[156:159],0
aw a94,v92
aw a95,v94
mf v[44:47],a[136:139],v[140:143]
v_mul_f32 v88, s37, v88
v_mul_f32 v89, s37, v89
mf v[44:47],a[132:135],v[124:127]
v_mul_f32 v90, s37, v90
v_mul_f32 v91, s37, v91
mf v[44:47],a[128:131],v[108:111]
wl
cv v88,v88,v89
cv v90,v90,v91
mz v[60:63],a[144:147],v[108:111],0
tr a[128:129],v12,0
aw a90,v88
mf v[60:63],a[148:151],v[124:127]
tr a[130:131],v12,512
aw a91,v90
mf v[60:63],a[152:155],v[140:143]
tr a[132:133],v12,4096
v_mul_f32 v84, s37, v84
mf v[60:63],a[156:159],v[156:159]
tr a[134:135],v12,4608
v_mul_f32 v85, s37, v85
mz v[56:59],a[156:159],v[152:155],0
tr a[136:137],v12,8192
v_mul_f32 v86, s37, v86
mf v[56:59],a[152:155],v[136:139]
tr a[138:139],v12,8704
v_mul_f32 v87, s37, v87
mf v[56:59],a[148:151],v[120:123]
tr a[140:141],v12,12288
cv v84,v84,v85
mf v[56:59],a[144:147],v[104:107]
tr a[142:143],v12,12800
cv v86,v86,v87
mz v[52:55],a[144:147],v[100:103],0
aw a86,v84
aw a87,v86
mf v[52:55],a[148:151],v[116:119]
v_mul_f32 v80, s37, v80
v_mul_f32 v81, s37, v81
mf v[52:55],a[152:155],v[132:135]
v_mul_f32 v82, s37, v82
v_mul_f32 v83, s37, v83
mf v[52:55],a[156:159],v[148:151]
cv v80,v80,v81
cv v82,v82,v83
mz v[48:51],a[156:159],v[144:147],0
aw a82,v80
aw a83,v82
mf v[48:51],a[152:155],v[128:131]
mf v[48:51],a[148:151],v[112:115]
mf v[48:51],a[144:147],v[96:99]
wl
mz v[64:67],a[128:131],v[96:99],0
tr a[144:145],v12,8
mf v[64:67],a[132:135],v[112:115]
tr a[146:147],v12,520
mf v[64:67],a[136:139],v[128:131]
tr a[148:149],v12,4104
mf v[64:67],a[140:143],v[144:147]
tr a[150:151],v12,4616
mz v[68:71],a[140:143],v[148:151],0
tr a[152:153],v12,8200
mf v[68:71],a[136:139],v[132:135]
tr a[154:155],v12,8712
mf v[68:71],a[132:135],v[116:119]
tr a[156:157],v12,12296
mf v[68:71],a[128:131],v[100:103]
tr a[158:159],v12,12808
mz v[72:75],a[128:131],v[104:107],0
mf v[72:75],a[132:135],v[120:123]
mf v[72:75],a[136:139],v[136:139]
mf v[72:75],a[140:143],v[152:155]
mz v[76:79],a[140:143],v[156:159],0
mf v[76:79],a[136:139],v[140:143]
mf v[76:79],a[132:135],v[124:127]
mf v[76:79],a[128:131],v[108:111]
wl
mz v[92:95],a[144:147],v[108:111],0
s_barrier
mf v[92:95],a[148:151],v[124:127]
tr a[128:129],v11,16384
mf v[92:95],a[152:155],v[140:143]
tr a[130:131],v11,16896
mf v[92:95],a[156:159],v[156:159]
tr a[132:133],v11,20480
mz v[88:91],a[156:159],v[152:155],0
tr a[134:135],v11,20992
mf v[88:91],a[152:155],v[136:139]
tr a[136:137],v11,20488
mf v[88:91],a[148:151],v[120:123]
tr a[138:139],v11,21000
mf v[88:91],a[144:147],v[104:107]
tr a[140:141],v11,16392
mz v[84:87],a[144:147],v[100:103],0
tr a[142:143],v11,16904
mf v[84:87],a[148:151],v[116:119]
mf v[84:87],a[152:155],v[132:135]
mf v[84:87],a[156:159],v[148:151]
mz v[80:83],a[156:159],v[144:147],0
mf v[80:83],a[152:155],v[128:131]
mf v[80:83],a[148:151],v[112:115]
mf v[80:83],a[144:147],v[96:99]
wl
mf v[32:35],a[128:131],v[160:163]
tr a[144:145],v12,16384
mf v[32:35],a[132:135],v[176:179]
tr a[146:147],v12,16896
mf v[48:51],a[136:139],v[176:179]
tr a[148:149],v12,20480
mf v[48:51],a[140:143],v[160:163]
tr a[150:151],v12,20992
mf v[52:55],a[140:143],v[164:167]
tr a[152:153],v12,20488
mf v[52:55],a[136:139],v[180:183]
tr a[154:155],v12,21000
mf v[36:39],a[132:135],v[180:183]
tr a[156:157],v12,16392
mf v[36:39],a[128:131],v[164:167]
tr a[158:159],v12,16904
mf v[40:43],a[128:131],v[168:171]
mf v[40:43],a[132:135],v[184:187]
mf v[56:59],a[136:139],v[184:187]
mf v[56:59],a[140:143],v[168:171]
mf v[60:63],a[140:143],v[172:175]
mf v[60:63],a[136:139],v[188:191]
mf v[44:47],a[132:135],v[188:191]
mf v[44:47],a[128:131],v[172:175]
wl
mf v[76:79],a[144:147],v[172:175]
s_barrier
mf v[76:79],a[148:151],v[188:191]
tr a[128:129],v11,32768
mf v[92:95],a[152:155],v[188:191]
tr a[130:131],v11,33280
mf v[92:95],a[156:159],v[172:175]
tr a[132:133],v11,36864
mf v[88:91],a[156:159],v[168:171]
tr a[134:135],v11,37376
mf v[88:91],a[152:155],v[184:187]
tr a[136:137],v11,40960
mf v[72:75],a[148:151],v[184:187]
tr a[138:139],v11,41472
mf v[72:75],a[144:147],v[168:171]
tr a[140:141],v11,45056
mf v[68:71],a[144:147],v[164:167]
tr a[142:143],v11,45568
mf v[68:71],a[148:151],v[180:183]
mf v[84:87],a[152:155],v[180:183]
mf v[84:87],a[156:159],v[164:167]
mf v[80:83],a[156:159],v[160:163]
mf v[80:83],a[152:155],v[176:179]
mf v[64:67],a[148:151],v[176:179]
mf v[64:67],a[144:147],v[160:163]
wl
mf v[32:35],a[128:131],v[192:195]
tr a[144:145],v11,32776
mf v[32:35],a[132:135],v[208:211]
tr a[146:147],v11,33288
mf v[32:35],a[136:139],v[224:227]
tr a[148:149],v11,36872
mf v[32:35],a[140:143],v[240:243]
tr a[150:151],v11,37384
mf v[36:39],a[140:143],v[244:247]
tr a[152:153],v11,40968
mf v[36:39],a[136:139],v[228:231]
tr a[154:155],v11,41480
mf v[36:39],a[132:135],v[212:215]
tr a[156:157],v11,45064
mf v[36:39],a[128:131],v[196:199]
tr a[158:159],v11,45576
mf v[40:43],a[128:131],v[200:203]
mf v[40:43],a[132:135],v[216:219]
mf v[40:43],a[136:139],v[232:235]
mf v[40:43],a[140:143],v[248:251]
mf v[44:47],a[140:143],v[252:255]
mf v[44:47],a[136:139],v[236:239]
mf v[44:47],a[132:135],v[220:223]
mf v[44:47],a[128:131],v[204:207]
wl
mf v[60:63],a[144:147],v[204:207]
tr a[128:129],v12,32768
mf v[60:63],a[148:151],v[220:223]
tr a[130:131],v12,33280
mf v[60:63],a[152:155],v[236:239]
tr a[132:133],v12,36864
mf v[60:63],a[156:159],v[252:255]
tr a[134:135],v12,37376
mf v[56:59],a[156:159],v[248:251]
tr a[136:137],v12,40960
mf v[56:59],a[152:155],v[232:235]
tr a[138:139],v12,41472
mf v[56:59],a[148:151],v[216:219]
tr a[140:141],v12,45056
mf v[56:59],a[144:147],v[200:203]
tr a[142:143],v12,45568
mf v[52:55],a[144:147],v[196:199]
mf v[52:55],a[148:151],v[212:215]
mf v[52:55],a[152:155],v[228:231]
mf v[52:55],a[156:159],v[244:247]
mf v[48:51],a[156:159],v[240:243]
mf v[48:51],a[152:155],v[224:227]
mf v[48:51],a[148:151],v[208:211]
mf v[48:51],a[144:147],v[192:195]
wl
mf v[64:67],a[128:131],v[192:195]
tr a[144:145],v12,32776
mf v[64:67],a[132:135],v[208:211]
tr a[146:147],v12,33288
mf v[64:67],a[136:139],v[224:227]
tr a[148:149],v12,36872
mf v[64:67],a[140:143],v[240:243]
tr a[150:151],v12,37384
mf v[68:71],a[140:143],v[244:247]
tr a[152:153],v12,40968
mf v[68:71],a[136:139],v[228:231]
tr a[154:155],v12,41480
mf v[68:71],a[132:135],v[212:215]
tr a[156:157],v12,45064
mf v[68:71],a[128:131],v[196:199]
tr a[158:159],v12,45576
mf v[72:75],a[128:131],v[200:203]
mf v[72:75],a[132:135],v[216:219]
mf v[72:75],a[136:139],v[232:235]
mf v[72:75],a[140:143],v[248:251]
mf v[76:79],a[140:143],v[252:255]
mf v[76:79],a[136:139],v[236:239]
mf v[76:79],a[132:135],v[220:223]
mf v[76:79],a[128:131],v[204:207]
wl
mf v[92:95],a[144:147],v[204:207]
s_barrier
mf v[92:95],a[148:151],v[220:223]
tr a[128:129],v11,49152
mf v[92:95],a[152:155],v[236:239]
tr a[130:131],v11,49664
mf v[92:95],a[156:159],v[252:255]
tr a[132:133],v11,53248
mf v[88:91],a[156:159],v[248:251]
tr a[134:135],v11,53760
mf v[88:91],a[152:155],v[232:235]
tr a[136:137],v11,57344
mf v[88:91],a[148:151],v[216:219]
tr a[138:139],v11,57856
mf v[88:91],a[144:147],v[200:203]
tr a[140:141],v11,61440
mf v[84:87],a[144:147],v[196:199]
tr a[142:143],v11,61952
mf v[84:87],a[148:151],v[212:215]
mf v[84:87],a[152:155],v[228:231]
mf v[84:87],a[156:159],v[244:247]
mf v[80:83],a[156:159],v[240:243]
mf v[80:83],a[152:155],v[224:227]
mf v[80:83],a[148:151],v[208:211]
mf v[80:83],a[144:147],v[192:195]
wl
mf v[32:35],a[128:131],a[160:163]
tr a[144:145],v11,49160
mf v[32:35],a[132:135],a[176:179]
tr a[146:147],v11,49672
mf v[32:35],a[136:139],a[192:195]
tr a[148:149],v11,53256
mf v[32:35],a[140:143],a[208:211]
tr a[150:151],v11,53768
mf v[36:39],a[140:143],a[212:215]
tr a[152:153],v11,57352
mf v[36:39],a[136:139],a[196:199]
tr a[154:155],v11,57864
mf v[36:39],a[132:135],a[180:183]
tr a[156:157],v11,61448
mf v[36:39],a[128:131],a[164:167]
tr a[158:159],v11,61960
mf v[40:43],a[128:131],a[168:171]
mf v[40:43],a[132:135],a[184:187]
v_mul_f32 v32, s37, v32
v_mul_f32 v33, s37, v33
mf v[40:43],a[136:139],a[200:203]
v_mul_f32 v34, s37, v34
v_mul_f32 v35, s37, v35
mf v[40:43],a[140:143],a[216:219]
cv v32,v32,v33
cv v34,v34,v35
mf v[44:47],a[140:143],a[220:223]
aw a96,v32
aw a97,v34
mf v[44:47],a[136:139],a[204:207]
v_mul_f32 v36, s37, v36
v_mul_f32 v37, s37, v37
mf v[44:47],a[132:135],a[188:191]
v_mul_f32 v38, s37, v38
v_mul_f32 v39, s37, v39
mf v[44:47],a[128:131],a[172:175]
wl
cv v36,v36,v37
cv v38,v38,v39
mf v[60:63],a[144:147],a[172:175]
tr a[128:129],v12,49152
aw a100,v36
mf v[60:63],a[148:151],a[188:191]
tr a[130:131],v12,49664
aw a101,v38
mf v[60:63],a[152:155],a[204:207]
tr a[132:133],v12,53248
v_mul_f32 v40, s37, v40
mf v[60:63],a[156:159],a[220:223]
tr a[134:135],v12,53760
v_mul_f32 v41, s37, v41
mf v[56:59],a[156:159],a[216:219]
tr a[136:137],v12,57344
v_mul_f32 v42, s37, v42
mf v[56:59],a[152:155],a[200:203]
tr a[138:139],v12,57856
v_mul_f32 v43, s37, v43
mf v[56:59],a[148:151],a[184:187]
tr a[140:141],v12,61440
cv v40,v40,v41
mf v[56:59],a[144:147],a[168:171]
tr a[142:143],v12,61952
cv v42,v42,v43
mf v[52:55],a[144:147],a[164:167]
aw a104,v40
aw a105,v42
mf v[52:55],a[148:151],a[180:183]
v_mul_f32 v44, s37, v44
v_mul_f32 v45, s37, v45
mf v[52:55],a[152:155],a[196:199]
v_mul_f32 v46, s37, v46
v_mul_f32 v47, s37, v47
mf v[52:55],a[156:159],a[212:215]
cv v44,v44,v45
cv v46,v46,v47
mf v[48:51],a[156:159],a[208:211]
aw a108,v44
aw a109,v46
mf v[48:51],a[152:155],a[192:195]
v_mul_f32 v60, s37, v60
v_mul_f32 v61, s37, v61
mf v[48:51],a[148:151],a[176:179]
v_mul_f32 v62, s37, v62
v_mul_f32 v63, s37, v63
mf v[48:51],a[144:147],a[160:163]
wl
cv v60,v60,v61
cv v62,v62,v63
mf v[64:67],a[128:131],a[160:163]
tr a[144:145],v12,49160
aw a110,v60
mf v[64:67],a[132:135],a[176:179]
tr a[146:147],v12,49672
aw a111,v62
mf v[64:67],a[136:139],a[192:195]
tr a[148:149],v12,53256
v_mul_f32 v56, s37, v56
mf v[64:67],a[140:143],a[208:211]
tr a[150:151],v12,53768
v_mul_f32 v57, s37, v57
mf v[68:71],a[140:143],a[212:215]
tr a[152:153],v12,57352
v_mul_f32 v58, s37, v58
mf v[68:71],a[136:139],a[196:199]
tr a[154:155],v12,57864
v_mul_f32 v59, s37, v59
mf v[68:71],a[132:135],a[180:183]
tr a[156:157],v12,61448
cv v56,v56,v57
mf v[68:71],a[128:131],a[164:167]
tr a[158:159],v12,61960
cv v58,v58,v59
mf v[72:75],a[128:131],a[168:171]
aw a106,v56
aw a107,v58
mf v[72:75],a[132:135],a[184:187]
v_mul_f32 v52, s37, v52
v_mul_f32 v53, s37, v53
mf v[72:75],a[136:139],a[200:203]
v_mul_f32 v54, s37, v54
v_mul_f32 v55, s37, v55
mf v[72:75],a[140:143],a[216:219]
cv v52,v52,v53
cv v54,v54,v55
mf v[76:79],a[140:143],a[220:223]
aw a102,v52
aw a103,v54
mf v[76:79],a[136:139],a[204:207]
v_mul_f32 v48, s37, v48
v_mul_f32 v49, s37, v49
mf v[76:79],a[132:135],a[188:191]
v_mul_f32 v50, s37, v50
v_mul_f32 v51, s37, v51
mf v[76:79],a[128:131],a[172:175]
wl
cv v48,v48,v49
cv v50,v50,v51
mf v[92:95],a[144:147],a[172:175]
s_barrier
aw a98,v48
aw a99,v50
mf v[92:95],a[148:151],a[188:191]
tr a[128:129],v11,0
v_mul_f32 v64, s37, v64
mf v[92:95],a[152:155],a[204:207]
tr a[130:131],v11,512
v_mul_f32 v65, s37, v65
mf v[92:95],a[156:159],a[220:223]
tr a[132:133],v11,4096
v_mul_f32 v66, s37, v66
mf v[88:91],a[156:159],a[216:219]
tr a[134:135],v11,4608
v_mul_f32 v67, s37, v67
mf v[88:91],a[152:155],a[200:203]
tr a[136:137],v11,8192
cv v64,v64,v65
mf v[88:91],a[148:151],a[184:187]
tr a[138:139],v11,8704
cv v66,v66,v67
mf v[88:91],a[144:147],a[168:171]
tr a[140:141],v11,12288
aw a112,v64
mf v[84:87],a[144:147],a[164:167]
tr a[142:143],v11,12800
aw a113,v66
mf v[84:87],a[148:151],a[180:183]
v_mul_f32 v68, s37, v68
v_mul_f32 v69, s37, v69
mf v[84:87],a[152:155],a[196:199]
v_mul_f32 v70, s37, v70
v_mul_f32 v71, s37, v71
mf v[84:87],a[156:159],a[212:215]
cv v68,v68,v69
cv v70,v70,v71
mf v[80:83],a[156:159],a[208:211]
aw a116,v68
aw a117,v70
mf v[80:83],a[152:155],a[192:195]
v_mul_f32 v72, s37, v72
v_mul_f32 v73, s37, v73
mf v[80:83],a[148:151],a[176:179]
v_mul_f32 v74, s37, v74
v_mul_f32 v75, s37, v75
mf v[80:83],a[144:147],a[160:163]
wl
cv v72,v72,v73
cv v74,v74,v75
mz v[32:35],a[128:131],v[96:99],0
tr a[144:145],v11,8
aw a120,v72
mf v[32:35],a[132:135],v[112:115]
tr a[146:147],v11,520
aw a121,v74
mf v[32:35],a[136:139],v[128:131]
tr a[148:149],v11,4104
v_mul_f32 v76, s37, v76
mf v[32:35],a[140:143],v[144:147]
tr a[150:151],v11,4616
v_mul_f32 v77, s37, v77
mz v[36:39],a[140:143],v[148:151],0
tr a[152:153],v11,8200
v_mul_f32 v78, s37, v78
mf v[36:39],a[136:139],v[132:135]
tr a[154:155],v11,8712
v_mul_f32 v79, s37, v79
mf v[36:39],a[132:135],v[116:119]
tr a[156:157],v11,12296
cv v76,v76,v77
mf v[36:39],a[128:131],v[100:103]
tr a[158:159],v11,12808
cv v78,v78,v79
mz v[40:43],a[128:131],v[104:107],0
aw a124,v76
aw a125,v78
mf v[40:43],a[132:135],v[120:123]
v_mul_f32 v92, s37, v92
v_mul_f32 v93, s37, v93
mf v[40:43],a[136:139],v[136:139]
v_mul_f32 v94, s37, v94
v_mul_f32 v95, s37, v95
mf v[40:43],a[140:143],v[152:155]
cv v92,v92,v93
cv v94,v94,v95
mz v[44:47],a[140:143],v[156:159],0
aw a126,v92
aw a127,v94
mf v[44:47],a[136:139],v[140:143]
v_mul_f32 v88, s37, v88
v_mul_f32 v89, s37, v89
mf v[44:47],a[132:135],v[124:127]
v_mul_f32 v90, s37, v90
v_mul_f32 v91, s37, v91
mf v[44:47],a[128:131],v[108:111]
wl
cv v88,v88,v89
cv v90,v90,v91
mz v[60:63],a[144:147],v[108:111],0
tr a[128:129],v12,0
aw a122,v88
mf v[60:63],a[148:151],v[124:127]
tr a[130:131],v12,512
aw a123,v90
mf v[60:63],a[152:155],v[140:143]
tr a[132:133],v12,4096
v_mul_f32 v84, s37, v84
mf v[60:63],a[156:159],v[156:159]
tr a[134:135],v12,4608
v_mul_f32 v85, s37, v85
mz v[56:59],a[156:159],v[152:155],0
tr a[136:137],v12,8192
v_mul_f32 v86, s37, v86
mf v[56:59],a[152:155],v[136:139]
tr a[138:139],v12,8704
v_mul_f32 v87, s37, v87
mf v[56:59],a[148:151],v[120:123]
tr a[140:141],v12,12288
cv v84,v84,v85
mf v[56:59],a[144:147],v[104:107]
tr a[142:143],v12,12800
cv v86,v86,v87
mz v[52:55],a[144:147],v[100:103],0
aw a118,v84
aw a119,v86
mf v[52:55],a[148:151],v[116:119]
v_mul_f32 v80, s37, v80
v_mul_f32 v81, s37, v81
mf v[52:55],a[152:155],v[132:135]
v_mul_f32 v82, s37, v82
v_mul_f32 v83, s37, v83
mf v[52:55],a[156:159],v[148:151]
cv v80,v80,v81
cv v82,v82,v83
mz v[48:51],a[156:159],v[144:147],0
aw a114,v80
aw a115,v82
mf v[48:51],a[152:155],v[128:131]
mf v[48:51],a[148:151],v[112:115]
mf v[48:51],a[144:147],v[96:99]
wl
mz v[64:67],a[128:131],v[96:99],0
tr a[144:145],v12,8
mf v[64:67],a[132:135],v[112:115]
tr a[146:147],v12,520
mf v[64:67],a[136:139],v[128:131]
tr a[148:149],v12,4104
mf v[64:67],a[140:143],v[144:147]
tr a[150:151],v12,4616
mz v[68:71],a[140:143],v[148:151],0
tr a[152:153],v12,8200
mf v[68:71],a[136:139],v[132:135]
tr a[154:155],v12,8712
mf v[68:71],a[132:135],v[116:119]
tr a[156:157],v12,12296
mf v[68:71],a[128:131],v[100:103]
tr a[158:159],v12,12808
mz v[72:75],a[128:131],v[104:107],0
mf v[72:75],a[132:135],v[120:123]
mf v[72:75],a[136:139],v[136:139]
mf v[72:75],a[140:143],v[152:155]
mz v[76:79],a[140:143],v[156:159],0
mf v[76:79],a[136:139],v[140:143]
mf v[76:79],a[132:135],v[124:127]
mf v[76:79],a[128:131],v[108:111]
wl
mz v[92:95],a[144:147],v[108:111],0
s_barrier
mf v[92:95],a[148:151],v[124:127]
tr a[128:129],v11,16384
mf v[92:95],a[152:155],v[140:143]
tr a[130:131],v11,16896
mf v[92:95],a[156:159],v[156:159]
tr a[132:133],v11,20480
mz v[88:91],a[156:159],v[152:155],0
tr a[134:135],v11,20992
mf v[88:91],a[152:155],v[136:139]
tr a[136:137],v11,20488
mf v[88:91],a[148:151],v[120:123]
tr a[138:139],v11,21000
mf v[88:91],a[144:147],v[104:107]
tr a[140:141],v11,16392
mz v[84:87],a[144:147],v[100:103],0
tr a[142:143],v11,16904
mf v[84:87],a[148:151],v[116:119]
mf v[84:87],a[152:155],v[132:135]
mf v[84:87],a[156:159],v[148:151]
mz v[80:83],a[156:159],v[144:147],0
mf v[80:83],a[152:155],v[128:131]
mf v[80:83],a[148:151],v[112:115]
mf v[80:83],a[144:147],v[96:99]
wl
mf v[32:35],a[128:131],v[160:163]
tr a[144:145],v12,16384
mf v[32:35],a[132:135],v[176:179]
tr a[146:147],v12,16896
mf v[48:51],a[136:139],v[176:179]
tr a[148:149],v12,20480
mf v[48:51],a[140:143],v[160:163]
tr a[150:151],v12,20992
mf v[52:55],a[140:143],v[164:167]
tr a[152:153],v12,20488
mf v[52:55],a[136:139],v[180:183]
tr a[154:155],v12,21000
mf v[36:39],a[132:135],v[180:183]
tr a[156:157],v12,16392
mf v[36:39],a[128:131],v[164:167]
tr a[158:159],v12,16904
mf v[40:43],a[128:131],v[168:171]
mf v[40:43],a[132:135],v[184:187]
mf v[56:59],a[136:139],v[184:187]
mf v[56:59],a[140:143],v[168:171]
mf v[60:63],a[140:143],v[172:175]
mf v[60:63],a[136:139],v[188:191]
mf v[44:47],a[132:135],v[188:191]
mf v[44:47],a[128:131],v[172:175]
wl
mf v[76:79],a[144:147],v[172:175]
s_barrier
mf v[76:79],a[148:151],v[188:191]
tr a[128:129],v11,32768
mf v[92:95],a[152:155],v[188:191]
tr a[130:131],v11,33280
mf v[92:95],a[156:159],v[172:175]
tr a[132:133],v11,36864
mf v[88:91],a[156:159],v[168:171]
tr a[134:135],v11,37376
mf v[88:91],a[152:155],v[184:187]
tr a[136:137],v11,40960
mf v[72:75],a[148:151],v[184:187]
tr a[138:139],v11,41472
mf v[72:75],a[144:147],v[168:171]
tr a[140:141],v11,45056
mf v[68:71],a[144:147],v[164:167]
tr a[142:143],v11,45568
mf v[68:71],a[148:151],v[180:183]
mf v[84:87],a[152:155],v[180:183]
mf v[84:87],a[156:159],v[164:167]
mf v[80:83],a[156:159],v[160:163]
mf v[80:83],a[152:155],v[176:179]
mf v[64:67],a[148:151],v[176:179]
mf v[64:67],a[144:147],v[160:163]
wl
mf v[32:35],a[128:131],v[192:195]
tr a[144:145],v11,32776
mf v[32:35],a[132:135],v[208:211]
tr a[146:147],v11,33288
mf v[32:35],a[136:139],v[224:227]
tr a[148:149],v11,36872
mf v[32:35],a[140:143],v[240:243]
tr a[150:151],v11,37384
mf v[36:39],a[140:143],v[244:247]
tr a[152:153],v11,40968
mf v[36:39],a[136:139],v[228:231]
tr a[154:155],v11,41480
mf v[36:39],a[132:135],v[212:215]
tr a[156:157],v11,45064
mf v[36:39],a[128:131],v[196:199]
tr a[158:159],v11,45576
mf v[40:43],a[128:131],v[200:203]
mf v[40:43],a[132:135],v[216:219]
mf v[40:43],a[136:139],v[232:235]
mf v[40:43],a[140:143],v[248:251]
mf v[44:47],a[140:143],v[252:255]
mf v[44:47],a[136:139],v[236:239]
mf v[44:47],a[132:135],v[220:223]
mf v[44:47],a[128:131],v[204:207]
wl
mf v[60:63],a[144:147],v[204:207]
tr a[128:129],v12,32768
mf v[60:63],a[148:151],v[220:223]
tr a[130:131],v12,33280
mf v[60:63],a[152:155],v[236:239]
tr a[132:133],v12,36864
mf v[60:63],a[156:159],v[252:255]
tr a[134:135],v12,37376
mf v[56:59],a[156:159],v[248:251]
tr a[136:137],v12,40960
mf v[56:59],a[152:155],v[232:235]
tr a[138:139],v12,41472
mf v[56:59],a[148:151],v[216:219]
tr a[140:141],v12,45056
mf v[56:59],a[144:147],v[200:203]
tr a[142:143],v12,45568
mf v[52:55],a[144:147],v[196:199]
mf v[52:55],a[148:151],v[212:215]
mf v[52:55],a[152:155],v[228:231]
mf v[52:55],a[156:159],v[244:247]
mf v[48:51],a[156:159],v[240:243]
mf v[48:51],a[152:155],v[224:227]
mf v[48:51],a[148:151],v[208:211]
mf v[48:51],a[144:147],v[192:195]
wl
mf v[64:67],a[128:131],v[192:195]
tr a[144:145],v12,32776
mf v[64:67],a[132:135],v[208:211]
tr a[146:147],v12,33288
mf v[64:67],a[136:139],v[224:227]
tr a[148:149],v12,36872
mf v[64:67],a[140:143],v[240:243]
tr a[150:151],v12,37384
mf v[68:71],a[140:143],v[244:247]
tr a[152:153],v12,40968
mf v[68:71],a[136:139],v[228:231]
tr a[154:155],v12,41480
mf v[68:71],a[132:135],v[212:215]
tr a[156:157],v12,45064
mf v[68:71],a[128:131],v[196:199]
tr a[158:159],v12,45576
mf v[72:75],a[128:131],v[200:203]
mf v[72:75],a[132:135],v[216:219]
mf v[72:75],a[136:139],v[232:235]
mf v[72:75],a[140:143],v[248:251]
mf v[76:79],a[140:143],v[252:255]
mf v[76:79],a[136:139],v[236:239]
mf v[76:79],a[132:135],v[220:223]
mf v[76:79],a[128:131],v[204:207]
wl
mf v[92:95],a[144:147],v[204:207]
s_barrier
mf v[92:95],a[148:151],v[220:223]
tr a[128:129],v11,49152
mf v[92:95],a[152:155],v[236:239]
tr a[130:131],v11,49664
mf v[92:95],a[156:159],v[252:255]
tr a[132:133],v11,53248
mf v[88:91],a[156:159],v[248:251]
tr a[134:135],v11,53760
mf v[88:91],a[152:155],v[232:235]
tr a[136:137],v11,57344
mf v[88:91],a[148:151],v[216:219]
tr a[138:139],v11,57856
mf v[88:91],a[144:147],v[200:203]
tr a[140:141],v11,61440
mf v[84:87],a[144:147],v[196:199]
tr a[142:143],v11,61952
mf v[84:87],a[148:151],v[212:215]
mf v[84:87],a[152:155],v[228:231]
mf v[84:87],a[156:159],v[244:247]
mf v[80:83],a[156:159],v[240:243]
mf v[80:83],a[152:155],v[224:227]
mf v[80:83],a[148:151],v[208:211]
mf v[80:83],a[144:147],v[192:195]
wl
mf v[32:35],a[128:131],a[160:163]
tr a[144:145],v11,49160
mf v[32:35],a[132:135],a[176:179]
tr a[146:147],v11,49672
mf v[32:35],a[136:139],a[192:195]
tr a[148:149],v11,53256
mf v[32:35],a[140:143],a[208:211]
tr a[150:151],v11,53768
mf v[36:39],a[140:143],a[212:215]
tr a[152:153],v11,57352
mf v[36:39],a[136:139],a[196:199]
tr a[154:155],v11,57864
mf v[36:39],a[132:135],a[180:183]
tr a[156:157],v11,61448
mf v[36:39],a[128:131],a[164:167]
tr a[158:159],v11,61960
mf v[40:43],a[128:131],a[168:171]
mf v[40:43],a[132:135],a[184:187]
v_mul_f32 v32, s37, v32
v_mul_f32 v33, s37, v33
mf v[40:43],a[136:139],a[200:203]
v_mul_f32 v34, s37, v34
v_mul_f32 v35, s37, v35
mf v[40:43],a[140:143],a[216:219]
cv v32,v32,v33
cv v33,v34,v35
mf v[44:47],a[140:143],a[220:223]
ds_write_b64 v4, v[32:33] offset:0
mf v[44:47],a[136:139],a[204:207]
v_mul_f32 v36, s37, v36
v_mul_f32 v37, s37, v37
mf v[44:47],a[132:135],a[188:191]
v_mul_f32 v38, s37, v38
v_mul_f32 v39, s37, v39
mf v[44:47],a[128:131],a[172:175]
s_waitcnt lgkmcnt(1)
cv v36,v36,v37
cv v37,v38,v39
mf v[60:63],a[144:147],a[172:175]
tr a[128:129],v12,49152
mf v[60:63],a[148:151],a[188:191]
tr a[130:131],v12,49664
v_mul_f32 v40, s37, v40
mf v[60:63],a[152:155],a[204:207]
tr a[132:133],v12,53248
v_mul_f32 v41, s37, v41
mf v[60:63],a[156:159],a[220:223]
tr a[134:135],v12,53760
v_mul_f32 v42, s37, v42
mf v[56:59],a[156:159],a[216:219]
tr a[136:137],v12,57344
v_mul_f32 v43, s37, v43
mf v[56:59],a[152:155],a[200:203]
tr a[138:139],v12,57856
cv v40,v40,v41
mf v[56:59],a[148:151],a[184:187]
tr a[140:141],v12,61440
cv v41,v42,v43
mf v[56:59],a[144:147],a[168:171]
tr a[142:143],v12,61952
v_mul_f32 v44, s37, v44
mf v[52:55],a[144:147],a[164:167]
ds_write_b64 v4, v[36:37] offset:1024
mf v[52:55],a[148:151],a[180:183]
v_mul_f32 v45, s37, v45
v_mul_f32 v46, s37, v46
mf v[52:55],a[152:155],a[196:199]
ds_write_b64 v4, v[40:41] offset:2048
mf v[52:55],a[156:159],a[212:215]
v_mul_f32 v47, s37, v47
cv v44,v44,v45
mf v[48:51],a[156:159],a[208:211]
cv v45,v46,v47
v_mul_f32 v60, s37, v60
mf v[48:51],a[152:155],a[192:195]
v_mul_f32 v61, s37, v61
v_mul_f32 v62, s37, v62
mf v[48:51],a[148:151],a[176:179]
v_mul_f32 v63, s37, v63
cv v60,v60,v61
mf v[48:51],a[144:147],a[160:163]
s_waitcnt lgkmcnt(2)
cv v61,v62,v63
v_mul_f32 v56, s37, v56
mf v[64:67],a[128:131],a[160:163]
tr a[144:145],v12,49160
v_mul_f32 v57, s37, v57
mf v[64:67],a[132:135],a[176:179]
tr a[146:147],v12,49672
v_mul_f32 v58, s37, v58
mf v[64:67],a[136:139],a[192:195]
tr a[148:149],v12,53256
v_mul_f32 v59, s37, v59
mf v[64:67],a[140:143],a[208:211]
tr a[150:151],v12,53768
cv v56,v56,v57
mf v[68:71],a[140:143],a[212:215]
tr a[152:153],v12,57352
cv v57,v58,v59
mf v[68:71],a[136:139],a[196:199]
tr a[154:155],v12,57864
v_mul_f32 v52, s37, v52
mf v[68:71],a[132:135],a[180:183]
tr a[156:157],v12,61448
v_mul_f32 v53, s37, v53
mf v[68:71],a[128:131],a[164:167]
tr a[158:159],v12,61960
v_mul_f32 v54, s37, v54
mf v[72:75],a[128:131],a[168:171]
ds_write_b64 v4, v[44:45] offset:3072
mf v[72:75],a[132:135],a[184:187]
v_mul_f32 v55, s37, v55
cv v52,v52,v53
mf v[72:75],a[136:139],a[200:203]
ds_write_b64 v4, v[60:61] offset:3080
mf v[72:75],a[140:143],a[216:219]
cv v53,v54,v55
v_mul_f32 v48, s37, v48
mf v[76:79],a[140:143],a[220:223]
ds_write_b64 v4, v[56:57] offset:2056
mf v[76:79],a[136:139],a[204:207]
v_mul_f32 v49, s37, v49
v_mul_f32 v50, s37, v50
mf v[76:79],a[132:135],a[188:191]
v_mul_f32 v51, s37, v51
cv v48,v48,v49
mf v[76:79],a[128:131],a[172:175]
s_waitcnt lgkmcnt(3)
cv v49,v50,v51
v_mul_f32 v64, s37, v64
mf v[92:95],a[144:147],a[172:175]
s_barrier
v_mul_f32 v65, s37, v65
v_mul_f32 v66, s37, v66
mf v[92:95],a[148:151],a[188:191]
tr a[128:129],v11,0
v_mul_f32 v67, s37, v67
mf v[92:95],a[152:155],a[204:207]
tr a[130:131],v11,512
cv v64,v64,v65
mf v[92:95],a[156:159],a[220:223]
tr a[132:133],v11,4096
cv v65,v66,v67
mf v[88:91],a[156:159],a[216:219]
tr a[134:135],v11,4608
v_mul_f32 v68, s37, v68
mf v[88:91],a[152:155],a[200:203]
tr a[136:137],v11,8192
v_mul_f32 v69, s37, v69
mf v[88:91],a[148:151],a[184:187]
tr a[138:139],v11,8704
v_mul_f32 v70, s37, v70
mf v[88:91],a[144:147],a[168:171]
tr a[140:141],v11,12288
v_mul_f32 v71, s37, v71
mf v[84:87],a[144:147],a[164:167]
tr a[142:143],v11,12800
cv v68,v68,v69
mf v[84:87],a[148:151],a[180:183]
cv v69,v70,v71
v_mul_f32 v72, s37, v72
mf v[84:87],a[152:155],a[196:199]
ds_write_b64 v4, v[52:53] offset:1032
mf v[84:87],a[156:159],a[212:215]
v_mul_f32 v73, s37, v73
v_mul_f32 v74, s37, v74
mf v[80:83],a[156:159],a[208:211]
ds_write_b64 v4, v[48:49] offset:8
mf v[80:83],a[152:155],a[192:195]
v_mul_f32 v75, s37, v75
cv v72,v72,v73
mf v[80:83],a[148:151],a[176:179]
cv v73,v74,v75
v_mul_f32 v76, s37, v76
mf v[80:83],a[144:147],a[160:163]
s_waitcnt lgkmcnt(2)
v_mul_f32 v77, s37, v77
v_mul_f32 v78, s37, v78
mz v[32:35],a[128:131],v[96:99],0
tr a[144:145],v11,8
v_mul_f32 v79, s37, v79
mf v[32:35],a[132:135],v[112:115]
tr a[146:147],v11,520
cv v76,v76,v77
mf v[32:35],a[136:139],v[128:131]
tr a[148:149],v11,4104
cv v77,v78,v79
mf v[32:35],a[140:143],v[144:147]
tr a[150:151],v11,4616
v_mul_f32 v92, s37, v92
mz v[36:39],a[140:143],v[148:151],0
tr a[152:153],v11,8200
v_mul_f32 v93, s37, v93
mf v[36:39],a[136:139],v[132:135]
tr a[154:155],v11,8712
v_mul_f32 v94, s37, v94
mf v[36:39],a[132:135],v[116:119]
tr a[156:157],v11,12296
v_mul_f32 v95, s37, v95
mf v[36:39],a[128:131],v[100:103]
tr a[158:159],v11,12808
cv v92,v92,v93
mz v[40:43],a[128:131],v[104:107],0
ds_write_b64 v4, v[64:65] offset:4096
mf v[40:43],a[132:135],v[120:123]
cv v93,v94,v95
v_mul_f32 v88, s37, v88
mf v[40:43],a[136:139],v[136:139]
ds_write_b64 v4, v[68:69] offset:5120
mf v[40:43],a[140:143],v[152:155]
v_mul_f32 v89, s37, v89
v_mul_f32 v90, s37, v90
mz v[44:47],a[140:143],v[156:159],0
ds_write_b64 v4, v[72:73] offset:6144
mf v[44:47],a[136:139],v[140:143]
v_mul_f32 v91, s37, v91
cv v88,v88,v89
mf v[44:47],a[132:135],v[124:127]
cv v89,v90,v91
v_mul_f32 v84, s37, v84
mf v[44:47],a[128:131],v[108:111]
s_waitcnt lgkmcnt(3)
v_mul_f32 v85, s37, v85
v_mul_f32 v86, s37, v86
mz v[60:63],a[144:147],v[108:111],0
tr a[128:129],v12,0
v_mul_f32 v87, s37, v87
mf v[60:63],a[148:151],v[124:127]
tr a[130:131],v12,512
cv v84,v84,v85
mf v[60:63],a[152:155],v[140:143]
tr a[132:133],v12,4096
cv v85,v86,v87
mf v[60:63],a[156:159],v[156:159]
tr a[134:135],v12,4608
v_mul_f32 v80, s37, v80
mz v[56:59],a[156:159],v[152:155],0
tr a[136:137],v12,8192
v_mul_f32 v81, s37, v81
mf v[56:59],a[152:155],v[136:139]
tr a[138:139],v12,8704
v_mul_f32 v82, s37, v82
mf v[56:59],a[148:151],v[120:123]
tr a[140:141],v12,12288
v_mul_f32 v83, s37, v83
mf v[56:59],a[144:147],v[104:107]
tr a[142:143],v12,12800
cv v80,v80,v81
mz v[52:55],a[144:147],v[100:103],0
ds_write_b64 v4, v[76:77] offset:7168
mf v[52:55],a[148:151],v[116:119]
cv v81,v82,v83
mf v[52:55],a[152:155],v[132:135]
ds_write_b64 v4, v[92:93] offset:7176
mf v[52:55],a[156:159],v[148:151]
mz v[48:51],a[156:159],v[144:147],0
ds_write_b64 v4, v[88:89] offset:6152
mf v[48:51],a[152:155],v[128:131]
mf v[48:51],a[148:151],v[112:115]
mf v[48:51],a[144:147],v[96:99]
s_waitcnt lgkmcnt(3)
mz v[64:67],a[128:131],v[96:99],0
tr a[144:145],v12,8
mf v[64:67],a[132:135],v[112:115]
tr a[146:147],v12,520
mf v[64:67],a[136:139],v[128:131]
tr a[148:149],v12,4104
mf v[64:67],a[140:143],v[144:147]
tr a[150:151],v12,4616
mz v[68:71],a[140:143],v[148:151],0
tr a[152:153],v12,8200
mf v[68:71],a[136:139],v[132:135]
tr a[154:155],v12,8712
mf v[68:71],a[132:135],v[116:119]
tr a[156:157],v12,12296
mf v[68:71],a[128:131],v[100:103]
tr a[158:159],v12,12808
mz v[72:75],a[128:131],v[104:107],0
ds_write_b64 v4, v[84:85] offset:5128
mf v[72:75],a[132:135],v[120:123]
mf v[72:75],a[136:139],v[136:139]
ds_write_b64 v4, v[80:81] offset:4104
mf v[72:75],a[140:143],v[152:155]
mz v[76:79],a[140:143],v[156:159],0
mf v[76:79],a[136:139],v[140:143]
mf v[76:79],a[132:135],v[124:127]
mf v[76:79],a[128:131],v[108:111]
s_waitcnt lgkmcnt(2)
mz v[92:95],a[144:147],v[108:111],0
s_barrier
mf v[92:95],a[148:151],v[124:127]
tr a[128:129],v11,16384
mf v[92:95],a[152:155],v[140:143]
tr a[130:131],v11,16896
mf v[92:95],a[156:159],v[156:159]
tr a[132:133],v11,20480
mz v[88:91],a[156:159],v[152:155],0
tr a[134:135],v11,20992
mf v[88:91],a[152:155],v[136:139]
tr a[136:137],v11,20488
mf v[88:91],a[148:151],v[120:123]
tr a[138:139],v11,21000
mf v[88:91],a[144:147],v[104:107]
tr a[140:141],v11,16392
mz v[84:87],a[144:147],v[100:103],0
tr a[142:143],v11,16904
mf v[84:87],a[148:151],v[116:119]
mf v[84:87],a[152:155],v[132:135]
mf v[84:87],a[156:159],v[148:151]
mz v[80:83],a[156:159],v[144:147],0
mf v[80:83],a[152:155],v[128:131]
mf v[80:83],a[148:151],v[112:115]
mf v[80:83],a[144:147],v[96:99]
wl
mf v[32:35],a[128:131],v[160:163]
tr a[144:145],v12,16384
mf v[32:35],a[132:135],v[176:179]
tr a[146:147],v12,16896
mf v[48:51],a[136:139],v[176:179]
tr a[148:149],v12,20480
mf v[48:51],a[140:143],v[160:163]
tr a[150:151],v12,20992
mf v[52:55],a[140:143],v[164:167]
tr a[152:153],v12,20488
mf v[52:55],a[136:139],v[180:183]
tr a[154:155],v12,21000
mf v[36:39],a[132:135],v[180:183]
tr a[156:157],v12,16392
mf v[36:39],a[128:131],v[164:167]
tr a[158:159],v12,16904
mf v[40:43],a[128:131],v[168:171]
mf v[40:43],a[132:135],v[184:187]
mf v[56:59],a[136:139],v[184:187]
mf v[56:59],a[140:143],v[168:171]
mf v[60:63],a[140:143],v[172:175]
mf v[60:63],a[136:139],v[188:191]
mf v[44:47],a[132:135],v[188:191]
mf v[44:47],a[128:131],v[172:175]
wl
mf v[76:79],a[144:147],v[172:175]
s_barrier
mf v[76:79],a[148:151],v[188:191]
tr a[128:129],v11,32768
mf v[92:95],a[152:155],v[188:191]
tr a[130:131],v11,33280
mf v[92:95],a[156:159],v[172:175]
tr a[132:133],v11,36864
mf v[88:91],a[156:159],v[168:171]
tr a[134:135],v11,37376
mf v[88:91],a[152:155],v[184:187]
tr a[136:137],v11,40960
mf v[72:75],a[148:151],v[184:187]
tr a[138:139],v11,41472
mf v[72:75],a[144:147],v[168:171]
tr a[140:141],v11,45056
mf v[68:71],a[144:147],v[164:167]
tr a[142:143],v11,45568
mf v[68:71],a[148:151],v[180:183]
mf v[84:87],a[152:155],v[180:183]
mf v[84:87],a[156:159],v[164:167]
mf v[80:83],a[156:159],v[160:163]
mf v[80:83],a[152:155],v[176:179]
mf v[64:67],a[148:151],v[176:179]
mf v[64:67],a[144:147],v[160:163]
wl
mf v[32:35],a[128:131],v[192:195]
tr a[144:145],v11,32776
mf v[32:35],a[132:135],v[208:211]
tr a[146:147],v11,33288
mf v[32:35],a[136:139],v[224:227]
tr a[148:149],v11,36872
mf v[32:35],a[140:143],v[240:243]
tr a[150:151],v11,37384
mf v[36:39],a[140:143],v[244:247]
tr a[152:153],v11,40968
mf v[36:39],a[136:139],v[228:231]
tr a[154:155],v11,41480
mf v[36:39],a[132:135],v[212:215]
tr a[156:157],v11,45064
mf v[36:39],a[128:131],v[196:199]
tr a[158:159],v11,45576
mf v[40:43],a[128:131],v[200:203]
mf v[40:43],a[132:135],v[216:219]
mf v[40:43],a[136:139],v[232:235]
mf v[40:43],a[140:143],v[248:251]
mf v[44:47],a[140:143],v[252:255]
mf v[44:47],a[136:139],v[236:239]
mf v[44:47],a[132:135],v[220:223]
mf v[44:47],a[128:131],v[204:207]
wl
mf v[60:63],a[144:147],v[204:207]
tr a[128:129],v12,32768
mf v[60:63],a[148:151],v[220:223]
tr a[130:131],v12,33280
mf v[60:63],a[152:155],v[236:239]
tr a[132:133],v12,36864
mf v[60:63],a[156:159],v[252:255]
tr a[134:135],v12,37376
mf v[56:59],a[156:159],v[248:251]
tr a[136:137],v12,40960
mf v[56:59],a[152:155],v[232:235]
tr a[138:139],v12,41472
mf v[56:59],a[148:151],v[216:219]
tr a[140:141],v12,45056
mf v[56:59],a[144:147],v[200:203]
tr a[142:143],v12,45568
mf v[52:55],a[144:147],v[196:199]
mf v[52:55],a[148:151],v[212:215]
mf v[52:55],a[152:155],v[228:231]
mf v[52:55],a[156:159],v[244:247]
mf v[48:51],a[156:159],v[240:243]
mf v[48:51],a[152:155],v[224:227]
mf v[48:51],a[148:151],v[208:211]
mf v[48:51],a[144:147],v[192:195]
wl
mf v[64:67],a[128:131],v[192:195]
tr a[144:145],v12,32776
mf v[64:67],a[132:135],v[208:211]
tr a[146:147],v12,33288
mf v[64:67],a[136:139],v[224:227]
tr a[148:149],v12,36872
mf v[64:67],a[140:143],v[240:243]
tr a[150:151],v12,37384
mf v[68:71],a[140:143],v[244:247]
tr a[152:153],v12,40968
mf v[68:71],a[136:139],v[228:231]
tr a[154:155],v12,41480
mf v[68:71],a[132:135],v[212:215]
tr a[156:157],v12,45064
mf v[68:71],a[128:131],v[196:199]
tr a[158:159],v12,45576
mf v[72:75],a[128:131],v[200:203]
mf v[72:75],a[132:135],v[216:219]
mf v[72:75],a[136:139],v[232:235]
mf v[72:75],a[140:143],v[248:251]
mf v[76:79],a[140:143],v[252:255]
mf v[76:79],a[136:139],v[236:239]
mf v[76:79],a[132:135],v[220:223]
mf v[76:79],a[128:131],v[204:207]
wl
mf v[92:95],a[144:147],v[204:207]
s_barrier
mf v[92:95],a[148:151],v[220:223]
tr a[128:129],v11,49152
mf v[92:95],a[152:155],v[236:239]
tr a[130:131],v11,49664
mf v[92:95],a[156:159],v[252:255]
tr a[132:133],v11,53248
mf v[88:91],a[156:159],v[248:251]
tr a[134:135],v11,53760
mf v[88:91],a[152:155],v[232:235]
tr a[136:137],v11,57344
mf v[88:91],a[148:151],v[216:219]
tr a[138:139],v11,57856
mf v[88:91],a[144:147],v[200:203]
tr a[140:141],v11,61440
mf v[84:87],a[144:147],v[196:199]
tr a[142:143],v11,61952
mf v[84:87],a[148:151],v[212:215]
mf v[84:87],a[152:155],v[228:231]
mf v[84:87],a[156:159],v[244:247]
mf v[80:83],a[156:159],v[240:243]
mf v[80:83],a[152:155],v[224:227]
mf v[80:83],a[148:151],v[208:211]
mf v[80:83],a[144:147],v[192:195]
wl
mf v[32:35],a[128:131],a[160:163]
tr a[144:145],v11,49160
mf v[32:35],a[132:135],a[176:179]
tr a[146:147],v11,49672
mf v[32:35],a[136:139],a[192:195]
tr a[148:149],v11,53256
mf v[32:35],a[140:143],a[208:211]
tr a[150:151],v11,53768
mf v[36:39],a[140:143],a[212:215]
tr a[152:153],v11,57352
mf v[36:39],a[136:139],a[196:199]
tr a[154:155],v11,57864
mf v[36:39],a[132:135],a[180:183]
tr a[156:157],v11,61448
mf v[36:39],a[128:131],a[164:167]
tr a[158:159],v11,61960
mf v[40:43],a[128:131],a[168:171]
mf v[40:43],a[132:135],a[184:187]
v_mul_f32 v32, s37, v32
v_mul_f32 v33, s37, v33
mf v[40:43],a[136:139],a[200:203]
v_mul_f32 v34, s37, v34
v_mul_f32 v35, s37, v35
mf v[40:43],a[140:143],a[216:219]
cv v32,v32,v33
cv v33,v34,v35
mf v[44:47],a[140:143],a[220:223]
ds_write_b64 v4, v[32:33] offset:8192
mf v[44:47],a[136:139],a[204:207]
v_mul_f32 v36, s37, v36
v_mul_f32 v37, s37, v37
mf v[44:47],a[132:135],a[188:191]
v_mul_f32 v38, s37, v38
v_mul_f32 v39, s37, v39
mf v[44:47],a[128:131],a[172:175]
s_waitcnt lgkmcnt(1)
cv v36,v36,v37
cv v37,v38,v39
mf v[60:63],a[144:147],a[172:175]
tr a[128:129],v12,49152
mf v[60:63],a[148:151],a[188:191]
tr a[130:131],v12,49664
v_mul_f32 v40, s37, v40
mf v[60:63],a[152:155],a[204:207]
tr a[132:133],v12,53248
v_mul_f32 v41, s37, v41
mf v[60:63],a[156:159],a[220:223]
tr a[134:135],v12,53760
v_mul_f32 v42, s37, v42
mf v[56:59],a[156:159],a[216:219]
tr a[136:137],v12,57344
v_mul_f32 v43, s37, v43
mf v[56:59],a[152:155],a[200:203]
tr a[138:139],v12,57856
cv v40,v40,v41
mf v[56:59],a[148:151],a[184:187]
tr a[140:141],v12,61440
cv v41,v42,v43
mf v[56:59],a[144:147],a[168:171]
tr a[142:143],v12,61952
v_mul_f32 v44, s37, v44
mf v[52:55],a[144:147],a[164:167]
ds_write_b64 v4, v[36:37] offset:9216
mf v[52:55],a[148:151],a[180:183]
v_mul_f32 v45, s37, v45
v_mul_f32 v46, s37, v46
mf v[52:55],a[152:155],a[196:199]
ds_write_b64 v4, v[40:41] offset:10240
mf v[52:55],a[156:159],a[212:215]
v_mul_f32 v47, s37, v47
cv v44,v44,v45
mf v[48:51],a[156:159],a[208:211]
cv v45,v46,v47
v_mul_f32 v60, s37, v60
mf v[48:51],a[152:155],a[192:195]
v_mul_f32 v61, s37, v61
v_mul_f32 v62, s37, v62
mf v[48:51],a[148:151],a[176:179]
v_mul_f32 v63, s37, v63
cv v60,v60,v61
mf v[48:51],a[144:147],a[160:163]
s_waitcnt lgkmcnt(2)
cv v61,v62,v63
v_mul_f32 v56, s37, v56
mf v[64:67],a[128:131],a[160:163]
tr a[144:145],v12,49160
v_mul_f32 v57, s37, v57
mf v[64:67],a[132:135],a[176:179]
tr a[146:147],v12,49672
v_mul_f32 v58, s37, v58
mf v[64:67],a[136:139],a[192:195]
tr a[148:149],v12,53256
v_mul_f32 v59, s37, v59
mf v[64:67],a[140:143],a[208:211]
tr a[150:151],v12,53768
cv v56,v56,v57
mf v[68:71],a[140:143],a[212:215]
tr a[152:153],v12,57352
cv v57,v58,v59
mf v[68:71],a[136:139],a[196:199]
tr a[154:155],v12,57864
v_mul_f32 v52, s37, v52
mf v[68:71],a[132:135],a[180:183]
tr a[156:157],v12,61448
v_mul_f32 v53, s37, v53
mf v[68:71],a[128:131],a[164:167]
tr a[158:159],v12,61960
v_mul_f32 v54, s37, v54
mf v[72:75],a[128:131],a[168:171]
ds_write_b64 v4, v[44:45] offset:11264
mf v[72:75],a[132:135],a[184:187]
v_mul_f32 v55, s37, v55
cv v52,v52,v53
mf v[72:75],a[136:139],a[200:203]
ds_write_b64 v4, v[60:61] offset:11272
mf v[72:75],a[140:143],a[216:219]
cv v53,v54,v55
v_mul_f32 v48, s37, v48
mf v[76:79],a[140:143],a[220:223]
ds_write_b64 v4, v[56:57] offset:10248
mf v[76:79],a[136:139],a[204:207]
v_mul_f32 v49, s37, v49
v_mul_f32 v50, s37, v50
mf v[76:79],a[132:135],a[188:191]
v_mul_f32 v51, s37, v51
cv v48,v48,v49
mf v[76:79],a[128:131],a[172:175]
s_waitcnt lgkmcnt(3)
cv v49,v50,v51
v_mul_f32 v64, s37, v64
mf v[92:95],a[144:147],a[172:175]
s_barrier
v_mul_f32 v65, s37, v65
v_mul_f32 v66, s37, v66
mf v[92:95],a[148:151],a[188:191]
tr a[128:129],v11,0
v_mul_f32 v67, s37, v67
mf v[92:95],a[152:155],a[204:207]
tr a[130:131],v11,512
cv v64,v64,v65
mf v[92:95],a[156:159],a[220:223]
tr a[132:133],v11,4096
cv v65,v66,v67
mf v[88:91],a[156:159],a[216:219]
tr a[134:135],v11,4608
v_mul_f32 v68, s37, v68
mf v[88:91],a[152:155],a[200:203]
tr a[136:137],v11,8192
v_mul_f32 v69, s37, v69
mf v[88:91],a[148:151],a[184:187]
tr a[138:139],v11,8704
v_mul_f32 v70, s37, v70
mf v[88:91],a[144:147],a[168:171]
tr a[140:141],v11,12288
v_mul_f32 v71, s37, v71
mf v[84:87],a[144:147],a[164:167]
tr a[142:143],v11,12800
cv v68,v68,v69
mf v[84:87],a[148:151],a[180:183]
cv v69,v70,v71
v_mul_f32 v72, s37, v72
mf v[84:87],a[152:155],a[196:199]
ds_write_b64 v4, v[52:53] offset:9224
mf v[84:87],a[156:159],a[212:215]
v_mul_f32 v73, s37, v73
v_mul_f32 v74, s37, v74
mf v[80:83],a[156:159],a[208:211]
ds_write_b64 v4, v[48:49] offset:8200
mf v[80:83],a[152:155],a[192:195]
v_mul_f32 v75, s37, v75
cv v72,v72,v73
mf v[80:83],a[148:151],a[176:179]
cv v73,v74,v75
v_mul_f32 v76, s37, v76
mf v[80:83],a[144:147],a[160:163]
s_waitcnt lgkmcnt(2)
v_mul_f32 v77, s37, v77
v_mul_f32 v78, s37, v78
mz v[32:35],a[128:131],v[96:99],0
tr a[144:145],v11,8
v_mul_f32 v79, s37, v79
mf v[32:35],a[132:135],v[112:115]
tr a[146:147],v11,520
cv v76,v76,v77
mf v[32:35],a[136:139],v[128:131]
tr a[148:149],v11,4104
cv v77,v78,v79
mf v[32:35],a[140:143],v[144:147]
tr a[150:151],v11,4616
v_mul_f32 v92, s37, v92
mz v[36:39],a[140:143],v[148:151],0
tr a[152:153],v11,8200
v_mul_f32 v93, s37, v93
mf v[36:39],a[136:139],v[132:135]
tr a[154:155],v11,8712
v_mul_f32 v94, s37, v94
mf v[36:39],a[132:135],v[116:119]
tr a[156:157],v11,12296
v_mul_f32 v95, s37, v95
mf v[36:39],a[128:131],v[100:103]
tr a[158:159],v11,12808
cv v92,v92,v93
mz v[40:43],a[128:131],v[104:107],0
ds_write_b64 v4, v[64:65] offset:12288
mf v[40:43],a[132:135],v[120:123]
cv v93,v94,v95
v_mul_f32 v88, s37, v88
mf v[40:43],a[136:139],v[136:139]
ds_write_b64 v4, v[68:69] offset:13312
mf v[40:43],a[140:143],v[152:155]
v_mul_f32 v89, s37, v89
v_mul_f32 v90, s37, v90
mz v[44:47],a[140:143],v[156:159],0
ds_write_b64 v4, v[72:73] offset:14336
mf v[44:47],a[136:139],v[140:143]
v_mul_f32 v91, s37, v91
cv v88,v88,v89
mf v[44:47],a[132:135],v[124:127]
cv v89,v90,v91
v_mul_f32 v84, s37, v84
mf v[44:47],a[128:131],v[108:111]
s_waitcnt lgkmcnt(3)
v_mul_f32 v85, s37, v85
v_mul_f32 v86, s37, v86
mz v[60:63],a[144:147],v[108:111],0
tr a[128:129],v12,0
v_mul_f32 v87, s37, v87
mf v[60:63],a[148:151],v[124:127]
tr a[130:131],v12,512
cv v84,v84,v85
mf v[60:63],a[152:155],v[140:143]
tr a[132:133],v12,4096
cv v85,v86,v87
mf v[60:63],a[156:159],v[156:159]
tr a[134:135],v12,4608
v_mul_f32 v80, s37, v80
mz v[56:59],a[156:159],v[152:155],0
tr a[136:137],v12,8192
v_mul_f32 v81, s37, v81
mf v[56:59],a[152:155],v[136:139]
tr a[138:139],v12,8704
v_mul_f32 v82, s37, v82
mf v[56:59],a[148:151],v[120:123]
tr a[140:141],v12,12288
v_mul_f32 v83, s37, v83
mf v[56:59],a[144:147],v[104:107]
tr a[142:143],v12,12800
cv v80,v80,v81
mz v[52:55],a[144:147],v[100:103],0
ds_write_b64 v4, v[76:77] offset:15360
mf v[52:55],a[148:151],v[116:119]
cv v81,v82,v83
mf v[52:55],a[152:155],v[132:135]
ds_write_b64 v4, v[92:93] offset:15368
mf v[52:55],a[156:159],v[148:151]
mz v[48:51],a[156:159],v[144:147],0
ds_write_b64 v4, v[88:89] offset:14344
mf v[48:51],a[152:155],v[128:131]
mf v[48:51],a[148:151],v[112:115]
mf v[48:51],a[144:147],v[96:99]
s_waitcnt lgkmcnt(3)
mz v[64:67],a[128:131],v[96:99],0
tr a[144:145],v12,8
mf v[64:67],a[132:135],v[112:115]
tr a[146:147],v12,520
mf v[64:67],a[136:139],v[128:131]
tr a[148:149],v12,4104
mf v[64:67],a[140:143],v[144:147]
tr a[150:151],v12,4616
mz v[68:71],a[140:143],v[148:151],0
tr a[152:153],v12,8200
mf v[68:71],a[136:139],v[132:135]
tr a[154:155],v12,8712
mf v[68:71],a[132:135],v[116:119]
tr a[156:157],v12,12296
mf v[68:71],a[128:131],v[100:103]
tr a[158:159],v12,12808
mz v[72:75],a[128:131],v[104:107],0
ds_write_b64 v4, v[84:85] offset:13320
mf v[72:75],a[132:135],v[120:123]
mf v[72:75],a[136:139],v[136:139]
ds_write_b64 v4, v[80:81] offset:12296
mf v[72:75],a[140:143],v[152:155]
mz v[76:79],a[140:143],v[156:159],0
mf v[76:79],a[136:139],v[140:143]
mf v[76:79],a[132:135],v[124:127]
mf v[76:79],a[128:131],v[108:111]
s_waitcnt lgkmcnt(2)
mz v[92:95],a[144:147],v[108:111],0
s_barrier
mf v[92:95],a[148:151],v[124:127]
tr a[128:129],v11,16384
mf v[92:95],a[152:155],v[140:143]
tr a[130:131],v11,16896
mf v[92:95],a[156:159],v[156:159]
tr a[132:133],v11,20480
mz v[88:91],a[156:159],v[152:155],0
tr a[134:135],v11,20992
mf v[88:91],a[152:155],v[136:139]
tr a[136:137],v11,20488
mf v[88:91],a[148:151],v[120:123]
tr a[138:139],v11,21000
mf v[88:91],a[144:147],v[104:107]
tr a[140:141],v11,16392
mz v[84:87],a[144:147],v[100:103],0
tr a[142:143],v11,16904
mf v[84:87],a[148:151],v[116:119]
mf v[84:87],a[152:155],v[132:135]
mf v[84:87],a[156:159],v[148:151]
mz v[80:83],a[156:159],v[144:147],0
mf v[80:83],a[152:155],v[128:131]
mf v[80:83],a[148:151],v[112:115]
mf v[80:83],a[144:147],v[96:99]
wl
mf v[32:35],a[128:131],v[160:163]
tr a[144:145],v12,16384
mf v[32:35],a[132:135],v[176:179]
tr a[146:147],v12,16896
mf v[48:51],a[136:139],v[176:179]
tr a[148:149],v12,20480
mf v[48:51],a[140:143],v[160:163]
tr a[150:151],v12,20992
mf v[52:55],a[140:143],v[164:167]
tr a[152:153],v12,20488
mf v[52:55],a[136:139],v[180:183]
tr a[154:155],v12,21000
mf v[36:39],a[132:135],v[180:183]
tr a[156:157],v12,16392
mf v[36:39],a[128:131],v[164:167]
tr a[158:159],v12,16904
mf v[40:43],a[128:131],v[168:171]
mf v[40:43],a[132:135],v[184:187]
mf v[56:59],a[136:139],v[184:187]
mf v[56:59],a[140:143],v[168:171]
mf v[60:63],a[140:143],v[172:175]
mf v[60:63],a[136:139],v[188:191]
mf v[44:47],a[132:135],v[188:191]
mf v[44:47],a[128:131],v[172:175]
wl
mf v[76:79],a[144:147],v[172:175]
s_barrier
mf v[76:79],a[148:151],v[188:191]
tr a[128:129],v11,32768
mf v[92:95],a[152:155],v[188:191]
tr a[130:131],v11,33280
mf v[92:95],a[156:159],v[172:175]
tr a[132:133],v11,36864
mf v[88:91],a[156:159],v[168:171]
tr a[134:135],v11,37376
mf v[88:91],a[152:155],v[184:187]
tr a[136:137],v11,40960
mf v[72:75],a[148:151],v[184:187]
tr a[138:139],v11,41472
mf v[72:75],a[144:147],v[168:171]
tr a[140:141],v11,45056
mf v[68:71],a[144:147],v[164:167]
tr a[142:143],v11,45568
mf v[68:71],a[148:151],v[180:183]
mf v[84:87],a[152:155],v[180:183]
mf v[84:87],a[156:159],v[164:167]
mf v[80:83],a[156:159],v[160:163]
mf v[80:83],a[152:155],v[176:179]
mf v[64:67],a[148:151],v[176:179]
mf v[64:67],a[144:147],v[160:163]
wl
mf v[32:35],a[128:131],v[192:195]
tr a[144:145],v11,32776
mf v[32:35],a[132:135],v[208:211]
tr a[146:147],v11,33288
mf v[32:35],a[136:139],v[224:227]
tr a[148:149],v11,36872
mf v[32:35],a[140:143],v[240:243]
tr a[150:151],v11,37384
mf v[36:39],a[140:143],v[244:247]
tr a[152:153],v11,40968
mf v[36:39],a[136:139],v[228:231]
tr a[154:155],v11,41480
mf v[36:39],a[132:135],v[212:215]
tr a[156:157],v11,45064
mf v[36:39],a[128:131],v[196:199]
tr a[158:159],v11,45576
mf v[40:43],a[128:131],v[200:203]
mf v[40:43],a[132:135],v[216:219]
mf v[40:43],a[136:139],v[232:235]
mf v[40:43],a[140:143],v[248:251]
mf v[44:47],a[140:143],v[252:255]
mf v[44:47],a[136:139],v[236:239]
mf v[44:47],a[132:135],v[220:223]
mf v[44:47],a[128:131],v[204:207]
wl
mf v[60:63],a[144:147],v[204:207]
tr a[128:129],v12,32768
mf v[60:63],a[148:151],v[220:223]
tr a[130:131],v12,33280
mf v[60:63],a[152:155],v[236:239]
tr a[132:133],v12,36864
mf v[60:63],a[156:159],v[252:255]
tr a[134:135],v12,37376
mf v[56:59],a[156:159],v[248:251]
tr a[136:137],v12,40960
mf v[56:59],a[152:155],v[232:235]
tr a[138:139],v12,41472
mf v[56:59],a[148:151],v[216:219]
tr a[140:141],v12,45056
mf v[56:59],a[144:147],v[200:203]
tr a[142:143],v12,45568
mf v[52:55],a[144:147],v[196:199]
mf v[52:55],a[148:151],v[212:215]
mf v[52:55],a[152:155],v[228:231]
mf v[52:55],a[156:159],v[244:247]
mf v[48:51],a[156:159],v[240:243]
mf v[48:51],a[152:155],v[224:227]
mf v[48:51],a[148:151],v[208:211]
mf v[48:51],a[144:147],v[192:195]
wl
mf v[64:67],a[128:131],v[192:195]
tr a[144:145],v12,32776
mf v[64:67],a[132:135],v[208:211]
tr a[146:147],v12,33288
mf v[64:67],a[136:139],v[224:227]
tr a[148:149],v12,36872
mf v[64:67],a[140:143],v[240:243]
tr a[150:151],v12,37384
mf v[68:71],a[140:143],v[244:247]
tr a[152:153],v12,40968
mf v[68:71],a[136:139],v[228:231]
tr a[154:155],v12,41480
mf v[68:71],a[132:135],v[212:215]
tr a[156:157],v12,45064
mf v[68:71],a[128:131],v[196:199]
tr a[158:159],v12,45576
mf v[72:75],a[128:131],v[200:203]
mf v[72:75],a[132:135],v[216:219]
mf v[72:75],a[136:139],v[232:235]
mf v[72:75],a[140:143],v[248:251]
mf v[76:79],a[140:143],v[252:255]
mf v[76:79],a[136:139],v[236:239]
mf v[76:79],a[132:135],v[220:223]
mf v[76:79],a[128:131],v[204:207]
wl
mf v[92:95],a[144:147],v[204:207]
s_barrier
mf v[92:95],a[148:151],v[220:223]
tr a[128:129],v11,49152
mf v[92:95],a[152:155],v[236:239]
tr a[130:131],v11,49664
mf v[92:95],a[156:159],v[252:255]
tr a[132:133],v11,53248
mf v[88:91],a[156:159],v[248:251]
tr a[134:135],v11,53760
mf v[88:91],a[152:155],v[232:235]
tr a[136:137],v11,57344
mf v[88:91],a[148:151],v[216:219]
tr a[138:139],v11,57856
mf v[88:91],a[144:147],v[200:203]
tr a[140:141],v11,61440
mf v[84:87],a[144:147],v[196:199]
tr a[142:143],v11,61952
mf v[84:87],a[148:151],v[212:215]
mf v[84:87],a[152:155],v[228:231]
mf v[84:87],a[156:159],v[244:247]
mf v[80:83],a[156:159],v[240:243]
mf v[80:83],a[152:155],v[224:227]
mf v[80:83],a[148:151],v[208:211]
mf v[80:83],a[144:147],v[192:195]
wl
mf v[32:35],a[128:131],a[160:163]
tr a[144:145],v11,49160
mf v[32:35],a[132:135],a[176:179]
tr a[146:147],v11,49672
mf v[32:35],a[136:139],a[192:195]
tr a[148:149],v11,53256
mf v[32:35],a[140:143],a[208:211]
tr a[150:151],v11,53768
mf v[36:39],a[140:143],a[212:215]
tr a[152:153],v11,57352
mf v[36:39],a[136:139],a[196:199]
tr a[154:155],v11,57864
mf v[36:39],a[132:135],a[180:183]
tr a[156:157],v11,61448
mf v[36:39],a[128:131],a[164:167]
tr a[158:159],v11,61960
mf v[40:43],a[128:131],a[168:171]
mf v[40:43],a[132:135],a[184:187]
v_mul_f32 v32, s37, v32
v_mul_f32 v33, s37, v33
mf v[40:43],a[136:139],a[200:203]
v_mul_f32 v34, s37, v34
v_mul_f32 v35, s37, v35
mf v[40:43],a[140:143],a[216:219]
cv v32,v32,v33
cv v33,v34,v35
mf v[44:47],a[140:143],a[220:223]
ds_write_b64 v4, v[32:33] offset:16384
mf v[44:47],a[136:139],a[204:207]
v_mul_f32 v36, s37, v36
v_mul_f32 v37, s37, v37
mf v[44:47],a[132:135],a[188:191]
v_mul_f32 v38, s37, v38
v_mul_f32 v39, s37, v39
mf v[44:47],a[128:131],a[172:175]
s_waitcnt lgkmcnt(1)
cv v36,v36,v37
cv v37,v38,v39
mf v[60:63],a[144:147],a[172:175]
tr a[128:129],v12,49152
mf v[60:63],a[148:151],a[188:191]
tr a[130:131],v12,49664
v_mul_f32 v40, s37, v40
mf v[60:63],a[152:155],a[204:207]
tr a[132:133],v12,53248
v_mul_f32 v41, s37, v41
mf v[60:63],a[156:159],a[220:223]
tr a[134:135],v12,53760
v_mul_f32 v42, s37, v42
mf v[56:59],a[156:159],a[216:219]
tr a[136:137],v12,57344
v_mul_f32 v43, s37, v43
mf v[56:59],a[152:155],a[200:203]
tr a[138:139],v12,57856
cv v40,v40,v41
mf v[56:59],a[148:151],a[184:187]
tr a[140:141],v12,61440
cv v41,v42,v43
mf v[56:59],a[144:147],a[168:171]
tr a[142:143],v12,61952
v_mul_f32 v44, s37, v44
mf v[52:55],a[144:147],a[164:167]
ds_write_b64 v4, v[36:37] offset:17408
mf v[52:55],a[148:151],a[180:183]
v_mul_f32 v45, s37, v45
v_mul_f32 v46, s37, v46
mf v[52:55],a[152:155],a[196:199]
ds_write_b64 v4, v[40:41] offset:18432
mf v[52:55],a[156:159],a[212:215]
v_mul_f32 v47, s37, v47
cv v44,v44,v45
mf v[48:51],a[156:159],a[208:211]
cv v45,v46,v47
v_mul_f32 v60, s37, v60
mf v[48:51],a[152:155],a[192:195]
v_mul_f32 v61, s37, v61
v_mul_f32 v62, s37, v62
mf v[48:51],a[148:151],a[176:179]
v_mul_f32 v63, s37, v63
cv v60,v60,v61
mf v[48:51],a[144:147],a[160:163]
s_waitcnt lgkmcnt(2)
cv v61,v62,v63
v_mul_f32 v56, s37, v56
mf v[64:67],a[128:131],a[160:163]
tr a[144:145],v12,49160
v_mul_f32 v57, s37, v57
mf v[64:67],a[132:135],a[176:179]
tr a[146:147],v12,49672
v_mul_f32 v58, s37, v58
mf v[64:67],a[136:139],a[192:195]
tr a[148:149],v12,53256
v_mul_f32 v59, s37, v59
mf v[64:67],a[140:143],a[208:211]
tr a[150:151],v12,53768
cv v56,v56,v57
mf v[68:71],a[140:143],a[212:215]
tr a[152:153],v12,57352
cv v57,v58,v59
mf v[68:71],a[136:139],a[196:199]
tr a[154:155],v12,57864
v_mul_f32 v52, s37, v52
mf v[68:71],a[132:135],a[180:183]
tr a[156:157],v12,61448
v_mul_f32 v53, s37, v53
mf v[68:71],a[128:131],a[164:167]
tr a[158:159],v12,61960
v_mul_f32 v54, s37, v54
mf v[72:75],a[128:131],a[168:171]
ds_write_b64 v4, v[44:45] offset:19456
mf v[72:75],a[132:135],a[184:187]
v_mul_f32 v55, s37, v55
cv v52,v52,v53
mf v[72:75],a[136:139],a[200:203]
ds_write_b64 v4, v[60:61] offset:19464
mf v[72:75],a[140:143],a[216:219]
cv v53,v54,v55
v_mul_f32 v48, s37, v48
mf v[76:79],a[140:143],a[220:223]
ds_write_b64 v4, v[56:57] offset:18440
mf v[76:79],a[136:139],a[204:207]
v_mul_f32 v49, s37, v49
v_mul_f32 v50, s37, v50
mf v[76:79],a[132:135],a[188:191]
v_mul_f32 v51, s37, v51
cv v48,v48,v49
mf v[76:79],a[128:131],a[172:175]
s_waitcnt lgkmcnt(3)
cv v49,v50,v51
v_mul_f32 v64, s37, v64
mf v[92:95],a[144:147],a[172:175]
s_barrier
v_mul_f32 v65, s37, v65
v_mul_f32 v66, s37, v66
mf v[92:95],a[148:151],a[188:191]
tr a[128:129],v11,0
v_mul_f32 v67, s37, v67
mf v[92:95],a[152:155],a[204:207]
tr a[130:131],v11,512
cv v64,v64,v65
mf v[92:95],a[156:159],a[220:223]
tr a[132:133],v11,4096
cv v65,v66,v67
mf v[88:91],a[156:159],a[216:219]
tr a[134:135],v11,4608
v_mul_f32 v68, s37, v68
mf v[88:91],a[152:155],a[200:203]
tr a[136:137],v11,8192
v_mul_f32 v69, s37, v69
mf v[88:91],a[148:151],a[184:187]
tr a[138:139],v11,8704
v_mul_f32 v70, s37, v70
mf v[88:91],a[144:147],a[168:171]
tr a[140:141],v11,12288
v_mul_f32 v71, s37, v71
mf v[84:87],a[144:147],a[164:167]
tr a[142:143],v11,12800
cv v68,v68,v69
mf v[84:87],a[148:151],a[180:183]
cv v69,v70,v71
v_mul_f32 v72, s37, v72
mf v[84:87],a[152:155],a[196:199]
ds_write_b64 v4, v[52:53] offset:17416
mf v[84:87],a[156:159],a[212:215]
v_mul_f32 v73, s37, v73
v_mul_f32 v74, s37, v74
mf v[80:83],a[156:159],a[208:211]
ds_write_b64 v4, v[48:49] offset:16392
mf v[80:83],a[152:155],a[192:195]
v_mul_f32 v75, s37, v75
cv v72,v72,v73
mf v[80:83],a[148:151],a[176:179]
cv v73,v74,v75
v_mul_f32 v76, s37, v76
mf v[80:83],a[144:147],a[160:163]
s_waitcnt lgkmcnt(2)
v_mul_f32 v77, s37, v77
v_mul_f32 v78, s37, v78
mz v[32:35],a[128:131],v[96:99],0
tr a[144:145],v11,8
v_mul_f32 v79, s37, v79
mf v[32:35],a[132:135],v[112:115]
tr a[146:147],v11,520
cv v76,v76,v77
mf v[32:35],a[136:139],v[128:131]
tr a[148:149],v11,4104
cv v77,v78,v79
mf v[32:35],a[140:143],v[144:147]
tr a[150:151],v11,4616
v_mul_f32 v92, s37, v92
mz v[36:39],a[140:143],v[148:151],0
tr a[152:153],v11,8200
v_mul_f32 v93, s37, v93
mf v[36:39],a[136:139],v[132:135]
tr a[154:155],v11,8712
v_mul_f32 v94, s37, v94
mf v[36:39],a[132:135],v[116:119]
tr a[156:157],v11,12296
v_mul_f32 v95, s37, v95
mf v[36:39],a[128:131],v[100:103]
tr a[158:159],v11,12808
cv v92,v92,v93
mz v[40:43],a[128:131],v[104:107],0
ds_write_b64 v4, v[64:65] offset:20480
mf v[40:43],a[132:135],v[120:123]
cv v93,v94,v95
v_mul_f32 v88, s37, v88
mf v[40:43],a[136:139],v[136:139]
ds_write_b64 v4, v[68:69] offset:21504
mf v[40:43],a[140:143],v[152:155]
v_mul_f32 v89, s37, v89
v_mul_f32 v90, s37, v90
mz v[44:47],a[140:143],v[156:159],0
ds_write_b64 v4, v[72:73] offset:22528
mf v[44:47],a[136:139],v[140:143]
v_mul_f32 v91, s37, v91
cv v88,v88,v89
mf v[44:47],a[132:135],v[124:127]
cv v89,v90,v91
v_mul_f32 v84, s37, v84
mf v[44:47],a[128:131],v[108:111]
s_waitcnt lgkmcnt(3)
v_mul_f32 v85, s37, v85
v_mul_f32 v86, s37, v86
mz v[60:63],a[144:147],v[108:111],0
tr a[128:129],v12,0
v_mul_f32 v87, s37, v87
mf v[60:63],a[148:151],v[124:127]
tr a[130:131],v12,512
cv v84,v84,v85
mf v[60:63],a[152:155],v[140:143]
tr a[132:133],v12,4096
cv v85,v86,v87
mf v[60:63],a[156:159],v[156:159]
tr a[134:135],v12,4608
v_mul_f32 v80, s37, v80
mz v[56:59],a[156:159],v[152:155],0
tr a[136:137],v12,8192
v_mul_f32 v81, s37, v81
mf v[56:59],a[152:155],v[136:139]
tr a[138:139],v12,8704
v_mul_f32 v82, s37, v82
mf v[56:59],a[148:151],v[120:123]
tr a[140:141],v12,12288
v_mul_f32 v83, s37, v83
mf v[56:59],a[144:147],v[104:107]
tr a[142:143],v12,12800
cv v80,v80,v81
mz v[52:55],a[144:147],v[100:103],0
ds_write_b64 v4, v[76:77] offset:23552
mf v[52:55],a[148:151],v[116:119]
cv v81,v82,v83
mf v[52:55],a[152:155],v[132:135]
ds_write_b64 v4, v[92:93] offset:23560
mf v[52:55],a[156:159],v[148:151]
mz v[48:51],a[156:159],v[144:147],0
ds_write_b64 v4, v[88:89] offset:22536
mf v[48:51],a[152:155],v[128:131]
mf v[48:51],a[148:151],v[112:115]
mf v[48:51],a[144:147],v[96:99]
s_waitcnt lgkmcnt(3)
mz v[64:67],a[128:131],v[96:99],0
tr a[144:145],v12,8
mf v[64:67],a[132:135],v[112:115]
tr a[146:147],v12,520
mf v[64:67],a[136:139],v[128:131]
tr a[148:149],v12,4104
mf v[64:67],a[140:143],v[144:147]
tr a[150:151],v12,4616
mz v[68:71],a[140:143],v[148:151],0
tr a[152:153],v12,8200
mf v[68:71],a[136:139],v[132:135]
tr a[154:155],v12,8712
mf v[68:71],a[132:135],v[116:119]
tr a[156:157],v12,12296
mf v[68:71],a[128:131],v[100:103]
tr a[158:159],v12,12808
mz v[72:75],a[128:131],v[104:107],0
ds_write_b64 v4, v[84:85] offset:21512
mf v[72:75],a[132:135],v[120:123]
mf v[72:75],a[136:139],v[136:139]
ds_write_b64 v4, v[80:81] offset:20488
mf v[72:75],a[140:143],v[152:155]
mz v[76:79],a[140:143],v[156:159],0
mf v[76:79],a[136:139],v[140:143]
mf v[76:79],a[132:135],v[124:127]
mf v[76:79],a[128:131],v[108:111]
s_waitcnt lgkmcnt(2)
mz v[92:95],a[144:147],v[108:111],0
s_barrier
mf v[92:95],a[148:151],v[124:127]
tr a[128:129],v11,16384
mf v[92:95],a[152:155],v[140:143]
tr a[130:131],v11,16896
mf v[92:95],a[156:159],v[156:159]
tr a[132:133],v11,20480
mz v[88:91],a[156:159],v[152:155],0
tr a[134:135],v11,20992
mf v[88:91],a[152:155],v[136:139]
tr a[136:137],v11,20488
mf v[88:91],a[148:151],v[120:123]
tr a[138:139],v11,21000
mf v[88:91],a[144:147],v[104:107]
tr a[140:141],v11,16392
mz v[84:87],a[144:147],v[100:103],0
tr a[142:143],v11,16904
mf v[84:87],a[148:151],v[116:119]
mf v[84:87],a[152:155],v[132:135]
mf v[84:87],a[156:159],v[148:151]
mz v[80:83],a[156:159],v[144:147],0
mf v[80:83],a[152:155],v[128:131]
mf v[80:83],a[148:151],v[112:115]
mf v[80:83],a[144:147],v[96:99]
wl
mf v[32:35],a[128:131],v[160:163]
tr a[144:145],v12,16384
mf v[32:35],a[132:135],v[176:179]
tr a[146:147],v12,16896
mf v[48:51],a[136:139],v[176:179]
tr a[148:149],v12,20480
mf v[48:51],a[140:143],v[160:163]
tr a[150:151],v12,20992
mf v[52:55],a[140:143],v[164:167]
tr a[152:153],v12,20488
mf v[52:55],a[136:139],v[180:183]
tr a[154:155],v12,21000
mf v[36:39],a[132:135],v[180:183]
tr a[156:157],v12,16392
mf v[36:39],a[128:131],v[164:167]
tr a[158:159],v12,16904
mf v[40:43],a[128:131],v[168:171]
mf v[40:43],a[132:135],v[184:187]
mf v[56:59],a[136:139],v[184:187]
mf v[56:59],a[140:143],v[168:171]
mf v[60:63],a[140:143],v[172:175]
mf v[60:63],a[136:139],v[188:191]
mf v[44:47],a[132:135],v[188:191]
mf v[44:47],a[128:131],v[172:175]
wl
mf v[76:79],a[144:147],v[172:175]
s_barrier
mf v[76:79],a[148:151],v[188:191]
tr a[128:129],v11,32768
mf v[92:95],a[152:155],v[188:191]
tr a[130:131],v11,33280
mf v[92:95],a[156:159],v[172:175]
tr a[132:133],v11,36864
mf v[88:91],a[156:159],v[168:171]
tr a[134:135],v11,37376
mf v[88:91],a[152:155],v[184:187]
tr a[136:137],v11,40960
mf v[72:75],a[148:151],v[184:187]
tr a[138:139],v11,41472
mf v[72:75],a[144:147],v[168:171]
tr a[140:141],v11,45056
mf v[68:71],a[144:147],v[164:167]
tr a[142:143],v11,45568
mf v[68:71],a[148:151],v[180:183]
mf v[84:87],a[152:155],v[180:183]
mf v[84:87],a[156:159],v[164:167]
mf v[80:83],a[156:159],v[160:163]
mf v[80:83],a[152:155],v[176:179]
mf v[64:67],a[148:151],v[176:179]
mf v[64:67],a[144:147],v[160:163]
wl
mf v[32:35],a[128:131],v[192:195]
tr a[144:145],v11,32776
mf v[32:35],a[132:135],v[208:211]
tr a[146:147],v11,33288
mf v[32:35],a[136:139],v[224:227]
tr a[148:149],v11,36872
mf v[32:35],a[140:143],v[240:243]
tr a[150:151],v11,37384
mf v[36:39],a[140:143],v[244:247]
tr a[152:153],v11,40968
mf v[36:39],a[136:139],v[228:231]
tr a[154:155],v11,41480
mf v[36:39],a[132:135],v[212:215]
tr a[156:157],v11,45064
mf v[36:39],a[128:131],v[196:199]
tr a[158:159],v11,45576
mf v[40:43],a[128:131],v[200:203]
mf v[40:43],a[132:135],v[216:219]
mf v[40:43],a[136:139],v[232:235]
mf v[40:43],a[140:143],v[248:251]
mf v[44:47],a[140:143],v[252:255]
mf v[44:47],a[136:139],v[236:239]
mf v[44:47],a[132:135],v[220:223]
mf v[44:47],a[128:131],v[204:207]
wl
mf v[60:63],a[144:147],v[204:207]
tr a[128:129],v12,32768
mf v[60:63],a[148:151],v[220:223]
tr a[130:131],v12,33280
mf v[60:63],a[152:155],v[236:239]
tr a[132:133],v12,36864
mf v[60:63],a[156:159],v[252:255]
tr a[134:135],v12,37376
mf v[56:59],a[156:159],v[248:251]
tr a[136:137],v12,40960
mf v[56:59],a[152:155],v[232:235]
tr a[138:139],v12,41472
mf v[56:59],a[148:151],v[216:219]
tr a[140:141],v12,45056
mf v[56:59],a[144:147],v[200:203]
tr a[142:143],v12,45568
mf v[52:55],a[144:147],v[196:199]
mf v[52:55],a[148:151],v[212:215]
mf v[52:55],a[152:155],v[228:231]
mf v[52:55],a[156:159],v[244:247]
mf v[48:51],a[156:159],v[240:243]
mf v[48:51],a[152:155],v[224:227]
mf v[48:51],a[148:151],v[208:211]
mf v[48:51],a[144:147],v[192:195]
wl
mf v[64:67],a[128:131],v[192:195]
tr a[144:145],v12,32776
mf v[64:67],a[132:135],v[208:211]
tr a[146:147],v12,33288
mf v[64:67],a[136:139],v[224:227]
tr a[148:149],v12,36872
mf v[64:67],a[140:143],v[240:243]
tr a[150:151],v12,37384
mf v[68:71],a[140:143],v[244:247]
tr a[152:153],v12,40968
mf v[68:71],a[136:139],v[228:231]
tr a[154:155],v12,41480
mf v[68:71],a[132:135],v[212:215]
tr a[156:157],v12,45064
mf v[68:71],a[128:131],v[196:199]
tr a[158:159],v12,45576
mf v[72:75],a[128:131],v[200:203]
mf v[72:75],a[132:135],v[216:219]
mf v[72:75],a[136:139],v[232:235]
mf v[72:75],a[140:143],v[248:251]
mf v[76:79],a[140:143],v[252:255]
mf v[76:79],a[136:139],v[236:239]
mf v[76:79],a[132:135],v[220:223]
mf v[76:79],a[128:131],v[204:207]
wl
mf v[92:95],a[144:147],v[204:207]
s_barrier
mf v[92:95],a[148:151],v[220:223]
tr a[128:129],v11,49152
mf v[92:95],a[152:155],v[236:239]
tr a[130:131],v11,49664
mf v[92:95],a[156:159],v[252:255]
tr a[132:133],v11,53248
mf v[88:91],a[156:159],v[248:251]
tr a[134:135],v11,53760
mf v[88:91],a[152:155],v[232:235]
tr a[136:137],v11,57344
mf v[88:91],a[148:151],v[216:219]
tr a[138:139],v11,57856
mf v[88:91],a[144:147],v[200:203]
tr a[140:141],v11,61440
mf v[84:87],a[144:147],v[196:199]
tr a[142:143],v11,61952
mf v[84:87],a[148:151],v[212:215]
mf v[84:87],a[152:155],v[228:231]
mf v[84:87],a[156:159],v[244:247]
mf v[80:83],a[156:159],v[240:243]
mf v[80:83],a[152:155],v[224:227]
mf v[80:83],a[148:151],v[208:211]
mf v[80:83],a[144:147],v[192:195]
wl
mf v[32:35],a[128:131],a[160:163]
tr a[144:145],v11,49160
mf v[32:35],a[132:135],a[176:179]
tr a[146:147],v11,49672
mf v[32:35],a[136:139],a[192:195]
tr a[148:149],v11,53256
mf v[32:35],a[140:143],a[208:211]
tr a[150:151],v11,53768
mf v[36:39],a[140:143],a[212:215]
tr a[152:153],v11,57352
mf v[36:39],a[136:139],a[196:199]
tr a[154:155],v11,57864
mf v[36:39],a[132:135],a[180:183]
tr a[156:157],v11,61448
mf v[36:39],a[128:131],a[164:167]
tr a[158:159],v11,61960
mf v[40:43],a[128:131],a[168:171]
mf v[40:43],a[132:135],a[184:187]
v_mul_f32 v32, s37, v32
v_mul_f32 v33, s37, v33
mf v[40:43],a[136:139],a[200:203]
v_mul_f32 v34, s37, v34
v_mul_f32 v35, s37, v35
mf v[40:43],a[140:143],a[216:219]
cv v32,v32,v33
cv v33,v34,v35
mf v[44:47],a[140:143],a[220:223]
ds_write_b64 v4, v[32:33] offset:24576
mf v[44:47],a[136:139],a[204:207]
v_mul_f32 v36, s37, v36
v_mul_f32 v37, s37, v37
mf v[44:47],a[132:135],a[188:191]
v_mul_f32 v38, s37, v38
v_mul_f32 v39, s37, v39
mf v[44:47],a[128:131],a[172:175]
s_waitcnt lgkmcnt(1)
cv v36,v36,v37
cv v37,v38,v39
mf v[48:51],a[144:147],a[160:163]
tr a[128:129],v12,49152
mf v[48:51],a[148:151],a[176:179]
tr a[130:131],v12,49664
v_mul_f32 v40, s37, v40
mf v[48:51],a[152:155],a[192:195]
tr a[132:133],v12,53248
v_mul_f32 v41, s37, v41
mf v[48:51],a[156:159],a[208:211]
tr a[134:135],v12,53760
v_mul_f32 v42, s37, v42
mf v[52:55],a[156:159],a[212:215]
tr a[136:137],v12,57344
v_mul_f32 v43, s37, v43
mf v[52:55],a[152:155],a[196:199]
tr a[138:139],v12,57856
cv v40,v40,v41
mf v[52:55],a[148:151],a[180:183]
tr a[140:141],v12,61440
cv v41,v42,v43
mf v[52:55],a[144:147],a[164:167]
tr a[142:143],v12,61952
v_mul_f32 v44, s37, v44
mf v[56:59],a[144:147],a[168:171]
ds_write_b64 v4, v[36:37] offset:25600
mf v[56:59],a[148:151],a[184:187]
v_mul_f32 v45, s37, v45
v_mul_f32 v46, s37, v46
mf v[56:59],a[152:155],a[200:203]
ds_write_b64 v4, v[40:41] offset:26624
mf v[56:59],a[156:159],a[216:219]
v_mul_f32 v47, s37, v47
cv v44,v44,v45
mf v[60:63],a[156:159],a[220:223]
cv v45,v46,v47
v_mul_f32 v48, s37, v48
mf v[60:63],a[152:155],a[204:207]
v_mul_f32 v49, s37, v49
v_mul_f32 v50, s37, v50
mf v[60:63],a[148:151],a[188:191]
v_mul_f32 v51, s37, v51
cv v48,v48,v49
mf v[60:63],a[144:147],a[172:175]
s_waitcnt lgkmcnt(2)
cv v49,v50,v51
v_mul_f32 v52, s37, v52
mf v[64:67],a[128:131],a[160:163]
tr a[144:145],v12,49160
v_mul_f32 v53, s37, v53
mf v[64:67],a[132:135],a[176:179]
tr a[146:147],v12,49672
v_mul_f32 v54, s37, v54
mf v[64:67],a[136:139],a[192:195]
tr a[148:149],v12,53256
v_mul_f32 v55, s37, v55
mf v[64:67],a[140:143],a[208:211]
tr a[150:151],v12,53768
cv v52,v52,v53
mf v[68:71],a[140:143],a[212:215]
tr a[152:153],v12,57352
cv v53,v54,v55
mf v[68:71],a[136:139],a[196:199]
tr a[154:155],v12,57864
v_mul_f32 v56, s37, v56
mf v[68:71],a[132:135],a[180:183]
tr a[156:157],v12,61448
v_mul_f32 v57, s37, v57
mf v[68:71],a[128:131],a[164:167]
tr a[158:159],v12,61960
v_mul_f32 v58, s37, v58
mf v[72:75],a[128:131],a[168:171]
ds_write_b64 v4, v[44:45] offset:27648
mf v[72:75],a[132:135],a[184:187]
v_mul_f32 v59, s37, v59
cv v56,v56,v57
mf v[72:75],a[136:139],a[200:203]
ds_write_b64 v4, v[48:49] offset:24584
mf v[72:75],a[140:143],a[216:219]
cv v57,v58,v59
v_mul_f32 v60, s37, v60
mf v[76:79],a[140:143],a[220:223]
ds_write_b64 v4, v[52:53] offset:25608
mf v[76:79],a[136:139],a[204:207]
v_mul_f32 v61, s37, v61
v_mul_f32 v62, s37, v62
mf v[76:79],a[132:135],a[188:191]
v_mul_f32 v63, s37, v63
cv v60,v60,v61
mf v[76:79],a[128:131],a[172:175]
s_waitcnt lgkmcnt(3)
cv v61,v62,v63
v_mul_f32 v64, s37, v64
mf v[80:83],a[144:147],a[160:163]
s_barrier
v_mul_f32 v65, s37, v65
v_mul_f32 v66, s37, v66
mf v[80:83],a[148:151],a[176:179]
ds_read_b128 a[128:131], v5 offset:0
v_mul_f32 v67, s37, v67
mf v[80:83],a[152:155],a[192:195]
ds_read_b128 a[132:135], v6 offset:0
cv v64,v64,v65
mf v[80:83],a[156:159],a[208:211]
ds_read_b128 a[136:139], v5 offset:1024
cv v65,v66,v67
mf v[84:87],a[156:159],a[212:215]
ds_read_b128 a[140:143], v6 offset:1024
v_mul_f32 v68, s37, v68
mf v[84:87],a[152:155],a[196:199]
v_mul_f32 v69, s37, v69
v_mul_f32 v70, s37, v70
mf v[84:87],a[148:151],a[180:183]
v_mul_f32 v71, s37, v71
cv v68,v68,v69
mf v[84:87],a[144:147],a[164:167]
cv v69,v70,v71
v_mul_f32 v72, s37, v72
mf v[88:91],a[144:147],a[168:171]
ds_write_b64 v4, v[56:57] offset:26632
mf v[88:91],a[148:151],a[184:187]
v_mul_f32 v73, s37, v73
v_mul_f32 v74, s37, v74
mf v[88:91],a[152:155],a[200:203]
ds_write_b64 v4, v[60:61] offset:27656
mf v[88:91],a[156:159],a[216:219]
v_mul_f32 v75, s37, v75
cv v72,v72,v73
mf v[92:95],a[156:159],a[220:223]
ds_write_b64 v4, v[64:65] offset:28672
mf v[92:95],a[152:155],a[204:207]
cv v73,v74,v75
v_mul_f32 v76, s37, v76
mf v[92:95],a[148:151],a[188:191]
v_mul_f32 v77, s37, v77
v_mul_f32 v78, s37, v78
mf v[92:95],a[144:147],a[172:175]
s_waitcnt lgkmcnt(3)
v_mul_f32 v79, s37, v79
cv v76,v76,v77
mz v[48:51],a[128:131],a[0:3],0
ds_read_b128 a[144:147], v5 offset:2048
cv v77,v78,v79
mf v[48:51],a[132:135],a[16:19]
ds_read_b128 a[148:151], v6 offset:2048
v_mul_f32 v80, s37, v80
mf v[48:51],a[136:139],a[32:35]
ds_read_b128 a[152:155], v5 offset:3072
v_mul_f32 v81, s37, v81
mf v[48:51],a[140:143],a[48:51]
ds_read_b128 a[156:159], v6 offset:3072
v_mul_f32 v82, s37, v82
mz v[52:55],a[140:143],a[52:55],0
v_mul_f32 v83, s37, v83
cv v80,v80,v81
mf v[52:55],a[136:139],a[36:39]
cv v81,v82,v83
v_mul_f32 v84, s37, v84
mf v[52:55],a[132:135],a[20:23]
v_mul_f32 v85, s37, v85
v_mul_f32 v86, s37, v86
mf v[52:55],a[128:131],a[4:7]
v_mul_f32 v87, s37, v87
cv v84,v84,v85
mz v[56:59],a[128:131],a[8:11],0
ds_write_b64 v4, v[68:69] offset:29696
mf v[56:59],a[132:135],a[24:27]
cv v85,v86,v87
v_mul_f32 v88, s37, v88
mf v[56:59],a[136:139],a[40:43]
ds_write_b64 v4, v[72:73] offset:30720
mf v[56:59],a[140:143],a[56:59]
v_mul_f32 v89, s37, v89
v_mul_f32 v90, s37, v90
mz v[60:63],a[140:143],a[60:63],0
ds_write_b64 v4, v[76:77] offset:31744
mf v[60:63],a[136:139],a[44:47]
v_mul_f32 v91, s37, v91
cv v88,v88,v89
mf v[60:63],a[132:135],a[28:31]
cv v89,v90,v91
v_mul_f32 v92, s37, v92
mf v[60:63],a[128:131],a[12:15]
s_waitcnt lgkmcnt(3)
v_mul_f32 v93, s37, v93
v_mul_f32 v94, s37, v94
mf v[60:63],a[144:147],a[76:79]
ds_read_b128 a[128:131], v5 offset:10240
v_mul_f32 v95, s37, v95
mf v[60:63],a[148:151],a[92:95]
ds_read_b128 a[132:135], v6 offset:10240
cv v92,v92,v93
mf v[60:63],a[152:155],a[108:111]
ds_read_b128 a[136:139], v5 offset:11264
cv v93,v94,v95
mf v[60:63],a[156:159],a[124:127]
ds_read_b128 a[140:143], v6 offset:11264
v_mov_b32 v32, 0
mf v[56:59],a[156:159],a[120:123]
v_mov_b32 v33, 0
v_mov_b32 v34, 0
mf v[56:59],a[152:155],a[104:107]
v_mov_b32 v35, 0
v_mov_b32 v36, 0
mf v[56:59],a[148:151],a[88:91]
v_mov_b32 v37, 0
v_mov_b32 v38, 0
mf v[56:59],a[144:147],a[72:75]
v_mov_b32 v39, 0
v_mov_b32 v40, 0
mf v[52:55],a[144:147],a[68:71]
ds_write_b64 v4, v[80:81] offset:28680
mf v[52:55],a[148:151],a[84:87]
v_mov_b32 v41, 0
v_mov_b32 v42, 0
mf v[52:55],a[152:155],a[100:103]
v_exp_f32 v60, v60
mf v[52:55],a[156:159],a[116:119]
v_exp_f32 v61, v61
mf v[48:51],a[156:159],a[112:115]
v_exp_f32 v62, v62
mf v[48:51],a[152:155],a[96:99]
v_exp_f32 v63, v63
mf v[48:51],a[148:151],a[80:83]
v_exp_f32 v56, v56
mf v[48:51],a[144:147],a[64:67]
s_waitcnt lgkmcnt(1)
v_exp_f32 v57, v57
mz v[80:83],a[128:131],a[64:67],0
ds_read_b128 a[144:147], v5 offset:8192
v_add_f32 v27, v60, v61
mf v[80:83],a[132:135],a[80:83]
ds_write_b64 v4, v[84:85] offset:29704
mf v[80:83],a[136:139],a[96:99]
ds_read_b128 a[148:151], v6 offset:8192
cv v60,v60,v61
mf v[80:83],a[140:143],a[112:115]
ds_read_b128 a[152:155], v5 offset:9216
v_add_f32 v27, v62, v27
mz v[84:87],a[140:143],a[116:119],0
ds_read_b128 a[156:159], v6 offset:9216
v_add_f32 v27, v63, v27
mf v[84:87],a[136:139],a[100:103]
ds_write_b64 v4, v[88:89] offset:30728
mf v[84:87],a[132:135],a[84:87]
v_exp_f32 v58, v58
mf v[84:87],a[128:131],a[68:71]
v_exp_f32 v59, v59
mz v[88:91],a[128:131],a[72:75],0
v_exp_f32 v52, v52
mf v[88:91],a[132:135],a[88:91]
ds_write_b64 v4, v[92:93] offset:31752
mf v[88:91],a[136:139],a[104:107]
v_exp_f32 v53, v53
mf v[88:91],a[140:143],a[120:123]
v_exp_f32 v54, v54
mz v[92:95],a[140:143],a[124:127],0
v_exp_f32 v55, v55
mf v[92:95],a[136:139],a[108:111]
v_exp_f32 v48, v48
mf v[92:95],a[132:135],a[92:95]
v_exp_f32 v49, v49
mf v[92:95],a[128:131],a[76:79]
s_waitcnt lgkmcnt(2)
v_exp_f32 v50, v50
mf v[92:95],a[144:147],a[12:15]
s_barrier
v_exp_f32 v51, v51
mf v[92:95],a[148:151],a[28:31]
ds_read_b128 a[128:131], v5 offset:16384
cv v61,v62,v63
mf v[92:95],a[152:155],a[44:47]
ds_read_b128 a[132:135], v6 offset:16384
v_add_f32 v26, v56, v57
mf v[92:95],a[156:159],a[60:63]
ds_read_b128 a[136:139], v5 offset:17408
cv v56,v56,v57
mf v[88:91],a[156:159],a[56:59]
ds_read_b128 a[140:143], v6 offset:17408
v_add_f32 v26, v58, v26
mf v[88:91],a[152:155],a[40:43]
v_add_f32 v26, v59, v26
cv v57,v58,v59
mf v[88:91],a[148:151],a[24:27]
v_add_f32 v25, v52, v53
cv v52,v52,v53
mf v[88:91],a[144:147],a[8:11]
v_add_f32 v25, v54, v25
v_add_f32 v25, v55, v25
mf v[84:87],a[144:147],a[4:7]
v_add_f32 v24, v48, v49
cv v53,v54,v55
mf v[84:87],a[148:151],a[20:23]
cv v48,v48,v49
v_add_f32 v24, v50, v24
mf v[84:87],a[152:155],a[36:39]
v_exp_f32 v92, v92
mf v[84:87],a[156:159],a[52:55]
v_exp_f32 v93, v93
mf v[80:83],a[156:159],a[48:51]
v_exp_f32 v94, v94
mf v[80:83],a[152:155],a[32:35]
v_exp_f32 v95, v95
mf v[80:83],a[148:151],a[16:19]
v_exp_f32 v88, v88
mf v[80:83],a[144:147],a[0:3]
wl
v_exp_f32 v89, v89
mz v[64:67],a[128:131],a[0:3],0
ds_read_b128 a[144:147], v5 offset:18432
v_add_f32 v27, v92, v27
mf v[64:67],a[132:135],a[16:19]
ds_read_b128 a[148:151], v6 offset:18432
v_add_f32 v27, v93, v27
mf v[64:67],a[136:139],a[32:35]
ds_read_b128 a[152:155], v5 offset:19456
cv v62,v92,v93
mf v[64:67],a[140:143],a[48:51]
ds_read_b128 a[156:159], v6 offset:19456
v_add_f32 v27, v94, v27
mz v[68:71],a[140:143],a[52:55],0
v_exp_f32 v90, v90
mf v[68:71],a[136:139],a[36:39]
v_exp_f32 v91, v91
mf v[68:71],a[132:135],a[20:23]
v_exp_f32 v84, v84
mf v[68:71],a[128:131],a[4:7]
v_exp_f32 v85, v85
mz v[72:75],a[128:131],a[8:11],0
v_exp_f32 v86, v86
mf v[72:75],a[132:135],a[24:27]
v_exp_f32 v87, v87
mf v[72:75],a[136:139],a[40:43]
v_exp_f32 v80, v80
mf v[72:75],a[140:143],a[56:59]
v_exp_f32 v81, v81
mz v[76:79],a[140:143],a[60:63],0
v_exp_f32 v82, v82
mf v[76:79],a[136:139],a[44:47]
v_exp_f32 v83, v83
mf v[76:79],a[132:135],a[28:31]
v_add_f32 v27, v95, v27
cv v63,v94,v95
mf v[76:79],a[128:131],a[12:15]
wl
v_add_f32 v26, v88, v26
v_add_f32 v26, v89, v26
mf v[76:79],a[144:147],a[76:79]
ds_read_b128 a[128:131], v5 offset:26624
cv v58,v88,v89
mf v[76:79],a[148:151],a[92:95]
ds_read_b128 a[132:135], v6 offset:26624
v_add_f32 v26, v90, v26
mf v[76:79],a[152:155],a[108:111]
ds_read_b128 a[136:139], v5 offset:27648
v_add_f32 v26, v91, v26
mf v[76:79],a[156:159],a[124:127]
ds_read_b128 a[140:143], v6 offset:27648
cv v59,v90,v91
mf v[72:75],a[156:159],a[120:123]
v_add_f32 v25, v84, v25
v_add_f32 v25, v85, v25
mf v[72:75],a[152:155],a[104:107]
cv v54,v84,v85
v_add_f32 v25, v86, v25
mf v[72:75],a[148:151],a[88:91]
v_add_f32 v25, v87, v25
cv v55,v86,v87
mf v[72:75],a[144:147],a[72:75]
v_add_f32 v24, v51, v24
cv v49,v50,v51
mf v[68:71],a[144:147],a[68:71]
v_add_f32 v24, v80, v24
v_add_f32 v24, v81, v24
mf v[68:71],a[148:151],a[84:87]
cv v50,v80,v81
v_add_f32 v24, v82, v24
v_add_f32 v24, v83, v24
cv v51,v82,v83
mf v[68:71],a[152:155],a[100:103]
v_min3_f32 v0, v24, v25, v26
v_min_f32 v0, v0, v27
mf v[68:71],a[156:159],a[116:119]
v_cmp_gt_f32 s[72:73], s55, v0
v_max3_f32 v0, v24, v25, v26
mf v[64:67],a[156:159],a[112:115]
v_mov_b32 v43, 0
v_mov_b32 v44, 0
v_mov_b32 v45, 0
v_mov_b32 v46, 0
v_mov_b32 v47, 0
mf v[64:67],a[152:155],a[96:99]
v_max_f32 v0, v0, v27
v_cmp_lt_f32 vcc, s36, v0
mf v[64:67],a[148:151],a[80:83]
mf v[64:67],a[144:147],a[64:67]
wl
s_or_b64 s[72:73], s[72:73], vcc
s_cbranch_scc1 Lslow_fronth_a
Lret_fronth_a:
mz v[80:83],a[128:131],a[64:67],v[32:35]
s_add_u32 s43, s43, 16384
ds_read_b128 a[144:147], v5 offset:24576
mf v[80:83],a[132:135],a[80:83]
ds_read_b128 a[148:151], v6 offset:24576
mf v[80:83],a[136:139],a[96:99]
ds_read_b128 a[152:155], v5 offset:25600
mf v[80:83],a[140:143],a[112:115]
ds_read_b128 a[156:159], v6 offset:25600
mz v[84:87],a[140:143],a[116:119],v[36:39]
v_exp_f32 v76, v76
mf v[84:87],a[136:139],a[100:103]
v_exp_f32 v77, v77
mf v[84:87],a[132:135],a[84:87]
v_exp_f32 v78, v78
mf v[84:87],a[128:131],a[68:71]
v_exp_f32 v79, v79
mz v[88:91],a[128:131],a[72:75],v[40:43]
v_exp_f32 v72, v72
mf v[88:91],a[132:135],a[88:91]
v_exp_f32 v73, v73
mf v[88:91],a[136:139],a[104:107]
v_exp_f32 v74, v74
mf v[88:91],a[140:143],a[120:123]
v_exp_f32 v75, v75
mz v[92:95],a[140:143],a[124:127],v[44:47]
v_exp_f32 v68, v68
mf v[92:95],a[136:139],a[108:111]
v_exp_f32 v69, v69
mf v[92:95],a[132:135],a[92:95]
v_exp_f32 v70, v70
mf v[92:95],a[128:131],a[76:79]
wl
v_exp_f32 v71, v71
mf v[92:95],a[144:147],a[12:15]
s_barrier
v_exp_f32 v64, v64
mf v[92:95],a[148:151],a[28:31]
tr a[128:129],v7,32768
v_add_f32 v31, v76, v77
mf v[92:95],a[152:155],a[44:47]
tr a[130:131],v7,40960
cv v76,v76,v77
mf v[92:95],a[156:159],a[60:63]
tr a[132:133],v8,32768
v_add_f32 v31, v78, v31
mf v[88:91],a[156:159],a[56:59]
tr a[134:135],v8,40960
v_add_f32 v31, v79, v31
mf v[88:91],a[152:155],a[40:43]
tr a[136:137],v9,32768
cv v77,v78,v79
mf v[88:91],a[148:151],a[24:27]
tr a[138:139],v9,40960
v_add_f32 v30, v72, v73
mf v[88:91],a[144:147],a[8:11]
tr a[140:141],v10,32768
cv v72,v72,v73
mf v[84:87],a[144:147],a[4:7]
tr a[142:143],v10,40960
v_add_f32 v30, v74, v30
mf v[84:87],a[148:151],a[20:23]
v_exp_f32 v65, v65
mf v[84:87],a[152:155],a[36:39]
v_exp_f32 v66, v66
mf v[84:87],a[156:159],a[52:55]
v_exp_f32 v67, v67
mf v[80:83],a[156:159],a[48:51]
v_exp_f32 v92, v92
mf v[80:83],a[152:155],a[32:35]
v_exp_f32 v93, v93
mf v[80:83],a[148:151],a[16:19]
v_exp_f32 v94, v94
mf v[80:83],a[144:147],a[0:3]
wl
v_exp_f32 v95, v95
mz v[96:99],a[128:131],v[48:51],0
tr a[144:145],v7,33792
v_add_f32 v31, v92, v31
mz v[100:103],a[128:131],v[52:55],0
tr a[146:147],v7,41984
v_add_f32 v31, v93, v31
mz v[104:107],a[128:131],v[56:59],0
tr a[148:149],v8,33792
cv v78,v92,v93
mz v[108:111],a[128:131],v[60:63],0
tr a[150:151],v8,41984
v_add_f32 v31, v94, v31
mz v[112:115],a[132:135],v[48:51],0
tr a[152:153],v9,33792
v_add_f32 v31, v95, v31
mz v[116:119],a[132:135],v[52:55],0
tr a[154:155],v9,41984
cv v79,v94,v95
mz v[120:123],a[132:135],v[56:59],0
tr a[156:157],v10,33792
v_add_f32 v30, v75, v30
mz v[124:127],a[132:135],v[60:63],0
tr a[158:159],v10,41984
cv v73,v74,v75
mz v[128:131],a[136:139],v[48:51],0
v_exp_f32 v88, v88
mz v[132:135],a[136:139],v[52:55],0
v_exp_f32 v89, v89
mz v[136:139],a[136:139],v[56:59],0
v_exp_f32 v90, v90
mz v[140:143],a[136:139],v[60:63],0
v_exp_f32 v91, v91
mz v[144:147],a[140:143],v[48:51],0
v_exp_f32 v84, v84
mz v[148:151],a[140:143],v[52:55],0
v_exp_f32 v85, v85
mz v[152:155],a[140:143],v[56:59],0
v_exp_f32 v86, v86
mz v[156:159],a[140:143],v[60:63],0
wl
v_exp_f32 v87, v87
mz v[160:163],a[144:147],v[48:51],0
tr a[128:129],v7,34816
v_add_f32 v30, v88, v30
mz v[164:167],a[144:147],v[52:55],0
tr a[130:131],v7,43008
v_add_f32 v30, v89, v30
mz v[168:171],a[144:147],v[56:59],0
tr a[132:133],v8,34816
cv v74,v88,v89
mz v[172:175],a[144:147],v[60:63],0
tr a[134:135],v8,43008
v_add_f32 v30, v90, v30
mz v[176:179],a[148:151],v[48:51],0
tr a[136:137],v9,34816
v_add_f32 v30, v91, v30
mz v[180:183],a[148:151],v[52:55],0
tr a[138:139],v9,43008
cv v75,v90,v91
mz v[184:187],a[148:151],v[56:59],0
tr a[140:141],v10,34816
v_add_f32 v29, v68, v69
mz v[188:191],a[148:151],v[60:63],0
tr a[142:143],v10,43008
cv v68,v68,v69
mz v[192:195],a[152:155],v[48:51],0
v_exp_f32 v80, v80
mz v[196:199],a[152:155],v[52:55],0
v_exp_f32 v81, v81
mz v[200:203],a[152:155],v[56:59],0
v_exp_f32 v82, v82
mz v[204:207],a[152:155],v[60:63],0
v_exp_f32 v83, v83
mz v[208:211],a[156:159],v[48:51],0
v_add_f32 v29, v70, v29
v_add_f32 v29, v71, v29
mz v[212:215],a[156:159],v[52:55],0
cv v69,v70,v71
v_add_f32 v29, v84, v29
mz v[216:219],a[156:159],v[56:59],0
v_add_f32 v29, v85, v29
cv v70,v84,v85
mz v[220:223],a[156:159],v[60:63],0
wl
v_add_f32 v29, v86, v29
v_add_f32 v29, v87, v29
mz v[224:227],a[128:131],v[48:51],0
tr a[144:145],v7,35840
cv v71,v86,v87
mz v[228:231],a[128:131],v[52:55],0
tr a[146:147],v7,44032
v_add_f32 v28, v64, v65
mz v[232:235],a[128:131],v[56:59],0
tr a[148:149],v8,35840
cv v64,v64,v65
mz v[236:239],a[128:131],v[60:63],0
tr a[150:151],v8,44032
v_add_f32 v28, v66, v28
mz v[240:243],a[132:135],v[48:51],0
tr a[152:153],v9,35840
v_add_f32 v28, v67, v28
mz v[244:247],a[132:135],v[52:55],0
tr a[154:155],v9,44032
cv v65,v66,v67
mz v[248:251],a[132:135],v[56:59],0
tr a[156:157],v10,35840
v_add_f32 v28, v80, v28
mz v[252:255],a[132:135],v[60:63],0
tr a[158:159],v10,44032
v_add_f32 v28, v81, v28
mz a[160:163],a[136:139],v[48:51],0
cv v66,v80,v81
v_add_f32 v28, v82, v28
mz a[164:167],a[136:139],v[52:55],0
v_add_f32 v28, v83, v28
cv v67,v82,v83
mz a[168:171],a[136:139],v[56:59],0
v_max3_f32 v0, v28, v29, v30
v_max_f32 v0, v0, v31
mz a[172:175],a[136:139],v[60:63],0
v_cmp_lt_f32 vcc, s36, v0
mz a[176:179],a[140:143],v[48:51],0
mz a[180:183],a[140:143],v[52:55],0
mz a[184:187],a[140:143],v[56:59],0
mz a[188:191],a[140:143],v[60:63],0
wl
mz a[192:195],a[144:147],v[48:51],0
s_cbranch_vccnz Lslow_front_a
Lret_front_a:
mz a[196:199],a[144:147],v[52:55],0
s_barrier
v_add_f32 v24, v24, v28
v_add_f32 v25, v25, v29
mz a[200:203],a[144:147],v[56:59],0
ds_read_b128 a[128:131], v5 offset:49152
v_add_f32 v26, v26, v30
mz a[204:207],a[144:147],v[60:63],0
ds_read_b128 a[132:135], v6 offset:49152
v_add_f32 v27, v27, v31
mz a[208:211],a[148:151],v[48:51],0
ds_read_b128 a[136:139], v5 offset:50176
mz a[212:215],a[148:151],v[52:55],0
ds_read_b128 a[140:143], v6 offset:50176
s_add_u32 s43, s43, 16384
mz a[216:219],a[148:151],v[56:59],0
mz a[220:223],a[148:151],v[60:63],0
mz a[224:227],a[152:155],v[48:51],0
mz a[228:231],a[152:155],v[52:55],0
mz a[232:235],a[152:155],v[56:59],0
mz a[236:239],a[152:155],v[60:63],0
mz a[240:243],a[156:159],v[48:51],0
mz a[244:247],a[156:159],v[52:55],0
mz a[248:251],a[156:159],v[56:59],0
mz a[252:255],a[156:159],v[60:63],0
wl
.p2align 5
Lloop_a:
mz v[48:51],a[128:131],a[0:3],v[32:35]
ds_read_b128 a[144:147], v5 offset:51200
mf v[48:51],a[132:135],a[16:19]
ds_read_b128 a[148:151], v6 offset:51200
mf v[48:51],a[136:139],a[32:35]
ds_read_b128 a[152:155], v5 offset:52224
mf v[48:51],a[140:143],a[48:51]
ds_read_b128 a[156:159], v6 offset:52224
mz v[52:55],a[140:143],a[52:55],v[36:39]
mf v[52:55],a[136:139],a[36:39]
mf v[52:55],a[132:135],a[20:23]
mf v[52:55],a[128:131],a[4:7]
mz v[56:59],a[128:131],a[8:11],v[40:43]
mf v[56:59],a[132:135],a[24:27]
mf v[56:59],a[136:139],a[40:43]
mf v[56:59],a[140:143],a[56:59]
mz v[60:63],a[140:143],a[60:63],v[44:47]
mf v[60:63],a[136:139],a[44:47]
mf v[60:63],a[132:135],a[28:31]
mf v[60:63],a[128:131],a[12:15]
wl
mf v[60:63],a[144:147],a[76:79]
ds_read_b128 a[128:131], v5 offset:59392
mf v[60:63],a[148:151],a[92:95]
ds_read_b128 a[132:135], v6 offset:59392
mf v[60:63],a[152:155],a[108:111]
ds_read_b128 a[136:139], v5 offset:60416
mf v[60:63],a[156:159],a[124:127]
ds_read_b128 a[140:143], v6 offset:60416
mf v[56:59],a[156:159],a[120:123]
mf v[56:59],a[152:155],a[104:107]
mf v[56:59],a[148:151],a[88:91]
mf v[56:59],a[144:147],a[72:75]
mf v[52:55],a[144:147],a[68:71]
mf v[52:55],a[148:151],a[84:87]
mf v[52:55],a[152:155],a[100:103]
v_exp_f32 v60, v60
mf v[52:55],a[156:159],a[116:119]
v_exp_f32 v61, v61
mf v[48:51],a[156:159],a[112:115]
v_exp_f32 v62, v62
mf v[48:51],a[152:155],a[96:99]
v_exp_f32 v63, v63
mf v[48:51],a[148:151],a[80:83]
v_exp_f32 v56, v56
mf v[48:51],a[144:147],a[64:67]
wl
v_exp_f32 v57, v57
mz v[80:83],a[128:131],a[64:67],v[32:35]
ds_read_b128 a[144:147], v5 offset:57344
v_add_f32 v31, v60, v61
mf v[80:83],a[132:135],a[80:83]
ds_read_b128 a[148:151], v6 offset:57344
cv v60,v60,v61
mf v[80:83],a[136:139],a[96:99]
ds_read_b128 a[152:155], v5 offset:58368
v_add_f32 v31, v62, v31
mf v[80:83],a[140:143],a[112:115]
ds_read_b128 a[156:159], v6 offset:58368
v_add_f32 v31, v63, v31
mz v[84:87],a[140:143],a[116:119],v[36:39]
v_exp_f32 v58, v58
mf v[84:87],a[136:139],a[100:103]
v_exp_f32 v59, v59
mf v[84:87],a[132:135],a[84:87]
v_exp_f32 v52, v52
mf v[84:87],a[128:131],a[68:71]
v_exp_f32 v53, v53
mz v[88:91],a[128:131],a[72:75],v[40:43]
v_exp_f32 v54, v54
mf v[88:91],a[132:135],a[88:91]
v_exp_f32 v55, v55
mf v[88:91],a[136:139],a[104:107]
v_exp_f32 v48, v48
mf v[88:91],a[140:143],a[120:123]
v_exp_f32 v49, v49
mz v[92:95],a[140:143],a[124:127],v[44:47]
v_exp_f32 v50, v50
mf v[92:95],a[136:139],a[108:111]
v_exp_f32 v51, v51
mf v[92:95],a[132:135],a[92:95]
v_add_f32 v30, v56, v57
cv v61,v62,v63
mf v[92:95],a[128:131],a[76:79]
wl
cv v56,v56,v57
v_add_f32 v30, v58, v30
mf v[92:95],a[144:147],a[12:15]
s_barrier
v_add_f32 v30, v59, v30
cv v57,v58,v59
mf v[92:95],a[148:151],a[28:31]
tr a[128:129],v7,0
v_add_f32 v29, v52, v53
mf v[92:95],a[152:155],a[44:47]
tr a[130:131],v7,8192
cv v52,v52,v53
mf v[92:95],a[156:159],a[60:63]
tr a[132:133],v8,0
v_add_f32 v29, v54, v29
mf v[88:91],a[156:159],a[56:59]
tr a[134:135],v8,8192
v_add_f32 v29, v55, v29
mf v[88:91],a[152:155],a[40:43]
tr a[136:137],v9,0
cv v53,v54,v55
mf v[88:91],a[148:151],a[24:27]
tr a[138:139],v9,8192
v_add_f32 v28, v48, v49
mf v[88:91],a[144:147],a[8:11]
tr a[140:141],v10,0
cv v48,v48,v49
mf v[84:87],a[144:147],a[4:7]
tr a[142:143],v10,8192
v_add_f32 v28, v50, v28
mf v[84:87],a[148:151],a[20:23]
v_add_f32 v28, v51, v28
cv v49,v50,v51
mf v[84:87],a[152:155],a[36:39]
v_exp_f32 v92, v92
mf v[84:87],a[156:159],a[52:55]
v_exp_f32 v93, v93
mf v[80:83],a[156:159],a[48:51]
v_exp_f32 v94, v94
mf v[80:83],a[152:155],a[32:35]
v_exp_f32 v95, v95
mf v[80:83],a[148:151],a[16:19]
v_exp_f32 v88, v88
mf v[80:83],a[144:147],a[0:3]
wl
v_exp_f32 v89, v89
mf v[96:99],a[128:131],v[64:67]
tr a[144:145],v7,1024
v_add_f32 v31, v92, v31
mf v[100:103],a[128:131],v[68:71]
tr a[146:147],v7,9216
v_add_f32 v31, v93, v31
mf v[104:107],a[128:131],v[72:75]
tr a[148:149],v8,1024
cv v62,v92,v93
mf v[108:111],a[128:131],v[76:79]
tr a[150:151],v8,9216
v_add_f32 v31, v94, v31
mf v[124:127],a[132:135],v[76:79]
tr a[152:153],v9,1024
v_add_f32 v31, v95, v31
mf v[120:123],a[132:135],v[72:75]
tr a[154:155],v9,9216
cv v63,v94,v95
mf v[116:119],a[132:135],v[68:71]
tr a[156:157],v10,1024
v_add_f32 v30, v88, v30
mf v[112:115],a[132:135],v[64:67]
tr a[158:159],v10,9216
v_add_f32 v30, v89, v30
mf v[128:131],a[136:139],v[64:67]
v_exp_f32 v90, v90
mf v[132:135],a[136:139],v[68:71]
v_exp_f32 v91, v91
mf v[136:139],a[136:139],v[72:75]
v_exp_f32 v84, v84
mf v[140:143],a[136:139],v[76:79]
v_exp_f32 v85, v85
mf v[156:159],a[140:143],v[76:79]
v_exp_f32 v86, v86
mf v[152:155],a[140:143],v[72:75]
v_exp_f32 v87, v87
mf v[148:151],a[140:143],v[68:71]
v_exp_f32 v80, v80
mf v[144:147],a[140:143],v[64:67]
wl
v_exp_f32 v81, v81
mf v[160:163],a[144:147],v[64:67]
tr a[128:129],v7,2048
cv v58,v88,v89
mf v[164:167],a[144:147],v[68:71]
tr a[130:131],v7,10240
v_add_f32 v30, v90, v30
mf v[168:171],a[144:147],v[72:75]
tr a[132:133],v8,2048
v_add_f32 v30, v91, v30
mf v[172:175],a[144:147],v[76:79]
tr a[134:135],v8,10240
cv v59,v90,v91
mf v[188:191],a[148:151],v[76:79]
tr a[136:137],v9,2048
v_add_f32 v29, v84, v29
mf v[184:187],a[148:151],v[72:75]
tr a[138:139],v9,10240
v_add_f32 v29, v85, v29
mf v[180:183],a[148:151],v[68:71]
tr a[140:141],v10,2048
cv v54,v84,v85
mf v[176:179],a[148:151],v[64:67]
tr a[142:143],v10,10240
v_add_f32 v29, v86, v29
mf v[192:195],a[152:155],v[64:67]
v_exp_f32 v82, v82
mf v[196:199],a[152:155],v[68:71]
v_exp_f32 v83, v83
mf v[200:203],a[152:155],v[72:75]
v_add_f32 v29, v87, v29
cv v55,v86,v87
mf v[204:207],a[152:155],v[76:79]
v_add_f32 v28, v80, v28
v_add_f32 v28, v81, v28
mf v[220:223],a[156:159],v[76:79]
cv v50,v80,v81
v_add_f32 v28, v82, v28
mf v[216:219],a[156:159],v[72:75]
v_add_f32 v28, v83, v28
cv v51,v82,v83
mf v[212:215],a[156:159],v[68:71]
v_max3_f32 v0, v28, v29, v30
v_max_f32 v0, v0, v31
mf v[208:211],a[156:159],v[64:67]
wl
v_cmp_lt_f32 vcc, s36, v0
mf v[224:227],a[128:131],v[64:67]
tr a[144:145],v7,3072
mf v[228:231],a[128:131],v[68:71]
tr a[146:147],v7,11264
mf v[232:235],a[128:131],v[72:75]
tr a[148:149],v8,3072
mf v[236:239],a[128:131],v[76:79]
tr a[150:151],v8,11264
mf v[252:255],a[132:135],v[76:79]
tr a[152:153],v9,3072
mf v[248:251],a[132:135],v[72:75]
tr a[154:155],v9,11264
mf v[244:247],a[132:135],v[68:71]
tr a[156:157],v10,3072
mf v[240:243],a[132:135],v[64:67]
tr a[158:159],v10,11264
mf a[160:163],a[136:139],v[64:67]
mf a[164:167],a[136:139],v[68:71]
mf a[168:171],a[136:139],v[72:75]
mf a[172:175],a[136:139],v[76:79]
mf a[188:191],a[140:143],v[76:79]
mf a[184:187],a[140:143],v[72:75]
mf a[180:183],a[140:143],v[68:71]
mf a[176:179],a[140:143],v[64:67]
wl
mf a[192:195],a[144:147],v[64:67]
s_cbranch_vccnz Lslow_lp0_a
Lret_lp0_a:
mf a[196:199],a[144:147],v[68:71]
s_barrier
v_add_f32 v24, v24, v28
v_add_f32 v25, v25, v29
mf a[200:203],a[144:147],v[72:75]
ds_read_b128 a[128:131], v5 offset:16384
v_add_f32 v26, v26, v30
mf a[204:207],a[144:147],v[76:79]
ds_read_b128 a[132:135], v6 offset:16384
v_add_f32 v27, v27, v31
mf a[220:223],a[148:151],v[76:79]
ds_read_b128 a[136:139], v5 offset:17408
mf a[216:219],a[148:151],v[72:75]
ds_read_b128 a[140:143], v6 offset:17408
s_add_u32 s43, s43, 16384
mf a[212:215],a[148:151],v[68:71]
mf a[208:211],a[148:151],v[64:67]
mf a[224:227],a[152:155],v[64:67]
mf a[228:231],a[152:155],v[68:71]
mf a[232:235],a[152:155],v[72:75]
mf a[236:239],a[152:155],v[76:79]
mf a[252:255],a[156:159],v[76:79]
mf a[248:251],a[156:159],v[72:75]
mf a[244:247],a[156:159],v[68:71]
mf a[240:243],a[156:159],v[64:67]
wl
mz v[64:67],a[128:131],a[0:3],v[32:35]
ds_read_b128 a[144:147], v5 offset:18432
mf v[64:67],a[132:135],a[16:19]
ds_read_b128 a[148:151], v6 offset:18432
mf v[64:67],a[136:139],a[32:35]
ds_read_b128 a[152:155], v5 offset:19456
mf v[64:67],a[140:143],a[48:51]
ds_read_b128 a[156:159], v6 offset:19456
mz v[68:71],a[140:143],a[52:55],v[36:39]
mf v[68:71],a[136:139],a[36:39]
mf v[68:71],a[132:135],a[20:23]
mf v[68:71],a[128:131],a[4:7]
mz v[72:75],a[128:131],a[8:11],v[40:43]
mf v[72:75],a[132:135],a[24:27]
mf v[72:75],a[136:139],a[40:43]
mf v[72:75],a[140:143],a[56:59]
mz v[76:79],a[140:143],a[60:63],v[44:47]
mf v[76:79],a[136:139],a[44:47]
mf v[76:79],a[132:135],a[28:31]
mf v[76:79],a[128:131],a[12:15]
wl
mf v[76:79],a[144:147],a[76:79]
ds_read_b128 a[128:131], v5 offset:26624
mf v[76:79],a[148:151],a[92:95]
ds_read_b128 a[132:135], v6 offset:26624
mf v[76:79],a[152:155],a[108:111]
ds_read_b128 a[136:139], v5 offset:27648
mf v[76:79],a[156:159],a[124:127]
ds_read_b128 a[140:143], v6 offset:27648
mf v[72:75],a[156:159],a[120:123]
mf v[72:75],a[152:155],a[104:107]
mf v[72:75],a[148:151],a[88:91]
mf v[72:75],a[144:147],a[72:75]
mf v[68:71],a[144:147],a[68:71]
mf v[68:71],a[148:151],a[84:87]
mf v[68:71],a[152:155],a[100:103]
v_exp_f32 v76, v76
mf v[68:71],a[156:159],a[116:119]
v_exp_f32 v77, v77
mf v[64:67],a[156:159],a[112:115]
v_exp_f32 v78, v78
mf v[64:67],a[152:155],a[96:99]
v_exp_f32 v79, v79
mf v[64:67],a[148:151],a[80:83]
v_exp_f32 v72, v72
mf v[64:67],a[144:147],a[64:67]
wl
v_exp_f32 v73, v73
mz v[80:83],a[128:131],a[64:67],v[32:35]
ds_read_b128 a[144:147], v5 offset:24576
v_add_f32 v31, v76, v77
mf v[80:83],a[132:135],a[80:83]
ds_read_b128 a[148:151], v6 offset:24576
cv v76,v76,v77
mf v[80:83],a[136:139],a[96:99]
ds_read_b128 a[152:155], v5 offset:25600
v_add_f32 v31, v78, v31
mf v[80:83],a[140:143],a[112:115]
ds_read_b128 a[156:159], v6 offset:25600
v_add_f32 v31, v79, v31
mz v[84:87],a[140:143],a[116:119],v[36:39]
v_exp_f32 v74, v74
mf v[84:87],a[136:139],a[100:103]
v_exp_f32 v75, v75
mf v[84:87],a[132:135],a[84:87]
v_exp_f32 v68, v68
mf v[84:87],a[128:131],a[68:71]
v_exp_f32 v69, v69
mz v[88:91],a[128:131],a[72:75],v[40:43]
v_exp_f32 v70, v70
mf v[88:91],a[132:135],a[88:91]
v_exp_f32 v71, v71
mf v[88:91],a[136:139],a[104:107]
v_exp_f32 v64, v64
mf v[88:91],a[140:143],a[120:123]
v_exp_f32 v65, v65
mz v[92:95],a[140:143],a[124:127],v[44:47]
v_exp_f32 v66, v66
mf v[92:95],a[136:139],a[108:111]
v_exp_f32 v67, v67
mf v[92:95],a[132:135],a[92:95]
v_add_f32 v30, v72, v73
cv v77,v78,v79
mf v[92:95],a[128:131],a[76:79]
wl
cv v72,v72,v73
v_add_f32 v30, v74, v30
mf v[92:95],a[144:147],a[12:15]
s_barrier
v_add_f32 v30, v75, v30
cv v73,v74,v75
mf v[92:95],a[148:151],a[28:31]
tr a[128:129],v7,32768
v_add_f32 v29, v68, v69
mf v[92:95],a[152:155],a[44:47]
tr a[130:131],v7,40960
cv v68,v68,v69
mf v[92:95],a[156:159],a[60:63]
tr a[132:133],v8,32768
v_add_f32 v29, v70, v29
mf v[88:91],a[156:159],a[56:59]
tr a[134:135],v8,40960
v_add_f32 v29, v71, v29
mf v[88:91],a[152:155],a[40:43]
tr a[136:137],v9,32768
cv v69,v70,v71
mf v[88:91],a[148:151],a[24:27]
tr a[138:139],v9,40960
v_add_f32 v28, v64, v65
mf v[88:91],a[144:147],a[8:11]
tr a[140:141],v10,32768
cv v64,v64,v65
mf v[84:87],a[144:147],a[4:7]
tr a[142:143],v10,40960
v_add_f32 v28, v66, v28
mf v[84:87],a[148:151],a[20:23]
v_add_f32 v28, v67, v28
cv v65,v66,v67
mf v[84:87],a[152:155],a[36:39]
v_exp_f32 v92, v92
mf v[84:87],a[156:159],a[52:55]
v_exp_f32 v93, v93
mf v[80:83],a[156:159],a[48:51]
v_exp_f32 v94, v94
mf v[80:83],a[152:155],a[32:35]
v_exp_f32 v95, v95
mf v[80:83],a[148:151],a[16:19]
v_exp_f32 v88, v88
mf v[80:83],a[144:147],a[0:3]
wl
v_exp_f32 v89, v89
mf v[96:99],a[128:131],v[48:51]
tr a[144:145],v7,33792
v_add_f32 v31, v92, v31
mf v[100:103],a[128:131],v[52:55]
tr a[146:147],v7,41984
v_add_f32 v31, v93, v31
mf v[104:107],a[128:131],v[56:59]
tr a[148:149],v8,33792
cv v78,v92,v93
mf v[108:111],a[128:131],v[60:63]
tr a[150:151],v8,41984
v_add_f32 v31, v94, v31
mf v[124:127],a[132:135],v[60:63]
tr a[152:153],v9,33792
v_add_f32 v31, v95, v31
mf v[120:123],a[132:135],v[56:59]
tr a[154:155],v9,41984
cv v79,v94,v95
mf v[116:119],a[132:135],v[52:55]
tr a[156:157],v10,33792
v_add_f32 v30, v88, v30
mf v[112:115],a[132:135],v[48:51]
tr a[158:159],v10,41984
v_add_f32 v30, v89, v30
mf v[128:131],a[136:139],v[48:51]
v_exp_f32 v90, v90
mf v[132:135],a[136:139],v[52:55]
v_exp_f32 v91, v91
mf v[136:139],a[136:139],v[56:59]
v_exp_f32 v84, v84
mf v[140:143],a[136:139],v[60:63]
v_exp_f32 v85, v85
mf v[156:159],a[140:143],v[60:63]
v_exp_f32 v86, v86
mf v[152:155],a[140:143],v[56:59]
v_exp_f32 v87, v87
mf v[148:151],a[140:143],v[52:55]
v_exp_f32 v80, v80
mf v[144:147],a[140:143],v[48:51]
wl
v_exp_f32 v81, v81
mf v[160:163],a[144:147],v[48:51]
tr a[128:129],v7,34816
cv v74,v88,v89
mf v[164:167],a[144:147],v[52:55]
tr a[130:131],v7,43008
v_add_f32 v30, v90, v30
mf v[168:171],a[144:147],v[56:59]
tr a[132:133],v8,34816
v_add_f32 v30, v91, v30
mf v[172:175],a[144:147],v[60:63]
tr a[134:135],v8,43008
cv v75,v90,v91
mf v[188:191],a[148:151],v[60:63]
tr a[136:137],v9,34816
v_add_f32 v29, v84, v29
mf v[184:187],a[148:151],v[56:59]
tr a[138:139],v9,43008
v_add_f32 v29, v85, v29
mf v[180:183],a[148:151],v[52:55]
tr a[140:141],v10,34816
cv v70,v84,v85
mf v[176:179],a[148:151],v[48:51]
tr a[142:143],v10,43008
v_add_f32 v29, v86, v29
mf v[192:195],a[152:155],v[48:51]
v_exp_f32 v82, v82
mf v[196:199],a[152:155],v[52:55]
v_exp_f32 v83, v83
mf v[200:203],a[152:155],v[56:59]
v_add_f32 v29, v87, v29
cv v71,v86,v87
mf v[204:207],a[152:155],v[60:63]
v_add_f32 v28, v80, v28
v_add_f32 v28, v81, v28
mf v[220:223],a[156:159],v[60:63]
cv v66,v80,v81
v_add_f32 v28, v82, v28
mf v[216:219],a[156:159],v[56:59]
v_add_f32 v28, v83, v28
cv v67,v82,v83
mf v[212:215],a[156:159],v[52:55]
v_max3_f32 v0, v28, v29, v30
v_max_f32 v0, v0, v31
mf v[208:211],a[156:159],v[48:51]
wl
v_cmp_lt_f32 vcc, s36, v0
mf v[224:227],a[128:131],v[48:51]
tr a[144:145],v7,35840
mf v[228:231],a[128:131],v[52:55]
tr a[146:147],v7,44032
mf v[232:235],a[128:131],v[56:59]
tr a[148:149],v8,35840
mf v[236:239],a[128:131],v[60:63]
tr a[150:151],v8,44032
mf v[252:255],a[132:135],v[60:63]
tr a[152:153],v9,35840
mf v[248:251],a[132:135],v[56:59]
tr a[154:155],v9,44032
mf v[244:247],a[132:135],v[52:55]
tr a[156:157],v10,35840
mf v[240:243],a[132:135],v[48:51]
tr a[158:159],v10,44032
mf a[160:163],a[136:139],v[48:51]
mf a[164:167],a[136:139],v[52:55]
mf a[168:171],a[136:139],v[56:59]
mf a[172:175],a[136:139],v[60:63]
mf a[188:191],a[140:143],v[60:63]
mf a[184:187],a[140:143],v[56:59]
mf a[180:183],a[140:143],v[52:55]
mf a[176:179],a[140:143],v[48:51]
wl
mf a[192:195],a[144:147],v[48:51]
s_cbranch_vccnz Lslow_lp1_a
Lret_lp1_a:
mf a[196:199],a[144:147],v[52:55]
s_barrier
v_add_f32 v24, v24, v28
v_add_f32 v25, v25, v29
mf a[200:203],a[144:147],v[56:59]
ds_read_b128 a[128:131], v5 offset:49152
v_add_f32 v26, v26, v30
mf a[204:207],a[144:147],v[60:63]
ds_read_b128 a[132:135], v6 offset:49152
v_add_f32 v27, v27, v31
mf a[220:223],a[148:151],v[60:63]
ds_read_b128 a[136:139], v5 offset:50176
mf a[216:219],a[148:151],v[56:59]
ds_read_b128 a[140:143], v6 offset:50176
s_add_u32 s43, s43, 16384
mf a[212:215],a[148:151],v[52:55]
mf a[208:211],a[148:151],v[48:51]
mf a[224:227],a[152:155],v[48:51]
mf a[228:231],a[152:155],v[52:55]
mf a[232:235],a[152:155],v[56:59]
mf a[236:239],a[152:155],v[60:63]
mf a[252:255],a[156:159],v[60:63]
mf a[248:251],a[156:159],v[56:59]
mf a[244:247],a[156:159],v[52:55]
s_add_u32 s41, s41, 1
s_cmp_lt_u32 s41, 6
mf a[240:243],a[156:159],v[48:51]
wl
s_cbranch_scc1 Lloop_a
mz v[48:51],a[128:131],a[0:3],v[32:35]
ds_read_b128 a[144:147], v5 offset:51200
mf v[48:51],a[132:135],a[16:19]
ds_read_b128 a[148:151], v6 offset:51200
mf v[48:51],a[136:139],a[32:35]
ds_read_b128 a[152:155], v5 offset:52224
mf v[48:51],a[140:143],a[48:51]
ds_read_b128 a[156:159], v6 offset:52224
mz v[52:55],a[140:143],a[52:55],v[36:39]
mf v[52:55],a[136:139],a[36:39]
mf v[52:55],a[132:135],a[20:23]
mf v[52:55],a[128:131],a[4:7]
mz v[56:59],a[128:131],a[8:11],v[40:43]
mf v[56:59],a[132:135],a[24:27]
mf v[56:59],a[136:139],a[40:43]
mf v[56:59],a[140:143],a[56:59]
mz v[60:63],a[140:143],a[60:63],v[44:47]
mf v[60:63],a[136:139],a[44:47]
mf v[60:63],a[132:135],a[28:31]
mf v[60:63],a[128:131],a[12:15]
wl
mf v[60:63],a[144:147],a[76:79]
ds_read_b128 a[128:131], v5 offset:59392
mf v[60:63],a[148:151],a[92:95]
ds_read_b128 a[132:135], v6 offset:59392
mf v[60:63],a[152:155],a[108:111]
ds_read_b128 a[136:139], v5 offset:60416
mf v[60:63],a[156:159],a[124:127]
ds_read_b128 a[140:143], v6 offset:60416
mf v[56:59],a[156:159],a[120:123]
mf v[56:59],a[152:155],a[104:107]
mf v[56:59],a[148:151],a[88:91]
mf v[56:59],a[144:147],a[72:75]
mf v[52:55],a[144:147],a[68:71]
mf v[52:55],a[148:151],a[84:87]
mf v[52:55],a[152:155],a[100:103]
v_exp_f32 v60, v60
mf v[52:55],a[156:159],a[116:119]
v_exp_f32 v61, v61
mf v[48:51],a[156:159],a[112:115]
v_exp_f32 v62, v62
mf v[48:51],a[152:155],a[96:99]
v_exp_f32 v63, v63
mf v[48:51],a[148:151],a[80:83]
v_exp_f32 v56, v56
mf v[48:51],a[144:147],a[64:67]
wl
v_exp_f32 v57, v57
mz v[80:83],a[128:131],a[64:67],v[32:35]
ds_read_b128 a[144:147], v5 offset:57344
v_add_f32 v31, v60, v61
mf v[80:83],a[132:135],a[80:83]
ds_read_b128 a[148:151], v6 offset:57344
cv v60,v60,v61
mf v[80:83],a[136:139],a[96:99]
ds_read_b128 a[152:155], v5 offset:58368
v_add_f32 v31, v62, v31
mf v[80:83],a[140:143],a[112:115]
ds_read_b128 a[156:159], v6 offset:58368
v_add_f32 v31, v63, v31
mz v[84:87],a[140:143],a[116:119],v[36:39]
v_exp_f32 v58, v58
mf v[84:87],a[136:139],a[100:103]
v_exp_f32 v59, v59
mf v[84:87],a[132:135],a[84:87]
v_exp_f32 v52, v52
mf v[84:87],a[128:131],a[68:71]
v_exp_f32 v53, v53
mz v[88:91],a[128:131],a[72:75],v[40:43]
v_exp_f32 v54, v54
mf v[88:91],a[132:135],a[88:91]
v_exp_f32 v55, v55
mf v[88:91],a[136:139],a[104:107]
v_exp_f32 v48, v48
mf v[88:91],a[140:143],a[120:123]
v_exp_f32 v49, v49
mz v[92:95],a[140:143],a[124:127],v[44:47]
v_exp_f32 v50, v50
mf v[92:95],a[136:139],a[108:111]
v_exp_f32 v51, v51
mf v[92:95],a[132:135],a[92:95]
v_add_f32 v30, v56, v57
cv v61,v62,v63
mf v[92:95],a[128:131],a[76:79]
wl
cv v56,v56,v57
v_add_f32 v30, v58, v30
mf v[92:95],a[144:147],a[12:15]
s_barrier
v_add_f32 v30, v59, v30
cv v57,v58,v59
mf v[92:95],a[148:151],a[28:31]
tr a[128:129],v7,0
v_add_f32 v29, v52, v53
mf v[92:95],a[152:155],a[44:47]
tr a[130:131],v7,8192
cv v52,v52,v53
mf v[92:95],a[156:159],a[60:63]
tr a[132:133],v8,0
v_add_f32 v29, v54, v29
mf v[88:91],a[156:159],a[56:59]
tr a[134:135],v8,8192
v_add_f32 v29, v55, v29
mf v[88:91],a[152:155],a[40:43]
tr a[136:137],v9,0
cv v53,v54,v55
mf v[88:91],a[148:151],a[24:27]
tr a[138:139],v9,8192
v_add_f32 v28, v48, v49
mf v[88:91],a[144:147],a[8:11]
tr a[140:141],v10,0
cv v48,v48,v49
mf v[84:87],a[144:147],a[4:7]
tr a[142:143],v10,8192
v_add_f32 v28, v50, v28
mf v[84:87],a[148:151],a[20:23]
v_add_f32 v28, v51, v28
cv v49,v50,v51
mf v[84:87],a[152:155],a[36:39]
v_exp_f32 v92, v92
mf v[84:87],a[156:159],a[52:55]
v_exp_f32 v93, v93
mf v[80:83],a[156:159],a[48:51]
v_exp_f32 v94, v94
mf v[80:83],a[152:155],a[32:35]
v_exp_f32 v95, v95
mf v[80:83],a[148:151],a[16:19]
v_exp_f32 v88, v88
mf v[80:83],a[144:147],a[0:3]
wl
v_exp_f32 v89, v89
mf v[96:99],a[128:131],v[64:67]
tr a[144:145],v7,1024
v_add_f32 v31, v92, v31
mf v[100:103],a[128:131],v[68:71]
tr a[146:147],v7,9216
v_add_f32 v31, v93, v31
mf v[104:107],a[128:131],v[72:75]
tr a[148:149],v8,1024
cv v62,v92,v93
mf v[108:111],a[128:131],v[76:79]
tr a[150:151],v8,9216
v_add_f32 v31, v94, v31
mf v[124:127],a[132:135],v[76:79]
tr a[152:153],v9,1024
v_add_f32 v31, v95, v31
mf v[120:123],a[132:135],v[72:75]
tr a[154:155],v9,9216
cv v63,v94,v95
mf v[116:119],a[132:135],v[68:71]
tr a[156:157],v10,1024
v_add_f32 v30, v88, v30
mf v[112:115],a[132:135],v[64:67]
tr a[158:159],v10,9216
v_add_f32 v30, v89, v30
mf v[128:131],a[136:139],v[64:67]
v_exp_f32 v90, v90
mf v[132:135],a[136:139],v[68:71]
v_exp_f32 v91, v91
mf v[136:139],a[136:139],v[72:75]
v_exp_f32 v84, v84
mf v[140:143],a[136:139],v[76:79]
v_exp_f32 v85, v85
mf v[156:159],a[140:143],v[76:79]
v_exp_f32 v86, v86
mf v[152:155],a[140:143],v[72:75]
v_exp_f32 v87, v87
mf v[148:151],a[140:143],v[68:71]
v_exp_f32 v80, v80
mf v[144:147],a[140:143],v[64:67]
wl
v_exp_f32 v81, v81
mf v[160:163],a[144:147],v[64:67]
tr a[128:129],v7,2048
cv v58,v88,v89
mf v[164:167],a[144:147],v[68:71]
tr a[130:131],v7,10240
v_add_f32 v30, v90, v30
mf v[168:171],a[144:147],v[72:75]
tr a[132:133],v8,2048
v_add_f32 v30, v91, v30
mf v[172:175],a[144:147],v[76:79]
tr a[134:135],v8,10240
cv v59,v90,v91
mf v[188:191],a[148:151],v[76:79]
tr a[136:137],v9,2048
v_add_f32 v29, v84, v29
mf v[184:187],a[148:151],v[72:75]
tr a[138:139],v9,10240
v_add_f32 v29, v85, v29
mf v[180:183],a[148:151],v[68:71]
tr a[140:141],v10,2048
cv v54,v84,v85
mf v[176:179],a[148:151],v[64:67]
tr a[142:143],v10,10240
v_add_f32 v29, v86, v29
mf v[192:195],a[152:155],v[64:67]
v_exp_f32 v82, v82
mf v[196:199],a[152:155],v[68:71]
v_exp_f32 v83, v83
mf v[200:203],a[152:155],v[72:75]
v_add_f32 v29, v87, v29
cv v55,v86,v87
mf v[204:207],a[152:155],v[76:79]
v_add_f32 v28, v80, v28
v_add_f32 v28, v81, v28
mf v[220:223],a[156:159],v[76:79]
cv v50,v80,v81
v_add_f32 v28, v82, v28
mf v[216:219],a[156:159],v[72:75]
v_add_f32 v28, v83, v28
cv v51,v82,v83
mf v[212:215],a[156:159],v[68:71]
v_max3_f32 v0, v28, v29, v30
v_max_f32 v0, v0, v31
mf v[208:211],a[156:159],v[64:67]
wl
v_cmp_lt_f32 vcc, s36, v0
mf v[224:227],a[128:131],v[64:67]
tr a[144:145],v7,3072
mf v[228:231],a[128:131],v[68:71]
tr a[146:147],v7,11264
mf v[232:235],a[128:131],v[72:75]
tr a[148:149],v8,3072
mf v[236:239],a[128:131],v[76:79]
tr a[150:151],v8,11264
mf v[252:255],a[132:135],v[76:79]
tr a[152:153],v9,3072
mf v[248:251],a[132:135],v[72:75]
tr a[154:155],v9,11264
mf v[244:247],a[132:135],v[68:71]
tr a[156:157],v10,3072
mf v[240:243],a[132:135],v[64:67]
tr a[158:159],v10,11264
mf a[160:163],a[136:139],v[64:67]
mf a[164:167],a[136:139],v[68:71]
mf a[168:171],a[136:139],v[72:75]
mf a[172:175],a[136:139],v[76:79]
mf a[188:191],a[140:143],v[76:79]
mf a[184:187],a[140:143],v[72:75]
mf a[180:183],a[140:143],v[68:71]
mf a[176:179],a[140:143],v[64:67]
wl
mf a[192:195],a[144:147],v[64:67]
s_cbranch_vccnz Lslow_it14_a
Lret_it14_a:
mf a[196:199],a[144:147],v[68:71]
s_barrier
v_add_f32 v24, v24, v28
v_add_f32 v25, v25, v29
mf a[200:203],a[144:147],v[72:75]
ds_read_b128 a[128:131], v5 offset:16384
v_add_f32 v26, v26, v30
mf a[204:207],a[144:147],v[76:79]
ds_read_b128 a[132:135], v6 offset:16384
v_add_f32 v27, v27, v31
mf a[220:223],a[148:151],v[76:79]
ds_read_b128 a[136:139], v5 offset:17408
mf a[216:219],a[148:151],v[72:75]
ds_read_b128 a[140:143], v6 offset:17408
s_add_u32 s43, s43, 16384
mf a[212:215],a[148:151],v[68:71]
mf a[208:211],a[148:151],v[64:67]
mf a[224:227],a[152:155],v[64:67]
mf a[228:231],a[152:155],v[68:71]
mf a[232:235],a[152:155],v[72:75]
mf a[236:239],a[152:155],v[76:79]
mf a[252:255],a[156:159],v[76:79]
mf a[248:251],a[156:159],v[72:75]
mf a[244:247],a[156:159],v[68:71]
s_cmp_eq_u32 s42, 1
mf a[240:243],a[156:159],v[64:67]
wl
s_cbranch_scc1 Ltail2_a
mz v[64:67],a[128:131],a[0:3],v[32:35]
ds_read_b128 a[144:147], v5 offset:18432
v_mov_b32 v21, 0
mf v[64:67],a[132:135],a[16:19]
ds_read_b128 a[148:151], v6 offset:18432
mf v[64:67],a[136:139],a[32:35]
ds_read_b128 a[152:155], v5 offset:19456
mf v[64:67],a[140:143],a[48:51]
ds_read_b128 a[156:159], v6 offset:19456
mz v[68:71],a[140:143],a[52:55],v[36:39]
buffer_load_dword v23, v21, s[96:99], s90 offen sc1
mf v[68:71],a[136:139],a[36:39]
mf v[68:71],a[132:135],a[20:23]
mf v[68:71],a[128:131],a[4:7]
mz v[72:75],a[128:131],a[8:11],v[40:43]
mf v[72:75],a[132:135],a[24:27]
mf v[72:75],a[136:139],a[40:43]
mf v[72:75],a[140:143],a[56:59]
mz v[76:79],a[140:143],a[60:63],v[44:47]
mf v[76:79],a[136:139],a[44:47]
mf v[76:79],a[132:135],a[28:31]
mf v[76:79],a[128:131],a[12:15]
wl
mf v[76:79],a[144:147],a[76:79]
ds_read_b128 a[128:131], v5 offset:26624
mf v[76:79],a[148:151],a[92:95]
ds_read_b128 a[132:135], v6 offset:26624
mf v[76:79],a[152:155],a[108:111]
ds_read_b128 a[136:139], v5 offset:27648
mf v[76:79],a[156:159],a[124:127]
ds_read_b128 a[140:143], v6 offset:27648
mf v[72:75],a[156:159],a[120:123]
mf v[72:75],a[152:155],a[104:107]
mf v[72:75],a[148:151],a[88:91]
mf v[72:75],a[144:147],a[72:75]
mf v[68:71],a[144:147],a[68:71]
mf v[68:71],a[148:151],a[84:87]
mf v[68:71],a[152:155],a[100:103]
v_exp_f32 v76, v76
mf v[68:71],a[156:159],a[116:119]
v_exp_f32 v77, v77
mf v[64:67],a[156:159],a[112:115]
v_exp_f32 v78, v78
mf v[64:67],a[152:155],a[96:99]
v_exp_f32 v79, v79
mf v[64:67],a[148:151],a[80:83]
v_exp_f32 v72, v72
mf v[64:67],a[144:147],a[64:67]
wl
v_exp_f32 v73, v73
mz v[80:83],a[128:131],a[64:67],v[32:35]
ds_read_b128 a[144:147], v5 offset:24576
v_add_f32 v31, v76, v77
mf v[80:83],a[132:135],a[80:83]
ds_read_b128 a[148:151], v6 offset:24576
cv v76,v76,v77
mf v[80:83],a[136:139],a[96:99]
ds_read_b128 a[152:155], v5 offset:25600
v_add_f32 v31, v78, v31
mf v[80:83],a[140:143],a[112:115]
ds_read_b128 a[156:159], v6 offset:25600
v_add_f32 v31, v79, v31
mz v[84:87],a[140:143],a[116:119],v[36:39]
v_exp_f32 v74, v74
mf v[84:87],a[136:139],a[100:103]
v_exp_f32 v75, v75
mf v[84:87],a[132:135],a[84:87]
v_exp_f32 v68, v68
mf v[84:87],a[128:131],a[68:71]
v_exp_f32 v69, v69
mz v[88:91],a[128:131],a[72:75],v[40:43]
v_exp_f32 v70, v70
mf v[88:91],a[132:135],a[88:91]
v_exp_f32 v71, v71
mf v[88:91],a[136:139],a[104:107]
v_exp_f32 v64, v64
mf v[88:91],a[140:143],a[120:123]
v_exp_f32 v65, v65
mz v[92:95],a[140:143],a[124:127],v[44:47]
v_exp_f32 v66, v66
mf v[92:95],a[136:139],a[108:111]
v_exp_f32 v67, v67
mf v[92:95],a[132:135],a[92:95]
v_add_f32 v30, v72, v73
cv v77,v78,v79
mf v[92:95],a[128:131],a[76:79]
wl
cv v72,v72,v73
v_add_f32 v30, v74, v30
mf v[92:95],a[144:147],a[12:15]
s_barrier
v_add_f32 v30, v75, v30
cv v73,v74,v75
mf v[92:95],a[148:151],a[28:31]
tr a[128:129],v7,32768
v_add_f32 v29, v68, v69
mf v[92:95],a[152:155],a[44:47]
tr a[130:131],v7,40960
cv v68,v68,v69
mf v[92:95],a[156:159],a[60:63]
tr a[132:133],v8,32768
v_add_f32 v29, v70, v29
mf v[88:91],a[156:159],a[56:59]
tr a[134:135],v8,40960
v_add_f32 v29, v71, v29
mf v[88:91],a[152:155],a[40:43]
tr a[136:137],v9,32768
cv v69,v70,v71
mf v[88:91],a[148:151],a[24:27]
tr a[138:139],v9,40960
v_add_f32 v28, v64, v65
mf v[88:91],a[144:147],a[8:11]
tr a[140:141],v10,32768
cv v64,v64,v65
mf v[84:87],a[144:147],a[4:7]
tr a[142:143],v10,40960
v_add_f32 v28, v66, v28
mf v[84:87],a[148:151],a[20:23]
v_add_f32 v28, v67, v28
cv v65,v66,v67
mf v[84:87],a[152:155],a[36:39]
v_exp_f32 v92, v92
mf v[84:87],a[156:159],a[52:55]
v_exp_f32 v93, v93
mf v[80:83],a[156:159],a[48:51]
v_exp_f32 v94, v94
mf v[80:83],a[152:155],a[32:35]
v_exp_f32 v95, v95
mf v[80:83],a[148:151],a[16:19]
v_exp_f32 v88, v88
mf v[80:83],a[144:147],a[0:3]
wl
v_exp_f32 v89, v89
mf v[96:99],a[128:131],v[48:51]
tr a[144:145],v7,33792
v_add_f32 v31, v92, v31
mf v[100:103],a[128:131],v[52:55]
tr a[146:147],v7,41984
v_add_f32 v31, v93, v31
mf v[104:107],a[128:131],v[56:59]
tr a[148:149],v8,33792
cv v78,v92,v93
mf v[108:111],a[128:131],v[60:63]
tr a[150:151],v8,41984
v_add_f32 v31, v94, v31
mf v[124:127],a[132:135],v[60:63]
tr a[152:153],v9,33792
v_add_f32 v31, v95, v31
mf v[120:123],a[132:135],v[56:59]
tr a[154:155],v9,41984
cv v79,v94,v95
mf v[116:119],a[132:135],v[52:55]
tr a[156:157],v10,33792
v_add_f32 v30, v88, v30
mf v[112:115],a[132:135],v[48:51]
tr a[158:159],v10,41984
v_add_f32 v30, v89, v30
mf v[128:131],a[136:139],v[48:51]
v_exp_f32 v90, v90
mf v[132:135],a[136:139],v[52:55]
v_exp_f32 v91, v91
mf v[136:139],a[136:139],v[56:59]
v_exp_f32 v84, v84
mf v[140:143],a[136:139],v[60:63]
v_exp_f32 v85, v85
mf v[156:159],a[140:143],v[60:63]
v_exp_f32 v86, v86
mf v[152:155],a[140:143],v[56:59]
v_exp_f32 v87, v87
mf v[148:151],a[140:143],v[52:55]
v_exp_f32 v80, v80
mf v[144:147],a[140:143],v[48:51]
wl
v_exp_f32 v81, v81
mf v[160:163],a[144:147],v[48:51]
tr a[128:129],v7,34816
cv v74,v88,v89
mf v[164:167],a[144:147],v[52:55]
tr a[130:131],v7,43008
v_add_f32 v30, v90, v30
mf v[168:171],a[144:147],v[56:59]
tr a[132:133],v8,34816
v_add_f32 v30, v91, v30
mf v[172:175],a[144:147],v[60:63]
tr a[134:135],v8,43008
cv v75,v90,v91
mf v[188:191],a[148:151],v[60:63]
tr a[136:137],v9,34816
v_add_f32 v29, v84, v29
mf v[184:187],a[148:151],v[56:59]
tr a[138:139],v9,43008
v_add_f32 v29, v85, v29
mf v[180:183],a[148:151],v[52:55]
tr a[140:141],v10,34816
cv v70,v84,v85
mf v[176:179],a[148:151],v[48:51]
tr a[142:143],v10,43008
v_add_f32 v29, v86, v29
mf v[192:195],a[152:155],v[48:51]
s_waitcnt vmcnt(0)
v_exp_f32 v82, v82
mf v[196:199],a[152:155],v[52:55]
v_exp_f32 v83, v83
mf v[200:203],a[152:155],v[56:59]
v_add_f32 v29, v87, v29
cv v71,v86,v87
mf v[204:207],a[152:155],v[60:63]
v_add_f32 v28, v80, v28
v_add_f32 v28, v81, v28
mf v[220:223],a[156:159],v[60:63]
cv v66,v80,v81
v_add_f32 v28, v82, v28
mf v[216:219],a[156:159],v[56:59]
v_add_f32 v28, v83, v28
cv v67,v82,v83
mf v[212:215],a[156:159],v[52:55]
v_max3_f32 v0, v28, v29, v30
v_max_f32 v0, v0, v31
mf v[208:211],a[156:159],v[48:51]
wl
v_readfirstlane_b32 s54, v23
v_cmp_lt_f32 vcc, s36, v0
mf v[224:227],a[128:131],v[48:51]
tr a[144:145],v7,35840
mf v[228:231],a[128:131],v[52:55]
s_and_b32 s73, s54, 0x0f0f0f0f
tr a[146:147],v7,44032
mf v[232:235],a[128:131],v[56:59]
s_lshr_b32 s72, s54, 4
tr a[148:149],v8,35840
mf v[236:239],a[128:131],v[60:63]
s_and_b32 s72, s72, 0x0f0f0f0f
tr a[150:151],v8,44032
mf v[252:255],a[132:135],v[60:63]
s_add_u32 s73, s73, s72
tr a[152:153],v9,35840
mf v[248:251],a[132:135],v[56:59]
s_mul_i32 s73, s73, 0x01010101
tr a[154:155],v9,44032
mf v[244:247],a[132:135],v[52:55]
s_lshr_b32 s73, s73, 24
tr a[156:157],v10,35840
mf v[240:243],a[132:135],v[48:51]
tr a[158:159],v10,44032
mf a[160:163],a[136:139],v[48:51]
s_cmp_lt_u32 s73, 8
s_cbranch_scc1 Lmodewait_a
Lmodeok_a:
mf a[164:167],a[136:139],v[52:55]
mf a[168:171],a[136:139],v[56:59]
mf a[172:175],a[136:139],v[60:63]
mf a[188:191],a[140:143],v[60:63]
mf a[184:187],a[140:143],v[56:59]
mf a[180:183],a[140:143],v[52:55]
mf a[176:179],a[140:143],v[48:51]
wl
mf a[192:195],a[144:147],v[48:51]
s_cbranch_vccnz Lslow_mid15_a
Lret_mid15_a:
mf a[196:199],a[144:147],v[52:55]
s_barrier
v_add_f32 v24, v24, v28
v_add_f32 v25, v25, v29
mf a[200:203],a[144:147],v[56:59]
tr a[128:129],v7,49152
v_add_f32 v26, v26, v30
mf a[204:207],a[144:147],v[60:63]
tr a[130:131],v7,57344
v_add_f32 v27, v27, v31
mf a[220:223],a[148:151],v[60:63]
tr a[132:133],v8,49152
mf a[216:219],a[148:151],v[56:59]
tr a[134:135],v8,57344
mf a[212:215],a[148:151],v[52:55]
tr a[136:137],v9,49152
mf a[208:211],a[148:151],v[48:51]
tr a[138:139],v9,57344
mf a[224:227],a[152:155],v[48:51]
tr a[140:141],v10,49152
mf a[228:231],a[152:155],v[52:55]
tr a[142:143],v10,57344
s_add_u32 s43, s43, 16384
mf a[232:235],a[152:155],v[56:59]
ds_read_b128 a[0:3], v4 offset:0
mf a[236:239],a[152:155],v[60:63]
ds_read_b128 a[4:7], v4 offset:1024
mf a[252:255],a[156:159],v[60:63]
ds_read_b128 a[8:11], v4 offset:2048
mf a[248:251],a[156:159],v[56:59]
ds_read_b128 a[12:15], v4 offset:3072
mf a[244:247],a[156:159],v[52:55]
ds_read_b128 a[16:19], v4 offset:4096
mf a[240:243],a[156:159],v[48:51]
ds_read_b128 a[20:23], v4 offset:5120
s_waitcnt lgkmcnt(6)
mf v[96:99],a[128:131],v[64:67]
tr a[144:145],v7,50176
v_mov_b32 v11, v24
mf v[100:103],a[128:131],v[68:71]
tr a[146:147],v7,58368
v_mov_b32 v12, v25
mf v[104:107],a[128:131],v[72:75]
tr a[148:149],v8,50176
v_mov_b32 v13, v26
mf v[108:111],a[128:131],v[76:79]
tr a[150:151],v8,58368
v_mov_b32 v14, v27
mf v[112:115],a[132:135],v[64:67]
tr a[152:153],v9,50176
mf v[116:119],a[132:135],v[68:71]
tr a[154:155],v9,58368
mf v[120:123],a[132:135],v[72:75]
tr a[156:157],v10,50176
mf v[124:127],a[132:135],v[76:79]
tr a[158:159],v10,58368
mf v[128:131],a[136:139],v[64:67]
ds_read_b128 a[24:27], v4 offset:6144
mf v[132:135],a[136:139],v[68:71]
ds_read_b128 a[28:31], v4 offset:7168
mf v[136:139],a[136:139],v[72:75]
ds_read_b128 a[32:35], v4 offset:8192
mf v[140:143],a[136:139],v[76:79]
ds_read_b128 a[36:39], v4 offset:9216
cv v96,v96,v97
mf v[144:147],a[140:143],v[64:67]
ds_read_b128 a[40:43], v4 offset:10240
cv v97,v98,v99
mf v[148:151],a[140:143],v[68:71]
ds_read_b128 a[44:47], v4 offset:11264
cv v98,v112,v113
mf v[152:155],a[140:143],v[72:75]
ds_read_b128 a[48:51], v4 offset:12288
cv v99,v114,v115
mf v[156:159],a[140:143],v[76:79]
ds_read_b128 a[52:55], v4 offset:13312
s_waitcnt lgkmcnt(8)
mf v[160:163],a[144:147],v[64:67]
tr a[128:129],v7,51200
cv v100,v100,v101
mf v[164:167],a[144:147],v[68:71]
tr a[130:131],v7,59392
cv v101,v102,v103
mf v[168:171],a[144:147],v[72:75]
tr a[132:133],v8,51200
cv v102,v116,v117
mf v[172:175],a[144:147],v[76:79]
tr a[134:135],v8,59392
cv v103,v118,v119
mf v[176:179],a[148:151],v[64:67]
tr a[136:137],v9,51200
cv v104,v104,v105
mf v[180:183],a[148:151],v[68:71]
tr a[138:139],v9,59392
cv v105,v106,v107
mf v[184:187],a[148:151],v[72:75]
tr a[140:141],v10,51200
cv v106,v120,v121
mf v[188:191],a[148:151],v[76:79]
tr a[142:143],v10,59392
cv v107,v122,v123
mf v[192:195],a[152:155],v[64:67]
ds_read_b128 a[56:59], v4 offset:14336
cv v108,v108,v109
mf v[196:199],a[152:155],v[68:71]
ds_read_b128 a[60:63], v4 offset:15360
cv v109,v110,v111
mf v[200:203],a[152:155],v[72:75]
ds_read_b128 a[64:67], v4 offset:16384
cv v110,v124,v125
mf v[204:207],a[152:155],v[76:79]
ds_read_b128 a[68:71], v4 offset:17408
cv v111,v126,v127
mf v[208:211],a[156:159],v[64:67]
ds_read_b128 a[72:75], v4 offset:18432
cv v128,v128,v129
mf v[212:215],a[156:159],v[68:71]
ds_read_b128 a[76:79], v4 offset:19456
cv v129,v130,v131
mf v[216:219],a[156:159],v[72:75]
ds_read_b128 a[80:83], v4 offset:20480
cv v130,v144,v145
mf v[220:223],a[156:159],v[76:79]
ds_read_b128 a[84:87], v4 offset:21504
s_waitcnt lgkmcnt(8)
mf v[224:227],a[128:131],v[64:67]
tr a[144:145],v7,52224
cv v131,v146,v147
mf v[228:231],a[128:131],v[68:71]
tr a[146:147],v7,60416
cv v132,v132,v133
mf v[232:235],a[128:131],v[72:75]
tr a[148:149],v8,52224
cv v133,v134,v135
mf v[236:239],a[128:131],v[76:79]
tr a[150:151],v8,60416
cv v134,v148,v149
mf v[240:243],a[132:135],v[64:67]
tr a[152:153],v9,52224
cv v135,v150,v151
mf v[244:247],a[132:135],v[68:71]
tr a[154:155],v9,60416
cv v136,v136,v137
mf v[248:251],a[132:135],v[72:75]
tr a[156:157],v10,52224
cv v137,v138,v139
mf v[252:255],a[132:135],v[76:79]
tr a[158:159],v10,60416
cv v138,v152,v153
mf a[160:163],a[136:139],v[64:67]
ds_read_b128 a[88:91], v4 offset:22528
cv v139,v154,v155
mf a[164:167],a[136:139],v[68:71]
ds_read_b128 a[92:95], v4 offset:23552
cv v140,v140,v141
mf a[168:171],a[136:139],v[72:75]
ds_read_b128 a[96:99], v4 offset:24576
cv v141,v142,v143
mf a[172:175],a[136:139],v[76:79]
ds_read_b128 a[100:103], v4 offset:25600
cv v142,v156,v157
mf a[176:179],a[140:143],v[64:67]
ds_read_b128 a[104:107], v4 offset:26624
cv v143,v158,v159
mf a[180:183],a[140:143],v[68:71]
ds_read_b128 a[108:111], v4 offset:27648
cv v160,v160,v161
mf a[184:187],a[140:143],v[72:75]
ds_read_b128 a[112:115], v4 offset:28672
cv v161,v162,v163
mf a[188:191],a[140:143],v[76:79]
ds_read_b128 a[116:119], v4 offset:29696
s_waitcnt lgkmcnt(8)
mf a[192:195],a[144:147],v[64:67]
ds_read_b128 a[120:123], v4 offset:30720
s_barrier
mf a[196:199],a[144:147],v[68:71]
ds_read_b128 a[128:131], v5 offset:0
cv v162,v176,v177
mf a[200:203],a[144:147],v[72:75]
ds_read_b128 a[132:135], v6 offset:0
cv v163,v178,v179
mf a[204:207],a[144:147],v[76:79]
ds_read_b128 a[136:139], v5 offset:1024
cv v164,v164,v165
mf a[208:211],a[148:151],v[64:67]
ds_read_b128 a[140:143], v6 offset:1024
cv v165,v166,v167
mf a[212:215],a[148:151],v[68:71]
ds_read_b128 a[124:127], v4 offset:31744
cv v166,v180,v181
mf a[216:219],a[148:151],v[72:75]
cv v167,v182,v183
cv v168,v168,v169
mf a[220:223],a[148:151],v[76:79]
cv v169,v170,v171
cv v170,v184,v185
mf a[224:227],a[152:155],v[64:67]
cv v171,v186,v187
cv v172,v172,v173
mf a[228:231],a[152:155],v[68:71]
cv v173,v174,v175
cv v174,v188,v189
mf a[232:235],a[152:155],v[72:75]
cv v175,v190,v191
cv v192,v192,v193
mf a[236:239],a[152:155],v[76:79]
cv v193,v194,v195
cv v194,v208,v209
mf a[240:243],a[156:159],v[64:67]
cv v195,v210,v211
cv v196,v196,v197
mf a[244:247],a[156:159],v[68:71]
cv v197,v198,v199
cv v198,v212,v213
mf a[248:251],a[156:159],v[72:75]
cv v199,v214,v215
cv v200,v200,v201
mf a[252:255],a[156:159],v[76:79]
s_waitcnt lgkmcnt(1)
cv v201,v202,v203
cv v202,v216,v217
mz v[48:51],a[128:131],a[0:3],v[32:35]
ds_read_b128 a[144:147], v5 offset:2048
cv v203,v218,v219
mf v[48:51],a[132:135],a[16:19]
ds_read_b128 a[148:151], v6 offset:2048
cv v204,v204,v205
mf v[48:51],a[136:139],a[32:35]
ds_read_b128 a[152:155], v5 offset:3072
cv v205,v206,v207
mf v[48:51],a[140:143],a[48:51]
ds_read_b128 a[156:159], v6 offset:3072
cv v206,v220,v221
mz v[52:55],a[140:143],a[52:55],v[36:39]
ds_write_b128 v4, v[96:99] offset:0
mf v[52:55],a[136:139],a[36:39]
cv v207,v222,v223
cv v224,v224,v225
mf v[52:55],a[132:135],a[20:23]
cv v225,v226,v227
cv v226,v240,v241
mf v[52:55],a[128:131],a[4:7]
cv v227,v242,v243
cv v228,v228,v229
mz v[56:59],a[128:131],a[8:11],v[40:43]
ds_write_b128 v4, v[100:103] offset:1024
mf v[56:59],a[132:135],a[24:27]
cv v229,v230,v231
cv v230,v244,v245
mf v[56:59],a[136:139],a[40:43]
cv v231,v246,v247
cv v232,v232,v233
mf v[56:59],a[140:143],a[56:59]
cv v233,v234,v235
cv v234,v248,v249
mz v[60:63],a[140:143],a[60:63],v[44:47]
ds_write_b128 v4, v[104:107] offset:2048
mf v[60:63],a[136:139],a[44:47]
cv v235,v250,v251
cv v236,v236,v237
mf v[60:63],a[132:135],a[28:31]
cv v237,v238,v239
cv v238,v252,v253
mf v[60:63],a[128:131],a[12:15]
s_waitcnt lgkmcnt(3)
cv v239,v254,v255
ar v21,a160
mf v[60:63],a[144:147],a[76:79]
ds_read_b128 a[128:131], v5 offset:10240
ar v22,a161
mf v[60:63],a[148:151],a[92:95]
ds_read_b128 a[132:135], v6 offset:10240
cv v240,v21,v22
mf v[60:63],a[152:155],a[108:111]
ds_read_b128 a[136:139], v5 offset:11264
ar v21,a162
mf v[60:63],a[156:159],a[124:127]
ds_read_b128 a[140:143], v6 offset:11264
ar v22,a163
mf v[56:59],a[156:159],a[120:123]
ds_write_b128 v4, v[108:111] offset:3072
mf v[56:59],a[152:155],a[104:107]
cv v241,v21,v22
ar v21,a176
mf v[56:59],a[148:151],a[88:91]
ar v22,a177
cv v242,v21,v22
mf v[56:59],a[144:147],a[72:75]
ar v21,a178
ar v22,a179
mf v[52:55],a[144:147],a[68:71]
ds_write_b128 v4, v[128:131] offset:4096
mf v[52:55],a[148:151],a[84:87]
cv v243,v21,v22
ar v21,a164
mf v[52:55],a[152:155],a[100:103]
v_exp_f32 v60, v60
mf v[52:55],a[156:159],a[116:119]
v_exp_f32 v61, v61
mf v[48:51],a[156:159],a[112:115]
ds_write_b128 v4, v[132:135] offset:5120
mf v[48:51],a[152:155],a[96:99]
v_exp_f32 v62, v62
mf v[48:51],a[148:151],a[80:83]
v_exp_f32 v63, v63
mf v[48:51],a[144:147],a[64:67]
s_waitcnt lgkmcnt(3)
v_exp_f32 v56, v56
mz v[80:83],a[128:131],a[64:67],v[32:35]
ds_read_b128 a[144:147], v5 offset:8192
v_add_f32 v27, v60, v61
mf v[80:83],a[132:135],a[80:83]
ds_read_b128 a[148:151], v6 offset:8192
cv v60,v60,v61
mf v[80:83],a[136:139],a[96:99]
ds_read_b128 a[152:155], v5 offset:9216
v_add_f32 v27, v62, v27
mf v[80:83],a[140:143],a[112:115]
ds_read_b128 a[156:159], v6 offset:9216
v_add_f32 v27, v63, v27
mz v[84:87],a[140:143],a[116:119],v[36:39]
ds_write_b128 v4, v[136:139] offset:6144
mf v[84:87],a[136:139],a[100:103]
v_exp_f32 v57, v57
mf v[84:87],a[132:135],a[84:87]
v_exp_f32 v58, v58
mf v[84:87],a[128:131],a[68:71]
v_exp_f32 v59, v59
mz v[88:91],a[128:131],a[72:75],v[40:43]
ds_write_b128 v4, v[140:143] offset:7168
mf v[88:91],a[132:135],a[88:91]
v_exp_f32 v52, v52
mf v[88:91],a[136:139],a[104:107]
v_exp_f32 v53, v53
mf v[88:91],a[140:143],a[120:123]
v_exp_f32 v54, v54
mz v[92:95],a[140:143],a[124:127],v[44:47]
ds_write_b128 v4, v[160:163] offset:8192
mf v[92:95],a[136:139],a[108:111]
v_exp_f32 v55, v55
mf v[92:95],a[132:135],a[92:95]
v_exp_f32 v48, v48
mf v[92:95],a[128:131],a[76:79]
s_waitcnt lgkmcnt(3)
v_exp_f32 v49, v49
mf v[92:95],a[144:147],a[12:15]
s_barrier
v_exp_f32 v50, v50
mf v[92:95],a[148:151],a[28:31]
ds_read_b128 a[128:131], v5 offset:16384
cv v61,v62,v63
mf v[92:95],a[152:155],a[44:47]
ds_read_b128 a[132:135], v6 offset:16384
v_add_f32 v26, v56, v57
mf v[92:95],a[156:159],a[60:63]
ds_read_b128 a[136:139], v5 offset:17408
cv v56,v56,v57
mf v[88:91],a[156:159],a[56:59]
ds_read_b128 a[140:143], v6 offset:17408
v_add_f32 v26, v58, v26
mf v[88:91],a[152:155],a[40:43]
v_exp_f32 v51, v51
mf v[88:91],a[148:151],a[24:27]
v_add_f32 v26, v59, v26
cv v57,v58,v59
mf v[88:91],a[144:147],a[8:11]
v_add_f32 v25, v52, v53
cv v52,v52,v53
mf v[84:87],a[144:147],a[4:7]
ds_write_b128 v4, v[164:167] offset:9216
mf v[84:87],a[148:151],a[20:23]
v_add_f32 v25, v54, v25
v_add_f32 v25, v55, v25
mf v[84:87],a[152:155],a[36:39]
v_exp_f32 v92, v92
mf v[84:87],a[156:159],a[52:55]
v_exp_f32 v93, v93
mf v[80:83],a[156:159],a[48:51]
ds_write_b128 v4, v[168:171] offset:10240
mf v[80:83],a[152:155],a[32:35]
v_exp_f32 v94, v94
mf v[80:83],a[148:151],a[16:19]
v_exp_f32 v95, v95
mf v[80:83],a[144:147],a[0:3]
s_waitcnt lgkmcnt(2)
v_exp_f32 v88, v88
mz v[64:67],a[128:131],a[0:3],v[32:35]
ds_read_b128 a[144:147], v5 offset:18432
v_add_f32 v27, v92, v27
mf v[64:67],a[132:135],a[16:19]
ds_read_b128 a[148:151], v6 offset:18432
v_add_f32 v27, v93, v27
mf v[64:67],a[136:139],a[32:35]
ds_read_b128 a[152:155], v5 offset:19456
cv v62,v92,v93
mf v[64:67],a[140:143],a[48:51]
ds_read_b128 a[156:159], v6 offset:19456
v_add_f32 v27, v94, v27
mz v[68:71],a[140:143],a[52:55],v[36:39]
ds_write_b128 v4, v[172:175] offset:11264
mf v[68:71],a[136:139],a[36:39]
v_exp_f32 v89, v89
mf v[68:71],a[132:135],a[20:23]
v_exp_f32 v90, v90
mf v[68:71],a[128:131],a[4:7]
v_exp_f32 v91, v91
mz v[72:75],a[128:131],a[8:11],v[40:43]
ds_write_b128 v4, v[192:195] offset:12288
mf v[72:75],a[132:135],a[24:27]
v_exp_f32 v84, v84
mf v[72:75],a[136:139],a[40:43]
v_exp_f32 v85, v85
mf v[72:75],a[140:143],a[56:59]
v_exp_f32 v86, v86
mz v[76:79],a[140:143],a[60:63],v[44:47]
ds_write_b128 v4, v[196:199] offset:13312
mf v[76:79],a[136:139],a[44:47]
v_exp_f32 v87, v87
mf v[76:79],a[132:135],a[28:31]
v_exp_f32 v80, v80
mf v[76:79],a[128:131],a[12:15]
s_waitcnt lgkmcnt(3)
v_exp_f32 v81, v81
mf v[76:79],a[144:147],a[76:79]
ds_read_b128 a[128:131], v5 offset:26624
v_add_f32 v27, v95, v27
mf v[76:79],a[148:151],a[92:95]
ds_read_b128 a[132:135], v6 offset:26624
cv v63,v94,v95
mf v[76:79],a[152:155],a[108:111]
ds_read_b128 a[136:139], v5 offset:27648
v_add_f32 v26, v88, v26
mf v[76:79],a[156:159],a[124:127]
ds_read_b128 a[140:143], v6 offset:27648
v_add_f32 v26, v89, v26
mf v[72:75],a[156:159],a[120:123]
ds_write_b128 v4, v[200:203] offset:14336
mf v[72:75],a[152:155],a[104:107]
v_exp_f32 v82, v82
mf v[72:75],a[148:151],a[88:91]
v_exp_f32 v83, v83
mf v[72:75],a[144:147],a[72:75]
cv v58,v88,v89
v_add_f32 v26, v90, v26
mf v[68:71],a[144:147],a[68:71]
ds_write_b128 v4, v[204:207] offset:15360
mf v[68:71],a[148:151],a[84:87]
v_add_f32 v24, v48, v49
cv v48,v48,v49
v_add_f32 v24, v50, v24
v_add_f32 v24, v51, v24
cv v49,v50,v51
v_add_f32 v24, v80, v24
v_add_f32 v24, v81, v24
cv v50,v80,v81
v_add_f32 v24, v82, v24
v_add_f32 v24, v83, v24
cv v51,v82,v83
cv v53,v54,v55
v_add_f32 v25, v84, v25
v_add_f32 v25, v85, v25
cv v54,v84,v85
v_add_f32 v25, v86, v25
v_add_f32 v25, v87, v25
cv v55,v86,v87
v_add_f32 v26, v91, v26
cv v59,v90,v91
mf v[68:71],a[152:155],a[100:103]
v_min3_f32 v0, v24, v25, v26
v_min_f32 v0, v0, v27
mf v[68:71],a[156:159],a[116:119]
v_cmp_gt_f32 s[72:73], s55, v0
v_max3_f32 v0, v24, v25, v26
mf v[64:67],a[156:159],a[112:115]
ds_write_b128 v4, v[224:227] offset:16384
mf v[64:67],a[152:155],a[96:99]
v_max_f32 v0, v0, v27
v_cmp_lt_f32 vcc, s36, v0
mf v[64:67],a[148:151],a[80:83]
ar v22,a165
cv v244,v21,v22
mf v[64:67],a[144:147],a[64:67]
s_waitcnt lgkmcnt(3)
s_or_b64 s[72:73], s[72:73], vcc
s_cbranch_scc1 Lslow_midh_a
Lret_midh_a:
mz v[80:83],a[128:131],a[64:67],v[32:35]
s_add_u32 s43, s43, 16384
ds_read_b128 a[144:147], v5 offset:24576
mf v[80:83],a[132:135],a[80:83]
ds_read_b128 a[148:151], v6 offset:24576
ar v21,a166
mf v[80:83],a[136:139],a[96:99]
ds_read_b128 a[152:155], v5 offset:25600
ar v22,a167
mf v[80:83],a[140:143],a[112:115]
ds_read_b128 a[156:159], v6 offset:25600
cv v245,v21,v22
mz v[84:87],a[140:143],a[116:119],v[36:39]
ds_write_b128 v4, v[228:231] offset:17408
mf v[84:87],a[136:139],a[100:103]
v_exp_f32 v76, v76
mf v[84:87],a[132:135],a[84:87]
v_exp_f32 v77, v77
mf v[84:87],a[128:131],a[68:71]
v_exp_f32 v78, v78
mz v[88:91],a[128:131],a[72:75],v[40:43]
ds_write_b128 v4, v[232:235] offset:18432
mf v[88:91],a[132:135],a[88:91]
v_exp_f32 v79, v79
mf v[88:91],a[136:139],a[104:107]
v_exp_f32 v72, v72
mf v[88:91],a[140:143],a[120:123]
v_exp_f32 v73, v73
mz v[92:95],a[140:143],a[124:127],v[44:47]
ds_write_b128 v4, v[236:239] offset:19456
mf v[92:95],a[136:139],a[108:111]
v_exp_f32 v74, v74
mf v[92:95],a[132:135],a[92:95]
v_exp_f32 v75, v75
mf v[92:95],a[128:131],a[76:79]
s_waitcnt lgkmcnt(3)
v_exp_f32 v68, v68
mf v[92:95],a[144:147],a[12:15]
s_barrier
v_exp_f32 v69, v69
mf v[92:95],a[148:151],a[28:31]
tr a[128:129],v7,32768
v_add_f32 v31, v76, v77
mf v[92:95],a[152:155],a[44:47]
tr a[130:131],v7,40960
cv v76,v76,v77
mf v[92:95],a[156:159],a[60:63]
tr a[132:133],v8,32768
v_add_f32 v31, v78, v31
mf v[88:91],a[156:159],a[56:59]
tr a[134:135],v8,40960
v_add_f32 v31, v79, v31
mf v[88:91],a[152:155],a[40:43]
tr a[136:137],v9,32768
cv v77,v78,v79
mf v[88:91],a[148:151],a[24:27]
tr a[138:139],v9,40960
v_add_f32 v30, v72, v73
mf v[88:91],a[144:147],a[8:11]
tr a[140:141],v10,32768
cv v72,v72,v73
mf v[84:87],a[144:147],a[4:7]
tr a[142:143],v10,40960
v_add_f32 v30, v74, v30
mf v[84:87],a[148:151],a[20:23]
ds_write_b128 v4, v[240:243] offset:20480
mf v[84:87],a[152:155],a[36:39]
v_exp_f32 v70, v70
mf v[84:87],a[156:159],a[52:55]
v_exp_f32 v71, v71
mf v[80:83],a[156:159],a[48:51]
v_exp_f32 v64, v64
mf v[80:83],a[152:155],a[32:35]
v_exp_f32 v65, v65
mf v[80:83],a[148:151],a[16:19]
v_exp_f32 v66, v66
mf v[80:83],a[144:147],a[0:3]
s_waitcnt lgkmcnt(1)
v_exp_f32 v67, v67
mz v[96:99],a[128:131],v[48:51],0
tr a[144:145],v7,33792
v_add_f32 v30, v75, v30
mz v[100:103],a[128:131],v[52:55],0
tr a[146:147],v7,41984
cv v73,v74,v75
mz v[104:107],a[128:131],v[56:59],0
tr a[148:149],v8,33792
v_add_f32 v29, v68, v69
mz v[108:111],a[128:131],v[60:63],0
tr a[150:151],v8,41984
cv v68,v68,v69
mz v[112:115],a[132:135],v[48:51],0
tr a[152:153],v9,33792
v_add_f32 v29, v70, v29
mz v[116:119],a[132:135],v[52:55],0
tr a[154:155],v9,41984
v_add_f32 v29, v71, v29
mz v[120:123],a[132:135],v[56:59],0
tr a[156:157],v10,33792
cv v69,v70,v71
mz v[124:127],a[132:135],v[60:63],0
tr a[158:159],v10,41984
v_add_f32 v28, v64, v65
mz v[128:131],a[136:139],v[48:51],0
v_exp_f32 v92, v92
mz v[132:135],a[136:139],v[52:55],0
v_exp_f32 v93, v93
mz v[136:139],a[136:139],v[56:59],0
v_exp_f32 v94, v94
mz v[140:143],a[136:139],v[60:63],0
v_exp_f32 v95, v95
mz v[144:147],a[140:143],v[48:51],0
v_exp_f32 v88, v88
mz v[148:151],a[140:143],v[52:55],0
v_exp_f32 v89, v89
mz v[152:155],a[140:143],v[56:59],0
v_exp_f32 v90, v90
mz v[156:159],a[140:143],v[60:63],0
wl
v_exp_f32 v91, v91
mz v[160:163],a[144:147],v[48:51],0
tr a[128:129],v7,34816
v_add_f32 v31, v92, v31
mz v[164:167],a[144:147],v[52:55],0
tr a[130:131],v7,43008
v_add_f32 v31, v93, v31
mz v[168:171],a[144:147],v[56:59],0
tr a[132:133],v8,34816
cv v78,v92,v93
mz v[172:175],a[144:147],v[60:63],0
tr a[134:135],v8,43008
v_add_f32 v31, v94, v31
mz v[176:179],a[148:151],v[48:51],0
tr a[136:137],v9,34816
v_add_f32 v31, v95, v31
mz v[180:183],a[148:151],v[52:55],0
tr a[138:139],v9,43008
cv v79,v94,v95
mz v[184:187],a[148:151],v[56:59],0
tr a[140:141],v10,34816
v_add_f32 v30, v88, v30
mz v[188:191],a[148:151],v[60:63],0
tr a[142:143],v10,43008
v_add_f32 v30, v89, v30
mz v[192:195],a[152:155],v[48:51],0
v_exp_f32 v84, v84
mz v[196:199],a[152:155],v[52:55],0
ar v21,a180
ar v22,a181
cv v246,v21,v22
ar v21,a182
ar v22,a183
cv v247,v21,v22
ar v21,a168
ar v22,a169
cv v248,v21,v22
ar v21,a170
ar v22,a171
cv v249,v21,v22
ar v21,a184
ar v22,a185
cv v250,v21,v22
ar v21,a186
ar v22,a187
cv v251,v21,v22
ar v21,a172
ar v22,a173
cv v252,v21,v22
ar v21,a174
ar v22,a175
cv v253,v21,v22
ar v21,a188
ar v22,a189
cv v254,v21,v22
ar v21,a190
ar v22,a191
cv v255,v21,v22
ar v21,a192
ar v22,a193
cv v208,v21,v22
ar v21,a194
ar v22,a195
cv v209,v21,v22
ar v21,a208
ar v22,a209
cv v210,v21,v22
ar v21,a210
ar v22,a211
cv v211,v21,v22
ds_write_b128 v4, v[244:247] offset:21504
ds_write_b128 v4, v[248:251] offset:22528
ds_write_b128 v4, v[252:255] offset:23552
ds_write_b128 v4, v[208:211] offset:24576
mz v[200:203],a[152:155],v[56:59],0
ar v21,a196
ar v22,a197
cv v212,v21,v22
ar v21,a198
ar v22,a199
cv v213,v21,v22
ar v21,a212
ar v22,a213
cv v214,v21,v22
ar v21,a214
ar v22,a215
cv v215,v21,v22
ds_write_b128 v4, v[212:215] offset:25600
mz v[204:207],a[152:155],v[60:63],0
ar v21,a200
ar v22,a201
cv v216,v21,v22
ar v21,a202
ar v22,a203
cv v217,v21,v22
ar v21,a216
ar v22,a217
cv v218,v21,v22
ar v21,a218
ar v22,a219
cv v219,v21,v22
ds_write_b128 v4, v[216:219] offset:26624
mz v[208:211],a[156:159],v[48:51],0
ar v21,a204
ar v22,a205
cv v220,v21,v22
ar v21,a206
ar v22,a207
cv v221,v21,v22
ar v21,a220
ar v22,a221
cv v222,v21,v22
ar v21,a222
ar v22,a223
cv v223,v21,v22
ds_write_b128 v4, v[220:223] offset:27648
mz v[212:215],a[156:159],v[52:55],0
v_exp_f32 v85, v85
mz v[216:219],a[156:159],v[56:59],0
v_exp_f32 v86, v86
mz v[220:223],a[156:159],v[60:63],0
s_waitcnt lgkmcnt(7)
v_exp_f32 v87, v87
mz v[224:227],a[128:131],v[48:51],0
tr a[144:145],v7,35840
cv v74,v88,v89
mz v[228:231],a[128:131],v[52:55],0
ar v21,a224
ar v22,a225
cv v240,v21,v22
ar v21,a226
ar v22,a227
cv v241,v21,v22
ar v21,a240
ar v22,a241
cv v242,v21,v22
ar v21,a242
ar v22,a243
cv v243,v21,v22
ds_write_b128 v4, v[240:243] offset:28672
mz v[232:235],a[128:131],v[56:59],0
ar v21,a228
ar v22,a229
cv v244,v21,v22
ar v21,a230
ar v22,a231
cv v245,v21,v22
ar v21,a244
ar v22,a245
cv v246,v21,v22
ar v21,a246
ar v22,a247
cv v247,v21,v22
ds_write_b128 v4, v[244:247] offset:29696
mz v[236:239],a[128:131],v[60:63],0
ar v21,a232
ar v22,a233
cv v248,v21,v22
ar v21,a234
ar v22,a235
cv v249,v21,v22
ar v21,a248
ar v22,a249
cv v250,v21,v22
ar v21,a250
ar v22,a251
cv v251,v21,v22
ds_write_b128 v4, v[248:251] offset:30720
mz v[240:243],a[132:135],v[48:51],0
ar v21,a236
ar v22,a237
cv v252,v21,v22
ar v21,a238
ar v22,a239
cv v253,v21,v22
ar v21,a252
ar v22,a253
cv v254,v21,v22
ar v21,a254
ar v22,a255
cv v255,v21,v22
ds_write_b128 v4, v[252:255] offset:31744
mz v[244:247],a[132:135],v[52:55],0
tr a[146:147],v7,44032
v_add_f32 v30, v90, v30
mz v[248:251],a[132:135],v[56:59],0
tr a[148:149],v8,35840
v_add_f32 v30, v91, v30
mz v[252:255],a[132:135],v[60:63],0
tr a[150:151],v8,44032
cv v75,v90,v91
mz a[160:163],a[136:139],v[48:51],0
tr a[152:153],v9,35840
v_add_f32 v29, v84, v29
mz a[164:167],a[136:139],v[52:55],0
tr a[154:155],v9,44032
v_add_f32 v29, v85, v29
mz a[168:171],a[136:139],v[56:59],0
v_exp_f32 v80, v80
v_exp_f32 v81, v81
v_exp_f32 v82, v82
v_exp_f32 v83, v83
mz a[172:175],a[136:139],v[60:63],0
cv v64,v64,v65
v_add_f32 v28, v66, v28
v_add_f32 v28, v67, v28
cv v65,v66,v67
v_add_f32 v28, v80, v28
v_add_f32 v28, v81, v28
cv v66,v80,v81
v_add_f32 v28, v82, v28
v_add_f32 v28, v83, v28
cv v67,v82,v83
cv v70,v84,v85
v_add_f32 v29, v86, v29
v_add_f32 v29, v87, v29
cv v71,v86,v87
mz a[176:179],a[140:143],v[48:51],0
tr a[156:157],v10,35840
v_max3_f32 v0, v28, v29, v30
mz a[180:183],a[140:143],v[52:55],0
tr a[158:159],v10,44032
v_max_f32 v0, v0, v31
mz a[184:187],a[140:143],v[56:59],0
v_cmp_lt_f32 vcc, s36, v0
mz a[188:191],a[140:143],v[60:63],0
wl
mz a[192:195],a[144:147],v[48:51],0
s_cbranch_vccnz Lslow_mid_a
Lret_mid_a:
mz a[196:199],a[144:147],v[52:55],0
s_barrier
v_add_f32 v24, v24, v28
v_add_f32 v25, v25, v29
mz a[200:203],a[144:147],v[56:59],0
ds_read_b128 a[128:131], v5 offset:49152
v_add_f32 v26, v26, v30
mz a[204:207],a[144:147],v[60:63],0
ds_read_b128 a[132:135], v6 offset:49152
v_add_f32 v27, v27, v31
mz a[208:211],a[148:151],v[48:51],0
ds_read_b128 a[136:139], v5 offset:50176
mz a[212:215],a[148:151],v[52:55],0
ds_read_b128 a[140:143], v6 offset:50176
s_add_u32 s43, s43, 16384
mz a[216:219],a[148:151],v[56:59],0
mz a[220:223],a[148:151],v[60:63],0
mz a[224:227],a[152:155],v[48:51],0
mz a[228:231],a[152:155],v[52:55],0
mz a[232:235],a[152:155],v[56:59],0
mz a[236:239],a[152:155],v[60:63],0
mz a[240:243],a[156:159],v[48:51],0
mz a[244:247],a[156:159],v[52:55],0
mz a[248:251],a[156:159],v[56:59],0
s_mov_b32 s42, 1
s_mov_b32 s41, 0
mz a[252:255],a[156:159],v[60:63],0
wl
s_branch Lloop_a
.p2align 5
Ltail2_a:
s_and_b32 s72, s54, 0x88888888
s_cbranch_scc0 Loslow_a
mz v[64:67],a[128:131],a[0:3],v[32:35]
ds_read_b128 a[144:147], v5 offset:18432
v_mov_b32 v21, v11
mf v[64:67],a[132:135],a[16:19]
s_add_u32 m0, s24, 0
ds_read_b128 a[148:151], v6 offset:18432
mf v[64:67],a[136:139],a[32:35]
ds_read_b128 a[152:155], v5 offset:19456
mf v[64:67],a[140:143],a[48:51]
ds_read_b128 a[156:159], v6 offset:19456
mz v[68:71],a[140:143],a[52:55],v[36:39]
s_add_u32 s39, s45, 0
buffer_load_dwordx4 v3, s[20:23], s39 offen  lds
mf v[68:71],a[136:139],a[36:39]
s_add_u32 m0, s24, 1024
v_permlane32_swap_b32 v11, v21
mf v[68:71],a[132:135],a[20:23]
s_add_u32 s39, s45, 7168
buffer_load_dwordx4 v3, s[20:23], s39 offen  lds
mf v[68:71],a[128:131],a[4:7]
s_add_u32 m0, s24, 2048
v_add_f32 v11, v11, v21
v_mov_b32 v21, v11
mz v[72:75],a[128:131],a[8:11],v[40:43]
mf v[72:75],a[132:135],a[24:27]
v_permlane16_swap_b32 v11, v21
mf v[72:75],a[136:139],a[40:43]
s_add_u32 s39, s45, 14336
buffer_load_dwordx4 v3, s[20:23], s39 offen  lds
mf v[72:75],a[140:143],a[56:59]
s_add_u32 m0, s24, 3072
v_add_f32 v11, v11, v21
mz v[76:79],a[140:143],a[60:63],v[44:47]
v_rcp_f32 v11, v11
mf v[76:79],a[136:139],a[44:47]
v_mov_b32 v21, v12
mf v[76:79],a[132:135],a[28:31]
mf v[76:79],a[128:131],a[12:15]
wl
v_permlane32_swap_b32 v12, v21
mf v[76:79],a[144:147],a[76:79]
ds_read_b128 a[128:131], v5 offset:26624
v_add_f32 v12, v12, v21
mf v[76:79],a[148:151],a[92:95]
ds_read_b128 a[132:135], v6 offset:26624
v_mov_b32 v21, v12
mf v[76:79],a[152:155],a[108:111]
ds_read_b128 a[136:139], v5 offset:27648
mf v[76:79],a[156:159],a[124:127]
ds_read_b128 a[140:143], v6 offset:27648
mf v[72:75],a[156:159],a[120:123]
s_add_u32 s39, s45, 21504
buffer_load_dwordx4 v3, s[20:23], s39 offen  lds
mf v[72:75],a[152:155],a[104:107]
v_permlane16_swap_b32 v12, v21
mf v[72:75],a[148:151],a[88:91]
v_add_f32 v12, v12, v21
mf v[72:75],a[144:147],a[72:75]
v_rcp_f32 v12, v12
mf v[68:71],a[144:147],a[68:71]
v_mov_b32 v21, v13
mf v[68:71],a[148:151],a[84:87]
mf v[68:71],a[152:155],a[100:103]
v_exp_f32 v76, v76
mf v[68:71],a[156:159],a[116:119]
v_exp_f32 v77, v77
mf v[64:67],a[156:159],a[112:115]
v_exp_f32 v78, v78
mf v[64:67],a[152:155],a[96:99]
v_exp_f32 v79, v79
mf v[64:67],a[148:151],a[80:83]
v_exp_f32 v72, v72
mf v[64:67],a[144:147],a[64:67]
wl
v_exp_f32 v73, v73
mz v[80:83],a[128:131],a[64:67],v[32:35]
ds_read_b128 a[144:147], v5 offset:24576
v_add_f32 v31, v76, v77
mf v[80:83],a[132:135],a[80:83]
ds_read_b128 a[148:151], v6 offset:24576
cv v76,v76,v77
mf v[80:83],a[136:139],a[96:99]
ds_read_b128 a[152:155], v5 offset:25600
v_add_f32 v31, v78, v31
mf v[80:83],a[140:143],a[112:115]
ds_read_b128 a[156:159], v6 offset:25600
v_add_f32 v31, v79, v31
mz v[84:87],a[140:143],a[116:119],v[36:39]
v_exp_f32 v74, v74
mf v[84:87],a[136:139],a[100:103]
v_exp_f32 v75, v75
mf v[84:87],a[132:135],a[84:87]
v_exp_f32 v68, v68
mf v[84:87],a[128:131],a[68:71]
v_exp_f32 v69, v69
mz v[88:91],a[128:131],a[72:75],v[40:43]
v_exp_f32 v70, v70
mf v[88:91],a[132:135],a[88:91]
v_exp_f32 v71, v71
mf v[88:91],a[136:139],a[104:107]
v_exp_f32 v64, v64
mf v[88:91],a[140:143],a[120:123]
s_add_u32 m0, s24, 16384
v_exp_f32 v65, v65
mz v[92:95],a[140:143],a[124:127],v[44:47]
v_exp_f32 v66, v66
mf v[92:95],a[136:139],a[108:111]
v_exp_f32 v67, v67
mf v[92:95],a[132:135],a[92:95]
v_add_f32 v30, v72, v73
cv v77,v78,v79
mf v[92:95],a[128:131],a[76:79]
wl
cv v72,v72,v73
v_add_f32 v30, v74, v30
mf v[92:95],a[144:147],a[12:15]
s_barrier
v_add_f32 v30, v75, v30
cv v73,v74,v75
mf v[92:95],a[148:151],a[28:31]
tr a[128:129],v7,32768
v_add_f32 v29, v68, v69
mf v[92:95],a[152:155],a[44:47]
tr a[130:131],v7,40960
cv v68,v68,v69
mf v[92:95],a[156:159],a[60:63]
tr a[132:133],v8,32768
v_add_f32 v29, v70, v29
mf v[88:91],a[156:159],a[56:59]
tr a[134:135],v8,40960
v_add_f32 v29, v71, v29
mf v[88:91],a[152:155],a[40:43]
tr a[136:137],v9,32768
cv v69,v70,v71
mf v[88:91],a[148:151],a[24:27]
tr a[138:139],v9,40960
v_add_f32 v28, v64, v65
mf v[88:91],a[144:147],a[8:11]
tr a[140:141],v10,32768
cv v64,v64,v65
mf v[84:87],a[144:147],a[4:7]
tr a[142:143],v10,40960
v_add_f32 v28, v66, v28
mf v[84:87],a[148:151],a[20:23]
s_add_u32 s39, s45, 114688
buffer_load_dwordx4 v3, s[20:23], s39 offen  lds
mf v[84:87],a[152:155],a[36:39]
s_add_u32 m0, s24, 17408
v_exp_f32 v92, v92
mf v[84:87],a[156:159],a[52:55]
s_add_u32 s39, s45, 121856
buffer_load_dwordx4 v3, s[20:23], s39 offen  lds
mf v[80:83],a[156:159],a[48:51]
s_add_u32 m0, s24, 18432
v_exp_f32 v93, v93
mf v[80:83],a[152:155],a[32:35]
s_add_u32 s39, s45, 129024
buffer_load_dwordx4 v3, s[20:23], s39 offen  lds
mf v[80:83],a[148:151],a[16:19]
s_add_u32 m0, s24, 19456
v_exp_f32 v94, v94
mf v[80:83],a[144:147],a[0:3]
wl
v_exp_f32 v95, v95
mf v[96:99],a[128:131],v[48:51]
tr a[144:145],v7,33792
v_add_f32 v31, v92, v31
mf v[100:103],a[128:131],v[52:55]
tr a[146:147],v7,41984
v_add_f32 v31, v93, v31
mf v[104:107],a[128:131],v[56:59]
tr a[148:149],v8,33792
cv v78,v92,v93
mf v[108:111],a[128:131],v[60:63]
tr a[150:151],v8,41984
v_add_f32 v31, v94, v31
mf v[124:127],a[132:135],v[60:63]
tr a[152:153],v9,33792
v_add_f32 v31, v95, v31
mf v[120:123],a[132:135],v[56:59]
tr a[154:155],v9,41984
cv v79,v94,v95
mf v[116:119],a[132:135],v[52:55]
tr a[156:157],v10,33792
v_add_f32 v28, v67, v28
mf v[112:115],a[132:135],v[48:51]
tr a[158:159],v10,41984
cv v65,v66,v67
mf v[128:131],a[136:139],v[48:51]
s_add_u32 s39, s45, 136192
buffer_load_dwordx4 v3, s[20:23], s39 offen  lds
mf v[132:135],a[136:139],v[52:55]
v_exp_f32 v88, v88
mf v[136:139],a[136:139],v[56:59]
v_exp_f32 v89, v89
mf v[140:143],a[136:139],v[60:63]
v_exp_f32 v90, v90
mf v[156:159],a[140:143],v[60:63]
v_exp_f32 v91, v91
mf v[152:155],a[140:143],v[56:59]
v_exp_f32 v84, v84
mf v[148:151],a[140:143],v[52:55]
v_exp_f32 v85, v85
mf v[144:147],a[140:143],v[48:51]
wl
v_exp_f32 v86, v86
mf v[160:163],a[144:147],v[48:51]
tr a[128:129],v7,34816
v_add_f32 v30, v88, v30
mf v[164:167],a[144:147],v[52:55]
tr a[130:131],v7,43008
v_add_f32 v30, v89, v30
mf v[168:171],a[144:147],v[56:59]
tr a[132:133],v8,34816
cv v74,v88,v89
mf v[172:175],a[144:147],v[60:63]
tr a[134:135],v8,43008
v_add_f32 v30, v90, v30
mf v[188:191],a[148:151],v[60:63]
tr a[136:137],v9,34816
v_add_f32 v30, v91, v30
mf v[184:187],a[148:151],v[56:59]
tr a[138:139],v9,43008
cv v75,v90,v91
mf v[180:183],a[148:151],v[52:55]
tr a[140:141],v10,34816
v_add_f32 v29, v84, v29
mf v[176:179],a[148:151],v[48:51]
tr a[142:143],v10,43008
v_add_f32 v29, v85, v29
mf v[192:195],a[152:155],v[48:51]
v_exp_f32 v87, v87
mf v[196:199],a[152:155],v[52:55]
v_exp_f32 v80, v80
mf v[200:203],a[152:155],v[56:59]
v_exp_f32 v81, v81
mf v[204:207],a[152:155],v[60:63]
v_exp_f32 v82, v82
mf v[220:223],a[156:159],v[60:63]
v_exp_f32 v83, v83
mf v[216:219],a[156:159],v[56:59]
cv v70,v84,v85
v_add_f32 v29, v86, v29
mf v[212:215],a[156:159],v[52:55]
v_add_f32 v29, v87, v29
cv v71,v86,v87
mf v[208:211],a[156:159],v[48:51]
wl
v_add_f32 v28, v80, v28
v_add_f32 v28, v81, v28
mf v[224:227],a[128:131],v[48:51]
tr a[144:145],v7,35840
cv v66,v80,v81
mf v[228:231],a[128:131],v[52:55]
tr a[146:147],v7,44032
v_add_f32 v28, v82, v28
mf v[232:235],a[128:131],v[56:59]
tr a[148:149],v8,35840
v_add_f32 v28, v83, v28
mf v[236:239],a[128:131],v[60:63]
tr a[150:151],v8,44032
cv v67,v82,v83
mf v[252:255],a[132:135],v[60:63]
tr a[152:153],v9,35840
v_max3_f32 v0, v28, v29, v30
mf v[248:251],a[132:135],v[56:59]
tr a[154:155],v9,44032
v_max_f32 v0, v0, v31
mf v[244:247],a[132:135],v[52:55]
tr a[156:157],v10,35840
v_cmp_lt_f32 vcc, s36, v0
mf v[240:243],a[132:135],v[48:51]
tr a[158:159],v10,44032
v_xor_b32 v5, 8, v15
mf a[160:163],a[136:139],v[48:51]
v_permlane32_swap_b32 v13, v21
mf a[164:167],a[136:139],v[52:55]
v_add_f32 v13, v13, v21
v_mov_b32 v21, v13
mf a[168:171],a[136:139],v[56:59]
v_xor_b32 v6, 8, v16
mf a[172:175],a[136:139],v[60:63]
v_permlane16_swap_b32 v13, v21
v_add_f32 v13, v13, v21
v_rcp_f32 v13, v13
v_mov_b32 v21, v14
mf a[188:191],a[140:143],v[60:63]
s_add_u32 m0, s24, 32768
mf a[184:187],a[140:143],v[56:59]
v_permlane32_swap_b32 v14, v21
v_add_f32 v14, v14, v21
v_mov_b32 v21, v14
mf a[180:183],a[140:143],v[52:55]
mf a[176:179],a[140:143],v[48:51]
wl
v_permlane16_swap_b32 v14, v21
v_add_f32 v14, v14, v21
v_rcp_f32 v14, v14
mf a[192:195],a[144:147],v[48:51]
s_cbranch_vccnz Lslow_endf15_a
Lret_endf15_a:
mf a[196:199],a[144:147],v[52:55]
s_barrier
v_add_f32 v24, v24, v28
v_add_f32 v25, v25, v29
mf a[200:203],a[144:147],v[56:59]
tr a[128:129],v7,49152
v_add_f32 v26, v26, v30
mf a[204:207],a[144:147],v[60:63]
tr a[130:131],v7,57344
v_add_f32 v27, v27, v31
mf a[220:223],a[148:151],v[60:63]
tr a[132:133],v8,49152
v_bfe_u32 v0, v1, 4, 4
mf a[216:219],a[148:151],v[56:59]
tr a[134:135],v8,57344
v_lshrrev_b32 v2, 8, v1
mf a[212:215],a[148:151],v[52:55]
tr a[136:137],v9,49152
v_mul_u32_u24 v0, 1792, v0
mf a[208:211],a[148:151],v[48:51]
tr a[138:139],v9,57344
v_lshl_add_u32 v2, v2, 4, v0
mf a[224:227],a[152:155],v[48:51]
tr a[140:141],v10,49152
v_bfe_u32 v0, v1, 4, 5
mf a[228:231],a[152:155],v[52:55]
tr a[142:143],v10,57344
s_add_u32 s43, s43, 16384
mf a[232:235],a[152:155],v[56:59]
s_add_u32 s39, s45, 229376
buffer_load_dwordx4 v3, s[20:23], s39 offen  lds
mf a[236:239],a[152:155],v[60:63]
ds_read_b128 a[0:3], v4 offset:0
v_lshlrev_b32 v0, 2, v0
mf a[252:255],a[156:159],v[60:63]
s_add_u32 m0, s24, 33792
ds_read_b128 a[4:7], v4 offset:1024
mf a[248:251],a[156:159],v[56:59]
s_add_u32 s39, s45, 236544
buffer_load_dwordx4 v3, s[20:23], s39 offen  lds
mf a[244:247],a[156:159],v[52:55]
s_add_u32 m0, s24, 34816
ds_read_b128 a[8:11], v4 offset:2048
mf a[240:243],a[156:159],v[48:51]
ds_read_b128 a[12:15], v4 offset:3072
s_waitcnt lgkmcnt(4)
mf v[96:99],a[128:131],v[64:67]
tr a[144:145],v7,50176
v_mov_b32 v28, v24
mf v[100:103],a[128:131],v[68:71]
tr a[146:147],v7,58368
v_mov_b32 v29, v25
mf v[104:107],a[128:131],v[72:75]
tr a[148:149],v8,50176
v_mov_b32 v30, v26
mf v[108:111],a[128:131],v[76:79]
tr a[150:151],v8,58368
v_mov_b32 v31, v27
mf v[112:115],a[132:135],v[64:67]
tr a[152:153],v9,50176
mf v[116:119],a[132:135],v[68:71]
tr a[154:155],v9,58368
mf v[120:123],a[132:135],v[72:75]
tr a[156:157],v10,50176
mf v[124:127],a[132:135],v[76:79]
tr a[158:159],v10,58368
mf v[128:131],a[136:139],v[64:67]
s_add_u32 s39, s45, 243712
buffer_load_dwordx4 v3, s[20:23], s39 offen  lds
mf v[132:135],a[136:139],v[68:71]
s_add_u32 m0, s24, 35840
v_permlane32_swap_b32 v24, v28
mf v[136:139],a[136:139],v[72:75]
s_add_u32 s39, s45, 250880
buffer_load_dwordx4 v3, s[20:23], s39 offen  lds
mf v[140:143],a[136:139],v[76:79]
s_mov_b32 s41, 0
v_add_f32 v24, v24, v28
v_mov_b32 v28, v24
mf v[144:147],a[140:143],v[64:67]
s_add_u32 s51, s45, 128
v_permlane32_swap_b32 v25, v29
mf v[148:151],a[140:143],v[68:71]
s_add_u32 s52, s45, 256
v_add_f32 v25, v25, v29
v_mov_b32 v29, v25
mf v[152:155],a[140:143],v[72:75]
v_permlane32_swap_b32 v26, v30
mf v[156:159],a[140:143],v[76:79]
wl
v_add_f32 v26, v26, v30
v_mov_b32 v30, v26
mf v[160:163],a[144:147],v[64:67]
tr a[128:129],v7,51200
cv v96,v96,v97
mf v[164:167],a[144:147],v[68:71]
tr a[130:131],v7,59392
cv v97,v98,v99
mf v[168:171],a[144:147],v[72:75]
tr a[132:133],v8,51200
cv v98,v112,v113
mf v[172:175],a[144:147],v[76:79]
tr a[134:135],v8,59392
cv v99,v114,v115
mf v[176:179],a[148:151],v[64:67]
tr a[136:137],v9,51200
cv v100,v100,v101
mf v[180:183],a[148:151],v[68:71]
tr a[138:139],v9,59392
cv v101,v102,v103
mf v[184:187],a[148:151],v[72:75]
tr a[140:141],v10,51200
cv v102,v116,v117
mf v[188:191],a[148:151],v[76:79]
tr a[142:143],v10,59392
cv v103,v118,v119
mf v[192:195],a[152:155],v[64:67]
v_permlane32_swap_b32 v27, v31
mf v[196:199],a[152:155],v[68:71]
v_add_f32 v27, v27, v31
v_mov_b32 v31, v27
mf v[200:203],a[152:155],v[72:75]
v_permlane16_swap_b32 v24, v28
mf v[204:207],a[152:155],v[76:79]
ds_read_b128 a[16:19], v4 offset:4096
v_add_f32 v24, v24, v28
mf v[208:211],a[156:159],v[64:67]
v_permlane16_swap_b32 v25, v29
mf v[212:215],a[156:159],v[68:71]
ds_read_b128 a[20:23], v4 offset:5120
v_add_f32 v25, v25, v29
mf v[216:219],a[156:159],v[72:75]
v_permlane16_swap_b32 v26, v30
mf v[220:223],a[156:159],v[76:79]
s_waitcnt lgkmcnt(2)
cv v104,v104,v105
v_add_f32 v26, v26, v30
mf v[224:227],a[128:131],v[64:67]
tr a[144:145],v7,52224
cv v105,v106,v107
mf v[228:231],a[128:131],v[68:71]
tr a[146:147],v7,60416
cv v106,v120,v121
mf v[232:235],a[128:131],v[72:75]
tr a[148:149],v8,52224
cv v107,v122,v123
mf v[236:239],a[128:131],v[76:79]
tr a[150:151],v8,60416
cv v108,v108,v109
mf v[240:243],a[132:135],v[64:67]
tr a[152:153],v9,52224
cv v109,v110,v111
mf v[244:247],a[132:135],v[68:71]
tr a[154:155],v9,60416
cv v110,v124,v125
mf v[248:251],a[132:135],v[72:75]
tr a[156:157],v10,52224
cv v111,v126,v127
mf v[252:255],a[132:135],v[76:79]
tr a[158:159],v10,60416
cv v128,v128,v129
mf a[160:163],a[136:139],v[64:67]
v_permlane16_swap_b32 v27, v31
mf a[164:167],a[136:139],v[68:71]
ds_read_b128 a[24:27], v4 offset:6144
v_add_f32 v27, v27, v31
mf a[168:171],a[136:139],v[72:75]
ds_read_b128 a[28:31], v4 offset:7168
cv v129,v130,v131
mf a[172:175],a[136:139],v[76:79]
ds_read_b128 a[32:35], v4 offset:8192
cv v130,v144,v145
mf a[176:179],a[140:143],v[64:67]
ds_read_b128 a[36:39], v4 offset:9216
cv v131,v146,v147
mf a[180:183],a[140:143],v[68:71]
ds_read_b128 a[40:43], v4 offset:10240
cv v132,v132,v133
mf a[184:187],a[140:143],v[72:75]
ds_read_b128 a[44:47], v4 offset:11264
cv v133,v134,v135
mf a[188:191],a[140:143],v[76:79]
ds_read_b128 a[48:51], v4 offset:12288
s_waitcnt lgkmcnt(7)
mf a[192:195],a[144:147],v[64:67]
s_waitcnt vmcnt(8)
cv v134,v148,v149
s_barrier
mf a[196:199],a[144:147],v[68:71]
tr a[128:129],v15,0
cv v135,v150,v151
mf a[200:203],a[144:147],v[72:75]
tr a[130:131],v15,2048
cv v136,v136,v137
mf a[204:207],a[144:147],v[76:79]
tr a[132:133],v15,4096
cv v137,v138,v139
mf a[208:211],a[148:151],v[64:67]
tr a[134:135],v15,6144
cv v138,v152,v153
mf a[212:215],a[148:151],v[68:71]
tr a[136:137],v15,8192
cv v139,v154,v155
mf a[216:219],a[148:151],v[72:75]
tr a[138:139],v15,10240
cv v140,v140,v141
mf a[220:223],a[148:151],v[76:79]
tr a[140:141],v15,12288
cv v141,v142,v143
mf a[224:227],a[152:155],v[64:67]
tr a[142:143],v15,14336
cv v142,v156,v157
mf a[228:231],a[152:155],v[68:71]
ds_read_b128 a[52:55], v4 offset:13312
cv v143,v158,v159
mf a[232:235],a[152:155],v[72:75]
ds_read_b128 a[56:59], v4 offset:14336
cv v160,v160,v161
mf a[236:239],a[152:155],v[76:79]
ds_read_b128 a[60:63], v4 offset:15360
cv v161,v162,v163
mf a[240:243],a[156:159],v[64:67]
ds_read_b128 a[64:67], v4 offset:16384
cv v162,v176,v177
mf a[244:247],a[156:159],v[68:71]
ds_read_b128 a[68:71], v4 offset:17408
cv v163,v178,v179
mf a[248:251],a[156:159],v[72:75]
ds_read_b128 a[72:75], v4 offset:18432
cv v164,v164,v165
mf a[252:255],a[156:159],v[76:79]
ds_read_b128 a[76:79], v4 offset:19456
s_waitcnt lgkmcnt(4)
mz v[32:35],a[128:131],a[0:3],0
tr a[144:145],v5,0
cv v165,v166,v167
mf v[32:35],a[132:135],a[16:19]
tr a[146:147],v5,2048
cv v166,v180,v181
mf v[32:35],a[136:139],a[32:35]
tr a[148:149],v5,4096
cv v167,v182,v183
mf v[32:35],a[140:143],a[48:51]
tr a[150:151],v5,6144
cv v168,v168,v169
mz v[36:39],a[140:143],a[52:55],0
tr a[152:153],v5,8192
cv v169,v170,v171
mf v[36:39],a[136:139],a[36:39]
tr a[154:155],v5,10240
cv v170,v184,v185
mf v[36:39],a[132:135],a[20:23]
tr a[156:157],v5,12288
cv v171,v186,v187
mf v[36:39],a[128:131],a[4:7]
tr a[158:159],v5,14336
cv v172,v172,v173
mz v[40:43],a[128:131],a[8:11],0
ds_read_b128 a[80:83], v4 offset:20480
cv v173,v174,v175
mf v[40:43],a[132:135],a[24:27]
ds_read_b128 a[84:87], v4 offset:21504
cv v174,v188,v189
mf v[40:43],a[136:139],a[40:43]
ds_read_b128 a[88:91], v4 offset:22528
cv v175,v190,v191
mf v[40:43],a[140:143],a[56:59]
ds_read_b128 a[92:95], v4 offset:23552
cv v192,v192,v193
mz v[44:47],a[140:143],a[60:63],0
ds_read_b128 a[96:99], v4 offset:24576
cv v193,v194,v195
mf v[44:47],a[136:139],a[44:47]
ds_read_b128 a[100:103], v4 offset:25600
cv v194,v208,v209
mf v[44:47],a[132:135],a[28:31]
ds_read_b128 a[104:107], v4 offset:26624
cv v195,v210,v211
mf v[44:47],a[128:131],a[12:15]
ds_read_b128 a[108:111], v4 offset:27648
s_waitcnt lgkmcnt(8)
mz v[60:63],a[144:147],a[12:15],0
tr a[128:129],v16,0
cv v196,v196,v197
mf v[60:63],a[148:151],a[28:31]
tr a[130:131],v16,2048
cv v197,v198,v199
mf v[60:63],a[152:155],a[44:47]
tr a[132:133],v16,4096
cv v198,v212,v213
mf v[60:63],a[156:159],a[60:63]
tr a[134:135],v16,6144
cv v199,v214,v215
mz v[56:59],a[156:159],a[56:59],0
tr a[136:137],v16,8192
cv v200,v200,v201
mf v[56:59],a[152:155],a[40:43]
tr a[138:139],v16,10240
cv v201,v202,v203
mf v[56:59],a[148:151],a[24:27]
tr a[140:141],v16,12288
cv v202,v216,v217
mf v[56:59],a[144:147],a[8:11]
tr a[142:143],v16,14336
cv v203,v218,v219
mz v[52:55],a[144:147],a[4:7],0
ds_read_b128 a[112:115], v4 offset:28672
cv v204,v204,v205
mf v[52:55],a[148:151],a[20:23]
ds_read_b128 a[116:119], v4 offset:29696
cv v205,v206,v207
mf v[52:55],a[152:155],a[36:39]
ds_read_b128 a[120:123], v4 offset:30720
cv v206,v220,v221
mf v[52:55],a[156:159],a[52:55]
ds_read_b128 a[124:127], v4 offset:31744
cv v207,v222,v223
mz v[48:51],a[156:159],a[48:51],0
s_add_u32 m0, s24, 49152
v_rcp_f32 v28, v24
mf v[48:51],a[152:155],a[32:35]
s_add_u32 s39, s45, 344064
buffer_load_dwordx4 v3, s[20:23], s39 offen  lds
mf v[48:51],a[148:151],a[16:19]
s_add_u32 m0, s24, 50176
cv v224,v224,v225
v_mul_f32 v24, v24, v11
mf v[48:51],a[144:147],a[0:3]
s_waitcnt lgkmcnt(4)
v_rcp_f32 v29, v25
mz v[64:67],a[128:131],a[0:3],0
tr a[144:145],v6,0
v_mul_f32 v25, v25, v12
mf v[64:67],a[132:135],a[16:19]
tr a[146:147],v6,2048
cv v225,v226,v227
mf v[64:67],a[136:139],a[32:35]
tr a[148:149],v6,4096
cv v226,v240,v241
mf v[64:67],a[140:143],a[48:51]
tr a[150:151],v6,6144
cv v227,v242,v243
mz v[68:71],a[140:143],a[52:55],0
tr a[152:153],v6,8192
ar v21,a160
mf v[68:71],a[136:139],a[36:39]
tr a[154:155],v6,10240
ar v22,a161
mf v[68:71],a[132:135],a[20:23]
tr a[156:157],v6,12288
cv v112,v21,v22
mf v[68:71],a[128:131],a[4:7]
tr a[158:159],v6,14336
ar v21,a162
mz v[72:75],a[128:131],a[8:11],0
s_add_u32 s39, s45, 351232
buffer_load_dwordx4 v3, s[20:23], s39 offen  lds
mf v[72:75],a[132:135],a[24:27]
s_add_u32 m0, s24, 51200
v_rcp_f32 v30, v26
mf v[72:75],a[136:139],a[40:43]
s_add_u32 s39, s45, 358400
buffer_load_dwordx4 v3, s[20:23], s39 offen  lds
mf v[72:75],a[140:143],a[56:59]
s_add_u32 m0, s24, 52224
ar v22,a163
v_mul_f32 v26, v26, v13
mz v[76:79],a[140:143],a[60:63],0
s_add_u32 s39, s45, 365568
buffer_load_dwordx4 v3, s[20:23], s39 offen  lds
mf v[76:79],a[136:139],a[44:47]
s_add_u32 m0, s25, 0
v_rcp_f32 v31, v27
mf v[76:79],a[132:135],a[28:31]
cv v113,v21,v22
v_mul_f32 v27, v27, v14
mf v[76:79],a[128:131],a[12:15]
wl
ar v21,a176
ar v22,a177
mz v[92:95],a[144:147],a[12:15],0
s_waitcnt vmcnt(4)
cv v114,v21,v22
s_barrier
mf v[92:95],a[148:151],a[28:31]
tr a[128:129],v15,16384
ar v21,a178
mf v[92:95],a[152:155],a[44:47]
tr a[130:131],v15,18432
ar v22,a179
mf v[92:95],a[156:159],a[60:63]
tr a[132:133],v15,20480
cv v115,v21,v22
mz v[88:91],a[156:159],a[56:59],0
tr a[134:135],v15,22528
ar v21,a192
mf v[88:91],a[152:155],a[40:43]
tr a[136:137],v15,24576
ar v22,a193
mf v[88:91],a[148:151],a[24:27]
tr a[138:139],v15,26624
cv v144,v21,v22
mf v[88:91],a[144:147],a[8:11]
tr a[140:141],v15,28672
ar v21,a194
mz v[84:87],a[144:147],a[4:7],0
tr a[142:143],v15,30720
ar v22,a195
mf v[84:87],a[148:151],a[20:23]
s_add_u32 s39, s51, 0
buffer_load_dwordx4 v3, s[20:23], s39 offen  lds
mf v[84:87],a[152:155],a[36:39]
s_add_u32 m0, s25, 1024
cv v145,v21,v22
ar v21,a208
mf v[84:87],a[156:159],a[52:55]
s_add_u32 s39, s51, 7168
buffer_load_dwordx4 v3, s[20:23], s39 offen  lds
mz v[80:83],a[156:159],a[48:51],0
s_add_u32 m0, s25, 2048
ar v22,a209
cv v146,v21,v22
mf v[80:83],a[152:155],a[32:35]
ar v21,a210
ar v22,a211
mf v[80:83],a[148:151],a[16:19]
cv v147,v21,v22
ar v21,a224
mf v[80:83],a[144:147],a[0:3]
wl
ar v22,a225
cv v176,v21,v22
mf v[32:35],a[128:131],a[64:67]
tr a[144:145],v5,16384
ar v21,a226
mf v[32:35],a[132:135],a[80:83]
tr a[146:147],v5,18432
ar v22,a227
mf v[32:35],a[136:139],a[96:99]
tr a[148:149],v5,20480
cv v177,v21,v22
mf v[32:35],a[140:143],a[112:115]
tr a[150:151],v5,22528
ar v21,a240
mf v[36:39],a[140:143],a[116:119]
tr a[152:153],v5,24576
ar v22,a241
mf v[36:39],a[136:139],a[100:103]
tr a[154:155],v5,26624
cv v178,v21,v22
mf v[36:39],a[132:135],a[84:87]
tr a[156:157],v5,28672
ar v21,a242
mf v[36:39],a[128:131],a[68:71]
tr a[158:159],v5,30720
ar v22,a243
mf v[40:43],a[128:131],a[72:75]
s_add_u32 s39, s51, 14336
buffer_load_dwordx4 v3, s[20:23], s39 offen  lds
mf v[40:43],a[132:135],a[88:91]
s_add_u32 m0, s25, 3072
v_mul_f32 v32, v32, v24
v_mul_f32 v33, v33, v24
mf v[40:43],a[136:139],a[104:107]
s_add_u32 s39, s51, 21504
buffer_load_dwordx4 v3, s[20:23], s39 offen  lds
mf v[40:43],a[140:143],a[120:123]
s_add_u32 m0, s25, 16384
v_mul_f32 v34, v34, v24
v_mul_f32 v35, v35, v24
mf v[44:47],a[140:143],a[124:127]
cv v179,v21,v22
cv v228,v228,v229
mf v[44:47],a[136:139],a[108:111]
v_mul_f32 v36, v36, v25
v_mul_f32 v37, v37, v25
mf v[44:47],a[132:135],a[92:95]
v_mul_f32 v38, v38, v25
v_mul_f32 v39, v39, v25
mf v[44:47],a[128:131],a[76:79]
wl
cv v229,v230,v231
cv v230,v244,v245
mf v[60:63],a[144:147],a[76:79]
tr a[128:129],v16,16384
cv v231,v246,v247
mf v[60:63],a[148:151],a[92:95]
tr a[130:131],v16,18432
v_mul_f32 v40, v40, v26
mf v[60:63],a[152:155],a[108:111]
tr a[132:133],v16,20480
v_mul_f32 v41, v41, v26
mf v[60:63],a[156:159],a[124:127]
tr a[134:135],v16,22528
v_mul_f32 v42, v42, v26
mf v[56:59],a[156:159],a[120:123]
tr a[136:137],v16,24576
v_mul_f32 v43, v43, v26
mf v[56:59],a[152:155],a[104:107]
tr a[138:139],v16,26624
v_mul_f32 v44, v44, v27
mf v[56:59],a[148:151],a[88:91]
tr a[140:141],v16,28672
v_mul_f32 v45, v45, v27
mf v[56:59],a[144:147],a[72:75]
tr a[142:143],v16,30720
v_mul_f32 v46, v46, v27
mf v[52:55],a[144:147],a[68:71]
s_add_u32 s39, s51, 114688
buffer_load_dwordx4 v3, s[20:23], s39 offen  lds
mf v[52:55],a[148:151],a[84:87]
s_add_u32 m0, s25, 17408
v_mul_f32 v47, v47, v27
v_mul_f32 v60, v60, v27
mf v[52:55],a[152:155],a[100:103]
s_add_u32 s39, s51, 121856
buffer_load_dwordx4 v3, s[20:23], s39 offen  lds
mf v[52:55],a[156:159],a[116:119]
s_add_u32 m0, s25, 18432
v_mul_f32 v61, v61, v27
v_mul_f32 v62, v62, v27
mf v[48:51],a[156:159],a[112:115]
ar v21,a164
v_mul_f32 v63, v63, v27
mf v[48:51],a[152:155],a[96:99]
v_mul_f32 v56, v56, v26
v_mul_f32 v57, v57, v26
mf v[48:51],a[148:151],a[80:83]
v_mul_f32 v58, v58, v26
v_mul_f32 v59, v59, v26
mf v[48:51],a[144:147],a[64:67]
wl
ar v22,a165
cv v116,v21,v22
mf v[64:67],a[128:131],a[64:67]
tr a[144:145],v6,16384
ar v21,a166
mf v[64:67],a[132:135],a[80:83]
tr a[146:147],v6,18432
v_mul_f32 v52, v52, v25
mf v[64:67],a[136:139],a[96:99]
tr a[148:149],v6,20480
v_mul_f32 v53, v53, v25
mf v[64:67],a[140:143],a[112:115]
tr a[150:151],v6,22528
v_mul_f32 v54, v54, v25
mf v[68:71],a[140:143],a[116:119]
tr a[152:153],v6,24576
v_mul_f32 v55, v55, v25
mf v[68:71],a[136:139],a[100:103]
tr a[154:155],v6,26624
v_mul_f32 v48, v48, v24
mf v[68:71],a[132:135],a[84:87]
tr a[156:157],v6,28672
v_mul_f32 v49, v49, v24
mf v[68:71],a[128:131],a[68:71]
tr a[158:159],v6,30720
v_mul_f32 v50, v50, v24
mf v[72:75],a[128:131],a[72:75]
s_add_u32 s39, s51, 129024
buffer_load_dwordx4 v3, s[20:23], s39 offen  lds
mf v[72:75],a[132:135],a[88:91]
s_add_u32 m0, s25, 19456
v_mul_f32 v51, v51, v24
v_mul_f32 v64, v64, v24
mf v[72:75],a[136:139],a[104:107]
s_add_u32 s39, s51, 136192
buffer_load_dwordx4 v3, s[20:23], s39 offen  lds
mf v[72:75],a[140:143],a[120:123]
s_add_u32 m0, s25, 32768
v_mul_f32 v65, v65, v24
v_mul_f32 v66, v66, v24
mf v[76:79],a[140:143],a[124:127]
ar v22,a167
v_mul_f32 v67, v67, v24
mf v[76:79],a[136:139],a[108:111]
v_mul_f32 v68, v68, v25
v_mul_f32 v69, v69, v25
mf v[76:79],a[132:135],a[92:95]
v_mul_f32 v70, v70, v25
v_mul_f32 v71, v71, v25
mf v[76:79],a[128:131],a[76:79]
wl
cv v117,v21,v22
ar v21,a180
mf v[92:95],a[144:147],a[76:79]
tr a[128:129],v15,32768
ar v22,a181
mf v[92:95],a[148:151],a[92:95]
tr a[130:131],v15,34816
v_mul_f32 v72, v72, v26
mf v[92:95],a[152:155],a[108:111]
tr a[132:133],v15,36864
v_mul_f32 v73, v73, v26
mf v[92:95],a[156:159],a[124:127]
tr a[134:135],v15,38912
v_mul_f32 v74, v74, v26
mf v[88:91],a[156:159],a[120:123]
tr a[136:137],v15,40960
v_mul_f32 v75, v75, v26
mf v[88:91],a[152:155],a[104:107]
tr a[138:139],v15,43008
v_mul_f32 v76, v76, v27
mf v[88:91],a[148:151],a[88:91]
tr a[140:141],v15,45056
v_mul_f32 v77, v77, v27
mf v[88:91],a[144:147],a[72:75]
tr a[142:143],v15,47104
v_mul_f32 v78, v78, v27
mf v[84:87],a[144:147],a[68:71]
s_add_u32 s39, s51, 229376
buffer_load_dwordx4 v3, s[20:23], s39 offen  lds
mf v[84:87],a[148:151],a[84:87]
s_add_u32 m0, s25, 33792
v_mul_f32 v79, v79, v27
v_mul_f32 v92, v92, v27
mf v[84:87],a[152:155],a[100:103]
s_add_u32 s39, s51, 236544
buffer_load_dwordx4 v3, s[20:23], s39 offen  lds
mf v[84:87],a[156:159],a[116:119]
s_add_u32 m0, s25, 34816
v_mul_f32 v93, v93, v27
v_mul_f32 v94, v94, v27
mf v[80:83],a[156:159],a[112:115]
cv v118,v21,v22
v_mul_f32 v95, v95, v27
mf v[80:83],a[152:155],a[96:99]
v_mul_f32 v88, v88, v26
v_mul_f32 v89, v89, v26
mf v[80:83],a[148:151],a[80:83]
v_mul_f32 v90, v90, v26
v_mul_f32 v91, v91, v26
mf v[80:83],a[144:147],a[64:67]
wl
ar v21,a182
ar v22,a183
mf v[32:35],a[128:131],v[96:99]
tr a[144:145],v5,32768
cv v119,v21,v22
mf v[32:35],a[132:135],v[128:131]
tr a[146:147],v5,34816
v_mul_f32 v84, v84, v25
mf v[32:35],a[136:139],v[160:163]
tr a[148:149],v5,36864
v_mul_f32 v85, v85, v25
mf v[32:35],a[140:143],v[192:195]
tr a[150:151],v5,38912
v_mul_f32 v86, v86, v25
mf v[36:39],a[140:143],v[196:199]
tr a[152:153],v5,40960
v_mul_f32 v87, v87, v25
mf v[36:39],a[136:139],v[164:167]
tr a[154:155],v5,43008
v_mul_f32 v80, v80, v24
mf v[36:39],a[132:135],v[132:135]
tr a[156:157],v5,45056
v_mul_f32 v81, v81, v24
mf v[36:39],a[128:131],v[100:103]
tr a[158:159],v5,47104
v_mul_f32 v82, v82, v24
mf v[40:43],a[128:131],v[104:107]
s_add_u32 s39, s51, 243712
buffer_load_dwordx4 v3, s[20:23], s39 offen  lds
mf v[40:43],a[132:135],v[136:139]
s_add_u32 m0, s25, 35840
ar v21,a196
v_mul_f32 v83, v83, v24
mf v[40:43],a[136:139],v[168:171]
s_add_u32 s39, s51, 250880
buffer_load_dwordx4 v3, s[20:23], s39 offen  lds
mf v[40:43],a[140:143],v[200:203]
s_add_u32 m0, s25, 49152
ar v22,a197
cv v148,v21,v22
mf v[44:47],a[140:143],v[204:207]
ar v21,a198
ar v22,a199
mf v[44:47],a[136:139],v[172:175]
cv v149,v21,v22
ar v21,a212
mf v[44:47],a[132:135],v[140:143]
ar v22,a213
cv v150,v21,v22
mf v[44:47],a[128:131],v[108:111]
wl
ar v21,a214
ar v22,a215
mf v[60:63],a[144:147],v[108:111]
tr a[128:129],v16,32768
cv v151,v21,v22
mf v[60:63],a[148:151],v[140:143]
tr a[130:131],v16,34816
ar v21,a228
mf v[60:63],a[152:155],v[172:175]
tr a[132:133],v16,36864
ar v22,a229
mf v[60:63],a[156:159],v[204:207]
tr a[134:135],v16,38912
cv v180,v21,v22
mf v[56:59],a[156:159],v[200:203]
tr a[136:137],v16,40960
ar v21,a230
mf v[56:59],a[152:155],v[168:171]
tr a[138:139],v16,43008
ar v22,a231
mf v[56:59],a[148:151],v[136:139]
tr a[140:141],v16,45056
cv v181,v21,v22
mf v[56:59],a[144:147],v[104:107]
tr a[142:143],v16,47104
ar v21,a244
mf v[52:55],a[144:147],v[100:103]
s_add_u32 s39, s51, 344064
buffer_load_dwordx4 v3, s[20:23], s39 offen  lds
mf v[52:55],a[148:151],v[132:135]
s_add_u32 m0, s25, 50176
ar v22,a245
cv v182,v21,v22
mf v[52:55],a[152:155],v[164:167]
s_add_u32 s39, s51, 351232
buffer_load_dwordx4 v3, s[20:23], s39 offen  lds
mf v[52:55],a[156:159],v[196:199]
s_add_u32 m0, s25, 51200
ar v21,a246
ar v22,a247
mf v[48:51],a[156:159],v[192:195]
cv v183,v21,v22
cv v232,v232,v233
mf v[48:51],a[152:155],v[160:163]
cv v233,v234,v235
cv v234,v248,v249
mf v[48:51],a[148:151],v[128:131]
cv v235,v250,v251
ar v21,a168
mf v[48:51],a[144:147],v[96:99]
wl
ar v22,a169
cv v120,v21,v22
mf v[64:67],a[128:131],v[96:99]
tr a[144:145],v6,32768
ar v21,a170
mf v[64:67],a[132:135],v[128:131]
tr a[146:147],v6,34816
ar v22,a171
mf v[64:67],a[136:139],v[160:163]
tr a[148:149],v6,36864
cv v121,v21,v22
mf v[64:67],a[140:143],v[192:195]
tr a[150:151],v6,38912
ar v21,a184
mf v[68:71],a[140:143],v[196:199]
tr a[152:153],v6,40960
ar v22,a185
mf v[68:71],a[136:139],v[164:167]
tr a[154:155],v6,43008
cv v122,v21,v22
mf v[68:71],a[132:135],v[132:135]
tr a[156:157],v6,45056
ar v21,a186
mf v[68:71],a[128:131],v[100:103]
tr a[158:159],v6,47104
ar v22,a187
mf v[72:75],a[128:131],v[104:107]
s_add_u32 s39, s51, 358400
buffer_load_dwordx4 v3, s[20:23], s39 offen  lds
mf v[72:75],a[132:135],v[136:139]
s_add_u32 m0, s25, 52224
cv v123,v21,v22
ar v21,a200
mf v[72:75],a[136:139],v[168:171]
s_add_u32 s39, s51, 365568
buffer_load_dwordx4 v3, s[20:23], s39 offen  lds
mf v[72:75],a[140:143],v[200:203]
s_add_u32 m0, s24, 0
ar v22,a201
cv v152,v21,v22
mf v[76:79],a[140:143],v[204:207]
ar v21,a202
ar v22,a203
mf v[76:79],a[136:139],v[172:175]
cv v153,v21,v22
ar v21,a216
mf v[76:79],a[132:135],v[140:143]
ar v22,a217
cv v154,v21,v22
mf v[76:79],a[128:131],v[108:111]
wl
ar v21,a218
ar v22,a219
mf v[92:95],a[144:147],v[108:111]
s_waitcnt vmcnt(16)
cv v155,v21,v22
s_barrier
mf v[92:95],a[148:151],v[140:143]
tr a[128:129],v15,49152
ar v21,a232
mf v[92:95],a[152:155],v[172:175]
tr a[130:131],v15,51200
ar v22,a233
mf v[92:95],a[156:159],v[204:207]
tr a[132:133],v15,53248
cv v184,v21,v22
mf v[88:91],a[156:159],v[200:203]
tr a[134:135],v15,55296
ar v21,a234
mf v[88:91],a[152:155],v[168:171]
tr a[136:137],v15,57344
ar v22,a235
mf v[88:91],a[148:151],v[136:139]
tr a[138:139],v15,59392
cv v185,v21,v22
mf v[88:91],a[144:147],v[104:107]
tr a[140:141],v15,61440
ar v21,a248
mf v[84:87],a[144:147],v[100:103]
tr a[142:143],v15,63488
ar v22,a249
mf v[84:87],a[148:151],v[132:135]
s_add_u32 s39, s52, 0
buffer_load_dwordx4 v3, s[20:23], s39 offen  lds
mf v[84:87],a[152:155],v[164:167]
s_add_u32 m0, s24, 1024
cv v186,v21,v22
ar v21,a250
mf v[84:87],a[156:159],v[196:199]
s_add_u32 s39, s52, 7168
buffer_load_dwordx4 v3, s[20:23], s39 offen  lds
mf v[80:83],a[156:159],v[192:195]
s_add_u32 m0, s24, 2048
ar v22,a251
cv v187,v21,v22
mf v[80:83],a[152:155],v[160:163]
cv v236,v236,v237
cv v237,v238,v239
mf v[80:83],a[148:151],v[128:131]
cv v238,v252,v253
cv v239,v254,v255
mf v[80:83],a[144:147],v[96:99]
wl
ar v21,a172
ar v22,a173
mf v[32:35],a[128:131],v[224:227]
tr a[144:145],v5,49152
cv v124,v21,v22
mf v[32:35],a[132:135],v[112:115]
tr a[146:147],v5,51200
ar v21,a174
mf v[32:35],a[136:139],v[144:147]
tr a[148:149],v5,53248
ar v22,a175
mf v[32:35],a[140:143],v[176:179]
tr a[150:151],v5,55296
cv v125,v21,v22
mf v[36:39],a[140:143],v[180:183]
tr a[152:153],v5,57344
ar v21,a188
mf v[36:39],a[136:139],v[148:151]
tr a[154:155],v5,59392
ar v22,a189
mf v[36:39],a[132:135],v[116:119]
tr a[156:157],v5,61440
cv v126,v21,v22
mf v[36:39],a[128:131],v[228:231]
tr a[158:159],v5,63488
ar v21,a190
mf v[40:43],a[128:131],v[232:235]
s_add_u32 s39, s52, 14336
buffer_load_dwordx4 v3, s[20:23], s39 offen  lds
mf v[40:43],a[132:135],v[120:123]
ar v22,a191
cv v127,v21,v22
ar v21,a204
ar v22,a205
cv v156,v21,v22
ar v21,a206
ar v22,a207
cv v157,v21,v22
ar v21,a220
ar v22,a221
cv v158,v21,v22
ar v21,a222
ar v22,a223
cv v159,v21,v22
ar v21,a236
ar v22,a237
cv v188,v21,v22
ar v21,a238
ar v22,a239
cv v189,v21,v22
ar v21,a252
ar v22,a253
cv v190,v21,v22
ar v21,a254
ar v22,a255
cv v191,v21,v22
mf v[40:43],a[136:139],v[152:155]
s_add_u32 m0, s24, 3072
v_mul_f32 v32, v32, v28
v_mul_f32 v33, v33, v28
mf v[40:43],a[140:143],v[184:187]
s_add_u32 s39, s52, 21504
buffer_load_dwordx4 v3, s[20:23], s39 offen  lds
mf v[44:47],a[140:143],v[188:191]
s_add_u32 m0, s24, 16384
v_mul_f32 v34, v34, v28
v_mul_f32 v35, v35, v28
mf v[44:47],a[136:139],v[156:159]
cv v32,v32,v33
cv v33,v34,v35
mf v[44:47],a[132:135],v[124:127]
v_mul_f32 v36, v36, v29
v_mul_f32 v37, v37, v29
mf v[44:47],a[128:131],v[236:239]
wl
v_mul_f32 v38, v38, v29
v_mul_f32 v39, v39, v29
mf v[60:63],a[144:147],v[236:239]
tr a[128:129],v16,49152
cv v36,v36,v37
mf v[60:63],a[148:151],v[124:127]
tr a[130:131],v16,51200
cv v37,v38,v39
mf v[60:63],a[152:155],v[156:159]
tr a[132:133],v16,53248
v_mul_f32 v40, v40, v30
mf v[60:63],a[156:159],v[188:191]
tr a[134:135],v16,55296
v_mul_f32 v41, v41, v30
mf v[56:59],a[156:159],v[184:187]
tr a[136:137],v16,57344
v_mul_f32 v42, v42, v30
mf v[56:59],a[152:155],v[152:155]
tr a[138:139],v16,59392
v_mul_f32 v43, v43, v30
mf v[56:59],a[148:151],v[120:123]
tr a[140:141],v16,61440
cv v40,v40,v41
mf v[56:59],a[144:147],v[232:235]
tr a[142:143],v16,63488
cv v41,v42,v43
mf v[52:55],a[144:147],v[228:231]
s_add_u32 s39, s52, 114688
buffer_load_dwordx4 v3, s[20:23], s39 offen  lds
mf v[52:55],a[148:151],v[116:119]
s_add_u32 m0, s24, 17408
v_mul_f32 v44, v44, v31
v_mul_f32 v45, v45, v31
mf v[52:55],a[152:155],v[148:151]
s_add_u32 s39, s52, 121856
buffer_load_dwordx4 v3, s[20:23], s39 offen  lds
mf v[52:55],a[156:159],v[180:183]
s_add_u32 m0, s24, 18432
v_mul_f32 v46, v46, v31
v_mul_f32 v47, v47, v31
mf v[48:51],a[156:159],v[176:179]
cv v44,v44,v45
cv v45,v46,v47
mf v[48:51],a[152:155],v[144:147]
v_mul_f32 v60, v60, v31
v_mul_f32 v61, v61, v31
mf v[48:51],a[148:151],v[112:115]
v_mul_f32 v62, v62, v31
v_mul_f32 v63, v63, v31
mf v[48:51],a[144:147],v[224:227]
wl
cv v46,v60,v61
cv v47,v62,v63
mf v[64:67],a[128:131],v[224:227]
tr a[144:145],v6,49152
v_mul_f32 v56, v56, v30
mf v[64:67],a[132:135],v[112:115]
tr a[146:147],v6,51200
v_mul_f32 v57, v57, v30
mf v[64:67],a[136:139],v[144:147]
tr a[148:149],v6,53248
v_mul_f32 v58, v58, v30
mf v[64:67],a[140:143],v[176:179]
tr a[150:151],v6,55296
v_mul_f32 v59, v59, v30
mf v[68:71],a[140:143],v[180:183]
tr a[152:153],v6,57344
cv v42,v56,v57
mf v[68:71],a[136:139],v[148:151]
tr a[154:155],v6,59392
cv v43,v58,v59
mf v[68:71],a[132:135],v[116:119]
tr a[156:157],v6,61440
v_mul_f32 v52, v52, v29
mf v[68:71],a[128:131],v[228:231]
tr a[158:159],v6,63488
v_mul_f32 v53, v53, v29
mf v[72:75],a[128:131],v[232:235]
s_add_u32 s39, s52, 129024
buffer_load_dwordx4 v3, s[20:23], s39 offen  lds
mf v[72:75],a[132:135],v[120:123]
s_add_u32 s38, s40, 49152
buffer_store_dwordx4 v[44:47], v1, s[28:31], s38 offen
mf v[72:75],a[136:139],v[152:155]
s_add_u32 s38, s40, 32768
buffer_store_dwordx4 v[40:43], v1, s[28:31], s38 offen
mf v[72:75],a[140:143],v[184:187]
s_add_u32 m0, s24, 19456
v_mul_f32 v54, v54, v29
v_mul_f32 v55, v55, v29
mf v[76:79],a[140:143],v[188:191]
s_add_u32 s39, s52, 136192
buffer_load_dwordx4 v3, s[20:23], s39 offen  lds
mf v[76:79],a[136:139],v[156:159]
s_mov_b32 s45, s51
cv v38,v52,v53
cv v39,v54,v55
mf v[76:79],a[132:135],v[124:127]
s_add_u32 s38, s40, 16384
buffer_store_dwordx4 v[36:39], v1, s[28:31], s38 offen
mf v[76:79],a[128:131],v[236:239]
wl
v_mul_f32 v48, v48, v28
v_mul_f32 v49, v49, v28
mf v[92:95],a[144:147],v[236:239]
s_waitcnt vmcnt(19)
v_mul_f32 v50, v50, v28
s_barrier
mf v[92:95],a[148:151],v[124:127]
s_mov_b32 s51, s52
v_mul_f32 v51, v51, v28
v_xor_b32 v15, 0x10000, v15
mf v[92:95],a[152:155],v[156:159]
tr a[128:129],v15,0
cv v34,v48,v49
mf v[92:95],a[156:159],v[188:191]
tr a[130:131],v15,2048
cv v35,v50,v51
mf v[88:91],a[156:159],v[184:187]
tr a[132:133],v15,4096
v_mul_f32 v64, v64, v28
mf v[88:91],a[152:155],v[152:155]
tr a[134:135],v15,6144
v_mul_f32 v65, v65, v28
mf v[88:91],a[148:151],v[120:123]
tr a[136:137],v15,8192
v_mul_f32 v66, v66, v28
mf v[88:91],a[144:147],v[232:235]
tr a[138:139],v15,10240
v_mul_f32 v67, v67, v28
mf v[84:87],a[144:147],v[228:231]
tr a[140:141],v15,12288
cv v64,v64,v65
mf v[84:87],a[148:151],v[116:119]
tr a[142:143],v15,14336
cv v65,v66,v67
mf v[84:87],a[152:155],v[148:151]
s_add_u32 s38, s40, 0
buffer_store_dwordx4 v[32:35], v1, s[28:31], s38 offen
mf v[84:87],a[156:159],v[180:183]
s_xor_b32 s24, s24, 0x10000
v_mul_f32 v68, v68, v29
v_mul_f32 v69, v69, v29
mf v[80:83],a[156:159],v[176:179]
s_xor_b32 s25, s25, 0x10000
v_mul_f32 v70, v70, v29
v_mul_f32 v71, v71, v29
mf v[80:83],a[152:155],v[144:147]
s_add_u32 s41, s41, 1
cv v68,v68,v69
cv v69,v70,v71
mf v[80:83],a[148:151],v[112:115]
v_mul_f32 v72, v72, v30
v_mul_f32 v73, v73, v30
v_mul_f32 v74, v74, v30
v_mul_f32 v75, v75, v30
cv v72,v72,v73
cv v73,v74,v75
v_mul_f32 v76, v76, v31
v_mul_f32 v77, v77, v31
v_mul_f32 v78, v78, v31
v_mul_f32 v79, v79, v31
cv v76,v76,v77
cv v77,v78,v79
mf v[80:83],a[144:147],v[224:227]
wl
v_add_u32 v4, 2359296, v0
v_bfe_u32 v218, v1, 5, 3
v_bfe_u32 v219, v1, 8, 2
v_lshlrev_b32 v219, 1, v219
v_xor_b32 v218, v218, v219
v_and_b32 v219, 16, v1
v_mov_b32 v0, 0x3f80
v_lshlrev_b32 v219, v219, v0
v_cmp_eq_u32 vcc, 0, v218
v_cmp_eq_u32 s[72:73], 1, v218
v_nop
v_cndmask_b32 v216, 0, v219, vcc
v_cndmask_b32 v217, 0, v219, s[72:73]
v_mov_b32 v218, v216
v_mov_b32 v219, v217
v_xor_b32 v5, 0x10000, v5
v_xor_b32 v16, 0x10000, v16
v_xor_b32 v6, 0x10000, v6
.p2align 5
Loloopf_a:
mz v[32:35],a[128:131],a[0:3],0
tr a[144:145],v15,16384
v_mul_f32 v92, v92, v31
mf v[32:35],a[132:135],a[16:19]
tr a[146:147],v15,18432
v_mul_f32 v93, v93, v31
mf v[32:35],a[136:139],a[32:35]
tr a[148:149],v15,20480
v_mul_f32 v94, v94, v31
mf v[32:35],a[140:143],a[48:51]
tr a[150:151],v15,22528
v_mul_f32 v95, v95, v31
mz v[36:39],a[140:143],a[52:55],0
tr a[152:153],v15,24576
cv v78,v92,v93
mf v[36:39],a[136:139],a[36:39]
tr a[154:155],v15,26624
cv v79,v94,v95
mf v[36:39],a[132:135],a[20:23]
tr a[156:157],v15,28672
v_mul_f32 v88, v88, v30
mf v[36:39],a[128:131],a[4:7]
tr a[158:159],v15,30720
v_mul_f32 v89, v89, v30
mz v[40:43],a[128:131],a[8:11],0
s_add_u32 s38, s40, 57344
buffer_store_dwordx4 v[76:79], v1, s[28:31], s38 offen
mf v[40:43],a[132:135],a[24:27]
s_add_u32 s48, s51, 128
v_mul_f32 v90, v90, v30
v_mul_f32 v91, v91, v30
mf v[40:43],a[136:139],a[40:43]
s_cmp_lt_u32 s41, 5
s_cselect_b32 s52, s48, 0x40000000
cv v74,v88,v89
cv v75,v90,v91
mf v[40:43],a[140:143],a[56:59]
s_add_u32 s38, s40, 40960
buffer_store_dwordx4 v[72:75], v1, s[28:31], s38 offen
mz v[44:47],a[140:143],a[60:63],0
v_mul_f32 v84, v84, v29
v_mul_f32 v85, v85, v29
mf v[44:47],a[136:139],a[44:47]
v_mul_f32 v86, v86, v29
v_mul_f32 v87, v87, v29
mf v[44:47],a[132:135],a[28:31]
cv v70,v84,v85
cv v71,v86,v87
mf v[44:47],a[128:131],a[12:15]
wl
v_mul_f32 v80, v80, v28
v_mul_f32 v81, v81, v28
mf v[44:47],a[144:147],a[76:79]
tr a[128:129],v5,16384
v_mul_f32 v82, v82, v28
mf v[44:47],a[148:151],a[92:95]
tr a[130:131],v5,18432
v_mul_f32 v83, v83, v28
mf v[44:47],a[152:155],a[108:111]
tr a[132:133],v5,20480
cv v66,v80,v81
mf v[44:47],a[156:159],a[124:127]
tr a[134:135],v5,22528
cv v67,v82,v83
mf v[40:43],a[156:159],a[120:123]
tr a[136:137],v5,24576
cv v222,v212,v213
mf v[40:43],a[152:155],a[104:107]
tr a[138:139],v5,26624
cv v223,v214,v215
mf v[40:43],a[148:151],a[88:91]
tr a[140:141],v5,28672
cv v220,v208,v209
mf v[40:43],a[144:147],a[72:75]
tr a[142:143],v5,30720
cv v221,v210,v211
mf v[36:39],a[144:147],a[68:71]
s_add_u32 s38, s40, 24576
buffer_store_dwordx4 v[68:71], v1, s[28:31], s38 offen
mf v[36:39],a[148:151],a[84:87]
v_mul_f32 v44, v44, v27
v_mul_f32 v45, v45, v27
mf v[36:39],a[152:155],a[100:103]
v_mul_f32 v46, v46, v27
v_mul_f32 v47, v47, v27
mf v[36:39],a[156:159],a[116:119]
s_add_u32 s38, s40, 8192
buffer_store_dwordx4 v[64:67], v1, s[28:31], s38 offen
mf v[32:35],a[156:159],a[112:115]
s_xor_b32 s40, s40, 262144
mf v[32:35],a[152:155],a[96:99]
v_mul_f32 v40, v40, v26
v_mul_f32 v41, v41, v26
mf v[32:35],a[148:151],a[80:83]
v_mul_f32 v42, v42, v26
v_mul_f32 v43, v43, v26
mf v[32:35],a[144:147],a[64:67]
wl
mz v[48:51],a[128:131],a[64:67],0
tr a[144:145],v5,0
mf v[48:51],a[132:135],a[80:83]
tr a[146:147],v5,2048
v_mul_f32 v36, v36, v25
mf v[48:51],a[136:139],a[96:99]
tr a[148:149],v5,4096
v_mul_f32 v37, v37, v25
mf v[48:51],a[140:143],a[112:115]
tr a[150:151],v5,6144
v_mul_f32 v38, v38, v25
mz v[52:55],a[140:143],a[116:119],0
tr a[152:153],v5,8192
v_mul_f32 v39, v39, v25
mf v[52:55],a[136:139],a[100:103]
tr a[154:155],v5,10240
v_mul_f32 v32, v32, v24
mf v[52:55],a[132:135],a[84:87]
tr a[156:157],v5,12288
v_mul_f32 v33, v33, v24
mf v[52:55],a[128:131],a[68:71]
tr a[158:159],v5,14336
v_mul_f32 v34, v34, v24
mz v[56:59],a[128:131],a[72:75],0
v_mul_f32 v35, v35, v24
mf v[56:59],a[132:135],a[88:91]
mf v[56:59],a[136:139],a[104:107]
mf v[56:59],a[140:143],a[120:123]
mz v[60:63],a[140:143],a[124:127],0
mf v[60:63],a[136:139],a[108:111]
mf v[60:63],a[132:135],a[92:95]
mf v[60:63],a[128:131],a[76:79]
wl
mf v[60:63],a[144:147],a[12:15]
tr a[128:129],v16,0
mf v[60:63],a[148:151],a[28:31]
tr a[130:131],v16,2048
mf v[60:63],a[152:155],a[44:47]
tr a[132:133],v16,4096
mf v[60:63],a[156:159],a[60:63]
tr a[134:135],v16,6144
mf v[56:59],a[156:159],a[56:59]
tr a[136:137],v16,8192
v_mov_b32 v0, s41
mf v[56:59],a[152:155],a[40:43]
tr a[138:139],v16,10240
mf v[56:59],a[148:151],a[24:27]
tr a[140:141],v16,12288
mf v[56:59],a[144:147],a[8:11]
tr a[142:143],v16,14336
mf v[52:55],a[144:147],a[4:7]
s_waitcnt vmcnt(0)
buffer_store_dword v0, v17, s[28:31], 0 offen
mf v[52:55],a[148:151],a[20:23]
v_mul_f32 v60, v60, v27
v_mul_f32 v61, v61, v27
mf v[52:55],a[152:155],a[36:39]
v_mul_f32 v62, v62, v27
v_mul_f32 v63, v63, v27
mf v[52:55],a[156:159],a[52:55]
mf v[48:51],a[156:159],a[48:51]
mf v[48:51],a[152:155],a[32:35]
v_mul_f32 v56, v56, v26
v_mul_f32 v57, v57, v26
mf v[48:51],a[148:151],a[16:19]
v_mul_f32 v58, v58, v26
v_mul_f32 v59, v59, v26
mf v[48:51],a[144:147],a[0:3]
wl
mz v[64:67],a[128:131],a[0:3],0
tr a[144:145],v16,16384
mf v[64:67],a[132:135],a[16:19]
tr a[146:147],v16,18432
v_mul_f32 v52, v52, v25
mf v[64:67],a[136:139],a[32:35]
tr a[148:149],v16,20480
v_mul_f32 v53, v53, v25
mf v[64:67],a[140:143],a[48:51]
tr a[150:151],v16,22528
v_mul_f32 v54, v54, v25
mz v[68:71],a[140:143],a[52:55],0
tr a[152:153],v16,24576
v_mul_f32 v55, v55, v25
mf v[68:71],a[136:139],a[36:39]
tr a[154:155],v16,26624
v_mul_f32 v48, v48, v24
mf v[68:71],a[132:135],a[20:23]
tr a[156:157],v16,28672
v_mul_f32 v49, v49, v24
mf v[68:71],a[128:131],a[4:7]
tr a[158:159],v16,30720
v_mul_f32 v50, v50, v24
mz v[72:75],a[128:131],a[8:11],0
v_mul_f32 v51, v51, v24
mf v[72:75],a[132:135],a[24:27]
mf v[72:75],a[136:139],a[40:43]
mf v[72:75],a[140:143],a[56:59]
mz v[76:79],a[140:143],a[60:63],0
mf v[76:79],a[136:139],a[44:47]
mf v[76:79],a[132:135],a[28:31]
mf v[76:79],a[128:131],a[12:15]
wl
mf v[76:79],a[144:147],a[76:79]
tr a[128:129],v6,16384
mf v[76:79],a[148:151],a[92:95]
tr a[130:131],v6,18432
mf v[76:79],a[152:155],a[108:111]
tr a[132:133],v6,20480
mf v[76:79],a[156:159],a[124:127]
tr a[134:135],v6,22528
mf v[72:75],a[156:159],a[120:123]
tr a[136:137],v6,24576
mf v[72:75],a[152:155],a[104:107]
tr a[138:139],v6,26624
mf v[72:75],a[148:151],a[88:91]
tr a[140:141],v6,28672
mf v[72:75],a[144:147],a[72:75]
tr a[142:143],v6,30720
mf v[68:71],a[144:147],a[68:71]
mf v[68:71],a[148:151],a[84:87]
v_mul_f32 v76, v76, v27
v_mul_f32 v77, v77, v27
mf v[68:71],a[152:155],a[100:103]
v_mul_f32 v78, v78, v27
v_mul_f32 v79, v79, v27
mf v[68:71],a[156:159],a[116:119]
mf v[64:67],a[156:159],a[112:115]
mf v[64:67],a[152:155],a[96:99]
v_mul_f32 v72, v72, v26
v_mul_f32 v73, v73, v26
mf v[64:67],a[148:151],a[80:83]
v_mul_f32 v74, v74, v26
v_mul_f32 v75, v75, v26
mf v[64:67],a[144:147],a[64:67]
wl
mz v[80:83],a[128:131],a[64:67],0
tr a[144:145],v6,0
mf v[80:83],a[132:135],a[80:83]
tr a[146:147],v6,2048
v_mul_f32 v68, v68, v25
mf v[80:83],a[136:139],a[96:99]
tr a[148:149],v6,4096
v_mul_f32 v69, v69, v25
mf v[80:83],a[140:143],a[112:115]
tr a[150:151],v6,6144
v_mul_f32 v70, v70, v25
mz v[84:87],a[140:143],a[116:119],0
tr a[152:153],v6,8192
v_mul_f32 v71, v71, v25
mf v[84:87],a[136:139],a[100:103]
tr a[154:155],v6,10240
v_mul_f32 v64, v64, v24
mf v[84:87],a[132:135],a[84:87]
tr a[156:157],v6,12288
v_mul_f32 v65, v65, v24
mf v[84:87],a[128:131],a[68:71]
tr a[158:159],v6,14336
v_mul_f32 v66, v66, v24
mz v[88:91],a[128:131],a[72:75],0
v_mul_f32 v67, v67, v24
mf v[88:91],a[132:135],a[88:91]
mf v[88:91],a[136:139],a[104:107]
mf v[88:91],a[140:143],a[120:123]
mz v[92:95],a[140:143],a[124:127],0
mf v[92:95],a[136:139],a[108:111]
buffer_store_dwordx4 v[220:223], v2, s[92:95], s53 offen nt
mf v[92:95],a[132:135],a[92:95]
s_mov_b32 s53, s27
s_add_u32 s27, s27, 128
mf v[92:95],a[128:131],a[76:79]
wl
mf v[92:95],a[144:147],a[12:15]
s_barrier
mf v[92:95],a[148:151],a[28:31]
tr a[128:129],v15,32768
mf v[92:95],a[152:155],a[44:47]
tr a[130:131],v15,34816
mf v[92:95],a[156:159],a[60:63]
tr a[132:133],v15,36864
mf v[88:91],a[156:159],a[56:59]
tr a[134:135],v15,38912
mf v[88:91],a[152:155],a[40:43]
tr a[136:137],v15,40960
mf v[88:91],a[148:151],a[24:27]
tr a[138:139],v15,43008
mf v[88:91],a[144:147],a[8:11]
tr a[140:141],v15,45056
mf v[84:87],a[144:147],a[4:7]
tr a[142:143],v15,47104
mf v[84:87],a[148:151],a[20:23]
buffer_load_dword v23, v4, s[28:31], 0 offen sc1
mf v[84:87],a[152:155],a[36:39]
v_mul_f32 v92, v92, v27
v_mul_f32 v93, v93, v27
mf v[84:87],a[156:159],a[52:55]
v_mul_f32 v94, v94, v27
v_mul_f32 v95, v95, v27
mf v[80:83],a[156:159],a[48:51]
mf v[80:83],a[152:155],a[32:35]
v_mul_f32 v88, v88, v26
v_mul_f32 v89, v89, v26
mf v[80:83],a[148:151],a[16:19]
v_mul_f32 v90, v90, v26
v_mul_f32 v91, v91, v26
mf v[80:83],a[144:147],a[0:3]
wl
mf v[32:35],a[128:131],v[96:99]
tr a[144:145],v15,49152
mf v[32:35],a[132:135],v[128:131]
tr a[146:147],v15,51200
v_mul_f32 v84, v84, v25
mf v[32:35],a[136:139],v[160:163]
tr a[148:149],v15,53248
v_mul_f32 v85, v85, v25
mf v[32:35],a[140:143],v[192:195]
tr a[150:151],v15,55296
v_mul_f32 v86, v86, v25
mf v[36:39],a[140:143],v[196:199]
tr a[152:153],v15,57344
v_mul_f32 v87, v87, v25
mf v[36:39],a[136:139],v[164:167]
tr a[154:155],v15,59392
v_mul_f32 v80, v80, v24
mf v[36:39],a[132:135],v[132:135]
tr a[156:157],v15,61440
v_mul_f32 v81, v81, v24
mf v[36:39],a[128:131],v[100:103]
tr a[158:159],v15,63488
v_mul_f32 v82, v82, v24
mf v[40:43],a[128:131],v[104:107]
v_mul_f32 v83, v83, v24
mf v[40:43],a[132:135],v[136:139]
mf v[40:43],a[136:139],v[168:171]
mf v[40:43],a[140:143],v[200:203]
mf v[44:47],a[140:143],v[204:207]
mf v[44:47],a[136:139],v[172:175]
mf v[44:47],a[132:135],v[140:143]
mf v[44:47],a[128:131],v[108:111]
wl
mf v[44:47],a[144:147],v[236:239]
tr a[128:129],v5,49152
mf v[44:47],a[148:151],v[124:127]
tr a[130:131],v5,51200
mf v[44:47],a[152:155],v[156:159]
tr a[132:133],v5,53248
mf v[44:47],a[156:159],v[188:191]
tr a[134:135],v5,55296
mf v[40:43],a[156:159],v[184:187]
s_waitcnt vmcnt(0)
tr a[136:137],v5,57344
mf v[40:43],a[152:155],v[152:155]
tr a[138:139],v5,59392
v_cmp_gt_u32 vcc, s41, v23
mf v[40:43],a[148:151],v[120:123]
tr a[140:141],v5,61440
mf v[40:43],a[144:147],v[232:235]
tr a[142:143],v5,63488
mf v[36:39],a[144:147],v[228:231]
s_cbranch_vccnz Lspinf_a
Lspunf_a:
mf v[36:39],a[148:151],v[116:119]
s_add_u32 s72, s26, 4096
buffer_load_dwordx2 a[162:163], v1, s[28:31], s26 offen offset:8 sc1
mf v[36:39],a[152:155],v[148:151]
v_mul_f32 v44, v44, v31
v_mul_f32 v45, v45, v31
mf v[36:39],a[156:159],v[180:183]
v_mul_f32 v46, v46, v31
v_mul_f32 v47, v47, v31
mf v[32:35],a[156:159],v[176:179]
buffer_load_dwordx4 a[164:167], v1, s[28:31], s26 offen offset:1024 sc1
mf v[32:35],a[152:155],v[144:147]
cv v44,v44,v45
cv v45,v46,v47
mf v[32:35],a[148:151],v[112:115]
v_mul_f32 v40, v40, v30
v_mul_f32 v41, v41, v30
mf v[32:35],a[144:147],v[224:227]
wl
buffer_load_dwordx4 a[168:171], v1, s[28:31], s26 offen offset:2048 sc1
mf v[48:51],a[128:131],v[224:227]
tr a[144:145],v5,32768
v_mul_f32 v42, v42, v30
mf v[48:51],a[132:135],v[112:115]
tr a[146:147],v5,34816
v_mul_f32 v43, v43, v30
mf v[48:51],a[136:139],v[144:147]
tr a[148:149],v5,36864
cv v40,v40,v41
mf v[48:51],a[140:143],v[176:179]
tr a[150:151],v5,38912
cv v41,v42,v43
mf v[52:55],a[140:143],v[180:183]
tr a[152:153],v5,40960
v_mul_f32 v36, v36, v29
mf v[52:55],a[136:139],v[148:151]
tr a[154:155],v5,43008
v_mul_f32 v37, v37, v29
mf v[52:55],a[132:135],v[116:119]
tr a[156:157],v5,45056
v_mul_f32 v38, v38, v29
mf v[52:55],a[128:131],v[228:231]
tr a[158:159],v5,47104
v_mul_f32 v39, v39, v29
mf v[56:59],a[128:131],v[232:235]
buffer_load_dwordx4 a[172:175], v1, s[28:31], s26 offen offset:3072 sc1
mf v[56:59],a[132:135],v[120:123]
cv v36,v36,v37
cv v37,v38,v39
mf v[56:59],a[136:139],v[152:155]
v_mul_f32 v32, v32, v28
v_mul_f32 v33, v33, v28
mf v[56:59],a[140:143],v[184:187]
buffer_load_dwordx4 a[176:179], v1, s[28:31], s72 offen offset:0 sc1
mf v[60:63],a[140:143],v[188:191]
v_mul_f32 v34, v34, v28
v_mul_f32 v35, v35, v28
mf v[60:63],a[136:139],v[156:159]
cv v32,v32,v33
cv v33,v34,v35
mf v[60:63],a[132:135],v[124:127]
buffer_load_dwordx4 a[180:183], v1, s[28:31], s72 offen offset:1024 sc1
mf v[60:63],a[128:131],v[236:239]
wl
mf v[60:63],a[144:147],v[108:111]
tr a[128:129],v16,32768
mf v[60:63],a[148:151],v[140:143]
tr a[130:131],v16,34816
mf v[60:63],a[152:155],v[172:175]
tr a[132:133],v16,36864
mf v[60:63],a[156:159],v[204:207]
tr a[134:135],v16,38912
mf v[56:59],a[156:159],v[200:203]
tr a[136:137],v16,40960
mf v[56:59],a[152:155],v[168:171]
tr a[138:139],v16,43008
mf v[56:59],a[148:151],v[136:139]
tr a[140:141],v16,45056
mf v[56:59],a[144:147],v[104:107]
tr a[142:143],v16,47104
mf v[52:55],a[144:147],v[100:103]
buffer_load_dwordx4 a[184:187], v1, s[28:31], s72 offen offset:2048 sc1
mf v[52:55],a[148:151],v[132:135]
v_mul_f32 v60, v60, v31
v_mul_f32 v61, v61, v31
mf v[52:55],a[152:155],v[164:167]
v_mul_f32 v62, v62, v31
v_mul_f32 v63, v63, v31
mf v[52:55],a[156:159],v[196:199]
buffer_load_dwordx4 a[188:191], v1, s[28:31], s72 offen offset:3072 sc1
mf v[48:51],a[156:159],v[192:195]
cv v46,v60,v61
cv v47,v62,v63
mf v[48:51],a[152:155],v[160:163]
v_mul_f32 v56, v56, v30
v_mul_f32 v57, v57, v30
mf v[48:51],a[148:151],v[128:131]
buffer_load_dwordx2 a[192:193], v1, s[28:31], s26 offen offset:0 sc1
mf v[48:51],a[144:147],v[96:99]
s_xor_b32 s26, s26, 262144
v_mul_f32 v58, v58, v30
wl
mf v[64:67],a[128:131],v[96:99]
tr a[144:145],v16,49152
v_mul_f32 v59, v59, v30
mf v[64:67],a[132:135],v[128:131]
tr a[146:147],v16,51200
cv v42,v56,v57
mf v[64:67],a[136:139],v[160:163]
tr a[148:149],v16,53248
cv v43,v58,v59
mf v[64:67],a[140:143],v[192:195]
tr a[150:151],v16,55296
v_mul_f32 v52, v52, v29
mf v[68:71],a[140:143],v[196:199]
tr a[152:153],v16,57344
v_mul_f32 v53, v53, v29
mf v[68:71],a[136:139],v[164:167]
tr a[154:155],v16,59392
v_mul_f32 v54, v54, v29
mf v[68:71],a[132:135],v[132:135]
tr a[156:157],v16,61440
v_mul_f32 v55, v55, v29
mf v[68:71],a[128:131],v[100:103]
tr a[158:159],v16,63488
cv v38,v52,v53
mf v[72:75],a[128:131],v[104:107]
s_mov_b32 s45, s51
cv v39,v54,v55
v_mul_f32 v48, v48, v28
mf v[72:75],a[132:135],v[136:139]
s_mov_b32 s51, s52
v_mul_f32 v49, v49, v28
v_mul_f32 v50, v50, v28
mf v[72:75],a[136:139],v[168:171]
s_xor_b32 s24, s24, 0x10000
v_mul_f32 v51, v51, v28
cv v34,v48,v49
mf v[72:75],a[140:143],v[200:203]
s_xor_b32 s25, s25, 0x10000
cv v35,v50,v51
mf v[76:79],a[140:143],v[204:207]
mf v[76:79],a[136:139],v[172:175]
mf v[76:79],a[132:135],v[140:143]
mf v[76:79],a[128:131],v[108:111]
wl
mf v[76:79],a[144:147],v[236:239]
tr a[128:129],v6,49152
mf v[76:79],a[148:151],v[124:127]
tr a[130:131],v6,51200
mf v[76:79],a[152:155],v[156:159]
tr a[132:133],v6,53248
mf v[76:79],a[156:159],v[188:191]
tr a[134:135],v6,55296
mf v[72:75],a[156:159],v[184:187]
tr a[136:137],v6,57344
mf v[72:75],a[152:155],v[152:155]
tr a[138:139],v6,59392
mf v[72:75],a[148:151],v[120:123]
tr a[140:141],v6,61440
mf v[72:75],a[144:147],v[232:235]
tr a[142:143],v6,63488
mf v[68:71],a[144:147],v[228:231]
mf v[68:71],a[148:151],v[116:119]
s_cmp_eq_u32 s41, 5
s_cbranch_scc1 Lofork_a
mf v[68:71],a[152:155],v[148:151]
s_add_u32 s38, s40, 49152
buffer_store_dwordx4 v[44:47], v1, s[28:31], s38 offen
mf v[68:71],a[156:159],v[180:183]
v_mul_f32 v76, v76, v31
v_mul_f32 v77, v77, v31
mf v[64:67],a[156:159],v[176:179]
v_mul_f32 v78, v78, v31
v_mul_f32 v79, v79, v31
mf v[64:67],a[152:155],v[144:147]
s_add_u32 s38, s40, 32768
buffer_store_dwordx4 v[40:43], v1, s[28:31], s38 offen
mf v[64:67],a[148:151],v[112:115]
cv v76,v76,v77
cv v77,v78,v79
mf v[64:67],a[144:147],v[224:227]
wl
v_mul_f32 v72, v72, v30
v_mul_f32 v73, v73, v30
mf v[80:83],a[128:131],v[224:227]
tr a[144:145],v6,32768
v_mul_f32 v74, v74, v30
mf v[80:83],a[132:135],v[112:115]
tr a[146:147],v6,34816
v_mul_f32 v75, v75, v30
mf v[80:83],a[136:139],v[144:147]
tr a[148:149],v6,36864
cv v72,v72,v73
mf v[80:83],a[140:143],v[176:179]
tr a[150:151],v6,38912
cv v73,v74,v75
mf v[84:87],a[140:143],v[180:183]
tr a[152:153],v6,40960
v_mul_f32 v68, v68, v29
mf v[84:87],a[136:139],v[148:151]
tr a[154:155],v6,43008
v_mul_f32 v69, v69, v29
mf v[84:87],a[132:135],v[116:119]
tr a[156:157],v6,45056
v_mul_f32 v70, v70, v29
mf v[84:87],a[128:131],v[228:231]
tr a[158:159],v6,47104
v_mul_f32 v71, v71, v29
mf v[88:91],a[128:131],v[232:235]
s_add_u32 s38, s40, 16384
buffer_store_dwordx4 v[36:39], v1, s[28:31], s38 offen
mf v[88:91],a[132:135],v[120:123]
cv v68,v68,v69
cv v69,v70,v71
mf v[88:91],a[136:139],v[152:155]
v_mul_f32 v64, v64, v28
v_mul_f32 v65, v65, v28
mf v[88:91],a[140:143],v[184:187]
s_add_u32 s38, s40, 0
buffer_store_dwordx4 v[32:35], v1, s[28:31], s38 offen
mf v[92:95],a[140:143],v[188:191]
v_mul_f32 v66, v66, v28
v_mul_f32 v67, v67, v28
mf v[92:95],a[136:139],v[156:159]
cv v64,v64,v65
cv v65,v66,v67
mf v[92:95],a[132:135],v[124:127]
mf v[92:95],a[128:131],v[236:239]
wl
mf v[92:95],a[144:147],v[108:111]
s_barrier
v_xor_b32 v5, 0x10000, v5
v_xor_b32 v16, 0x10000, v16
mf v[92:95],a[148:151],v[140:143]
v_xor_b32 v6, 0x10000, v6
v_xor_b32 v15, 0x10000, v15
mf v[92:95],a[152:155],v[172:175]
tr a[128:129],v15,0
mf v[92:95],a[156:159],v[204:207]
tr a[130:131],v15,2048
mf v[88:91],a[156:159],v[200:203]
tr a[132:133],v15,4096
mf v[88:91],a[152:155],v[168:171]
tr a[134:135],v15,6144
mf v[88:91],a[148:151],v[136:139]
tr a[136:137],v15,8192
mf v[88:91],a[144:147],v[104:107]
tr a[138:139],v15,10240
mf v[84:87],a[144:147],v[100:103]
tr a[140:141],v15,12288
mf v[84:87],a[148:151],v[132:135]
tr a[142:143],v15,14336
mf v[84:87],a[152:155],v[164:167]
mf v[84:87],a[156:159],v[196:199]
mf v[80:83],a[156:159],v[192:195]
mf v[80:83],a[152:155],v[160:163]
s_add_u32 s41, s41, 1
mf v[80:83],a[148:151],v[128:131]
s_waitcnt vmcnt(4)
mf v[80:83],a[144:147],v[96:99]
wl
mz v[212:215],v[216:219],a[162:165],0
mf v[212:215],v[216:219],a[170:173]
mf v[212:215],v[216:219],a[178:181]
mf v[212:215],v[216:219],a[186:189]
mz v[208:211],v[216:219],a[166:169],0
mf v[208:211],v[216:219],a[174:177]
mf v[208:211],v[216:219],a[182:185]
mf v[208:211],v[216:219],a[190:193]
s_branch Loloopf_a
.p2align 5
Lofork_a:
mf v[68:71],a[152:155],v[148:151]
s_add_u32 s38, s40, 49152
buffer_store_dwordx4 v[44:47], v1, s[28:31], s38 offen  nt
mf v[68:71],a[156:159],v[180:183]
v_mul_f32 v76, v76, v31
v_mul_f32 v77, v77, v31
mf v[64:67],a[156:159],v[176:179]
v_mul_f32 v78, v78, v31
v_mul_f32 v79, v79, v31
mf v[64:67],a[152:155],v[144:147]
s_add_u32 s38, s40, 32768
buffer_store_dwordx4 v[40:43], v1, s[28:31], s38 offen  nt
mf v[64:67],a[148:151],v[112:115]
cv v76,v76,v77
cv v77,v78,v79
mf v[64:67],a[144:147],v[224:227]
wl
v_mul_f32 v72, v72, v30
v_mul_f32 v73, v73, v30
mf v[80:83],a[128:131],v[224:227]
tr a[144:145],v6,32768
v_mul_f32 v74, v74, v30
mf v[80:83],a[132:135],v[112:115]
tr a[146:147],v6,34816
v_mul_f32 v75, v75, v30
mf v[80:83],a[136:139],v[144:147]
tr a[148:149],v6,36864
cv v72,v72,v73
mf v[80:83],a[140:143],v[176:179]
tr a[150:151],v6,38912
cv v73,v74,v75
mf v[84:87],a[140:143],v[180:183]
tr a[152:153],v6,40960
v_mul_f32 v68, v68, v29
mf v[84:87],a[136:139],v[148:151]
tr a[154:155],v6,43008
v_mul_f32 v69, v69, v29
mf v[84:87],a[132:135],v[116:119]
tr a[156:157],v6,45056
v_mul_f32 v70, v70, v29
mf v[84:87],a[128:131],v[228:231]
tr a[158:159],v6,47104
v_mul_f32 v71, v71, v29
mf v[88:91],a[128:131],v[232:235]
s_add_u32 s38, s40, 16384
buffer_store_dwordx4 v[36:39], v1, s[28:31], s38 offen  nt
mf v[88:91],a[132:135],v[120:123]
cv v68,v68,v69
cv v69,v70,v71
mf v[88:91],a[136:139],v[152:155]
v_mul_f32 v64, v64, v28
v_mul_f32 v65, v65, v28
mf v[88:91],a[140:143],v[184:187]
s_add_u32 s38, s40, 0
buffer_store_dwordx4 v[32:35], v1, s[28:31], s38 offen  nt
mf v[92:95],a[140:143],v[188:191]
v_mul_f32 v66, v66, v28
v_mul_f32 v67, v67, v28
mf v[92:95],a[136:139],v[156:159]
cv v64,v64,v65
cv v65,v66,v67
mf v[92:95],a[132:135],v[124:127]
mf v[92:95],a[128:131],v[236:239]
wl
mf v[92:95],a[144:147],v[108:111]
s_barrier
v_xor_b32 v5, 0x10000, v5
v_xor_b32 v16, 0x10000, v16
mf v[92:95],a[148:151],v[140:143]
v_xor_b32 v6, 0x10000, v6
v_xor_b32 v15, 0x10000, v15
mf v[92:95],a[152:155],v[172:175]
tr a[128:129],v15,0
mf v[92:95],a[156:159],v[204:207]
tr a[130:131],v15,2048
mf v[88:91],a[156:159],v[200:203]
tr a[132:133],v15,4096
mf v[88:91],a[152:155],v[168:171]
tr a[134:135],v15,6144
mf v[88:91],a[148:151],v[136:139]
tr a[136:137],v15,8192
mf v[88:91],a[144:147],v[104:107]
tr a[138:139],v15,10240
mf v[84:87],a[144:147],v[100:103]
tr a[140:141],v15,12288
mf v[84:87],a[148:151],v[132:135]
tr a[142:143],v15,14336
mf v[84:87],a[152:155],v[164:167]
mf v[84:87],a[156:159],v[196:199]
mf v[80:83],a[156:159],v[192:195]
mf v[80:83],a[152:155],v[160:163]
s_add_u32 s41, s41, 1
mf v[80:83],a[148:151],v[128:131]
s_waitcnt vmcnt(4)
mf v[80:83],a[144:147],v[96:99]
wl
mz v[212:215],v[216:219],a[162:165],0
mf v[212:215],v[216:219],a[170:173]
mf v[212:215],v[216:219],a[178:181]
mf v[212:215],v[216:219],a[186:189]
mz v[208:211],v[216:219],a[166:169],0
mf v[208:211],v[216:219],a[174:177]
mf v[208:211],v[216:219],a[182:185]
mf v[208:211],v[216:219],a[190:193]
s_nop 0
mz v[32:35],a[128:131],a[0:3],0
tr a[144:145],v15,16384
v_mul_f32 v92, v92, v31
mf v[32:35],a[132:135],a[16:19]
tr a[146:147],v15,18432
v_mul_f32 v93, v93, v31
mf v[32:35],a[136:139],a[32:35]
tr a[148:149],v15,20480
v_mul_f32 v94, v94, v31
mf v[32:35],a[140:143],a[48:51]
tr a[150:151],v15,22528
v_mul_f32 v95, v95, v31
mz v[36:39],a[140:143],a[52:55],0
tr a[152:153],v15,24576
cv v78,v92,v93
mf v[36:39],a[136:139],a[36:39]
tr a[154:155],v15,26624
cv v79,v94,v95
mf v[36:39],a[132:135],a[20:23]
tr a[156:157],v15,28672
v_mul_f32 v88, v88, v30
mf v[36:39],a[128:131],a[4:7]
tr a[158:159],v15,30720
v_mul_f32 v89, v89, v30
mz v[40:43],a[128:131],a[8:11],0
s_add_u32 s38, s40, 57344
buffer_store_dwordx4 v[76:79], v1, s[28:31], s38 offen nt
mf v[40:43],a[132:135],a[24:27]
v_mul_f32 v90, v90, v30
v_mul_f32 v91, v91, v30
mf v[40:43],a[136:139],a[40:43]
cv v74,v88,v89
cv v75,v90,v91
mf v[40:43],a[140:143],a[56:59]
s_add_u32 s38, s40, 40960
buffer_store_dwordx4 v[72:75], v1, s[28:31], s38 offen nt
mz v[44:47],a[140:143],a[60:63],0
v_mul_f32 v84, v84, v29
v_mul_f32 v85, v85, v29
mf v[44:47],a[136:139],a[44:47]
v_mul_f32 v86, v86, v29
v_mul_f32 v87, v87, v29
mf v[44:47],a[132:135],a[28:31]
cv v70,v84,v85
cv v71,v86,v87
mf v[44:47],a[128:131],a[12:15]
wl
v_mul_f32 v80, v80, v28
v_mul_f32 v81, v81, v28
mf v[44:47],a[144:147],a[76:79]
tr a[128:129],v5,16384
v_mul_f32 v82, v82, v28
mf v[44:47],a[148:151],a[92:95]
tr a[130:131],v5,18432
v_mul_f32 v83, v83, v28
mf v[44:47],a[152:155],a[108:111]
tr a[132:133],v5,20480
cv v66,v80,v81
mf v[44:47],a[156:159],a[124:127]
tr a[134:135],v5,22528
cv v67,v82,v83
mf v[40:43],a[156:159],a[120:123]
tr a[136:137],v5,24576
cv v222,v212,v213
mf v[40:43],a[152:155],a[104:107]
tr a[138:139],v5,26624
cv v223,v214,v215
mf v[40:43],a[148:151],a[88:91]
tr a[140:141],v5,28672
cv v220,v208,v209
mf v[40:43],a[144:147],a[72:75]
tr a[142:143],v5,30720
cv v221,v210,v211
mf v[36:39],a[144:147],a[68:71]
s_add_u32 s38, s40, 24576
buffer_store_dwordx4 v[68:71], v1, s[28:31], s38 offen nt
mf v[36:39],a[148:151],a[84:87]
v_mul_f32 v44, v44, v27
v_mul_f32 v45, v45, v27
mf v[36:39],a[152:155],a[100:103]
v_mul_f32 v46, v46, v27
v_mul_f32 v47, v47, v27
mf v[36:39],a[156:159],a[116:119]
s_add_u32 s38, s40, 8192
buffer_store_dwordx4 v[64:67], v1, s[28:31], s38 offen nt
mf v[32:35],a[156:159],a[112:115]
s_xor_b32 s40, s40, 262144
mf v[32:35],a[152:155],a[96:99]
v_mul_f32 v40, v40, v26
v_mul_f32 v41, v41, v26
mf v[32:35],a[148:151],a[80:83]
v_mul_f32 v42, v42, v26
v_mul_f32 v43, v43, v26
mf v[32:35],a[144:147],a[64:67]
wl
mz v[48:51],a[128:131],a[64:67],0
tr a[144:145],v5,0
mf v[48:51],a[132:135],a[80:83]
tr a[146:147],v5,2048
v_mul_f32 v36, v36, v25
mf v[48:51],a[136:139],a[96:99]
tr a[148:149],v5,4096
v_mul_f32 v37, v37, v25
mf v[48:51],a[140:143],a[112:115]
tr a[150:151],v5,6144
v_mul_f32 v38, v38, v25
mz v[52:55],a[140:143],a[116:119],0
tr a[152:153],v5,8192
v_mul_f32 v39, v39, v25
mf v[52:55],a[136:139],a[100:103]
tr a[154:155],v5,10240
v_mul_f32 v32, v32, v24
mf v[52:55],a[132:135],a[84:87]
tr a[156:157],v5,12288
v_mul_f32 v33, v33, v24
mf v[52:55],a[128:131],a[68:71]
tr a[158:159],v5,14336
v_mul_f32 v34, v34, v24
mz v[56:59],a[128:131],a[72:75],0
v_mul_f32 v35, v35, v24
mf v[56:59],a[132:135],a[88:91]
mf v[56:59],a[136:139],a[104:107]
mf v[56:59],a[140:143],a[120:123]
mz v[60:63],a[140:143],a[124:127],0
mf v[60:63],a[136:139],a[108:111]
mf v[60:63],a[132:135],a[92:95]
mf v[60:63],a[128:131],a[76:79]
wl
mf v[60:63],a[144:147],a[12:15]
tr a[128:129],v16,0
mf v[60:63],a[148:151],a[28:31]
tr a[130:131],v16,2048
mf v[60:63],a[152:155],a[44:47]
tr a[132:133],v16,4096
mf v[60:63],a[156:159],a[60:63]
tr a[134:135],v16,6144
mf v[56:59],a[156:159],a[56:59]
tr a[136:137],v16,8192
v_mov_b32 v0, s41
mf v[56:59],a[152:155],a[40:43]
tr a[138:139],v16,10240
mf v[56:59],a[148:151],a[24:27]
tr a[140:141],v16,12288
mf v[56:59],a[144:147],a[8:11]
tr a[142:143],v16,14336
mf v[52:55],a[144:147],a[4:7]
s_waitcnt vmcnt(0)
buffer_store_dword v0, v17, s[28:31], 0 offen
mf v[52:55],a[148:151],a[20:23]
v_mul_f32 v60, v60, v27
v_mul_f32 v61, v61, v27
mf v[52:55],a[152:155],a[36:39]
v_mul_f32 v62, v62, v27
v_mul_f32 v63, v63, v27
mf v[52:55],a[156:159],a[52:55]
mf v[48:51],a[156:159],a[48:51]
mf v[48:51],a[152:155],a[32:35]
v_mul_f32 v56, v56, v26
v_mul_f32 v57, v57, v26
mf v[48:51],a[148:151],a[16:19]
v_mul_f32 v58, v58, v26
v_mul_f32 v59, v59, v26
mf v[48:51],a[144:147],a[0:3]
wl
mz v[64:67],a[128:131],a[0:3],0
tr a[144:145],v16,16384
mf v[64:67],a[132:135],a[16:19]
tr a[146:147],v16,18432
v_mul_f32 v52, v52, v25
mf v[64:67],a[136:139],a[32:35]
tr a[148:149],v16,20480
v_mul_f32 v53, v53, v25
mf v[64:67],a[140:143],a[48:51]
tr a[150:151],v16,22528
v_mul_f32 v54, v54, v25
mz v[68:71],a[140:143],a[52:55],0
tr a[152:153],v16,24576
v_mul_f32 v55, v55, v25
mf v[68:71],a[136:139],a[36:39]
tr a[154:155],v16,26624
v_mul_f32 v48, v48, v24
mf v[68:71],a[132:135],a[20:23]
tr a[156:157],v16,28672
v_mul_f32 v49, v49, v24
mf v[68:71],a[128:131],a[4:7]
tr a[158:159],v16,30720
v_mul_f32 v50, v50, v24
mz v[72:75],a[128:131],a[8:11],0
v_mul_f32 v51, v51, v24
mf v[72:75],a[132:135],a[24:27]
mf v[72:75],a[136:139],a[40:43]
mf v[72:75],a[140:143],a[56:59]
mz v[76:79],a[140:143],a[60:63],0
mf v[76:79],a[136:139],a[44:47]
mf v[76:79],a[132:135],a[28:31]
mf v[76:79],a[128:131],a[12:15]
wl
mf v[76:79],a[144:147],a[76:79]
tr a[128:129],v6,16384
mf v[76:79],a[148:151],a[92:95]
tr a[130:131],v6,18432
mf v[76:79],a[152:155],a[108:111]
tr a[132:133],v6,20480
mf v[76:79],a[156:159],a[124:127]
tr a[134:135],v6,22528
mf v[72:75],a[156:159],a[120:123]
tr a[136:137],v6,24576
mf v[72:75],a[152:155],a[104:107]
tr a[138:139],v6,26624
mf v[72:75],a[148:151],a[88:91]
tr a[140:141],v6,28672
mf v[72:75],a[144:147],a[72:75]
tr a[142:143],v6,30720
mf v[68:71],a[144:147],a[68:71]
mf v[68:71],a[148:151],a[84:87]
v_mul_f32 v76, v76, v27
v_mul_f32 v77, v77, v27
mf v[68:71],a[152:155],a[100:103]
v_mul_f32 v78, v78, v27
v_mul_f32 v79, v79, v27
mf v[68:71],a[156:159],a[116:119]
mf v[64:67],a[156:159],a[112:115]
mf v[64:67],a[152:155],a[96:99]
v_mul_f32 v72, v72, v26
v_mul_f32 v73, v73, v26
mf v[64:67],a[148:151],a[80:83]
v_mul_f32 v74, v74, v26
v_mul_f32 v75, v75, v26
mf v[64:67],a[144:147],a[64:67]
wl
mz v[80:83],a[128:131],a[64:67],0
tr a[144:145],v6,0
mf v[80:83],a[132:135],a[80:83]
tr a[146:147],v6,2048
v_mul_f32 v68, v68, v25
mf v[80:83],a[136:139],a[96:99]
tr a[148:149],v6,4096
v_mul_f32 v69, v69, v25
mf v[80:83],a[140:143],a[112:115]
tr a[150:151],v6,6144
v_mul_f32 v70, v70, v25
mz v[84:87],a[140:143],a[116:119],0
tr a[152:153],v6,8192
v_mul_f32 v71, v71, v25
mf v[84:87],a[136:139],a[100:103]
tr a[154:155],v6,10240
v_mul_f32 v64, v64, v24
mf v[84:87],a[132:135],a[84:87]
tr a[156:157],v6,12288
v_mul_f32 v65, v65, v24
mf v[84:87],a[128:131],a[68:71]
tr a[158:159],v6,14336
v_mul_f32 v66, v66, v24
mz v[88:91],a[128:131],a[72:75],0
v_mul_f32 v67, v67, v24
mf v[88:91],a[132:135],a[88:91]
mf v[88:91],a[136:139],a[104:107]
mf v[88:91],a[140:143],a[120:123]
mz v[92:95],a[140:143],a[124:127],0
mf v[92:95],a[136:139],a[108:111]
buffer_store_dwordx4 v[220:223], v2, s[92:95], s53 offen nt
mf v[92:95],a[132:135],a[92:95]
s_mov_b32 s53, s27
s_add_u32 s27, s27, 128
mf v[92:95],a[128:131],a[76:79]
wl
mf v[92:95],a[144:147],a[12:15]
s_barrier
mf v[92:95],a[148:151],a[28:31]
tr a[128:129],v15,32768
mf v[92:95],a[152:155],a[44:47]
tr a[130:131],v15,34816
mf v[92:95],a[156:159],a[60:63]
tr a[132:133],v15,36864
mf v[88:91],a[156:159],a[56:59]
tr a[134:135],v15,38912
mf v[88:91],a[152:155],a[40:43]
tr a[136:137],v15,40960
mf v[88:91],a[148:151],a[24:27]
tr a[138:139],v15,43008
mf v[88:91],a[144:147],a[8:11]
tr a[140:141],v15,45056
mf v[84:87],a[144:147],a[4:7]
tr a[142:143],v15,47104
mf v[84:87],a[148:151],a[20:23]
buffer_load_dword v23, v4, s[28:31], 0 offen sc1
mf v[84:87],a[152:155],a[36:39]
v_mul_f32 v92, v92, v27
v_mul_f32 v93, v93, v27
mf v[84:87],a[156:159],a[52:55]
v_mul_f32 v94, v94, v27
v_mul_f32 v95, v95, v27
mf v[80:83],a[156:159],a[48:51]
mf v[80:83],a[152:155],a[32:35]
v_mul_f32 v88, v88, v26
v_mul_f32 v89, v89, v26
mf v[80:83],a[148:151],a[16:19]
v_mul_f32 v90, v90, v26
v_mul_f32 v91, v91, v26
mf v[80:83],a[144:147],a[0:3]
wl
mf v[32:35],a[128:131],v[96:99]
tr a[144:145],v15,49152
mf v[32:35],a[132:135],v[128:131]
tr a[146:147],v15,51200
v_mul_f32 v84, v84, v25
mf v[32:35],a[136:139],v[160:163]
tr a[148:149],v15,53248
v_mul_f32 v85, v85, v25
mf v[32:35],a[140:143],v[192:195]
tr a[150:151],v15,55296
v_mul_f32 v86, v86, v25
mf v[36:39],a[140:143],v[196:199]
tr a[152:153],v15,57344
v_mul_f32 v87, v87, v25
mf v[36:39],a[136:139],v[164:167]
tr a[154:155],v15,59392
v_mul_f32 v80, v80, v24
mf v[36:39],a[132:135],v[132:135]
tr a[156:157],v15,61440
v_mul_f32 v81, v81, v24
mf v[36:39],a[128:131],v[100:103]
tr a[158:159],v15,63488
v_mul_f32 v82, v82, v24
mf v[40:43],a[128:131],v[104:107]
v_mul_f32 v83, v83, v24
mf v[40:43],a[132:135],v[136:139]
mf v[40:43],a[136:139],v[168:171]
mf v[40:43],a[140:143],v[200:203]
mf v[44:47],a[140:143],v[204:207]
mf v[44:47],a[136:139],v[172:175]
mf v[44:47],a[132:135],v[140:143]
mf v[44:47],a[128:131],v[108:111]
wl
mf v[44:47],a[144:147],v[236:239]
tr a[128:129],v5,49152
mf v[44:47],a[148:151],v[124:127]
tr a[130:131],v5,51200
mf v[44:47],a[152:155],v[156:159]
tr a[132:133],v5,53248
mf v[44:47],a[156:159],v[188:191]
tr a[134:135],v5,55296
mf v[40:43],a[156:159],v[184:187]
s_waitcnt vmcnt(0)
tr a[136:137],v5,57344
mf v[40:43],a[152:155],v[152:155]
tr a[138:139],v5,59392
v_cmp_gt_u32 vcc, s41, v23
mf v[40:43],a[148:151],v[120:123]
tr a[140:141],v5,61440
mf v[40:43],a[144:147],v[232:235]
tr a[142:143],v5,63488
mf v[36:39],a[144:147],v[228:231]
s_cbranch_vccnz Lspinfb_a
Lspunfb_a:
mf v[36:39],a[148:151],v[116:119]
s_add_u32 s72, s26, 4096
buffer_load_dwordx2 a[162:163], v1, s[28:31], s26 offen offset:8 sc1
mf v[36:39],a[152:155],v[148:151]
v_mul_f32 v44, v44, v31
v_mul_f32 v45, v45, v31
mf v[36:39],a[156:159],v[180:183]
v_mul_f32 v46, v46, v31
v_mul_f32 v47, v47, v31
mf v[32:35],a[156:159],v[176:179]
buffer_load_dwordx4 a[164:167], v1, s[28:31], s26 offen offset:1024 sc1
mf v[32:35],a[152:155],v[144:147]
cv v44,v44,v45
cv v45,v46,v47
mf v[32:35],a[148:151],v[112:115]
v_mul_f32 v40, v40, v30
v_mul_f32 v41, v41, v30
mf v[32:35],a[144:147],v[224:227]
wl
buffer_load_dwordx4 a[168:171], v1, s[28:31], s26 offen offset:2048 sc1
mf v[48:51],a[128:131],v[224:227]
tr a[144:145],v5,32768
v_mul_f32 v42, v42, v30
mf v[48:51],a[132:135],v[112:115]
tr a[146:147],v5,34816
v_mul_f32 v43, v43, v30
mf v[48:51],a[136:139],v[144:147]
tr a[148:149],v5,36864
cv v40,v40,v41
mf v[48:51],a[140:143],v[176:179]
tr a[150:151],v5,38912
cv v41,v42,v43
mf v[52:55],a[140:143],v[180:183]
tr a[152:153],v5,40960
v_mul_f32 v36, v36, v29
mf v[52:55],a[136:139],v[148:151]
tr a[154:155],v5,43008
v_mul_f32 v37, v37, v29
mf v[52:55],a[132:135],v[116:119]
tr a[156:157],v5,45056
v_mul_f32 v38, v38, v29
mf v[52:55],a[128:131],v[228:231]
tr a[158:159],v5,47104
v_mul_f32 v39, v39, v29
mf v[56:59],a[128:131],v[232:235]
buffer_load_dwordx4 a[172:175], v1, s[28:31], s26 offen offset:3072 sc1
mf v[56:59],a[132:135],v[120:123]
cv v36,v36,v37
cv v37,v38,v39
mf v[56:59],a[136:139],v[152:155]
v_mul_f32 v32, v32, v28
v_mul_f32 v33, v33, v28
mf v[56:59],a[140:143],v[184:187]
buffer_load_dwordx4 a[176:179], v1, s[28:31], s72 offen offset:0 sc1
mf v[60:63],a[140:143],v[188:191]
v_mul_f32 v34, v34, v28
v_mul_f32 v35, v35, v28
mf v[60:63],a[136:139],v[156:159]
cv v32,v32,v33
cv v33,v34,v35
mf v[60:63],a[132:135],v[124:127]
buffer_load_dwordx4 a[180:183], v1, s[28:31], s72 offen offset:1024 sc1
mf v[60:63],a[128:131],v[236:239]
wl
mf v[60:63],a[144:147],v[108:111]
tr a[128:129],v16,32768
mf v[60:63],a[148:151],v[140:143]
tr a[130:131],v16,34816
mf v[60:63],a[152:155],v[172:175]
tr a[132:133],v16,36864
mf v[60:63],a[156:159],v[204:207]
tr a[134:135],v16,38912
mf v[56:59],a[156:159],v[200:203]
tr a[136:137],v16,40960
mf v[56:59],a[152:155],v[168:171]
tr a[138:139],v16,43008
mf v[56:59],a[148:151],v[136:139]
tr a[140:141],v16,45056
mf v[56:59],a[144:147],v[104:107]
tr a[142:143],v16,47104
mf v[52:55],a[144:147],v[100:103]
buffer_load_dwordx4 a[184:187], v1, s[28:31], s72 offen offset:2048 sc1
mf v[52:55],a[148:151],v[132:135]
v_mul_f32 v60, v60, v31
v_mul_f32 v61, v61, v31
mf v[52:55],a[152:155],v[164:167]
v_mul_f32 v62, v62, v31
v_mul_f32 v63, v63, v31
mf v[52:55],a[156:159],v[196:199]
buffer_load_dwordx4 a[188:191], v1, s[28:31], s72 offen offset:3072 sc1
mf v[48:51],a[156:159],v[192:195]
cv v46,v60,v61
cv v47,v62,v63
mf v[48:51],a[152:155],v[160:163]
v_mul_f32 v56, v56, v30
v_mul_f32 v57, v57, v30
mf v[48:51],a[148:151],v[128:131]
buffer_load_dwordx2 a[192:193], v1, s[28:31], s26 offen offset:0 sc1
mf v[48:51],a[144:147],v[96:99]
s_xor_b32 s26, s26, 262144
v_mul_f32 v58, v58, v30
wl
mf v[64:67],a[128:131],v[96:99]
tr a[144:145],v16,49152
v_mul_f32 v59, v59, v30
mf v[64:67],a[132:135],v[128:131]
tr a[146:147],v16,51200
cv v42,v56,v57
mf v[64:67],a[136:139],v[160:163]
tr a[148:149],v16,53248
cv v43,v58,v59
mf v[64:67],a[140:143],v[192:195]
tr a[150:151],v16,55296
v_mul_f32 v52, v52, v29
mf v[68:71],a[140:143],v[196:199]
tr a[152:153],v16,57344
v_mul_f32 v53, v53, v29
mf v[68:71],a[136:139],v[164:167]
tr a[154:155],v16,59392
v_mul_f32 v54, v54, v29
mf v[68:71],a[132:135],v[132:135]
tr a[156:157],v16,61440
v_mul_f32 v55, v55, v29
mf v[68:71],a[128:131],v[100:103]
tr a[158:159],v16,63488
cv v38,v52,v53
mf v[72:75],a[128:131],v[104:107]
s_add_u32 s38, s40, 49152
buffer_store_dwordx4 v[44:47], v1, s[28:31], s38 offen nt
mf v[72:75],a[132:135],v[136:139]
cv v39,v54,v55
v_mul_f32 v48, v48, v28
mf v[72:75],a[136:139],v[168:171]
v_mul_f32 v49, v49, v28
v_mul_f32 v50, v50, v28
mf v[72:75],a[140:143],v[200:203]
s_add_u32 s38, s40, 32768
buffer_store_dwordx4 v[40:43], v1, s[28:31], s38 offen nt
mf v[76:79],a[140:143],v[204:207]
v_mul_f32 v51, v51, v28
cv v34,v48,v49
mf v[76:79],a[136:139],v[172:175]
cv v35,v50,v51
mf v[76:79],a[132:135],v[140:143]
s_add_u32 s38, s40, 16384
buffer_store_dwordx4 v[36:39], v1, s[28:31], s38 offen nt
mf v[76:79],a[128:131],v[108:111]
wl
mf v[76:79],a[144:147],v[236:239]
tr a[128:129],v6,49152
mf v[76:79],a[148:151],v[124:127]
tr a[130:131],v6,51200
mf v[76:79],a[152:155],v[156:159]
tr a[132:133],v6,53248
mf v[76:79],a[156:159],v[188:191]
tr a[134:135],v6,55296
mf v[72:75],a[156:159],v[184:187]
tr a[136:137],v6,57344
mf v[72:75],a[152:155],v[152:155]
tr a[138:139],v6,59392
mf v[72:75],a[148:151],v[120:123]
tr a[140:141],v6,61440
mf v[72:75],a[144:147],v[232:235]
tr a[142:143],v6,63488
mf v[68:71],a[144:147],v[228:231]
s_add_u32 s38, s40, 0
buffer_store_dwordx4 v[32:35], v1, s[28:31], s38 offen nt
mf v[68:71],a[148:151],v[116:119]
v_mul_f32 v76, v76, v31
v_mul_f32 v77, v77, v31
mf v[68:71],a[152:155],v[148:151]
v_mul_f32 v78, v78, v31
v_mul_f32 v79, v79, v31
mf v[68:71],a[156:159],v[180:183]
cv v76,v76,v77
cv v77,v78,v79
mf v[64:67],a[156:159],v[176:179]
mf v[64:67],a[152:155],v[144:147]
v_mul_f32 v72, v72, v30
v_mul_f32 v73, v73, v30
mf v[64:67],a[148:151],v[112:115]
v_mul_f32 v74, v74, v30
v_mul_f32 v75, v75, v30
mf v[64:67],a[144:147],v[224:227]
wl
cv v72,v72,v73
cv v73,v74,v75
mf v[80:83],a[128:131],v[224:227]
tr a[144:145],v6,32768
mf v[80:83],a[132:135],v[112:115]
tr a[146:147],v6,34816
v_mul_f32 v68, v68, v29
mf v[80:83],a[136:139],v[144:147]
tr a[148:149],v6,36864
v_mul_f32 v69, v69, v29
mf v[80:83],a[140:143],v[176:179]
tr a[150:151],v6,38912
v_mul_f32 v70, v70, v29
mf v[84:87],a[140:143],v[180:183]
tr a[152:153],v6,40960
v_mul_f32 v71, v71, v29
mf v[84:87],a[136:139],v[148:151]
tr a[154:155],v6,43008
cv v68,v68,v69
mf v[84:87],a[132:135],v[116:119]
tr a[156:157],v6,45056
cv v69,v70,v71
mf v[84:87],a[128:131],v[228:231]
tr a[158:159],v6,47104
v_mul_f32 v64, v64, v28
mf v[88:91],a[128:131],v[232:235]
v_mul_f32 v65, v65, v28
v_mul_f32 v66, v66, v28
mf v[88:91],a[132:135],v[120:123]
v_mul_f32 v67, v67, v28
cv v64,v64,v65
mf v[88:91],a[136:139],v[152:155]
cv v65,v66,v67
mf v[88:91],a[140:143],v[184:187]
mf v[92:95],a[140:143],v[188:191]
mf v[92:95],a[136:139],v[156:159]
mf v[92:95],a[132:135],v[124:127]
mf v[92:95],a[128:131],v[236:239]
wl
mf v[92:95],a[144:147],v[108:111]
mf v[92:95],a[148:151],v[140:143]
mf v[92:95],a[152:155],v[172:175]
mf v[92:95],a[156:159],v[204:207]
mf v[88:91],a[156:159],v[200:203]
mf v[88:91],a[152:155],v[168:171]
mf v[88:91],a[148:151],v[136:139]
mf v[88:91],a[144:147],v[104:107]
mf v[84:87],a[144:147],v[100:103]
mf v[84:87],a[148:151],v[132:135]
s_nop 1
v_mul_f32 v92, v92, v31
v_mul_f32 v93, v93, v31
mf v[84:87],a[152:155],v[164:167]
v_mul_f32 v94, v94, v31
v_mul_f32 v95, v95, v31
mf v[84:87],a[156:159],v[196:199]
cv v78,v92,v93
cv v79,v94,v95
mf v[80:83],a[156:159],v[192:195]
s_add_u32 s38, s40, 57344
buffer_store_dwordx4 v[76:79], v1, s[28:31], s38 offen nt
mf v[80:83],a[152:155],v[160:163]
s_add_u32 s41, s41, 1
v_mul_f32 v88, v88, v30
v_mul_f32 v89, v89, v30
mf v[80:83],a[148:151],v[128:131]
s_waitcnt vmcnt(5)
v_mul_f32 v90, v90, v30
v_mul_f32 v91, v91, v30
mf v[80:83],a[144:147],v[96:99]
cv v74,v88,v89
cv v75,v90,v91
mz v[212:215],v[216:219],a[162:165],0
s_add_u32 s38, s40, 40960
buffer_store_dwordx4 v[72:75], v1, s[28:31], s38 offen nt
mf v[212:215],v[216:219],a[170:173]
v_mul_f32 v84, v84, v29
v_mul_f32 v85, v85, v29
mf v[212:215],v[216:219],a[178:181]
v_mul_f32 v86, v86, v29
v_mul_f32 v87, v87, v29
mf v[212:215],v[216:219],a[186:189]
cv v70,v84,v85
cv v71,v86,v87
mz v[208:211],v[216:219],a[166:169],0
s_add_u32 s38, s40, 24576
buffer_store_dwordx4 v[68:71], v1, s[28:31], s38 offen nt
mf v[208:211],v[216:219],a[174:177]
v_mul_f32 v80, v80, v28
v_mul_f32 v81, v81, v28
mf v[208:211],v[216:219],a[182:185]
v_mul_f32 v82, v82, v28
v_mul_f32 v83, v83, v28
mf v[208:211],v[216:219],a[190:193]
cv v66,v80,v81
cv v67,v82,v83
s_add_u32 s38, s40, 8192
buffer_store_dwordx4 v[64:67], v1, s[28:31], s38 offen nt
s_bfe_u32 s73, s26, 0x20010
s_lshl_b32 s73, s73, 2
s_add_u32 s73, s73, 2359296
v_and_b32 v4, 0x70, v1
v_add_u32 v4, s73, v4
cv v222,v212,v213
cv v223,v214,v215
cv v220,v208,v209
cv v221,v210,v211
v_mov_b32 v0, s41
s_waitcnt vmcnt(0)
buffer_store_dword v0, v17, s[28:31], 0 offen
buffer_load_dword v23, v4, s[28:31], 0 offen sc1
s_waitcnt vmcnt(0)
v_cmp_gt_u32 vcc, s41, v23
s_cbranch_vccnz Lspintf_a
Lspuntf_a:
s_add_u32 s72, s26, 4096
buffer_load_dwordx2 a[162:163], v1, s[28:31], s26 offen offset:8 sc1
buffer_load_dwordx4 a[164:167], v1, s[28:31], s26 offen offset:1024 sc1
buffer_load_dwordx4 a[168:171], v1, s[28:31], s26 offen offset:2048 sc1
buffer_load_dwordx4 a[172:175], v1, s[28:31], s26 offen offset:3072 sc1
buffer_load_dwordx4 a[176:179], v1, s[28:31], s72 offen offset:0 sc1
buffer_load_dwordx4 a[180:183], v1, s[28:31], s72 offen offset:1024 sc1
buffer_load_dwordx4 a[184:187], v1, s[28:31], s72 offen offset:2048 sc1
buffer_load_dwordx4 a[188:191], v1, s[28:31], s72 offen offset:3072 sc1
buffer_load_dwordx2 a[192:193], v1, s[28:31], s26 offen offset:0 sc1
s_xor_b32 s26, s26, 262144
buffer_store_dwordx4 v[220:223], v2, s[92:95], s53 offen nt
s_mov_b32 s53, s27
s_add_u32 s27, s27, 128
s_waitcnt vmcnt(1)
mz v[212:215],v[216:219],a[162:165],0
mf v[212:215],v[216:219],a[170:173]
mf v[212:215],v[216:219],a[178:181]
mf v[212:215],v[216:219],a[186:189]
mz v[208:211],v[216:219],a[166:169],0
mf v[208:211],v[216:219],a[174:177]
mf v[208:211],v[216:219],a[182:185]
mf v[208:211],v[216:219],a[190:193]
s_nop 3
cv v222,v212,v213
cv v223,v214,v215
s_nop 1
cv v220,v208,v209
cv v221,v210,v211
buffer_store_dwordx4 v[220:223], v2, s[92:95], s53 offen nt
s_endpgm
Loslow_a:
s_add_u32 s40, s40, 524288
s_add_u32 s26, s26, 524288
mz v[64:67],a[128:131],a[0:3],v[32:35]
ds_read_b128 a[144:147], v5 offset:18432
v_mov_b32 v21, v11
mf v[64:67],a[132:135],a[16:19]
s_add_u32 m0, s24, 0
ds_read_b128 a[148:151], v6 offset:18432
mf v[64:67],a[136:139],a[32:35]
ds_read_b128 a[152:155], v5 offset:19456
mf v[64:67],a[140:143],a[48:51]
ds_read_b128 a[156:159], v6 offset:19456
mz v[68:71],a[140:143],a[52:55],v[36:39]
s_add_u32 s39, s45, 0
buffer_load_dwordx4 v3, s[20:23], s39 offen  lds
mf v[68:71],a[136:139],a[36:39]
s_add_u32 m0, s24, 1024
v_permlane32_swap_b32 v11, v21
mf v[68:71],a[132:135],a[20:23]
s_add_u32 s39, s45, 7168
buffer_load_dwordx4 v3, s[20:23], s39 offen  lds
mf v[68:71],a[128:131],a[4:7]
s_add_u32 m0, s24, 2048
v_add_f32 v11, v11, v21
v_mov_b32 v21, v11
mz v[72:75],a[128:131],a[8:11],v[40:43]
mf v[72:75],a[132:135],a[24:27]
v_permlane16_swap_b32 v11, v21
mf v[72:75],a[136:139],a[40:43]
s_add_u32 s39, s45, 14336
buffer_load_dwordx4 v3, s[20:23], s39 offen  lds
mf v[72:75],a[140:143],a[56:59]
s_add_u32 m0, s24, 3072
v_add_f32 v11, v11, v21
mz v[76:79],a[140:143],a[60:63],v[44:47]
v_rcp_f32 v11, v11
mf v[76:79],a[136:139],a[44:47]
v_mov_b32 v21, v12
mf v[76:79],a[132:135],a[28:31]
mf v[76:79],a[128:131],a[12:15]
wl
v_permlane32_swap_b32 v12, v21
mf v[76:79],a[144:147],a[76:79]
ds_read_b128 a[128:131], v5 offset:26624
v_add_f32 v12, v12, v21
mf v[76:79],a[148:151],a[92:95]
ds_read_b128 a[132:135], v6 offset:26624
v_mov_b32 v21, v12
mf v[76:79],a[152:155],a[108:111]
ds_read_b128 a[136:139], v5 offset:27648
mf v[76:79],a[156:159],a[124:127]
ds_read_b128 a[140:143], v6 offset:27648
mf v[72:75],a[156:159],a[120:123]
s_add_u32 s39, s45, 21504
buffer_load_dwordx4 v3, s[20:23], s39 offen  lds
mf v[72:75],a[152:155],a[104:107]
v_permlane16_swap_b32 v12, v21
mf v[72:75],a[148:151],a[88:91]
v_add_f32 v12, v12, v21
mf v[72:75],a[144:147],a[72:75]
v_rcp_f32 v12, v12
mf v[68:71],a[144:147],a[68:71]
v_mov_b32 v21, v13
mf v[68:71],a[148:151],a[84:87]
mf v[68:71],a[152:155],a[100:103]
v_exp_f32 v76, v76
mf v[68:71],a[156:159],a[116:119]
v_exp_f32 v77, v77
mf v[64:67],a[156:159],a[112:115]
v_exp_f32 v78, v78
mf v[64:67],a[152:155],a[96:99]
v_exp_f32 v79, v79
mf v[64:67],a[148:151],a[80:83]
v_exp_f32 v72, v72
mf v[64:67],a[144:147],a[64:67]
wl
v_exp_f32 v73, v73
mz v[80:83],a[128:131],a[64:67],v[32:35]
ds_read_b128 a[144:147], v5 offset:24576
v_add_f32 v31, v76, v77
mf v[80:83],a[132:135],a[80:83]
ds_read_b128 a[148:151], v6 offset:24576
cv v76,v76,v77
mf v[80:83],a[136:139],a[96:99]
ds_read_b128 a[152:155], v5 offset:25600
v_add_f32 v31, v78, v31
mf v[80:83],a[140:143],a[112:115]
ds_read_b128 a[156:159], v6 offset:25600
v_add_f32 v31, v79, v31
mz v[84:87],a[140:143],a[116:119],v[36:39]
v_exp_f32 v74, v74
mf v[84:87],a[136:139],a[100:103]
v_exp_f32 v75, v75
mf v[84:87],a[132:135],a[84:87]
v_exp_f32 v68, v68
mf v[84:87],a[128:131],a[68:71]
v_exp_f32 v69, v69
mz v[88:91],a[128:131],a[72:75],v[40:43]
v_exp_f32 v70, v70
mf v[88:91],a[132:135],a[88:91]
v_exp_f32 v71, v71
mf v[88:91],a[136:139],a[104:107]
v_exp_f32 v64, v64
mf v[88:91],a[140:143],a[120:123]
s_add_u32 m0, s24, 16384
v_exp_f32 v65, v65
mz v[92:95],a[140:143],a[124:127],v[44:47]
v_exp_f32 v66, v66
mf v[92:95],a[136:139],a[108:111]
v_exp_f32 v67, v67
mf v[92:95],a[132:135],a[92:95]
v_add_f32 v30, v72, v73
cv v77,v78,v79
mf v[92:95],a[128:131],a[76:79]
wl
cv v72,v72,v73
v_add_f32 v30, v74, v30
mf v[92:95],a[144:147],a[12:15]
s_barrier
v_add_f32 v30, v75, v30
cv v73,v74,v75
mf v[92:95],a[148:151],a[28:31]
tr a[128:129],v7,32768
v_add_f32 v29, v68, v69
mf v[92:95],a[152:155],a[44:47]
tr a[130:131],v7,40960
cv v68,v68,v69
mf v[92:95],a[156:159],a[60:63]
tr a[132:133],v8,32768
v_add_f32 v29, v70, v29
mf v[88:91],a[156:159],a[56:59]
tr a[134:135],v8,40960
v_add_f32 v29, v71, v29
mf v[88:91],a[152:155],a[40:43]
tr a[136:137],v9,32768
cv v69,v70,v71
mf v[88:91],a[148:151],a[24:27]
tr a[138:139],v9,40960
v_add_f32 v28, v64, v65
mf v[88:91],a[144:147],a[8:11]
tr a[140:141],v10,32768
cv v64,v64,v65
mf v[84:87],a[144:147],a[4:7]
tr a[142:143],v10,40960
v_add_f32 v28, v66, v28
mf v[84:87],a[148:151],a[20:23]
s_add_u32 s39, s45, 114688
buffer_load_dwordx4 v3, s[20:23], s39 offen  lds
mf v[84:87],a[152:155],a[36:39]
s_add_u32 m0, s24, 17408
v_exp_f32 v92, v92
mf v[84:87],a[156:159],a[52:55]
s_add_u32 s39, s45, 121856
buffer_load_dwordx4 v3, s[20:23], s39 offen  lds
mf v[80:83],a[156:159],a[48:51]
s_add_u32 m0, s24, 18432
v_exp_f32 v93, v93
mf v[80:83],a[152:155],a[32:35]
s_add_u32 s39, s45, 129024
buffer_load_dwordx4 v3, s[20:23], s39 offen  lds
mf v[80:83],a[148:151],a[16:19]
s_add_u32 m0, s24, 19456
v_exp_f32 v94, v94
mf v[80:83],a[144:147],a[0:3]
wl
v_exp_f32 v95, v95
mf v[96:99],a[128:131],v[48:51]
tr a[144:145],v7,33792
v_add_f32 v31, v92, v31
mf v[100:103],a[128:131],v[52:55]
tr a[146:147],v7,41984
v_add_f32 v31, v93, v31
mf v[104:107],a[128:131],v[56:59]
tr a[148:149],v8,33792
cv v78,v92,v93
mf v[108:111],a[128:131],v[60:63]
tr a[150:151],v8,41984
v_add_f32 v31, v94, v31
mf v[124:127],a[132:135],v[60:63]
tr a[152:153],v9,33792
v_add_f32 v31, v95, v31
mf v[120:123],a[132:135],v[56:59]
tr a[154:155],v9,41984
cv v79,v94,v95
mf v[116:119],a[132:135],v[52:55]
tr a[156:157],v10,33792
v_add_f32 v28, v67, v28
mf v[112:115],a[132:135],v[48:51]
tr a[158:159],v10,41984
cv v65,v66,v67
mf v[128:131],a[136:139],v[48:51]
s_add_u32 s39, s45, 136192
buffer_load_dwordx4 v3, s[20:23], s39 offen  lds
mf v[132:135],a[136:139],v[52:55]
v_exp_f32 v88, v88
mf v[136:139],a[136:139],v[56:59]
v_exp_f32 v89, v89
mf v[140:143],a[136:139],v[60:63]
v_exp_f32 v90, v90
mf v[156:159],a[140:143],v[60:63]
v_exp_f32 v91, v91
mf v[152:155],a[140:143],v[56:59]
v_exp_f32 v84, v84
mf v[148:151],a[140:143],v[52:55]
v_exp_f32 v85, v85
mf v[144:147],a[140:143],v[48:51]
wl
v_exp_f32 v86, v86
mf v[160:163],a[144:147],v[48:51]
tr a[128:129],v7,34816
v_add_f32 v30, v88, v30
mf v[164:167],a[144:147],v[52:55]
tr a[130:131],v7,43008
v_add_f32 v30, v89, v30
mf v[168:171],a[144:147],v[56:59]
tr a[132:133],v8,34816
cv v74,v88,v89
mf v[172:175],a[144:147],v[60:63]
tr a[134:135],v8,43008
v_add_f32 v30, v90, v30
mf v[188:191],a[148:151],v[60:63]
tr a[136:137],v9,34816
v_add_f32 v30, v91, v30
mf v[184:187],a[148:151],v[56:59]
tr a[138:139],v9,43008
cv v75,v90,v91
mf v[180:183],a[148:151],v[52:55]
tr a[140:141],v10,34816
v_add_f32 v29, v84, v29
mf v[176:179],a[148:151],v[48:51]
tr a[142:143],v10,43008
v_add_f32 v29, v85, v29
mf v[192:195],a[152:155],v[48:51]
v_exp_f32 v87, v87
mf v[196:199],a[152:155],v[52:55]
v_exp_f32 v80, v80
mf v[200:203],a[152:155],v[56:59]
v_exp_f32 v81, v81
mf v[204:207],a[152:155],v[60:63]
v_exp_f32 v82, v82
mf v[220:223],a[156:159],v[60:63]
v_exp_f32 v83, v83
mf v[216:219],a[156:159],v[56:59]
cv v70,v84,v85
v_add_f32 v29, v86, v29
mf v[212:215],a[156:159],v[52:55]
v_add_f32 v29, v87, v29
cv v71,v86,v87
mf v[208:211],a[156:159],v[48:51]
wl
v_add_f32 v28, v80, v28
v_add_f32 v28, v81, v28
mf v[224:227],a[128:131],v[48:51]
tr a[144:145],v7,35840
cv v66,v80,v81
mf v[228:231],a[128:131],v[52:55]
tr a[146:147],v7,44032
v_add_f32 v28, v82, v28
mf v[232:235],a[128:131],v[56:59]
tr a[148:149],v8,35840
v_add_f32 v28, v83, v28
mf v[236:239],a[128:131],v[60:63]
tr a[150:151],v8,44032
cv v67,v82,v83
mf v[252:255],a[132:135],v[60:63]
tr a[152:153],v9,35840
v_max3_f32 v0, v28, v29, v30
mf v[248:251],a[132:135],v[56:59]
tr a[154:155],v9,44032
v_max_f32 v0, v0, v31
mf v[244:247],a[132:135],v[52:55]
tr a[156:157],v10,35840
v_cmp_lt_f32 vcc, s36, v0
mf v[240:243],a[132:135],v[48:51]
tr a[158:159],v10,44032
v_xor_b32 v5, 8, v15
mf a[160:163],a[136:139],v[48:51]
v_permlane32_swap_b32 v13, v21
mf a[164:167],a[136:139],v[52:55]
v_add_f32 v13, v13, v21
v_mov_b32 v21, v13
mf a[168:171],a[136:139],v[56:59]
v_xor_b32 v6, 8, v16
mf a[172:175],a[136:139],v[60:63]
v_permlane16_swap_b32 v13, v21
v_add_f32 v13, v13, v21
v_rcp_f32 v13, v13
v_mov_b32 v21, v14
mf a[188:191],a[140:143],v[60:63]
s_add_u32 m0, s24, 32768
mf a[184:187],a[140:143],v[56:59]
v_permlane32_swap_b32 v14, v21
v_add_f32 v14, v14, v21
v_mov_b32 v21, v14
mf a[180:183],a[140:143],v[52:55]
mf a[176:179],a[140:143],v[48:51]
wl
v_permlane16_swap_b32 v14, v21
v_add_f32 v14, v14, v21
v_rcp_f32 v14, v14
mf a[192:195],a[144:147],v[48:51]
s_cbranch_vccnz Lslow_ends15_a
Lret_ends15_a:
mf a[196:199],a[144:147],v[52:55]
s_barrier
v_add_f32 v24, v24, v28
v_add_f32 v25, v25, v29
mf a[200:203],a[144:147],v[56:59]
tr a[128:129],v7,49152
v_add_f32 v26, v26, v30
mf a[204:207],a[144:147],v[60:63]
tr a[130:131],v7,57344
v_add_f32 v27, v27, v31
mf a[220:223],a[148:151],v[60:63]
tr a[132:133],v8,49152
v_bfe_u32 v0, v1, 4, 4
mf a[216:219],a[148:151],v[56:59]
tr a[134:135],v8,57344
v_lshrrev_b32 v2, 8, v1
mf a[212:215],a[148:151],v[52:55]
tr a[136:137],v9,49152
v_mul_u32_u24 v0, 1792, v0
mf a[208:211],a[148:151],v[48:51]
tr a[138:139],v9,57344
v_lshl_add_u32 v2, v2, 4, v0
mf a[224:227],a[152:155],v[48:51]
tr a[140:141],v10,49152
v_bfe_u32 v0, v1, 4, 5
mf a[228:231],a[152:155],v[52:55]
tr a[142:143],v10,57344
s_add_u32 s43, s43, 16384
mf a[232:235],a[152:155],v[56:59]
s_add_u32 s39, s45, 229376
buffer_load_dwordx4 v3, s[20:23], s39 offen  lds
mf a[236:239],a[152:155],v[60:63]
ds_read_b128 a[0:3], v4 offset:0
v_lshlrev_b32 v0, 2, v0
mf a[252:255],a[156:159],v[60:63]
s_add_u32 m0, s24, 33792
ds_read_b128 a[4:7], v4 offset:1024
mf a[248:251],a[156:159],v[56:59]
s_add_u32 s39, s45, 236544
buffer_load_dwordx4 v3, s[20:23], s39 offen  lds
mf a[244:247],a[156:159],v[52:55]
s_add_u32 m0, s24, 34816
ds_read_b128 a[8:11], v4 offset:2048
mf a[240:243],a[156:159],v[48:51]
ds_read_b128 a[12:15], v4 offset:3072
s_waitcnt lgkmcnt(4)
mf v[96:99],a[128:131],v[64:67]
tr a[144:145],v7,50176
v_mov_b32 v28, v24
mf v[100:103],a[128:131],v[68:71]
tr a[146:147],v7,58368
v_mov_b32 v29, v25
mf v[104:107],a[128:131],v[72:75]
tr a[148:149],v8,50176
v_mov_b32 v30, v26
mf v[108:111],a[128:131],v[76:79]
tr a[150:151],v8,58368
v_mov_b32 v31, v27
mf v[112:115],a[132:135],v[64:67]
tr a[152:153],v9,50176
mf v[116:119],a[132:135],v[68:71]
tr a[154:155],v9,58368
mf v[120:123],a[132:135],v[72:75]
tr a[156:157],v10,50176
mf v[124:127],a[132:135],v[76:79]
tr a[158:159],v10,58368
mf v[128:131],a[136:139],v[64:67]
s_add_u32 s39, s45, 243712
buffer_load_dwordx4 v3, s[20:23], s39 offen  lds
mf v[132:135],a[136:139],v[68:71]
s_add_u32 m0, s24, 35840
v_permlane32_swap_b32 v24, v28
mf v[136:139],a[136:139],v[72:75]
s_add_u32 s39, s45, 250880
buffer_load_dwordx4 v3, s[20:23], s39 offen  lds
mf v[140:143],a[136:139],v[76:79]
s_mov_b32 s41, 0
v_add_f32 v24, v24, v28
v_mov_b32 v28, v24
mf v[144:147],a[140:143],v[64:67]
s_add_u32 s51, s45, 128
v_permlane32_swap_b32 v25, v29
mf v[148:151],a[140:143],v[68:71]
s_add_u32 s52, s45, 256
v_add_f32 v25, v25, v29
v_mov_b32 v29, v25
mf v[152:155],a[140:143],v[72:75]
v_permlane32_swap_b32 v26, v30
mf v[156:159],a[140:143],v[76:79]
wl
v_add_f32 v26, v26, v30
v_mov_b32 v30, v26
mf v[160:163],a[144:147],v[64:67]
tr a[128:129],v7,51200
cv v96,v96,v97
mf v[164:167],a[144:147],v[68:71]
tr a[130:131],v7,59392
cv v97,v98,v99
mf v[168:171],a[144:147],v[72:75]
tr a[132:133],v8,51200
cv v98,v112,v113
mf v[172:175],a[144:147],v[76:79]
tr a[134:135],v8,59392
cv v99,v114,v115
mf v[176:179],a[148:151],v[64:67]
tr a[136:137],v9,51200
cv v100,v100,v101
mf v[180:183],a[148:151],v[68:71]
tr a[138:139],v9,59392
cv v101,v102,v103
mf v[184:187],a[148:151],v[72:75]
tr a[140:141],v10,51200
cv v102,v116,v117
mf v[188:191],a[148:151],v[76:79]
tr a[142:143],v10,59392
cv v103,v118,v119
mf v[192:195],a[152:155],v[64:67]
v_permlane32_swap_b32 v27, v31
mf v[196:199],a[152:155],v[68:71]
v_add_f32 v27, v27, v31
v_mov_b32 v31, v27
mf v[200:203],a[152:155],v[72:75]
v_permlane16_swap_b32 v24, v28
mf v[204:207],a[152:155],v[76:79]
ds_read_b128 a[16:19], v4 offset:4096
v_add_f32 v24, v24, v28
mf v[208:211],a[156:159],v[64:67]
v_permlane16_swap_b32 v25, v29
mf v[212:215],a[156:159],v[68:71]
ds_read_b128 a[20:23], v4 offset:5120
v_add_f32 v25, v25, v29
mf v[216:219],a[156:159],v[72:75]
v_permlane16_swap_b32 v26, v30
mf v[220:223],a[156:159],v[76:79]
s_waitcnt lgkmcnt(2)
cv v104,v104,v105
v_add_f32 v26, v26, v30
mf v[224:227],a[128:131],v[64:67]
tr a[144:145],v7,52224
cv v105,v106,v107
mf v[228:231],a[128:131],v[68:71]
tr a[146:147],v7,60416
cv v106,v120,v121
mf v[232:235],a[128:131],v[72:75]
tr a[148:149],v8,52224
cv v107,v122,v123
mf v[236:239],a[128:131],v[76:79]
tr a[150:151],v8,60416
cv v108,v108,v109
mf v[240:243],a[132:135],v[64:67]
tr a[152:153],v9,52224
cv v109,v110,v111
mf v[244:247],a[132:135],v[68:71]
tr a[154:155],v9,60416
cv v110,v124,v125
mf v[248:251],a[132:135],v[72:75]
tr a[156:157],v10,52224
cv v111,v126,v127
mf v[252:255],a[132:135],v[76:79]
tr a[158:159],v10,60416
cv v128,v128,v129
mf a[160:163],a[136:139],v[64:67]
v_permlane16_swap_b32 v27, v31
mf a[164:167],a[136:139],v[68:71]
ds_read_b128 a[24:27], v4 offset:6144
v_add_f32 v27, v27, v31
mf a[168:171],a[136:139],v[72:75]
ds_read_b128 a[28:31], v4 offset:7168
cv v129,v130,v131
mf a[172:175],a[136:139],v[76:79]
ds_read_b128 a[32:35], v4 offset:8192
cv v130,v144,v145
mf a[176:179],a[140:143],v[64:67]
ds_read_b128 a[36:39], v4 offset:9216
cv v131,v146,v147
mf a[180:183],a[140:143],v[68:71]
ds_read_b128 a[40:43], v4 offset:10240
cv v132,v132,v133
mf a[184:187],a[140:143],v[72:75]
ds_read_b128 a[44:47], v4 offset:11264
cv v133,v134,v135
mf a[188:191],a[140:143],v[76:79]
ds_read_b128 a[48:51], v4 offset:12288
s_waitcnt lgkmcnt(7)
mf a[192:195],a[144:147],v[64:67]
s_waitcnt vmcnt(8)
cv v134,v148,v149
s_barrier
mf a[196:199],a[144:147],v[68:71]
tr a[128:129],v15,0
cv v135,v150,v151
mf a[200:203],a[144:147],v[72:75]
tr a[130:131],v15,2048
cv v136,v136,v137
mf a[204:207],a[144:147],v[76:79]
tr a[132:133],v15,4096
cv v137,v138,v139
mf a[208:211],a[148:151],v[64:67]
tr a[134:135],v15,6144
cv v138,v152,v153
mf a[212:215],a[148:151],v[68:71]
tr a[136:137],v15,8192
cv v139,v154,v155
mf a[216:219],a[148:151],v[72:75]
tr a[138:139],v15,10240
cv v140,v140,v141
mf a[220:223],a[148:151],v[76:79]
tr a[140:141],v15,12288
cv v141,v142,v143
mf a[224:227],a[152:155],v[64:67]
tr a[142:143],v15,14336
cv v142,v156,v157
mf a[228:231],a[152:155],v[68:71]
ds_read_b128 a[52:55], v4 offset:13312
cv v143,v158,v159
mf a[232:235],a[152:155],v[72:75]
ds_read_b128 a[56:59], v4 offset:14336
cv v160,v160,v161
mf a[236:239],a[152:155],v[76:79]
ds_read_b128 a[60:63], v4 offset:15360
cv v161,v162,v163
mf a[240:243],a[156:159],v[64:67]
ds_read_b128 a[64:67], v4 offset:16384
cv v162,v176,v177
mf a[244:247],a[156:159],v[68:71]
ds_read_b128 a[68:71], v4 offset:17408
cv v163,v178,v179
mf a[248:251],a[156:159],v[72:75]
ds_read_b128 a[72:75], v4 offset:18432
cv v164,v164,v165
mf a[252:255],a[156:159],v[76:79]
ds_read_b128 a[76:79], v4 offset:19456
s_waitcnt lgkmcnt(4)
mz v[32:35],a[128:131],a[0:3],0
tr a[144:145],v5,0
cv v165,v166,v167
mf v[32:35],a[132:135],a[16:19]
tr a[146:147],v5,2048
cv v166,v180,v181
mf v[32:35],a[136:139],a[32:35]
tr a[148:149],v5,4096
cv v167,v182,v183
mf v[32:35],a[140:143],a[48:51]
tr a[150:151],v5,6144
cv v168,v168,v169
mz v[36:39],a[140:143],a[52:55],0
tr a[152:153],v5,8192
cv v169,v170,v171
mf v[36:39],a[136:139],a[36:39]
tr a[154:155],v5,10240
cv v170,v184,v185
mf v[36:39],a[132:135],a[20:23]
tr a[156:157],v5,12288
cv v171,v186,v187
mf v[36:39],a[128:131],a[4:7]
tr a[158:159],v5,14336
cv v172,v172,v173
mz v[40:43],a[128:131],a[8:11],0
ds_read_b128 a[80:83], v4 offset:20480
cv v173,v174,v175
mf v[40:43],a[132:135],a[24:27]
ds_read_b128 a[84:87], v4 offset:21504
cv v174,v188,v189
mf v[40:43],a[136:139],a[40:43]
ds_read_b128 a[88:91], v4 offset:22528
cv v175,v190,v191
mf v[40:43],a[140:143],a[56:59]
ds_read_b128 a[92:95], v4 offset:23552
cv v192,v192,v193
mz v[44:47],a[140:143],a[60:63],0
ds_read_b128 a[96:99], v4 offset:24576
cv v193,v194,v195
mf v[44:47],a[136:139],a[44:47]
ds_read_b128 a[100:103], v4 offset:25600
cv v194,v208,v209
mf v[44:47],a[132:135],a[28:31]
ds_read_b128 a[104:107], v4 offset:26624
cv v195,v210,v211
mf v[44:47],a[128:131],a[12:15]
ds_read_b128 a[108:111], v4 offset:27648
s_waitcnt lgkmcnt(8)
mz v[60:63],a[144:147],a[12:15],0
tr a[128:129],v16,0
cv v196,v196,v197
mf v[60:63],a[148:151],a[28:31]
tr a[130:131],v16,2048
cv v197,v198,v199
mf v[60:63],a[152:155],a[44:47]
tr a[132:133],v16,4096
cv v198,v212,v213
mf v[60:63],a[156:159],a[60:63]
tr a[134:135],v16,6144
cv v199,v214,v215
mz v[56:59],a[156:159],a[56:59],0
tr a[136:137],v16,8192
cv v200,v200,v201
mf v[56:59],a[152:155],a[40:43]
tr a[138:139],v16,10240
cv v201,v202,v203
mf v[56:59],a[148:151],a[24:27]
tr a[140:141],v16,12288
cv v202,v216,v217
mf v[56:59],a[144:147],a[8:11]
tr a[142:143],v16,14336
cv v203,v218,v219
mz v[52:55],a[144:147],a[4:7],0
ds_read_b128 a[112:115], v4 offset:28672
cv v204,v204,v205
mf v[52:55],a[148:151],a[20:23]
ds_read_b128 a[116:119], v4 offset:29696
cv v205,v206,v207
mf v[52:55],a[152:155],a[36:39]
ds_read_b128 a[120:123], v4 offset:30720
cv v206,v220,v221
mf v[52:55],a[156:159],a[52:55]
ds_read_b128 a[124:127], v4 offset:31744
cv v207,v222,v223
mz v[48:51],a[156:159],a[48:51],0
s_add_u32 m0, s24, 49152
v_rcp_f32 v28, v24
mf v[48:51],a[152:155],a[32:35]
s_add_u32 s39, s45, 344064
buffer_load_dwordx4 v3, s[20:23], s39 offen  lds
mf v[48:51],a[148:151],a[16:19]
s_add_u32 m0, s24, 50176
cv v224,v224,v225
v_mul_f32 v24, v24, v11
mf v[48:51],a[144:147],a[0:3]
s_waitcnt lgkmcnt(4)
v_rcp_f32 v29, v25
mz v[64:67],a[128:131],a[0:3],0
tr a[144:145],v6,0
v_mul_f32 v25, v25, v12
mf v[64:67],a[132:135],a[16:19]
tr a[146:147],v6,2048
cv v225,v226,v227
mf v[64:67],a[136:139],a[32:35]
tr a[148:149],v6,4096
cv v226,v240,v241
mf v[64:67],a[140:143],a[48:51]
tr a[150:151],v6,6144
cv v227,v242,v243
mz v[68:71],a[140:143],a[52:55],0
tr a[152:153],v6,8192
ar v21,a160
mf v[68:71],a[136:139],a[36:39]
tr a[154:155],v6,10240
ar v22,a161
mf v[68:71],a[132:135],a[20:23]
tr a[156:157],v6,12288
cv v112,v21,v22
mf v[68:71],a[128:131],a[4:7]
tr a[158:159],v6,14336
ar v21,a162
mz v[72:75],a[128:131],a[8:11],0
s_add_u32 s39, s45, 351232
buffer_load_dwordx4 v3, s[20:23], s39 offen  lds
mf v[72:75],a[132:135],a[24:27]
s_add_u32 m0, s24, 51200
v_rcp_f32 v30, v26
mf v[72:75],a[136:139],a[40:43]
s_add_u32 s39, s45, 358400
buffer_load_dwordx4 v3, s[20:23], s39 offen  lds
mf v[72:75],a[140:143],a[56:59]
s_add_u32 m0, s24, 52224
ar v22,a163
v_mul_f32 v26, v26, v13
mz v[76:79],a[140:143],a[60:63],0
s_add_u32 s39, s45, 365568
buffer_load_dwordx4 v3, s[20:23], s39 offen  lds
mf v[76:79],a[136:139],a[44:47]
s_add_u32 m0, s25, 0
v_rcp_f32 v31, v27
mf v[76:79],a[132:135],a[28:31]
cv v113,v21,v22
v_mul_f32 v27, v27, v14
mf v[76:79],a[128:131],a[12:15]
wl
ar v21,a176
ar v22,a177
mz v[92:95],a[144:147],a[12:15],0
s_waitcnt vmcnt(4)
cv v114,v21,v22
s_barrier
mf v[92:95],a[148:151],a[28:31]
tr a[128:129],v15,16384
ar v21,a178
mf v[92:95],a[152:155],a[44:47]
tr a[130:131],v15,18432
ar v22,a179
mf v[92:95],a[156:159],a[60:63]
tr a[132:133],v15,20480
cv v115,v21,v22
mz v[88:91],a[156:159],a[56:59],0
tr a[134:135],v15,22528
ar v21,a192
mf v[88:91],a[152:155],a[40:43]
tr a[136:137],v15,24576
ar v22,a193
mf v[88:91],a[148:151],a[24:27]
tr a[138:139],v15,26624
cv v144,v21,v22
mf v[88:91],a[144:147],a[8:11]
tr a[140:141],v15,28672
ar v21,a194
mz v[84:87],a[144:147],a[4:7],0
tr a[142:143],v15,30720
ar v22,a195
mf v[84:87],a[148:151],a[20:23]
s_add_u32 s39, s51, 0
buffer_load_dwordx4 v3, s[20:23], s39 offen  lds
mf v[84:87],a[152:155],a[36:39]
s_add_u32 m0, s25, 1024
cv v145,v21,v22
ar v21,a208
mf v[84:87],a[156:159],a[52:55]
s_add_u32 s39, s51, 7168
buffer_load_dwordx4 v3, s[20:23], s39 offen  lds
mz v[80:83],a[156:159],a[48:51],0
s_add_u32 m0, s25, 2048
ar v22,a209
cv v146,v21,v22
mf v[80:83],a[152:155],a[32:35]
ar v21,a210
ar v22,a211
mf v[80:83],a[148:151],a[16:19]
cv v147,v21,v22
ar v21,a224
mf v[80:83],a[144:147],a[0:3]
wl
ar v22,a225
cv v176,v21,v22
mf v[32:35],a[128:131],a[64:67]
tr a[144:145],v5,16384
ar v21,a226
mf v[32:35],a[132:135],a[80:83]
tr a[146:147],v5,18432
ar v22,a227
mf v[32:35],a[136:139],a[96:99]
tr a[148:149],v5,20480
cv v177,v21,v22
mf v[32:35],a[140:143],a[112:115]
tr a[150:151],v5,22528
ar v21,a240
mf v[36:39],a[140:143],a[116:119]
tr a[152:153],v5,24576
ar v22,a241
mf v[36:39],a[136:139],a[100:103]
tr a[154:155],v5,26624
cv v178,v21,v22
mf v[36:39],a[132:135],a[84:87]
tr a[156:157],v5,28672
ar v21,a242
mf v[36:39],a[128:131],a[68:71]
tr a[158:159],v5,30720
ar v22,a243
mf v[40:43],a[128:131],a[72:75]
s_add_u32 s39, s51, 14336
buffer_load_dwordx4 v3, s[20:23], s39 offen  lds
mf v[40:43],a[132:135],a[88:91]
s_add_u32 m0, s25, 3072
v_mul_f32 v32, v32, v24
v_mul_f32 v33, v33, v24
mf v[40:43],a[136:139],a[104:107]
s_add_u32 s39, s51, 21504
buffer_load_dwordx4 v3, s[20:23], s39 offen  lds
mf v[40:43],a[140:143],a[120:123]
s_add_u32 m0, s25, 16384
v_mul_f32 v34, v34, v24
v_mul_f32 v35, v35, v24
mf v[44:47],a[140:143],a[124:127]
cv v179,v21,v22
cv v228,v228,v229
mf v[44:47],a[136:139],a[108:111]
v_mul_f32 v36, v36, v25
v_mul_f32 v37, v37, v25
mf v[44:47],a[132:135],a[92:95]
v_mul_f32 v38, v38, v25
v_mul_f32 v39, v39, v25
mf v[44:47],a[128:131],a[76:79]
wl
cv v229,v230,v231
cv v230,v244,v245
mf v[60:63],a[144:147],a[76:79]
tr a[128:129],v16,16384
cv v231,v246,v247
mf v[60:63],a[148:151],a[92:95]
tr a[130:131],v16,18432
v_mul_f32 v40, v40, v26
mf v[60:63],a[152:155],a[108:111]
tr a[132:133],v16,20480
v_mul_f32 v41, v41, v26
mf v[60:63],a[156:159],a[124:127]
tr a[134:135],v16,22528
v_mul_f32 v42, v42, v26
mf v[56:59],a[156:159],a[120:123]
tr a[136:137],v16,24576
v_mul_f32 v43, v43, v26
mf v[56:59],a[152:155],a[104:107]
tr a[138:139],v16,26624
v_mul_f32 v44, v44, v27
mf v[56:59],a[148:151],a[88:91]
tr a[140:141],v16,28672
v_mul_f32 v45, v45, v27
mf v[56:59],a[144:147],a[72:75]
tr a[142:143],v16,30720
v_mul_f32 v46, v46, v27
mf v[52:55],a[144:147],a[68:71]
s_add_u32 s39, s51, 114688
buffer_load_dwordx4 v3, s[20:23], s39 offen  lds
mf v[52:55],a[148:151],a[84:87]
s_add_u32 m0, s25, 17408
v_mul_f32 v47, v47, v27
v_mul_f32 v60, v60, v27
mf v[52:55],a[152:155],a[100:103]
s_add_u32 s39, s51, 121856
buffer_load_dwordx4 v3, s[20:23], s39 offen  lds
mf v[52:55],a[156:159],a[116:119]
s_add_u32 m0, s25, 18432
v_mul_f32 v61, v61, v27
v_mul_f32 v62, v62, v27
mf v[48:51],a[156:159],a[112:115]
ar v21,a164
v_mul_f32 v63, v63, v27
mf v[48:51],a[152:155],a[96:99]
v_mul_f32 v56, v56, v26
v_mul_f32 v57, v57, v26
mf v[48:51],a[148:151],a[80:83]
v_mul_f32 v58, v58, v26
v_mul_f32 v59, v59, v26
mf v[48:51],a[144:147],a[64:67]
wl
ar v22,a165
cv v116,v21,v22
mf v[64:67],a[128:131],a[64:67]
tr a[144:145],v6,16384
ar v21,a166
mf v[64:67],a[132:135],a[80:83]
tr a[146:147],v6,18432
v_mul_f32 v52, v52, v25
mf v[64:67],a[136:139],a[96:99]
tr a[148:149],v6,20480
v_mul_f32 v53, v53, v25
mf v[64:67],a[140:143],a[112:115]
tr a[150:151],v6,22528
v_mul_f32 v54, v54, v25
mf v[68:71],a[140:143],a[116:119]
tr a[152:153],v6,24576
v_mul_f32 v55, v55, v25
mf v[68:71],a[136:139],a[100:103]
tr a[154:155],v6,26624
v_mul_f32 v48, v48, v24
mf v[68:71],a[132:135],a[84:87]
tr a[156:157],v6,28672
v_mul_f32 v49, v49, v24
mf v[68:71],a[128:131],a[68:71]
tr a[158:159],v6,30720
v_mul_f32 v50, v50, v24
mf v[72:75],a[128:131],a[72:75]
s_add_u32 s39, s51, 129024
buffer_load_dwordx4 v3, s[20:23], s39 offen  lds
mf v[72:75],a[132:135],a[88:91]
s_add_u32 m0, s25, 19456
v_mul_f32 v51, v51, v24
v_mul_f32 v64, v64, v24
mf v[72:75],a[136:139],a[104:107]
s_add_u32 s39, s51, 136192
buffer_load_dwordx4 v3, s[20:23], s39 offen  lds
mf v[72:75],a[140:143],a[120:123]
s_add_u32 m0, s25, 32768
v_mul_f32 v65, v65, v24
v_mul_f32 v66, v66, v24
mf v[76:79],a[140:143],a[124:127]
ar v22,a167
v_mul_f32 v67, v67, v24
mf v[76:79],a[136:139],a[108:111]
v_mul_f32 v68, v68, v25
v_mul_f32 v69, v69, v25
mf v[76:79],a[132:135],a[92:95]
v_mul_f32 v70, v70, v25
v_mul_f32 v71, v71, v25
mf v[76:79],a[128:131],a[76:79]
wl
cv v117,v21,v22
ar v21,a180
mf v[92:95],a[144:147],a[76:79]
tr a[128:129],v15,32768
ar v22,a181
mf v[92:95],a[148:151],a[92:95]
tr a[130:131],v15,34816
v_mul_f32 v72, v72, v26
mf v[92:95],a[152:155],a[108:111]
tr a[132:133],v15,36864
v_mul_f32 v73, v73, v26
mf v[92:95],a[156:159],a[124:127]
tr a[134:135],v15,38912
v_mul_f32 v74, v74, v26
mf v[88:91],a[156:159],a[120:123]
tr a[136:137],v15,40960
v_mul_f32 v75, v75, v26
mf v[88:91],a[152:155],a[104:107]
tr a[138:139],v15,43008
v_mul_f32 v76, v76, v27
mf v[88:91],a[148:151],a[88:91]
tr a[140:141],v15,45056
v_mul_f32 v77, v77, v27
mf v[88:91],a[144:147],a[72:75]
tr a[142:143],v15,47104
v_mul_f32 v78, v78, v27
mf v[84:87],a[144:147],a[68:71]
s_add_u32 s39, s51, 229376
buffer_load_dwordx4 v3, s[20:23], s39 offen  lds
mf v[84:87],a[148:151],a[84:87]
s_add_u32 m0, s25, 33792
v_mul_f32 v79, v79, v27
v_mul_f32 v92, v92, v27
mf v[84:87],a[152:155],a[100:103]
s_add_u32 s39, s51, 236544
buffer_load_dwordx4 v3, s[20:23], s39 offen  lds
mf v[84:87],a[156:159],a[116:119]
s_add_u32 m0, s25, 34816
v_mul_f32 v93, v93, v27
v_mul_f32 v94, v94, v27
mf v[80:83],a[156:159],a[112:115]
cv v118,v21,v22
v_mul_f32 v95, v95, v27
mf v[80:83],a[152:155],a[96:99]
v_mul_f32 v88, v88, v26
v_mul_f32 v89, v89, v26
mf v[80:83],a[148:151],a[80:83]
v_mul_f32 v90, v90, v26
v_mul_f32 v91, v91, v26
mf v[80:83],a[144:147],a[64:67]
wl
ar v21,a182
ar v22,a183
mf v[32:35],a[128:131],v[96:99]
tr a[144:145],v5,32768
cv v119,v21,v22
mf v[32:35],a[132:135],v[128:131]
tr a[146:147],v5,34816
v_mul_f32 v84, v84, v25
mf v[32:35],a[136:139],v[160:163]
tr a[148:149],v5,36864
v_mul_f32 v85, v85, v25
mf v[32:35],a[140:143],v[192:195]
tr a[150:151],v5,38912
v_mul_f32 v86, v86, v25
mf v[36:39],a[140:143],v[196:199]
tr a[152:153],v5,40960
v_mul_f32 v87, v87, v25
mf v[36:39],a[136:139],v[164:167]
tr a[154:155],v5,43008
v_mul_f32 v80, v80, v24
mf v[36:39],a[132:135],v[132:135]
tr a[156:157],v5,45056
v_mul_f32 v81, v81, v24
mf v[36:39],a[128:131],v[100:103]
tr a[158:159],v5,47104
v_mul_f32 v82, v82, v24
mf v[40:43],a[128:131],v[104:107]
s_add_u32 s39, s51, 243712
buffer_load_dwordx4 v3, s[20:23], s39 offen  lds
mf v[40:43],a[132:135],v[136:139]
s_add_u32 m0, s25, 35840
ar v21,a196
v_mul_f32 v83, v83, v24
mf v[40:43],a[136:139],v[168:171]
s_add_u32 s39, s51, 250880
buffer_load_dwordx4 v3, s[20:23], s39 offen  lds
mf v[40:43],a[140:143],v[200:203]
s_add_u32 m0, s25, 49152
ar v22,a197
cv v148,v21,v22
mf v[44:47],a[140:143],v[204:207]
ar v21,a198
ar v22,a199
mf v[44:47],a[136:139],v[172:175]
cv v149,v21,v22
ar v21,a212
mf v[44:47],a[132:135],v[140:143]
ar v22,a213
cv v150,v21,v22
mf v[44:47],a[128:131],v[108:111]
wl
ar v21,a214
ar v22,a215
mf v[60:63],a[144:147],v[108:111]
tr a[128:129],v16,32768
cv v151,v21,v22
mf v[60:63],a[148:151],v[140:143]
tr a[130:131],v16,34816
ar v21,a228
mf v[60:63],a[152:155],v[172:175]
tr a[132:133],v16,36864
ar v22,a229
mf v[60:63],a[156:159],v[204:207]
tr a[134:135],v16,38912
cv v180,v21,v22
mf v[56:59],a[156:159],v[200:203]
tr a[136:137],v16,40960
ar v21,a230
mf v[56:59],a[152:155],v[168:171]
tr a[138:139],v16,43008
ar v22,a231
mf v[56:59],a[148:151],v[136:139]
tr a[140:141],v16,45056
cv v181,v21,v22
mf v[56:59],a[144:147],v[104:107]
tr a[142:143],v16,47104
ar v21,a244
mf v[52:55],a[144:147],v[100:103]
s_add_u32 s39, s51, 344064
buffer_load_dwordx4 v3, s[20:23], s39 offen  lds
mf v[52:55],a[148:151],v[132:135]
s_add_u32 m0, s25, 50176
ar v22,a245
cv v182,v21,v22
mf v[52:55],a[152:155],v[164:167]
s_add_u32 s39, s51, 351232
buffer_load_dwordx4 v3, s[20:23], s39 offen  lds
mf v[52:55],a[156:159],v[196:199]
s_add_u32 m0, s25, 51200
ar v21,a246
ar v22,a247
mf v[48:51],a[156:159],v[192:195]
cv v183,v21,v22
cv v232,v232,v233
mf v[48:51],a[152:155],v[160:163]
cv v233,v234,v235
cv v234,v248,v249
mf v[48:51],a[148:151],v[128:131]
cv v235,v250,v251
ar v21,a168
mf v[48:51],a[144:147],v[96:99]
wl
ar v22,a169
cv v120,v21,v22
mf v[64:67],a[128:131],v[96:99]
tr a[144:145],v6,32768
ar v21,a170
mf v[64:67],a[132:135],v[128:131]
tr a[146:147],v6,34816
ar v22,a171
mf v[64:67],a[136:139],v[160:163]
tr a[148:149],v6,36864
cv v121,v21,v22
mf v[64:67],a[140:143],v[192:195]
tr a[150:151],v6,38912
ar v21,a184
mf v[68:71],a[140:143],v[196:199]
tr a[152:153],v6,40960
ar v22,a185
mf v[68:71],a[136:139],v[164:167]
tr a[154:155],v6,43008
cv v122,v21,v22
mf v[68:71],a[132:135],v[132:135]
tr a[156:157],v6,45056
ar v21,a186
mf v[68:71],a[128:131],v[100:103]
tr a[158:159],v6,47104
ar v22,a187
mf v[72:75],a[128:131],v[104:107]
s_add_u32 s39, s51, 358400
buffer_load_dwordx4 v3, s[20:23], s39 offen  lds
mf v[72:75],a[132:135],v[136:139]
s_add_u32 m0, s25, 52224
cv v123,v21,v22
ar v21,a200
mf v[72:75],a[136:139],v[168:171]
s_add_u32 s39, s51, 365568
buffer_load_dwordx4 v3, s[20:23], s39 offen  lds
mf v[72:75],a[140:143],v[200:203]
s_add_u32 m0, s24, 0
ar v22,a201
cv v152,v21,v22
mf v[76:79],a[140:143],v[204:207]
ar v21,a202
ar v22,a203
mf v[76:79],a[136:139],v[172:175]
cv v153,v21,v22
ar v21,a216
mf v[76:79],a[132:135],v[140:143]
ar v22,a217
cv v154,v21,v22
mf v[76:79],a[128:131],v[108:111]
wl
ar v21,a218
ar v22,a219
mf v[92:95],a[144:147],v[108:111]
s_waitcnt vmcnt(16)
cv v155,v21,v22
s_barrier
mf v[92:95],a[148:151],v[140:143]
tr a[128:129],v15,49152
ar v21,a232
mf v[92:95],a[152:155],v[172:175]
tr a[130:131],v15,51200
ar v22,a233
mf v[92:95],a[156:159],v[204:207]
tr a[132:133],v15,53248
cv v184,v21,v22
mf v[88:91],a[156:159],v[200:203]
tr a[134:135],v15,55296
ar v21,a234
mf v[88:91],a[152:155],v[168:171]
tr a[136:137],v15,57344
ar v22,a235
mf v[88:91],a[148:151],v[136:139]
tr a[138:139],v15,59392
cv v185,v21,v22
mf v[88:91],a[144:147],v[104:107]
tr a[140:141],v15,61440
ar v21,a248
mf v[84:87],a[144:147],v[100:103]
tr a[142:143],v15,63488
ar v22,a249
mf v[84:87],a[148:151],v[132:135]
s_add_u32 s39, s52, 0
buffer_load_dwordx4 v3, s[20:23], s39 offen  lds
mf v[84:87],a[152:155],v[164:167]
s_add_u32 m0, s24, 1024
cv v186,v21,v22
ar v21,a250
mf v[84:87],a[156:159],v[196:199]
s_add_u32 s39, s52, 7168
buffer_load_dwordx4 v3, s[20:23], s39 offen  lds
mf v[80:83],a[156:159],v[192:195]
s_add_u32 m0, s24, 2048
ar v22,a251
cv v187,v21,v22
mf v[80:83],a[152:155],v[160:163]
cv v236,v236,v237
cv v237,v238,v239
mf v[80:83],a[148:151],v[128:131]
cv v238,v252,v253
cv v239,v254,v255
mf v[80:83],a[144:147],v[96:99]
wl
ar v21,a172
ar v22,a173
mf v[32:35],a[128:131],v[224:227]
tr a[144:145],v5,49152
cv v124,v21,v22
mf v[32:35],a[132:135],v[112:115]
tr a[146:147],v5,51200
ar v21,a174
mf v[32:35],a[136:139],v[144:147]
tr a[148:149],v5,53248
ar v22,a175
mf v[32:35],a[140:143],v[176:179]
tr a[150:151],v5,55296
cv v125,v21,v22
mf v[36:39],a[140:143],v[180:183]
tr a[152:153],v5,57344
ar v21,a188
mf v[36:39],a[136:139],v[148:151]
tr a[154:155],v5,59392
ar v22,a189
mf v[36:39],a[132:135],v[116:119]
tr a[156:157],v5,61440
cv v126,v21,v22
mf v[36:39],a[128:131],v[228:231]
tr a[158:159],v5,63488
ar v21,a190
mf v[40:43],a[128:131],v[232:235]
s_add_u32 s39, s52, 14336
buffer_load_dwordx4 v3, s[20:23], s39 offen  lds
mf v[40:43],a[132:135],v[120:123]
ar v22,a191
cv v127,v21,v22
ar v21,a204
ar v22,a205
cv v156,v21,v22
ar v21,a206
ar v22,a207
cv v157,v21,v22
ar v21,a220
ar v22,a221
cv v158,v21,v22
ar v21,a222
ar v22,a223
cv v159,v21,v22
ar v21,a236
ar v22,a237
cv v188,v21,v22
ar v21,a238
ar v22,a239
cv v189,v21,v22
ar v21,a252
ar v22,a253
cv v190,v21,v22
ar v21,a254
ar v22,a255
cv v191,v21,v22
mf v[40:43],a[136:139],v[152:155]
s_add_u32 m0, s24, 3072
v_mul_f32 v32, v32, v28
v_mul_f32 v33, v33, v28
mf v[40:43],a[140:143],v[184:187]
s_add_u32 s39, s52, 21504
buffer_load_dwordx4 v3, s[20:23], s39 offen  lds
mf v[44:47],a[140:143],v[188:191]
s_add_u32 m0, s24, 16384
v_mul_f32 v34, v34, v28
v_mul_f32 v35, v35, v28
mf v[44:47],a[136:139],v[156:159]
cv v32,v32,v33
cv v33,v34,v35
mf v[44:47],a[132:135],v[124:127]
v_mul_f32 v36, v36, v29
v_mul_f32 v37, v37, v29
mf v[44:47],a[128:131],v[236:239]
wl
v_mul_f32 v38, v38, v29
v_mul_f32 v39, v39, v29
mf v[60:63],a[144:147],v[236:239]
tr a[128:129],v16,49152
cv v36,v36,v37
mf v[60:63],a[148:151],v[124:127]
tr a[130:131],v16,51200
cv v37,v38,v39
mf v[60:63],a[152:155],v[156:159]
tr a[132:133],v16,53248
v_mul_f32 v40, v40, v30
mf v[60:63],a[156:159],v[188:191]
tr a[134:135],v16,55296
v_mul_f32 v41, v41, v30
mf v[56:59],a[156:159],v[184:187]
tr a[136:137],v16,57344
v_mul_f32 v42, v42, v30
mf v[56:59],a[152:155],v[152:155]
tr a[138:139],v16,59392
v_mul_f32 v43, v43, v30
mf v[56:59],a[148:151],v[120:123]
tr a[140:141],v16,61440
cv v40,v40,v41
mf v[56:59],a[144:147],v[232:235]
tr a[142:143],v16,63488
cv v41,v42,v43
mf v[52:55],a[144:147],v[228:231]
s_add_u32 s39, s52, 114688
buffer_load_dwordx4 v3, s[20:23], s39 offen  lds
mf v[52:55],a[148:151],v[116:119]
s_add_u32 m0, s24, 17408
v_mul_f32 v44, v44, v31
v_mul_f32 v45, v45, v31
mf v[52:55],a[152:155],v[148:151]
s_add_u32 s39, s52, 121856
buffer_load_dwordx4 v3, s[20:23], s39 offen  lds
mf v[52:55],a[156:159],v[180:183]
s_add_u32 m0, s24, 18432
v_mul_f32 v46, v46, v31
v_mul_f32 v47, v47, v31
mf v[48:51],a[156:159],v[176:179]
cv v44,v44,v45
cv v45,v46,v47
mf v[48:51],a[152:155],v[144:147]
v_mul_f32 v60, v60, v31
v_mul_f32 v61, v61, v31
mf v[48:51],a[148:151],v[112:115]
v_mul_f32 v62, v62, v31
v_mul_f32 v63, v63, v31
mf v[48:51],a[144:147],v[224:227]
wl
cv v46,v60,v61
cv v47,v62,v63
mf v[64:67],a[128:131],v[224:227]
tr a[144:145],v6,49152
v_mul_f32 v56, v56, v30
mf v[64:67],a[132:135],v[112:115]
tr a[146:147],v6,51200
v_mul_f32 v57, v57, v30
mf v[64:67],a[136:139],v[144:147]
tr a[148:149],v6,53248
v_mul_f32 v58, v58, v30
mf v[64:67],a[140:143],v[176:179]
tr a[150:151],v6,55296
v_mul_f32 v59, v59, v30
mf v[68:71],a[140:143],v[180:183]
tr a[152:153],v6,57344
cv v42,v56,v57
mf v[68:71],a[136:139],v[148:151]
tr a[154:155],v6,59392
cv v43,v58,v59
mf v[68:71],a[132:135],v[116:119]
tr a[156:157],v6,61440
v_mul_f32 v52, v52, v29
mf v[68:71],a[128:131],v[228:231]
tr a[158:159],v6,63488
v_mul_f32 v53, v53, v29
mf v[72:75],a[128:131],v[232:235]
s_add_u32 s39, s52, 129024
buffer_load_dwordx4 v3, s[20:23], s39 offen  lds
mf v[72:75],a[132:135],v[120:123]
s_add_u32 s38, s40, 49152
buffer_store_dwordx4 v[44:47], v1, s[28:31], s38 offen sc1
mf v[72:75],a[136:139],v[152:155]
s_add_u32 s38, s40, 32768
buffer_store_dwordx4 v[40:43], v1, s[28:31], s38 offen sc1
mf v[72:75],a[140:143],v[184:187]
s_add_u32 m0, s24, 19456
v_mul_f32 v54, v54, v29
v_mul_f32 v55, v55, v29
mf v[76:79],a[140:143],v[188:191]
s_add_u32 s39, s52, 136192
buffer_load_dwordx4 v3, s[20:23], s39 offen  lds
mf v[76:79],a[136:139],v[156:159]
s_mov_b32 s45, s51
cv v38,v52,v53
cv v39,v54,v55
mf v[76:79],a[132:135],v[124:127]
s_add_u32 s38, s40, 16384
buffer_store_dwordx4 v[36:39], v1, s[28:31], s38 offen sc1
mf v[76:79],a[128:131],v[236:239]
wl
v_mul_f32 v48, v48, v28
v_mul_f32 v49, v49, v28
mf v[92:95],a[144:147],v[236:239]
s_waitcnt vmcnt(19)
v_mul_f32 v50, v50, v28
s_barrier
mf v[92:95],a[148:151],v[124:127]
s_mov_b32 s51, s52
v_mul_f32 v51, v51, v28
v_xor_b32 v15, 0x10000, v15
mf v[92:95],a[152:155],v[156:159]
tr a[128:129],v15,0
cv v34,v48,v49
mf v[92:95],a[156:159],v[188:191]
tr a[130:131],v15,2048
cv v35,v50,v51
mf v[88:91],a[156:159],v[184:187]
tr a[132:133],v15,4096
v_mul_f32 v64, v64, v28
mf v[88:91],a[152:155],v[152:155]
tr a[134:135],v15,6144
v_mul_f32 v65, v65, v28
mf v[88:91],a[148:151],v[120:123]
tr a[136:137],v15,8192
v_mul_f32 v66, v66, v28
mf v[88:91],a[144:147],v[232:235]
tr a[138:139],v15,10240
v_mul_f32 v67, v67, v28
mf v[84:87],a[144:147],v[228:231]
tr a[140:141],v15,12288
cv v64,v64,v65
mf v[84:87],a[148:151],v[116:119]
tr a[142:143],v15,14336
cv v65,v66,v67
mf v[84:87],a[152:155],v[148:151]
s_add_u32 s38, s40, 0
buffer_store_dwordx4 v[32:35], v1, s[28:31], s38 offen sc1
mf v[84:87],a[156:159],v[180:183]
s_xor_b32 s24, s24, 0x10000
v_mul_f32 v68, v68, v29
v_mul_f32 v69, v69, v29
mf v[80:83],a[156:159],v[176:179]
s_xor_b32 s25, s25, 0x10000
v_mul_f32 v70, v70, v29
v_mul_f32 v71, v71, v29
mf v[80:83],a[152:155],v[144:147]
s_add_u32 s41, s41, 1
cv v68,v68,v69
cv v69,v70,v71
mf v[80:83],a[148:151],v[112:115]
v_mul_f32 v72, v72, v30
v_mul_f32 v73, v73, v30
v_mul_f32 v74, v74, v30
v_mul_f32 v75, v75, v30
cv v72,v72,v73
cv v73,v74,v75
v_mul_f32 v76, v76, v31
v_mul_f32 v77, v77, v31
v_mul_f32 v78, v78, v31
v_mul_f32 v79, v79, v31
cv v76,v76,v77
cv v77,v78,v79
mf v[80:83],a[144:147],v[224:227]
wl
v_add_u32 v4, 2359296, v0
v_bfe_u32 v218, v1, 5, 3
v_bfe_u32 v219, v1, 8, 2
v_lshlrev_b32 v219, 1, v219
v_xor_b32 v218, v218, v219
v_and_b32 v219, 16, v1
v_mov_b32 v0, 0x3f80
v_lshlrev_b32 v219, v219, v0
v_cmp_eq_u32 vcc, 0, v218
v_cmp_eq_u32 s[72:73], 1, v218
v_nop
v_cndmask_b32 v216, 0, v219, vcc
v_cndmask_b32 v217, 0, v219, s[72:73]
v_mov_b32 v218, v216
v_mov_b32 v219, v217
v_xor_b32 v5, 0x10000, v5
v_xor_b32 v16, 0x10000, v16
v_xor_b32 v6, 0x10000, v6
.p2align 5
Loloops_a:
mz v[32:35],a[128:131],a[0:3],0
tr a[144:145],v15,16384
v_mul_f32 v92, v92, v31
mf v[32:35],a[132:135],a[16:19]
tr a[146:147],v15,18432
v_mul_f32 v93, v93, v31
mf v[32:35],a[136:139],a[32:35]
tr a[148:149],v15,20480
v_mul_f32 v94, v94, v31
mf v[32:35],a[140:143],a[48:51]
tr a[150:151],v15,22528
v_mul_f32 v95, v95, v31
mz v[36:39],a[140:143],a[52:55],0
tr a[152:153],v15,24576
cv v78,v92,v93
mf v[36:39],a[136:139],a[36:39]
tr a[154:155],v15,26624
cv v79,v94,v95
mf v[36:39],a[132:135],a[20:23]
tr a[156:157],v15,28672
v_mul_f32 v88, v88, v30
mf v[36:39],a[128:131],a[4:7]
tr a[158:159],v15,30720
v_mul_f32 v89, v89, v30
mz v[40:43],a[128:131],a[8:11],0
s_add_u32 s38, s40, 57344
buffer_store_dwordx4 v[76:79], v1, s[28:31], s38 offen sc1
mf v[40:43],a[132:135],a[24:27]
s_add_u32 s48, s51, 128
v_mul_f32 v90, v90, v30
v_mul_f32 v91, v91, v30
mf v[40:43],a[136:139],a[40:43]
s_cmp_lt_u32 s41, 5
s_cselect_b32 s52, s48, 0x40000000
cv v74,v88,v89
cv v75,v90,v91
mf v[40:43],a[140:143],a[56:59]
s_add_u32 s38, s40, 40960
buffer_store_dwordx4 v[72:75], v1, s[28:31], s38 offen sc1
mz v[44:47],a[140:143],a[60:63],0
v_mul_f32 v84, v84, v29
v_mul_f32 v85, v85, v29
mf v[44:47],a[136:139],a[44:47]
v_mul_f32 v86, v86, v29
v_mul_f32 v87, v87, v29
mf v[44:47],a[132:135],a[28:31]
cv v70,v84,v85
cv v71,v86,v87
mf v[44:47],a[128:131],a[12:15]
wl
v_mul_f32 v80, v80, v28
v_mul_f32 v81, v81, v28
mf v[44:47],a[144:147],a[76:79]
tr a[128:129],v5,16384
v_mul_f32 v82, v82, v28
mf v[44:47],a[148:151],a[92:95]
tr a[130:131],v5,18432
v_mul_f32 v83, v83, v28
mf v[44:47],a[152:155],a[108:111]
tr a[132:133],v5,20480
cv v66,v80,v81
mf v[44:47],a[156:159],a[124:127]
tr a[134:135],v5,22528
cv v67,v82,v83
mf v[40:43],a[156:159],a[120:123]
tr a[136:137],v5,24576
cv v222,v212,v213
mf v[40:43],a[152:155],a[104:107]
tr a[138:139],v5,26624
cv v223,v214,v215
mf v[40:43],a[148:151],a[88:91]
tr a[140:141],v5,28672
cv v220,v208,v209
mf v[40:43],a[144:147],a[72:75]
tr a[142:143],v5,30720
cv v221,v210,v211
mf v[36:39],a[144:147],a[68:71]
s_add_u32 s38, s40, 24576
buffer_store_dwordx4 v[68:71], v1, s[28:31], s38 offen sc1
mf v[36:39],a[148:151],a[84:87]
v_mul_f32 v44, v44, v27
v_mul_f32 v45, v45, v27
mf v[36:39],a[152:155],a[100:103]
v_mul_f32 v46, v46, v27
v_mul_f32 v47, v47, v27
mf v[36:39],a[156:159],a[116:119]
s_add_u32 s38, s40, 8192
buffer_store_dwordx4 v[64:67], v1, s[28:31], s38 offen sc1
mf v[32:35],a[156:159],a[112:115]
s_add_u32 s40, s40, 262144
mf v[32:35],a[152:155],a[96:99]
v_mul_f32 v40, v40, v26
v_mul_f32 v41, v41, v26
mf v[32:35],a[148:151],a[80:83]
v_mul_f32 v42, v42, v26
v_mul_f32 v43, v43, v26
mf v[32:35],a[144:147],a[64:67]
wl
mz v[48:51],a[128:131],a[64:67],0
tr a[144:145],v5,0
mf v[48:51],a[132:135],a[80:83]
tr a[146:147],v5,2048
v_mul_f32 v36, v36, v25
mf v[48:51],a[136:139],a[96:99]
tr a[148:149],v5,4096
v_mul_f32 v37, v37, v25
mf v[48:51],a[140:143],a[112:115]
tr a[150:151],v5,6144
v_mul_f32 v38, v38, v25
mz v[52:55],a[140:143],a[116:119],0
tr a[152:153],v5,8192
v_mul_f32 v39, v39, v25
mf v[52:55],a[136:139],a[100:103]
tr a[154:155],v5,10240
v_mul_f32 v32, v32, v24
mf v[52:55],a[132:135],a[84:87]
tr a[156:157],v5,12288
v_mul_f32 v33, v33, v24
mf v[52:55],a[128:131],a[68:71]
tr a[158:159],v5,14336
v_mul_f32 v34, v34, v24
mz v[56:59],a[128:131],a[72:75],0
v_mul_f32 v35, v35, v24
mf v[56:59],a[132:135],a[88:91]
mf v[56:59],a[136:139],a[104:107]
mf v[56:59],a[140:143],a[120:123]
mz v[60:63],a[140:143],a[124:127],0
mf v[60:63],a[136:139],a[108:111]
mf v[60:63],a[132:135],a[92:95]
mf v[60:63],a[128:131],a[76:79]
wl
mf v[60:63],a[144:147],a[12:15]
tr a[128:129],v16,0
mf v[60:63],a[148:151],a[28:31]
tr a[130:131],v16,2048
mf v[60:63],a[152:155],a[44:47]
tr a[132:133],v16,4096
mf v[60:63],a[156:159],a[60:63]
tr a[134:135],v16,6144
mf v[56:59],a[156:159],a[56:59]
tr a[136:137],v16,8192
v_mov_b32 v0, s41
mf v[56:59],a[152:155],a[40:43]
tr a[138:139],v16,10240
mf v[56:59],a[148:151],a[24:27]
tr a[140:141],v16,12288
mf v[56:59],a[144:147],a[8:11]
tr a[142:143],v16,14336
mf v[52:55],a[144:147],a[4:7]
s_waitcnt vmcnt(0)
buffer_store_dword v0, v17, s[28:31], 0 offen sc1
mf v[52:55],a[148:151],a[20:23]
v_mul_f32 v60, v60, v27
v_mul_f32 v61, v61, v27
mf v[52:55],a[152:155],a[36:39]
v_mul_f32 v62, v62, v27
v_mul_f32 v63, v63, v27
mf v[52:55],a[156:159],a[52:55]
mf v[48:51],a[156:159],a[48:51]
mf v[48:51],a[152:155],a[32:35]
v_mul_f32 v56, v56, v26
v_mul_f32 v57, v57, v26
mf v[48:51],a[148:151],a[16:19]
v_mul_f32 v58, v58, v26
v_mul_f32 v59, v59, v26
mf v[48:51],a[144:147],a[0:3]
wl
mz v[64:67],a[128:131],a[0:3],0
tr a[144:145],v16,16384
mf v[64:67],a[132:135],a[16:19]
tr a[146:147],v16,18432
v_mul_f32 v52, v52, v25
mf v[64:67],a[136:139],a[32:35]
tr a[148:149],v16,20480
v_mul_f32 v53, v53, v25
mf v[64:67],a[140:143],a[48:51]
tr a[150:151],v16,22528
v_mul_f32 v54, v54, v25
mz v[68:71],a[140:143],a[52:55],0
tr a[152:153],v16,24576
v_mul_f32 v55, v55, v25
mf v[68:71],a[136:139],a[36:39]
tr a[154:155],v16,26624
v_mul_f32 v48, v48, v24
mf v[68:71],a[132:135],a[20:23]
tr a[156:157],v16,28672
v_mul_f32 v49, v49, v24
mf v[68:71],a[128:131],a[4:7]
tr a[158:159],v16,30720
v_mul_f32 v50, v50, v24
mz v[72:75],a[128:131],a[8:11],0
v_mul_f32 v51, v51, v24
mf v[72:75],a[132:135],a[24:27]
mf v[72:75],a[136:139],a[40:43]
mf v[72:75],a[140:143],a[56:59]
mz v[76:79],a[140:143],a[60:63],0
mf v[76:79],a[136:139],a[44:47]
mf v[76:79],a[132:135],a[28:31]
mf v[76:79],a[128:131],a[12:15]
wl
mf v[76:79],a[144:147],a[76:79]
tr a[128:129],v6,16384
mf v[76:79],a[148:151],a[92:95]
tr a[130:131],v6,18432
mf v[76:79],a[152:155],a[108:111]
tr a[132:133],v6,20480
mf v[76:79],a[156:159],a[124:127]
tr a[134:135],v6,22528
mf v[72:75],a[156:159],a[120:123]
tr a[136:137],v6,24576
mf v[72:75],a[152:155],a[104:107]
tr a[138:139],v6,26624
mf v[72:75],a[148:151],a[88:91]
tr a[140:141],v6,28672
mf v[72:75],a[144:147],a[72:75]
tr a[142:143],v6,30720
mf v[68:71],a[144:147],a[68:71]
mf v[68:71],a[148:151],a[84:87]
v_mul_f32 v76, v76, v27
v_mul_f32 v77, v77, v27
mf v[68:71],a[152:155],a[100:103]
v_mul_f32 v78, v78, v27
v_mul_f32 v79, v79, v27
mf v[68:71],a[156:159],a[116:119]
mf v[64:67],a[156:159],a[112:115]
mf v[64:67],a[152:155],a[96:99]
v_mul_f32 v72, v72, v26
v_mul_f32 v73, v73, v26
mf v[64:67],a[148:151],a[80:83]
v_mul_f32 v74, v74, v26
v_mul_f32 v75, v75, v26
mf v[64:67],a[144:147],a[64:67]
wl
mz v[80:83],a[128:131],a[64:67],0
tr a[144:145],v6,0
mf v[80:83],a[132:135],a[80:83]
tr a[146:147],v6,2048
v_mul_f32 v68, v68, v25
mf v[80:83],a[136:139],a[96:99]
tr a[148:149],v6,4096
v_mul_f32 v69, v69, v25
mf v[80:83],a[140:143],a[112:115]
tr a[150:151],v6,6144
v_mul_f32 v70, v70, v25
mz v[84:87],a[140:143],a[116:119],0
tr a[152:153],v6,8192
v_mul_f32 v71, v71, v25
mf v[84:87],a[136:139],a[100:103]
tr a[154:155],v6,10240
v_mul_f32 v64, v64, v24
mf v[84:87],a[132:135],a[84:87]
tr a[156:157],v6,12288
v_mul_f32 v65, v65, v24
mf v[84:87],a[128:131],a[68:71]
tr a[158:159],v6,14336
v_mul_f32 v66, v66, v24
mz v[88:91],a[128:131],a[72:75],0
v_mul_f32 v67, v67, v24
mf v[88:91],a[132:135],a[88:91]
mf v[88:91],a[136:139],a[104:107]
mf v[88:91],a[140:143],a[120:123]
mz v[92:95],a[140:143],a[124:127],0
mf v[92:95],a[136:139],a[108:111]
buffer_store_dwordx4 v[220:223], v2, s[92:95], s53 offen nt
mf v[92:95],a[132:135],a[92:95]
s_mov_b32 s53, s27
s_add_u32 s27, s27, 128
mf v[92:95],a[128:131],a[76:79]
wl
mf v[92:95],a[144:147],a[12:15]
s_barrier
mf v[92:95],a[148:151],a[28:31]
tr a[128:129],v15,32768
mf v[92:95],a[152:155],a[44:47]
tr a[130:131],v15,34816
mf v[92:95],a[156:159],a[60:63]
tr a[132:133],v15,36864
mf v[88:91],a[156:159],a[56:59]
tr a[134:135],v15,38912
mf v[88:91],a[152:155],a[40:43]
tr a[136:137],v15,40960
mf v[88:91],a[148:151],a[24:27]
tr a[138:139],v15,43008
mf v[88:91],a[144:147],a[8:11]
tr a[140:141],v15,45056
mf v[84:87],a[144:147],a[4:7]
tr a[142:143],v15,47104
mf v[84:87],a[148:151],a[20:23]
buffer_load_dword v23, v4, s[28:31], 0 offen sc1
mf v[84:87],a[152:155],a[36:39]
v_mul_f32 v92, v92, v27
v_mul_f32 v93, v93, v27
mf v[84:87],a[156:159],a[52:55]
v_mul_f32 v94, v94, v27
v_mul_f32 v95, v95, v27
mf v[80:83],a[156:159],a[48:51]
mf v[80:83],a[152:155],a[32:35]
v_mul_f32 v88, v88, v26
v_mul_f32 v89, v89, v26
mf v[80:83],a[148:151],a[16:19]
v_mul_f32 v90, v90, v26
v_mul_f32 v91, v91, v26
mf v[80:83],a[144:147],a[0:3]
wl
mf v[32:35],a[128:131],v[96:99]
tr a[144:145],v15,49152
mf v[32:35],a[132:135],v[128:131]
tr a[146:147],v15,51200
v_mul_f32 v84, v84, v25
mf v[32:35],a[136:139],v[160:163]
tr a[148:149],v15,53248
v_mul_f32 v85, v85, v25
mf v[32:35],a[140:143],v[192:195]
tr a[150:151],v15,55296
v_mul_f32 v86, v86, v25
mf v[36:39],a[140:143],v[196:199]
tr a[152:153],v15,57344
v_mul_f32 v87, v87, v25
mf v[36:39],a[136:139],v[164:167]
tr a[154:155],v15,59392
v_mul_f32 v80, v80, v24
mf v[36:39],a[132:135],v[132:135]
tr a[156:157],v15,61440
v_mul_f32 v81, v81, v24
mf v[36:39],a[128:131],v[100:103]
tr a[158:159],v15,63488
v_mul_f32 v82, v82, v24
mf v[40:43],a[128:131],v[104:107]
v_mul_f32 v83, v83, v24
mf v[40:43],a[132:135],v[136:139]
mf v[40:43],a[136:139],v[168:171]
mf v[40:43],a[140:143],v[200:203]
mf v[44:47],a[140:143],v[204:207]
mf v[44:47],a[136:139],v[172:175]
mf v[44:47],a[132:135],v[140:143]
mf v[44:47],a[128:131],v[108:111]
wl
mf v[44:47],a[144:147],v[236:239]
tr a[128:129],v5,49152
mf v[44:47],a[148:151],v[124:127]
tr a[130:131],v5,51200
mf v[44:47],a[152:155],v[156:159]
tr a[132:133],v5,53248
mf v[44:47],a[156:159],v[188:191]
tr a[134:135],v5,55296
mf v[40:43],a[156:159],v[184:187]
s_waitcnt vmcnt(0)
tr a[136:137],v5,57344
mf v[40:43],a[152:155],v[152:155]
tr a[138:139],v5,59392
v_cmp_gt_u32 vcc, s41, v23
mf v[40:43],a[148:151],v[120:123]
tr a[140:141],v5,61440
mf v[40:43],a[144:147],v[232:235]
tr a[142:143],v5,63488
mf v[36:39],a[144:147],v[228:231]
s_cbranch_vccnz Lspins_a
Lspuns_a:
mf v[36:39],a[148:151],v[116:119]
s_add_u32 s72, s26, 4096
buffer_load_dwordx2 a[162:163], v1, s[28:31], s26 offen offset:8 sc1
mf v[36:39],a[152:155],v[148:151]
v_mul_f32 v44, v44, v31
v_mul_f32 v45, v45, v31
mf v[36:39],a[156:159],v[180:183]
v_mul_f32 v46, v46, v31
v_mul_f32 v47, v47, v31
mf v[32:35],a[156:159],v[176:179]
buffer_load_dwordx4 a[164:167], v1, s[28:31], s26 offen offset:1024 sc1
mf v[32:35],a[152:155],v[144:147]
cv v44,v44,v45
cv v45,v46,v47
mf v[32:35],a[148:151],v[112:115]
v_mul_f32 v40, v40, v30
v_mul_f32 v41, v41, v30
mf v[32:35],a[144:147],v[224:227]
wl
buffer_load_dwordx4 a[168:171], v1, s[28:31], s26 offen offset:2048 sc1
mf v[48:51],a[128:131],v[224:227]
tr a[144:145],v5,32768
v_mul_f32 v42, v42, v30
mf v[48:51],a[132:135],v[112:115]
tr a[146:147],v5,34816
v_mul_f32 v43, v43, v30
mf v[48:51],a[136:139],v[144:147]
tr a[148:149],v5,36864
cv v40,v40,v41
mf v[48:51],a[140:143],v[176:179]
tr a[150:151],v5,38912
cv v41,v42,v43
mf v[52:55],a[140:143],v[180:183]
tr a[152:153],v5,40960
v_mul_f32 v36, v36, v29
mf v[52:55],a[136:139],v[148:151]
tr a[154:155],v5,43008
v_mul_f32 v37, v37, v29
mf v[52:55],a[132:135],v[116:119]
tr a[156:157],v5,45056
v_mul_f32 v38, v38, v29
mf v[52:55],a[128:131],v[228:231]
tr a[158:159],v5,47104
v_mul_f32 v39, v39, v29
mf v[56:59],a[128:131],v[232:235]
buffer_load_dwordx4 a[172:175], v1, s[28:31], s26 offen offset:3072 sc1
mf v[56:59],a[132:135],v[120:123]
cv v36,v36,v37
cv v37,v38,v39
mf v[56:59],a[136:139],v[152:155]
v_mul_f32 v32, v32, v28
v_mul_f32 v33, v33, v28
mf v[56:59],a[140:143],v[184:187]
buffer_load_dwordx4 a[176:179], v1, s[28:31], s72 offen offset:0 sc1
mf v[60:63],a[140:143],v[188:191]
v_mul_f32 v34, v34, v28
v_mul_f32 v35, v35, v28
mf v[60:63],a[136:139],v[156:159]
cv v32,v32,v33
cv v33,v34,v35
mf v[60:63],a[132:135],v[124:127]
buffer_load_dwordx4 a[180:183], v1, s[28:31], s72 offen offset:1024 sc1
mf v[60:63],a[128:131],v[236:239]
wl
mf v[60:63],a[144:147],v[108:111]
tr a[128:129],v16,32768
mf v[60:63],a[148:151],v[140:143]
tr a[130:131],v16,34816
mf v[60:63],a[152:155],v[172:175]
tr a[132:133],v16,36864
mf v[60:63],a[156:159],v[204:207]
tr a[134:135],v16,38912
mf v[56:59],a[156:159],v[200:203]
tr a[136:137],v16,40960
mf v[56:59],a[152:155],v[168:171]
tr a[138:139],v16,43008
mf v[56:59],a[148:151],v[136:139]
tr a[140:141],v16,45056
mf v[56:59],a[144:147],v[104:107]
tr a[142:143],v16,47104
mf v[52:55],a[144:147],v[100:103]
buffer_load_dwordx4 a[184:187], v1, s[28:31], s72 offen offset:2048 sc1
mf v[52:55],a[148:151],v[132:135]
v_mul_f32 v60, v60, v31
v_mul_f32 v61, v61, v31
mf v[52:55],a[152:155],v[164:167]
v_mul_f32 v62, v62, v31
v_mul_f32 v63, v63, v31
mf v[52:55],a[156:159],v[196:199]
buffer_load_dwordx4 a[188:191], v1, s[28:31], s72 offen offset:3072 sc1
mf v[48:51],a[156:159],v[192:195]
cv v46,v60,v61
cv v47,v62,v63
mf v[48:51],a[152:155],v[160:163]
v_mul_f32 v56, v56, v30
v_mul_f32 v57, v57, v30
mf v[48:51],a[148:151],v[128:131]
buffer_load_dwordx2 a[192:193], v1, s[28:31], s26 offen offset:0 sc1
mf v[48:51],a[144:147],v[96:99]
s_add_u32 s26, s26, 262144
v_mul_f32 v58, v58, v30
wl
mf v[64:67],a[128:131],v[96:99]
tr a[144:145],v16,49152
v_mul_f32 v59, v59, v30
mf v[64:67],a[132:135],v[128:131]
tr a[146:147],v16,51200
cv v42,v56,v57
mf v[64:67],a[136:139],v[160:163]
tr a[148:149],v16,53248
cv v43,v58,v59
mf v[64:67],a[140:143],v[192:195]
tr a[150:151],v16,55296
v_mul_f32 v52, v52, v29
mf v[68:71],a[140:143],v[196:199]
tr a[152:153],v16,57344
v_mul_f32 v53, v53, v29
mf v[68:71],a[136:139],v[164:167]
tr a[154:155],v16,59392
v_mul_f32 v54, v54, v29
mf v[68:71],a[132:135],v[132:135]
tr a[156:157],v16,61440
v_mul_f32 v55, v55, v29
mf v[68:71],a[128:131],v[100:103]
tr a[158:159],v16,63488
cv v38,v52,v53
mf v[72:75],a[128:131],v[104:107]
s_add_u32 s38, s40, 49152
buffer_store_dwordx4 v[44:47], v1, s[28:31], s38 offen sc1
mf v[72:75],a[132:135],v[136:139]
s_mov_b32 s45, s51
cv v39,v54,v55
v_mul_f32 v48, v48, v28
mf v[72:75],a[136:139],v[168:171]
s_mov_b32 s51, s52
v_mul_f32 v49, v49, v28
v_mul_f32 v50, v50, v28
mf v[72:75],a[140:143],v[200:203]
s_add_u32 s38, s40, 32768
buffer_store_dwordx4 v[40:43], v1, s[28:31], s38 offen sc1
mf v[76:79],a[140:143],v[204:207]
s_xor_b32 s24, s24, 0x10000
v_mul_f32 v51, v51, v28
cv v34,v48,v49
mf v[76:79],a[136:139],v[172:175]
s_xor_b32 s25, s25, 0x10000
cv v35,v50,v51
mf v[76:79],a[132:135],v[140:143]
s_add_u32 s38, s40, 16384
buffer_store_dwordx4 v[36:39], v1, s[28:31], s38 offen sc1
mf v[76:79],a[128:131],v[108:111]
wl
mf v[76:79],a[144:147],v[236:239]
tr a[128:129],v6,49152
mf v[76:79],a[148:151],v[124:127]
tr a[130:131],v6,51200
mf v[76:79],a[152:155],v[156:159]
tr a[132:133],v6,53248
mf v[76:79],a[156:159],v[188:191]
tr a[134:135],v6,55296
mf v[72:75],a[156:159],v[184:187]
tr a[136:137],v6,57344
mf v[72:75],a[152:155],v[152:155]
tr a[138:139],v6,59392
mf v[72:75],a[148:151],v[120:123]
tr a[140:141],v6,61440
mf v[72:75],a[144:147],v[232:235]
tr a[142:143],v6,63488
mf v[68:71],a[144:147],v[228:231]
s_add_u32 s38, s40, 0
buffer_store_dwordx4 v[32:35], v1, s[28:31], s38 offen sc1
mf v[68:71],a[148:151],v[116:119]
v_mul_f32 v76, v76, v31
v_mul_f32 v77, v77, v31
mf v[68:71],a[152:155],v[148:151]
v_mul_f32 v78, v78, v31
v_mul_f32 v79, v79, v31
mf v[68:71],a[156:159],v[180:183]
cv v76,v76,v77
cv v77,v78,v79
mf v[64:67],a[156:159],v[176:179]
mf v[64:67],a[152:155],v[144:147]
v_mul_f32 v72, v72, v30
v_mul_f32 v73, v73, v30
mf v[64:67],a[148:151],v[112:115]
v_mul_f32 v74, v74, v30
v_mul_f32 v75, v75, v30
mf v[64:67],a[144:147],v[224:227]
wl
cv v72,v72,v73
cv v73,v74,v75
mf v[80:83],a[128:131],v[224:227]
tr a[144:145],v6,32768
mf v[80:83],a[132:135],v[112:115]
tr a[146:147],v6,34816
v_mul_f32 v68, v68, v29
mf v[80:83],a[136:139],v[144:147]
tr a[148:149],v6,36864
v_mul_f32 v69, v69, v29
mf v[80:83],a[140:143],v[176:179]
tr a[150:151],v6,38912
v_mul_f32 v70, v70, v29
mf v[84:87],a[140:143],v[180:183]
tr a[152:153],v6,40960
v_mul_f32 v71, v71, v29
mf v[84:87],a[136:139],v[148:151]
tr a[154:155],v6,43008
cv v68,v68,v69
mf v[84:87],a[132:135],v[116:119]
tr a[156:157],v6,45056
cv v69,v70,v71
mf v[84:87],a[128:131],v[228:231]
tr a[158:159],v6,47104
v_mul_f32 v64, v64, v28
mf v[88:91],a[128:131],v[232:235]
v_mul_f32 v65, v65, v28
v_mul_f32 v66, v66, v28
mf v[88:91],a[132:135],v[120:123]
v_mul_f32 v67, v67, v28
cv v64,v64,v65
mf v[88:91],a[136:139],v[152:155]
cv v65,v66,v67
mf v[88:91],a[140:143],v[184:187]
mf v[92:95],a[140:143],v[188:191]
mf v[92:95],a[136:139],v[156:159]
mf v[92:95],a[132:135],v[124:127]
mf v[92:95],a[128:131],v[236:239]
wl
mf v[92:95],a[144:147],v[108:111]
s_barrier
v_xor_b32 v5, 0x10000, v5
v_xor_b32 v16, 0x10000, v16
mf v[92:95],a[148:151],v[140:143]
v_xor_b32 v6, 0x10000, v6
v_xor_b32 v15, 0x10000, v15
mf v[92:95],a[152:155],v[172:175]
tr a[128:129],v15,0
mf v[92:95],a[156:159],v[204:207]
tr a[130:131],v15,2048
mf v[88:91],a[156:159],v[200:203]
tr a[132:133],v15,4096
mf v[88:91],a[152:155],v[168:171]
tr a[134:135],v15,6144
mf v[88:91],a[148:151],v[136:139]
tr a[136:137],v15,8192
mf v[88:91],a[144:147],v[104:107]
tr a[138:139],v15,10240
mf v[84:87],a[144:147],v[100:103]
tr a[140:141],v15,12288
mf v[84:87],a[148:151],v[132:135]
tr a[142:143],v15,14336
mf v[84:87],a[152:155],v[164:167]
mf v[84:87],a[156:159],v[196:199]
mf v[80:83],a[156:159],v[192:195]
mf v[80:83],a[152:155],v[160:163]
s_add_u32 s41, s41, 1
mf v[80:83],a[148:151],v[128:131]
s_waitcnt vmcnt(4)
mf v[80:83],a[144:147],v[96:99]
wl
mz v[212:215],v[216:219],a[162:165],0
mf v[212:215],v[216:219],a[170:173]
mf v[212:215],v[216:219],a[178:181]
mf v[212:215],v[216:219],a[186:189]
mz v[208:211],v[216:219],a[166:169],0
mf v[208:211],v[216:219],a[174:177]
mf v[208:211],v[216:219],a[182:185]
mf v[208:211],v[216:219],a[190:193]
s_cmp_lt_u32 s41, 6
s_cbranch_scc1 Loloops_a
mz v[32:35],a[128:131],a[0:3],0
tr a[144:145],v15,16384
v_mul_f32 v92, v92, v31
mf v[32:35],a[132:135],a[16:19]
tr a[146:147],v15,18432
v_mul_f32 v93, v93, v31
mf v[32:35],a[136:139],a[32:35]
tr a[148:149],v15,20480
v_mul_f32 v94, v94, v31
mf v[32:35],a[140:143],a[48:51]
tr a[150:151],v15,22528
v_mul_f32 v95, v95, v31
mz v[36:39],a[140:143],a[52:55],0
tr a[152:153],v15,24576
cv v78,v92,v93
mf v[36:39],a[136:139],a[36:39]
tr a[154:155],v15,26624
cv v79,v94,v95
mf v[36:39],a[132:135],a[20:23]
tr a[156:157],v15,28672
v_mul_f32 v88, v88, v30
mf v[36:39],a[128:131],a[4:7]
tr a[158:159],v15,30720
v_mul_f32 v89, v89, v30
mz v[40:43],a[128:131],a[8:11],0
s_add_u32 s38, s40, 57344
buffer_store_dwordx4 v[76:79], v1, s[28:31], s38 offen sc1
mf v[40:43],a[132:135],a[24:27]
v_mul_f32 v90, v90, v30
v_mul_f32 v91, v91, v30
mf v[40:43],a[136:139],a[40:43]
cv v74,v88,v89
cv v75,v90,v91
mf v[40:43],a[140:143],a[56:59]
s_add_u32 s38, s40, 40960
buffer_store_dwordx4 v[72:75], v1, s[28:31], s38 offen sc1
mz v[44:47],a[140:143],a[60:63],0
v_mul_f32 v84, v84, v29
v_mul_f32 v85, v85, v29
mf v[44:47],a[136:139],a[44:47]
v_mul_f32 v86, v86, v29
v_mul_f32 v87, v87, v29
mf v[44:47],a[132:135],a[28:31]
cv v70,v84,v85
cv v71,v86,v87
mf v[44:47],a[128:131],a[12:15]
wl
v_mul_f32 v80, v80, v28
v_mul_f32 v81, v81, v28
mf v[44:47],a[144:147],a[76:79]
tr a[128:129],v5,16384
v_mul_f32 v82, v82, v28
mf v[44:47],a[148:151],a[92:95]
tr a[130:131],v5,18432
v_mul_f32 v83, v83, v28
mf v[44:47],a[152:155],a[108:111]
tr a[132:133],v5,20480
cv v66,v80,v81
mf v[44:47],a[156:159],a[124:127]
tr a[134:135],v5,22528
cv v67,v82,v83
mf v[40:43],a[156:159],a[120:123]
tr a[136:137],v5,24576
cv v222,v212,v213
mf v[40:43],a[152:155],a[104:107]
tr a[138:139],v5,26624
cv v223,v214,v215
mf v[40:43],a[148:151],a[88:91]
tr a[140:141],v5,28672
cv v220,v208,v209
mf v[40:43],a[144:147],a[72:75]
tr a[142:143],v5,30720
cv v221,v210,v211
mf v[36:39],a[144:147],a[68:71]
s_add_u32 s38, s40, 24576
buffer_store_dwordx4 v[68:71], v1, s[28:31], s38 offen sc1
mf v[36:39],a[148:151],a[84:87]
v_mul_f32 v44, v44, v27
v_mul_f32 v45, v45, v27
mf v[36:39],a[152:155],a[100:103]
v_mul_f32 v46, v46, v27
v_mul_f32 v47, v47, v27
mf v[36:39],a[156:159],a[116:119]
s_add_u32 s38, s40, 8192
buffer_store_dwordx4 v[64:67], v1, s[28:31], s38 offen sc1
mf v[32:35],a[156:159],a[112:115]
s_add_u32 s40, s40, 262144
mf v[32:35],a[152:155],a[96:99]
v_mul_f32 v40, v40, v26
v_mul_f32 v41, v41, v26
mf v[32:35],a[148:151],a[80:83]
v_mul_f32 v42, v42, v26
v_mul_f32 v43, v43, v26
mf v[32:35],a[144:147],a[64:67]
wl
mz v[48:51],a[128:131],a[64:67],0
tr a[144:145],v5,0
mf v[48:51],a[132:135],a[80:83]
tr a[146:147],v5,2048
v_mul_f32 v36, v36, v25
mf v[48:51],a[136:139],a[96:99]
tr a[148:149],v5,4096
v_mul_f32 v37, v37, v25
mf v[48:51],a[140:143],a[112:115]
tr a[150:151],v5,6144
v_mul_f32 v38, v38, v25
mz v[52:55],a[140:143],a[116:119],0
tr a[152:153],v5,8192
v_mul_f32 v39, v39, v25
mf v[52:55],a[136:139],a[100:103]
tr a[154:155],v5,10240
v_mul_f32 v32, v32, v24
mf v[52:55],a[132:135],a[84:87]
tr a[156:157],v5,12288
v_mul_f32 v33, v33, v24
mf v[52:55],a[128:131],a[68:71]
tr a[158:159],v5,14336
v_mul_f32 v34, v34, v24
mz v[56:59],a[128:131],a[72:75],0
v_mul_f32 v35, v35, v24
mf v[56:59],a[132:135],a[88:91]
mf v[56:59],a[136:139],a[104:107]
mf v[56:59],a[140:143],a[120:123]
mz v[60:63],a[140:143],a[124:127],0
mf v[60:63],a[136:139],a[108:111]
mf v[60:63],a[132:135],a[92:95]
mf v[60:63],a[128:131],a[76:79]
wl
mf v[60:63],a[144:147],a[12:15]
tr a[128:129],v16,0
mf v[60:63],a[148:151],a[28:31]
tr a[130:131],v16,2048
mf v[60:63],a[152:155],a[44:47]
tr a[132:133],v16,4096
mf v[60:63],a[156:159],a[60:63]
tr a[134:135],v16,6144
mf v[56:59],a[156:159],a[56:59]
tr a[136:137],v16,8192
v_mov_b32 v0, s41
mf v[56:59],a[152:155],a[40:43]
tr a[138:139],v16,10240
mf v[56:59],a[148:151],a[24:27]
tr a[140:141],v16,12288
mf v[56:59],a[144:147],a[8:11]
tr a[142:143],v16,14336
mf v[52:55],a[144:147],a[4:7]
s_waitcnt vmcnt(0)
buffer_store_dword v0, v17, s[28:31], 0 offen sc1
mf v[52:55],a[148:151],a[20:23]
v_mul_f32 v60, v60, v27
v_mul_f32 v61, v61, v27
mf v[52:55],a[152:155],a[36:39]
v_mul_f32 v62, v62, v27
v_mul_f32 v63, v63, v27
mf v[52:55],a[156:159],a[52:55]
mf v[48:51],a[156:159],a[48:51]
mf v[48:51],a[152:155],a[32:35]
v_mul_f32 v56, v56, v26
v_mul_f32 v57, v57, v26
mf v[48:51],a[148:151],a[16:19]
v_mul_f32 v58, v58, v26
v_mul_f32 v59, v59, v26
mf v[48:51],a[144:147],a[0:3]
wl
mz v[64:67],a[128:131],a[0:3],0
tr a[144:145],v16,16384
mf v[64:67],a[132:135],a[16:19]
tr a[146:147],v16,18432
v_mul_f32 v52, v52, v25
mf v[64:67],a[136:139],a[32:35]
tr a[148:149],v16,20480
v_mul_f32 v53, v53, v25
mf v[64:67],a[140:143],a[48:51]
tr a[150:151],v16,22528
v_mul_f32 v54, v54, v25
mz v[68:71],a[140:143],a[52:55],0
tr a[152:153],v16,24576
v_mul_f32 v55, v55, v25
mf v[68:71],a[136:139],a[36:39]
tr a[154:155],v16,26624
v_mul_f32 v48, v48, v24
mf v[68:71],a[132:135],a[20:23]
tr a[156:157],v16,28672
v_mul_f32 v49, v49, v24
mf v[68:71],a[128:131],a[4:7]
tr a[158:159],v16,30720
v_mul_f32 v50, v50, v24
mz v[72:75],a[128:131],a[8:11],0
v_mul_f32 v51, v51, v24
mf v[72:75],a[132:135],a[24:27]
mf v[72:75],a[136:139],a[40:43]
mf v[72:75],a[140:143],a[56:59]
mz v[76:79],a[140:143],a[60:63],0
mf v[76:79],a[136:139],a[44:47]
mf v[76:79],a[132:135],a[28:31]
mf v[76:79],a[128:131],a[12:15]
wl
mf v[76:79],a[144:147],a[76:79]
tr a[128:129],v6,16384
mf v[76:79],a[148:151],a[92:95]
tr a[130:131],v6,18432
mf v[76:79],a[152:155],a[108:111]
tr a[132:133],v6,20480
mf v[76:79],a[156:159],a[124:127]
tr a[134:135],v6,22528
mf v[72:75],a[156:159],a[120:123]
tr a[136:137],v6,24576
mf v[72:75],a[152:155],a[104:107]
tr a[138:139],v6,26624
mf v[72:75],a[148:151],a[88:91]
tr a[140:141],v6,28672
mf v[72:75],a[144:147],a[72:75]
tr a[142:143],v6,30720
mf v[68:71],a[144:147],a[68:71]
mf v[68:71],a[148:151],a[84:87]
v_mul_f32 v76, v76, v27
v_mul_f32 v77, v77, v27
mf v[68:71],a[152:155],a[100:103]
v_mul_f32 v78, v78, v27
v_mul_f32 v79, v79, v27
mf v[68:71],a[156:159],a[116:119]
mf v[64:67],a[156:159],a[112:115]
mf v[64:67],a[152:155],a[96:99]
v_mul_f32 v72, v72, v26
v_mul_f32 v73, v73, v26
mf v[64:67],a[148:151],a[80:83]
v_mul_f32 v74, v74, v26
v_mul_f32 v75, v75, v26
mf v[64:67],a[144:147],a[64:67]
wl
mz v[80:83],a[128:131],a[64:67],0
tr a[144:145],v6,0
mf v[80:83],a[132:135],a[80:83]
tr a[146:147],v6,2048
v_mul_f32 v68, v68, v25
mf v[80:83],a[136:139],a[96:99]
tr a[148:149],v6,4096
v_mul_f32 v69, v69, v25
mf v[80:83],a[140:143],a[112:115]
tr a[150:151],v6,6144
v_mul_f32 v70, v70, v25
mz v[84:87],a[140:143],a[116:119],0
tr a[152:153],v6,8192
v_mul_f32 v71, v71, v25
mf v[84:87],a[136:139],a[100:103]
tr a[154:155],v6,10240
v_mul_f32 v64, v64, v24
mf v[84:87],a[132:135],a[84:87]
tr a[156:157],v6,12288
v_mul_f32 v65, v65, v24
mf v[84:87],a[128:131],a[68:71]
tr a[158:159],v6,14336
v_mul_f32 v66, v66, v24
mz v[88:91],a[128:131],a[72:75],0
v_mul_f32 v67, v67, v24
mf v[88:91],a[132:135],a[88:91]
mf v[88:91],a[136:139],a[104:107]
mf v[88:91],a[140:143],a[120:123]
mz v[92:95],a[140:143],a[124:127],0
mf v[92:95],a[136:139],a[108:111]
buffer_store_dwordx4 v[220:223], v2, s[92:95], s53 offen nt
mf v[92:95],a[132:135],a[92:95]
s_mov_b32 s53, s27
s_add_u32 s27, s27, 128
mf v[92:95],a[128:131],a[76:79]
wl
mf v[92:95],a[144:147],a[12:15]
s_barrier
mf v[92:95],a[148:151],a[28:31]
tr a[128:129],v15,32768
mf v[92:95],a[152:155],a[44:47]
tr a[130:131],v15,34816
mf v[92:95],a[156:159],a[60:63]
tr a[132:133],v15,36864
mf v[88:91],a[156:159],a[56:59]
tr a[134:135],v15,38912
mf v[88:91],a[152:155],a[40:43]
tr a[136:137],v15,40960
mf v[88:91],a[148:151],a[24:27]
tr a[138:139],v15,43008
mf v[88:91],a[144:147],a[8:11]
tr a[140:141],v15,45056
mf v[84:87],a[144:147],a[4:7]
tr a[142:143],v15,47104
mf v[84:87],a[148:151],a[20:23]
buffer_load_dword v23, v4, s[28:31], 0 offen sc1
mf v[84:87],a[152:155],a[36:39]
v_mul_f32 v92, v92, v27
v_mul_f32 v93, v93, v27
mf v[84:87],a[156:159],a[52:55]
v_mul_f32 v94, v94, v27
v_mul_f32 v95, v95, v27
mf v[80:83],a[156:159],a[48:51]
mf v[80:83],a[152:155],a[32:35]
v_mul_f32 v88, v88, v26
v_mul_f32 v89, v89, v26
mf v[80:83],a[148:151],a[16:19]
v_mul_f32 v90, v90, v26
v_mul_f32 v91, v91, v26
mf v[80:83],a[144:147],a[0:3]
wl
mf v[32:35],a[128:131],v[96:99]
tr a[144:145],v15,49152
mf v[32:35],a[132:135],v[128:131]
tr a[146:147],v15,51200
v_mul_f32 v84, v84, v25
mf v[32:35],a[136:139],v[160:163]
tr a[148:149],v15,53248
v_mul_f32 v85, v85, v25
mf v[32:35],a[140:143],v[192:195]
tr a[150:151],v15,55296
v_mul_f32 v86, v86, v25
mf v[36:39],a[140:143],v[196:199]
tr a[152:153],v15,57344
v_mul_f32 v87, v87, v25
mf v[36:39],a[136:139],v[164:167]
tr a[154:155],v15,59392
v_mul_f32 v80, v80, v24
mf v[36:39],a[132:135],v[132:135]
tr a[156:157],v15,61440
v_mul_f32 v81, v81, v24
mf v[36:39],a[128:131],v[100:103]
tr a[158:159],v15,63488
v_mul_f32 v82, v82, v24
mf v[40:43],a[128:131],v[104:107]
v_mul_f32 v83, v83, v24
mf v[40:43],a[132:135],v[136:139]
mf v[40:43],a[136:139],v[168:171]
mf v[40:43],a[140:143],v[200:203]
mf v[44:47],a[140:143],v[204:207]
mf v[44:47],a[136:139],v[172:175]
mf v[44:47],a[132:135],v[140:143]
mf v[44:47],a[128:131],v[108:111]
wl
mf v[44:47],a[144:147],v[236:239]
tr a[128:129],v5,49152
mf v[44:47],a[148:151],v[124:127]
tr a[130:131],v5,51200
mf v[44:47],a[152:155],v[156:159]
tr a[132:133],v5,53248
mf v[44:47],a[156:159],v[188:191]
tr a[134:135],v5,55296
mf v[40:43],a[156:159],v[184:187]
s_waitcnt vmcnt(0)
tr a[136:137],v5,57344
mf v[40:43],a[152:155],v[152:155]
tr a[138:139],v5,59392
v_cmp_gt_u32 vcc, s41, v23
mf v[40:43],a[148:151],v[120:123]
tr a[140:141],v5,61440
mf v[40:43],a[144:147],v[232:235]
tr a[142:143],v5,63488
mf v[36:39],a[144:147],v[228:231]
s_cbranch_vccnz Lspinsb_a
Lspunsb_a:
mf v[36:39],a[148:151],v[116:119]
s_add_u32 s72, s26, 4096
buffer_load_dwordx2 a[162:163], v1, s[28:31], s26 offen offset:8 sc1
mf v[36:39],a[152:155],v[148:151]
v_mul_f32 v44, v44, v31
v_mul_f32 v45, v45, v31
mf v[36:39],a[156:159],v[180:183]
v_mul_f32 v46, v46, v31
v_mul_f32 v47, v47, v31
mf v[32:35],a[156:159],v[176:179]
buffer_load_dwordx4 a[164:167], v1, s[28:31], s26 offen offset:1024 sc1
mf v[32:35],a[152:155],v[144:147]
cv v44,v44,v45
cv v45,v46,v47
mf v[32:35],a[148:151],v[112:115]
v_mul_f32 v40, v40, v30
v_mul_f32 v41, v41, v30
mf v[32:35],a[144:147],v[224:227]
wl
buffer_load_dwordx4 a[168:171], v1, s[28:31], s26 offen offset:2048 sc1
mf v[48:51],a[128:131],v[224:227]
tr a[144:145],v5,32768
v_mul_f32 v42, v42, v30
mf v[48:51],a[132:135],v[112:115]
tr a[146:147],v5,34816
v_mul_f32 v43, v43, v30
mf v[48:51],a[136:139],v[144:147]
tr a[148:149],v5,36864
cv v40,v40,v41
mf v[48:51],a[140:143],v[176:179]
tr a[150:151],v5,38912
cv v41,v42,v43
mf v[52:55],a[140:143],v[180:183]
tr a[152:153],v5,40960
v_mul_f32 v36, v36, v29
mf v[52:55],a[136:139],v[148:151]
tr a[154:155],v5,43008
v_mul_f32 v37, v37, v29
mf v[52:55],a[132:135],v[116:119]
tr a[156:157],v5,45056
v_mul_f32 v38, v38, v29
mf v[52:55],a[128:131],v[228:231]
tr a[158:159],v5,47104
v_mul_f32 v39, v39, v29
mf v[56:59],a[128:131],v[232:235]
buffer_load_dwordx4 a[172:175], v1, s[28:31], s26 offen offset:3072 sc1
mf v[56:59],a[132:135],v[120:123]
cv v36,v36,v37
cv v37,v38,v39
mf v[56:59],a[136:139],v[152:155]
v_mul_f32 v32, v32, v28
v_mul_f32 v33, v33, v28
mf v[56:59],a[140:143],v[184:187]
buffer_load_dwordx4 a[176:179], v1, s[28:31], s72 offen offset:0 sc1
mf v[60:63],a[140:143],v[188:191]
v_mul_f32 v34, v34, v28
v_mul_f32 v35, v35, v28
mf v[60:63],a[136:139],v[156:159]
cv v32,v32,v33
cv v33,v34,v35
mf v[60:63],a[132:135],v[124:127]
buffer_load_dwordx4 a[180:183], v1, s[28:31], s72 offen offset:1024 sc1
mf v[60:63],a[128:131],v[236:239]
wl
mf v[60:63],a[144:147],v[108:111]
tr a[128:129],v16,32768
mf v[60:63],a[148:151],v[140:143]
tr a[130:131],v16,34816
mf v[60:63],a[152:155],v[172:175]
tr a[132:133],v16,36864
mf v[60:63],a[156:159],v[204:207]
tr a[134:135],v16,38912
mf v[56:59],a[156:159],v[200:203]
tr a[136:137],v16,40960
mf v[56:59],a[152:155],v[168:171]
tr a[138:139],v16,43008
mf v[56:59],a[148:151],v[136:139]
tr a[140:141],v16,45056
mf v[56:59],a[144:147],v[104:107]
tr a[142:143],v16,47104
mf v[52:55],a[144:147],v[100:103]
buffer_load_dwordx4 a[184:187], v1, s[28:31], s72 offen offset:2048 sc1
mf v[52:55],a[148:151],v[132:135]
v_mul_f32 v60, v60, v31
v_mul_f32 v61, v61, v31
mf v[52:55],a[152:155],v[164:167]
v_mul_f32 v62, v62, v31
v_mul_f32 v63, v63, v31
mf v[52:55],a[156:159],v[196:199]
buffer_load_dwordx4 a[188:191], v1, s[28:31], s72 offen offset:3072 sc1
mf v[48:51],a[156:159],v[192:195]
cv v46,v60,v61
cv v47,v62,v63
mf v[48:51],a[152:155],v[160:163]
v_mul_f32 v56, v56, v30
v_mul_f32 v57, v57, v30
mf v[48:51],a[148:151],v[128:131]
buffer_load_dwordx2 a[192:193], v1, s[28:31], s26 offen offset:0 sc1
mf v[48:51],a[144:147],v[96:99]
s_add_u32 s26, s26, 262144
v_mul_f32 v58, v58, v30
wl
mf v[64:67],a[128:131],v[96:99]
tr a[144:145],v16,49152
v_mul_f32 v59, v59, v30
mf v[64:67],a[132:135],v[128:131]
tr a[146:147],v16,51200
cv v42,v56,v57
mf v[64:67],a[136:139],v[160:163]
tr a[148:149],v16,53248
cv v43,v58,v59
mf v[64:67],a[140:143],v[192:195]
tr a[150:151],v16,55296
v_mul_f32 v52, v52, v29
mf v[68:71],a[140:143],v[196:199]
tr a[152:153],v16,57344
v_mul_f32 v53, v53, v29
mf v[68:71],a[136:139],v[164:167]
tr a[154:155],v16,59392
v_mul_f32 v54, v54, v29
mf v[68:71],a[132:135],v[132:135]
tr a[156:157],v16,61440
v_mul_f32 v55, v55, v29
mf v[68:71],a[128:131],v[100:103]
tr a[158:159],v16,63488
cv v38,v52,v53
mf v[72:75],a[128:131],v[104:107]
s_add_u32 s38, s40, 49152
buffer_store_dwordx4 v[44:47], v1, s[28:31], s38 offen sc1
mf v[72:75],a[132:135],v[136:139]
cv v39,v54,v55
v_mul_f32 v48, v48, v28
mf v[72:75],a[136:139],v[168:171]
v_mul_f32 v49, v49, v28
v_mul_f32 v50, v50, v28
mf v[72:75],a[140:143],v[200:203]
s_add_u32 s38, s40, 32768
buffer_store_dwordx4 v[40:43], v1, s[28:31], s38 offen sc1
mf v[76:79],a[140:143],v[204:207]
v_mul_f32 v51, v51, v28
cv v34,v48,v49
mf v[76:79],a[136:139],v[172:175]
cv v35,v50,v51
mf v[76:79],a[132:135],v[140:143]
s_add_u32 s38, s40, 16384
buffer_store_dwordx4 v[36:39], v1, s[28:31], s38 offen sc1
mf v[76:79],a[128:131],v[108:111]
wl
mf v[76:79],a[144:147],v[236:239]
tr a[128:129],v6,49152
mf v[76:79],a[148:151],v[124:127]
tr a[130:131],v6,51200
mf v[76:79],a[152:155],v[156:159]
tr a[132:133],v6,53248
mf v[76:79],a[156:159],v[188:191]
tr a[134:135],v6,55296
mf v[72:75],a[156:159],v[184:187]
tr a[136:137],v6,57344
mf v[72:75],a[152:155],v[152:155]
tr a[138:139],v6,59392
mf v[72:75],a[148:151],v[120:123]
tr a[140:141],v6,61440
mf v[72:75],a[144:147],v[232:235]
tr a[142:143],v6,63488
mf v[68:71],a[144:147],v[228:231]
s_add_u32 s38, s40, 0
buffer_store_dwordx4 v[32:35], v1, s[28:31], s38 offen sc1
mf v[68:71],a[148:151],v[116:119]
v_mul_f32 v76, v76, v31
v_mul_f32 v77, v77, v31
mf v[68:71],a[152:155],v[148:151]
v_mul_f32 v78, v78, v31
v_mul_f32 v79, v79, v31
mf v[68:71],a[156:159],v[180:183]
cv v76,v76,v77
cv v77,v78,v79
mf v[64:67],a[156:159],v[176:179]
mf v[64:67],a[152:155],v[144:147]
v_mul_f32 v72, v72, v30
v_mul_f32 v73, v73, v30
mf v[64:67],a[148:151],v[112:115]
v_mul_f32 v74, v74, v30
v_mul_f32 v75, v75, v30
mf v[64:67],a[144:147],v[224:227]
wl
cv v72,v72,v73
cv v73,v74,v75
mf v[80:83],a[128:131],v[224:227]
tr a[144:145],v6,32768
mf v[80:83],a[132:135],v[112:115]
tr a[146:147],v6,34816
v_mul_f32 v68, v68, v29
mf v[80:83],a[136:139],v[144:147]
tr a[148:149],v6,36864
v_mul_f32 v69, v69, v29
mf v[80:83],a[140:143],v[176:179]
tr a[150:151],v6,38912
v_mul_f32 v70, v70, v29
mf v[84:87],a[140:143],v[180:183]
tr a[152:153],v6,40960
v_mul_f32 v71, v71, v29
mf v[84:87],a[136:139],v[148:151]
tr a[154:155],v6,43008
cv v68,v68,v69
mf v[84:87],a[132:135],v[116:119]
tr a[156:157],v6,45056
cv v69,v70,v71
mf v[84:87],a[128:131],v[228:231]
tr a[158:159],v6,47104
v_mul_f32 v64, v64, v28
mf v[88:91],a[128:131],v[232:235]
v_mul_f32 v65, v65, v28
v_mul_f32 v66, v66, v28
mf v[88:91],a[132:135],v[120:123]
v_mul_f32 v67, v67, v28
cv v64,v64,v65
mf v[88:91],a[136:139],v[152:155]
cv v65,v66,v67
mf v[88:91],a[140:143],v[184:187]
mf v[92:95],a[140:143],v[188:191]
mf v[92:95],a[136:139],v[156:159]
mf v[92:95],a[132:135],v[124:127]
mf v[92:95],a[128:131],v[236:239]
wl
mf v[92:95],a[144:147],v[108:111]
mf v[92:95],a[148:151],v[140:143]
mf v[92:95],a[152:155],v[172:175]
mf v[92:95],a[156:159],v[204:207]
mf v[88:91],a[156:159],v[200:203]
mf v[88:91],a[152:155],v[168:171]
mf v[88:91],a[148:151],v[136:139]
mf v[88:91],a[144:147],v[104:107]
mf v[84:87],a[144:147],v[100:103]
mf v[84:87],a[148:151],v[132:135]
s_nop 1
v_mul_f32 v92, v92, v31
v_mul_f32 v93, v93, v31
mf v[84:87],a[152:155],v[164:167]
v_mul_f32 v94, v94, v31
v_mul_f32 v95, v95, v31
mf v[84:87],a[156:159],v[196:199]
cv v78,v92,v93
cv v79,v94,v95
mf v[80:83],a[156:159],v[192:195]
s_add_u32 s38, s40, 57344
buffer_store_dwordx4 v[76:79], v1, s[28:31], s38 offen sc1
mf v[80:83],a[152:155],v[160:163]
s_add_u32 s41, s41, 1
v_mul_f32 v88, v88, v30
v_mul_f32 v89, v89, v30
mf v[80:83],a[148:151],v[128:131]
s_waitcnt vmcnt(5)
v_mul_f32 v90, v90, v30
v_mul_f32 v91, v91, v30
mf v[80:83],a[144:147],v[96:99]
cv v74,v88,v89
cv v75,v90,v91
mz v[212:215],v[216:219],a[162:165],0
s_add_u32 s38, s40, 40960
buffer_store_dwordx4 v[72:75], v1, s[28:31], s38 offen sc1
mf v[212:215],v[216:219],a[170:173]
v_mul_f32 v84, v84, v29
v_mul_f32 v85, v85, v29
mf v[212:215],v[216:219],a[178:181]
v_mul_f32 v86, v86, v29
v_mul_f32 v87, v87, v29
mf v[212:215],v[216:219],a[186:189]
cv v70,v84,v85
cv v71,v86,v87
mz v[208:211],v[216:219],a[166:169],0
s_add_u32 s38, s40, 24576
buffer_store_dwordx4 v[68:71], v1, s[28:31], s38 offen sc1
mf v[208:211],v[216:219],a[174:177]
v_mul_f32 v80, v80, v28
v_mul_f32 v81, v81, v28
mf v[208:211],v[216:219],a[182:185]
v_mul_f32 v82, v82, v28
v_mul_f32 v83, v83, v28
mf v[208:211],v[216:219],a[190:193]
cv v66,v80,v81
cv v67,v82,v83
s_add_u32 s38, s40, 8192
buffer_store_dwordx4 v[64:67], v1, s[28:31], s38 offen sc1
s_bfe_u32 s73, s26, 0x20010
s_lshl_b32 s73, s73, 2
s_add_u32 s73, s73, 2359296
v_and_b32 v4, 0x70, v1
v_add_u32 v4, s73, v4
cv v222,v212,v213
cv v223,v214,v215
cv v220,v208,v209
cv v221,v210,v211
v_mov_b32 v0, s41
s_waitcnt vmcnt(0)
buffer_store_dword v0, v17, s[28:31], 0 offen sc1
buffer_load_dword v23, v4, s[28:31], 0 offen sc1
s_waitcnt vmcnt(0)
v_cmp_gt_u32 vcc, s41, v23
s_cbranch_vccnz Lspints_a
Lspunts_a:
s_add_u32 s72, s26, 4096
buffer_load_dwordx2 a[162:163], v1, s[28:31], s26 offen offset:8 sc1
buffer_load_dwordx4 a[164:167], v1, s[28:31], s26 offen offset:1024 sc1
buffer_load_dwordx4 a[168:171], v1, s[28:31], s26 offen offset:2048 sc1
buffer_load_dwordx4 a[172:175], v1, s[28:31], s26 offen offset:3072 sc1
buffer_load_dwordx4 a[176:179], v1, s[28:31], s72 offen offset:0 sc1
buffer_load_dwordx4 a[180:183], v1, s[28:31], s72 offen offset:1024 sc1
buffer_load_dwordx4 a[184:187], v1, s[28:31], s72 offen offset:2048 sc1
buffer_load_dwordx4 a[188:191], v1, s[28:31], s72 offen offset:3072 sc1
buffer_load_dwordx2 a[192:193], v1, s[28:31], s26 offen offset:0 sc1
s_add_u32 s26, s26, 262144
buffer_store_dwordx4 v[220:223], v2, s[92:95], s53 offen nt
s_mov_b32 s53, s27
s_add_u32 s27, s27, 128
s_waitcnt vmcnt(1)
mz v[212:215],v[216:219],a[162:165],0
mf v[212:215],v[216:219],a[170:173]
mf v[212:215],v[216:219],a[178:181]
mf v[212:215],v[216:219],a[186:189]
mz v[208:211],v[216:219],a[166:169],0
mf v[208:211],v[216:219],a[174:177]
mf v[208:211],v[216:219],a[182:185]
mf v[208:211],v[216:219],a[190:193]
s_nop 3
cv v222,v212,v213
cv v223,v214,v215
s_nop 1
cv v220,v208,v209
cv v221,v210,v211
buffer_store_dwordx4 v[220:223], v2, s[92:95], s53 offen nt
s_endpgm
Lslow_fronth_a:
s_call_b64 s[84:85], Lslowh_a
s_branch Lret_fronth_a
Lslow_front_a:
s_call_b64 s[84:85], Lslow1_a
s_branch Lret_front_a
Lslow_lp0_a:
s_call_b64 s[84:85], Lslow0_a
s_branch Lret_lp0_a
Lslow_lp1_a:
s_call_b64 s[84:85], Lslow1_a
s_branch Lret_lp1_a
Lslow_it14_a:
s_call_b64 s[84:85], Lslow0_a
s_branch Lret_it14_a
Lslow_mid15_a:
s_call_b64 s[84:85], Lslow1_a
s_branch Lret_mid15_a
Lmodewait_a:
s_cmp_eq_u32 s49, 0
s_cbranch_scc1 Lmodeok_a
s_sub_u32 s49, s49, 1
buffer_load_dword v23, v21, s[96:99], s90 offen sc1
s_waitcnt vmcnt(0)
v_readfirstlane_b32 s54, v23
s_nop 1
s_and_b32 s73, s54, 0x0f0f0f0f
s_lshr_b32 s72, s54, 4
s_and_b32 s72, s72, 0x0f0f0f0f
s_add_u32 s73, s73, s72
s_mul_i32 s73, s73, 0x01010101
s_lshr_b32 s73, s73, 24
s_cmp_lt_u32 s73, 8
s_cbranch_scc1 Lmodewait_a
s_branch Lmodeok_a
Lslow_midh_a:
s_call_b64 s[84:85], Lslowh_a
s_branch Lret_midh_a
Lslow_mid_a:
s_call_b64 s[84:85], Lslow1_a
s_branch Lret_mid_a
Lslow_endf15_a:
s_call_b64 s[84:85], Lslow1_a
s_branch Lret_endf15_a
Lspinf_a:
s_cmp_eq_u32 s49, 0
s_cbranch_scc1 Lspunf_a
s_sub_u32 s49, s49, 1
buffer_load_dword v23, v4, s[28:31], 0 offen sc1
s_waitcnt vmcnt(0)
v_cmp_gt_u32 vcc, s41, v23
s_cbranch_vccnz Lspinf_a
s_branch Lspunf_a
Lspinfb_a:
s_cmp_eq_u32 s49, 0
s_cbranch_scc1 Lspunfb_a
s_sub_u32 s49, s49, 1
buffer_load_dword v23, v4, s[28:31], 0 offen sc1
s_waitcnt vmcnt(0)
v_cmp_gt_u32 vcc, s41, v23
s_cbranch_vccnz Lspinfb_a
s_branch Lspunfb_a
Lspintf_a:
s_cmp_eq_u32 s49, 0
s_cbranch_scc1 Lspuntf_a
s_sub_u32 s49, s49, 1
buffer_load_dword v23, v4, s[28:31], 0 offen sc1
s_waitcnt vmcnt(0)
v_cmp_gt_u32 vcc, s41, v23
s_cbranch_vccnz Lspintf_a
s_branch Lspuntf_a
Lslow_ends15_a:
s_call_b64 s[84:85], Lslow1_a
s_branch Lret_ends15_a
Lspins_a:
s_cmp_eq_u32 s49, 0
s_cbranch_scc1 Lspuns_a
s_sub_u32 s49, s49, 1
buffer_load_dword v23, v4, s[28:31], 0 offen sc1
s_waitcnt vmcnt(0)
v_cmp_gt_u32 vcc, s41, v23
s_cbranch_vccnz Lspins_a
s_branch Lspuns_a
Lspinsb_a:
s_cmp_eq_u32 s49, 0
s_cbranch_scc1 Lspunsb_a
s_sub_u32 s49, s49, 1
buffer_load_dword v23, v4, s[28:31], 0 offen sc1
s_waitcnt vmcnt(0)
v_cmp_gt_u32 vcc, s41, v23
s_cbranch_vccnz Lspinsb_a
s_branch Lspunsb_a
Lspints_a:
s_cmp_eq_u32 s49, 0
s_cbranch_scc1 Lspunts_a
s_sub_u32 s49, s49, 1
buffer_load_dword v23, v4, s[28:31], 0 offen sc1
s_waitcnt vmcnt(0)
v_cmp_gt_u32 vcc, s41, v23
s_cbranch_vccnz Lspints_a
s_branch Lspunts_a
Lslow0_a:
s_nop 15
v_bfe_u32 v0, v1, 4, 4
v_lshrrev_b32 v23, 8, v1
v_lshlrev_b32 v23, 4, v23
v_lshl_add_u32 v0, v0, 9, v23
s_add_u32 s72, s43, 0
buffer_load_dwordx4 a[128:131], v0, s[12:15], s72 offen offset:0
buffer_load_dwordx4 a[132:135], v0, s[12:15], s72 offen offset:64
buffer_load_dwordx4 a[136:139], v0, s[12:15], s72 offen offset:128
buffer_load_dwordx4 a[140:143], v0, s[12:15], s72 offen offset:192
s_waitcnt vmcnt(0)
mz v[48:51],a[128:131],a[0:3],v[32:35]
mf v[48:51],a[132:135],a[16:19]
mf v[48:51],a[136:139],a[32:35]
mf v[48:51],a[140:143],a[48:51]
mz v[52:55],a[128:131],a[4:7],v[36:39]
mf v[52:55],a[132:135],a[20:23]
mf v[52:55],a[136:139],a[36:39]
mf v[52:55],a[140:143],a[52:55]
mz v[56:59],a[128:131],a[8:11],v[40:43]
mf v[56:59],a[132:135],a[24:27]
mf v[56:59],a[136:139],a[40:43]
mf v[56:59],a[140:143],a[56:59]
mz v[60:63],a[128:131],a[12:15],v[44:47]
mf v[60:63],a[132:135],a[28:31]
mf v[60:63],a[136:139],a[44:47]
mf v[60:63],a[140:143],a[60:63]
s_nop 7
buffer_load_dwordx4 a[128:131], v0, s[12:15], s72 offen offset:256
buffer_load_dwordx4 a[132:135], v0, s[12:15], s72 offen offset:320
buffer_load_dwordx4 a[136:139], v0, s[12:15], s72 offen offset:384
buffer_load_dwordx4 a[140:143], v0, s[12:15], s72 offen offset:448
s_waitcnt vmcnt(0)
mf v[48:51],a[128:131],a[64:67]
mf v[48:51],a[132:135],a[80:83]
mf v[48:51],a[136:139],a[96:99]
mf v[48:51],a[140:143],a[112:115]
mf v[52:55],a[128:131],a[68:71]
mf v[52:55],a[132:135],a[84:87]
mf v[52:55],a[136:139],a[100:103]
mf v[52:55],a[140:143],a[116:119]
mf v[56:59],a[128:131],a[72:75]
mf v[56:59],a[132:135],a[88:91]
mf v[56:59],a[136:139],a[104:107]
mf v[56:59],a[140:143],a[120:123]
mf v[60:63],a[128:131],a[76:79]
mf v[60:63],a[132:135],a[92:95]
mf v[60:63],a[136:139],a[108:111]
mf v[60:63],a[140:143],a[124:127]
s_nop 7
s_add_u32 s72, s43, 8192
buffer_load_dwordx4 a[128:131], v0, s[12:15], s72 offen offset:0
buffer_load_dwordx4 a[132:135], v0, s[12:15], s72 offen offset:64
buffer_load_dwordx4 a[136:139], v0, s[12:15], s72 offen offset:128
buffer_load_dwordx4 a[140:143], v0, s[12:15], s72 offen offset:192
s_waitcnt vmcnt(0)
mz v[80:83],a[128:131],a[0:3],v[32:35]
mf v[80:83],a[132:135],a[16:19]
mf v[80:83],a[136:139],a[32:35]
mf v[80:83],a[140:143],a[48:51]
mz v[84:87],a[128:131],a[4:7],v[36:39]
mf v[84:87],a[132:135],a[20:23]
mf v[84:87],a[136:139],a[36:39]
mf v[84:87],a[140:143],a[52:55]
mz v[88:91],a[128:131],a[8:11],v[40:43]
mf v[88:91],a[132:135],a[24:27]
mf v[88:91],a[136:139],a[40:43]
mf v[88:91],a[140:143],a[56:59]
mz v[92:95],a[128:131],a[12:15],v[44:47]
mf v[92:95],a[132:135],a[28:31]
mf v[92:95],a[136:139],a[44:47]
mf v[92:95],a[140:143],a[60:63]
s_nop 7
buffer_load_dwordx4 a[128:131], v0, s[12:15], s72 offen offset:256
buffer_load_dwordx4 a[132:135], v0, s[12:15], s72 offen offset:320
buffer_load_dwordx4 a[136:139], v0, s[12:15], s72 offen offset:384
buffer_load_dwordx4 a[140:143], v0, s[12:15], s72 offen offset:448
s_waitcnt vmcnt(0)
mf v[80:83],a[128:131],a[64:67]
mf v[80:83],a[132:135],a[80:83]
mf v[80:83],a[136:139],a[96:99]
mf v[80:83],a[140:143],a[112:115]
mf v[84:87],a[128:131],a[68:71]
mf v[84:87],a[132:135],a[84:87]
mf v[84:87],a[136:139],a[100:103]
mf v[84:87],a[140:143],a[116:119]
mf v[88:91],a[128:131],a[72:75]
mf v[88:91],a[132:135],a[88:91]
mf v[88:91],a[136:139],a[104:107]
mf v[88:91],a[140:143],a[120:123]
mf v[92:95],a[128:131],a[76:79]
mf v[92:95],a[132:135],a[92:95]
mf v[92:95],a[136:139],a[108:111]
mf v[92:95],a[140:143],a[124:127]
s_nop 7
s_nop 15
aw a128,v21
v_max3_f32 v0, v48, v49, v50
v_max3_f32 v0, v0, v51, v80
v_max3_f32 v0, v0, v81, v82
v_max_f32 v0, v0, v83
v_mov_b32 v23, v0
s_nop 1
v_permlane32_swap_b32 v0, v23
v_max_f32 v0, v0, v23
v_mov_b32 v23, v0
s_nop 1
v_permlane16_swap_b32 v0, v23
v_max_f32 v0, v0, v23
v_ceil_f32 v0, v0
v_max_f32 v0, 0, v0
v_exp_f32 v21, -v0
v_sub_f32 v32, v32, v0
v_sub_f32 v33, v33, v0
v_sub_f32 v34, v34, v0
v_sub_f32 v35, v35, v0
v_sub_f32 v48, v48, v0
v_sub_f32 v49, v49, v0
v_sub_f32 v50, v50, v0
v_sub_f32 v51, v51, v0
v_sub_f32 v80, v80, v0
v_sub_f32 v81, v81, v0
v_sub_f32 v82, v82, v0
v_sub_f32 v83, v83, v0
v_exp_f32 v48, v48
v_exp_f32 v49, v49
s_nop 0
v_add_f32 v28, v48, v49
cv v48,v48,v49
v_exp_f32 v50, v50
v_exp_f32 v51, v51
v_add_f32 v28, v50, v28
v_add_f32 v28, v51, v28
cv v49,v50,v51
v_exp_f32 v80, v80
v_exp_f32 v81, v81
v_add_f32 v28, v80, v28
v_add_f32 v28, v81, v28
cv v50,v80,v81
v_exp_f32 v82, v82
v_exp_f32 v83, v83
v_add_f32 v28, v82, v28
v_add_f32 v28, v83, v28
cv v51,v82,v83
v_mul_f32 v24, v24, v21
v_lshlrev_b32 v0, 16, v64
v_and_b32 v23, 0xffff0000, v64
v_mul_f32 v0, v0, v21
v_mul_f32 v23, v23, v21
cv v64,v0,v23
v_lshlrev_b32 v0, 16, v65
v_and_b32 v23, 0xffff0000, v65
v_mul_f32 v0, v0, v21
v_mul_f32 v23, v23, v21
cv v65,v0,v23
v_lshlrev_b32 v0, 16, v66
v_and_b32 v23, 0xffff0000, v66
v_mul_f32 v0, v0, v21
v_mul_f32 v23, v23, v21
cv v66,v0,v23
v_lshlrev_b32 v0, 16, v67
v_and_b32 v23, 0xffff0000, v67
v_mul_f32 v0, v0, v21
v_mul_f32 v23, v23, v21
cv v67,v0,v23
v_mul_f32 v96, v96, v21
v_mul_f32 v97, v97, v21
v_mul_f32 v98, v98, v21
v_mul_f32 v99, v99, v21
v_mul_f32 v112, v112, v21
v_mul_f32 v113, v113, v21
v_mul_f32 v114, v114, v21
v_mul_f32 v115, v115, v21
v_mul_f32 v128, v128, v21
v_mul_f32 v129, v129, v21
v_mul_f32 v130, v130, v21
v_mul_f32 v131, v131, v21
v_mul_f32 v144, v144, v21
v_mul_f32 v145, v145, v21
v_mul_f32 v146, v146, v21
v_mul_f32 v147, v147, v21
v_mul_f32 v160, v160, v21
v_mul_f32 v161, v161, v21
v_mul_f32 v162, v162, v21
v_mul_f32 v163, v163, v21
v_mul_f32 v176, v176, v21
v_mul_f32 v177, v177, v21
v_mul_f32 v178, v178, v21
v_mul_f32 v179, v179, v21
v_mul_f32 v192, v192, v21
v_mul_f32 v193, v193, v21
v_mul_f32 v194, v194, v21
v_mul_f32 v195, v195, v21
v_mul_f32 v208, v208, v21
v_mul_f32 v209, v209, v21
v_mul_f32 v210, v210, v21
v_mul_f32 v211, v211, v21
v_mul_f32 v224, v224, v21
v_mul_f32 v225, v225, v21
v_mul_f32 v226, v226, v21
v_mul_f32 v227, v227, v21
v_mul_f32 v240, v240, v21
v_mul_f32 v241, v241, v21
v_mul_f32 v242, v242, v21
v_mul_f32 v243, v243, v21
ar v23,a160
v_mul_f32 v23, v23, v21
aw a160,v23
ar v23,a161
v_mul_f32 v23, v23, v21
aw a161,v23
ar v23,a162
v_mul_f32 v23, v23, v21
aw a162,v23
ar v23,a163
v_mul_f32 v23, v23, v21
aw a163,v23
ar v23,a176
v_mul_f32 v23, v23, v21
aw a176,v23
ar v23,a177
v_mul_f32 v23, v23, v21
aw a177,v23
ar v23,a178
v_mul_f32 v23, v23, v21
aw a178,v23
ar v23,a179
v_mul_f32 v23, v23, v21
aw a179,v23
ar v23,a192
v_mul_f32 v23, v23, v21
aw a192,v23
ar v23,a193
v_mul_f32 v23, v23, v21
aw a193,v23
ar v23,a194
v_mul_f32 v23, v23, v21
aw a194,v23
ar v23,a195
v_mul_f32 v23, v23, v21
aw a195,v23
ar v23,a208
v_mul_f32 v23, v23, v21
aw a208,v23
ar v23,a209
v_mul_f32 v23, v23, v21
aw a209,v23
ar v23,a210
v_mul_f32 v23, v23, v21
aw a210,v23
ar v23,a211
v_mul_f32 v23, v23, v21
aw a211,v23
ar v23,a224
v_mul_f32 v23, v23, v21
aw a224,v23
ar v23,a225
v_mul_f32 v23, v23, v21
aw a225,v23
ar v23,a226
v_mul_f32 v23, v23, v21
aw a226,v23
ar v23,a227
v_mul_f32 v23, v23, v21
aw a227,v23
ar v23,a240
v_mul_f32 v23, v23, v21
aw a240,v23
ar v23,a241
v_mul_f32 v23, v23, v21
aw a241,v23
ar v23,a242
v_mul_f32 v23, v23, v21
aw a242,v23
ar v23,a243
v_mul_f32 v23, v23, v21
aw a243,v23
v_max3_f32 v0, v52, v53, v54
v_max3_f32 v0, v0, v55, v84
v_max3_f32 v0, v0, v85, v86
v_max_f32 v0, v0, v87
v_mov_b32 v23, v0
s_nop 1
v_permlane32_swap_b32 v0, v23
v_max_f32 v0, v0, v23
v_mov_b32 v23, v0
s_nop 1
v_permlane16_swap_b32 v0, v23
v_max_f32 v0, v0, v23
v_ceil_f32 v0, v0
v_max_f32 v0, 0, v0
v_exp_f32 v21, -v0
v_sub_f32 v36, v36, v0
v_sub_f32 v37, v37, v0
v_sub_f32 v38, v38, v0
v_sub_f32 v39, v39, v0
v_sub_f32 v52, v52, v0
v_sub_f32 v53, v53, v0
v_sub_f32 v54, v54, v0
v_sub_f32 v55, v55, v0
v_sub_f32 v84, v84, v0
v_sub_f32 v85, v85, v0
v_sub_f32 v86, v86, v0
v_sub_f32 v87, v87, v0
v_exp_f32 v52, v52
v_exp_f32 v53, v53
s_nop 0
v_add_f32 v29, v52, v53
cv v52,v52,v53
v_exp_f32 v54, v54
v_exp_f32 v55, v55
v_add_f32 v29, v54, v29
v_add_f32 v29, v55, v29
cv v53,v54,v55
v_exp_f32 v84, v84
v_exp_f32 v85, v85
v_add_f32 v29, v84, v29
v_add_f32 v29, v85, v29
cv v54,v84,v85
v_exp_f32 v86, v86
v_exp_f32 v87, v87
v_add_f32 v29, v86, v29
v_add_f32 v29, v87, v29
cv v55,v86,v87
v_mul_f32 v25, v25, v21
v_lshlrev_b32 v0, 16, v68
v_and_b32 v23, 0xffff0000, v68
v_mul_f32 v0, v0, v21
v_mul_f32 v23, v23, v21
cv v68,v0,v23
v_lshlrev_b32 v0, 16, v69
v_and_b32 v23, 0xffff0000, v69
v_mul_f32 v0, v0, v21
v_mul_f32 v23, v23, v21
cv v69,v0,v23
v_lshlrev_b32 v0, 16, v70
v_and_b32 v23, 0xffff0000, v70
v_mul_f32 v0, v0, v21
v_mul_f32 v23, v23, v21
cv v70,v0,v23
v_lshlrev_b32 v0, 16, v71
v_and_b32 v23, 0xffff0000, v71
v_mul_f32 v0, v0, v21
v_mul_f32 v23, v23, v21
cv v71,v0,v23
v_mul_f32 v100, v100, v21
v_mul_f32 v101, v101, v21
v_mul_f32 v102, v102, v21
v_mul_f32 v103, v103, v21
v_mul_f32 v116, v116, v21
v_mul_f32 v117, v117, v21
v_mul_f32 v118, v118, v21
v_mul_f32 v119, v119, v21
v_mul_f32 v132, v132, v21
v_mul_f32 v133, v133, v21
v_mul_f32 v134, v134, v21
v_mul_f32 v135, v135, v21
v_mul_f32 v148, v148, v21
v_mul_f32 v149, v149, v21
v_mul_f32 v150, v150, v21
v_mul_f32 v151, v151, v21
v_mul_f32 v164, v164, v21
v_mul_f32 v165, v165, v21
v_mul_f32 v166, v166, v21
v_mul_f32 v167, v167, v21
v_mul_f32 v180, v180, v21
v_mul_f32 v181, v181, v21
v_mul_f32 v182, v182, v21
v_mul_f32 v183, v183, v21
v_mul_f32 v196, v196, v21
v_mul_f32 v197, v197, v21
v_mul_f32 v198, v198, v21
v_mul_f32 v199, v199, v21
v_mul_f32 v212, v212, v21
v_mul_f32 v213, v213, v21
v_mul_f32 v214, v214, v21
v_mul_f32 v215, v215, v21
v_mul_f32 v228, v228, v21
v_mul_f32 v229, v229, v21
v_mul_f32 v230, v230, v21
v_mul_f32 v231, v231, v21
v_mul_f32 v244, v244, v21
v_mul_f32 v245, v245, v21
v_mul_f32 v246, v246, v21
v_mul_f32 v247, v247, v21
ar v23,a164
v_mul_f32 v23, v23, v21
aw a164,v23
ar v23,a165
v_mul_f32 v23, v23, v21
aw a165,v23
ar v23,a166
v_mul_f32 v23, v23, v21
aw a166,v23
ar v23,a167
v_mul_f32 v23, v23, v21
aw a167,v23
ar v23,a180
v_mul_f32 v23, v23, v21
aw a180,v23
ar v23,a181
v_mul_f32 v23, v23, v21
aw a181,v23
ar v23,a182
v_mul_f32 v23, v23, v21
aw a182,v23
ar v23,a183
v_mul_f32 v23, v23, v21
aw a183,v23
ar v23,a196
v_mul_f32 v23, v23, v21
aw a196,v23
ar v23,a197
v_mul_f32 v23, v23, v21
aw a197,v23
ar v23,a198
v_mul_f32 v23, v23, v21
aw a198,v23
ar v23,a199
v_mul_f32 v23, v23, v21
aw a199,v23
ar v23,a212
v_mul_f32 v23, v23, v21
aw a212,v23
ar v23,a213
v_mul_f32 v23, v23, v21
aw a213,v23
ar v23,a214
v_mul_f32 v23, v23, v21
aw a214,v23
ar v23,a215
v_mul_f32 v23, v23, v21
aw a215,v23
ar v23,a228
v_mul_f32 v23, v23, v21
aw a228,v23
ar v23,a229
v_mul_f32 v23, v23, v21
aw a229,v23
ar v23,a230
v_mul_f32 v23, v23, v21
aw a230,v23
ar v23,a231
v_mul_f32 v23, v23, v21
aw a231,v23
ar v23,a244
v_mul_f32 v23, v23, v21
aw a244,v23
ar v23,a245
v_mul_f32 v23, v23, v21
aw a245,v23
ar v23,a246
v_mul_f32 v23, v23, v21
aw a246,v23
ar v23,a247
v_mul_f32 v23, v23, v21
aw a247,v23
v_max3_f32 v0, v56, v57, v58
v_max3_f32 v0, v0, v59, v88
v_max3_f32 v0, v0, v89, v90
v_max_f32 v0, v0, v91
v_mov_b32 v23, v0
s_nop 1
v_permlane32_swap_b32 v0, v23
v_max_f32 v0, v0, v23
v_mov_b32 v23, v0
s_nop 1
v_permlane16_swap_b32 v0, v23
v_max_f32 v0, v0, v23
v_ceil_f32 v0, v0
v_max_f32 v0, 0, v0
v_exp_f32 v21, -v0
v_sub_f32 v40, v40, v0
v_sub_f32 v41, v41, v0
v_sub_f32 v42, v42, v0
v_sub_f32 v43, v43, v0
v_sub_f32 v56, v56, v0
v_sub_f32 v57, v57, v0
v_sub_f32 v58, v58, v0
v_sub_f32 v59, v59, v0
v_sub_f32 v88, v88, v0
v_sub_f32 v89, v89, v0
v_sub_f32 v90, v90, v0
v_sub_f32 v91, v91, v0
v_exp_f32 v56, v56
v_exp_f32 v57, v57
s_nop 0
v_add_f32 v30, v56, v57
cv v56,v56,v57
v_exp_f32 v58, v58
v_exp_f32 v59, v59
v_add_f32 v30, v58, v30
v_add_f32 v30, v59, v30
cv v57,v58,v59
v_exp_f32 v88, v88
v_exp_f32 v89, v89
v_add_f32 v30, v88, v30
v_add_f32 v30, v89, v30
cv v58,v88,v89
v_exp_f32 v90, v90
v_exp_f32 v91, v91
v_add_f32 v30, v90, v30
v_add_f32 v30, v91, v30
cv v59,v90,v91
v_mul_f32 v26, v26, v21
v_lshlrev_b32 v0, 16, v72
v_and_b32 v23, 0xffff0000, v72
v_mul_f32 v0, v0, v21
v_mul_f32 v23, v23, v21
cv v72,v0,v23
v_lshlrev_b32 v0, 16, v73
v_and_b32 v23, 0xffff0000, v73
v_mul_f32 v0, v0, v21
v_mul_f32 v23, v23, v21
cv v73,v0,v23
v_lshlrev_b32 v0, 16, v74
v_and_b32 v23, 0xffff0000, v74
v_mul_f32 v0, v0, v21
v_mul_f32 v23, v23, v21
cv v74,v0,v23
v_lshlrev_b32 v0, 16, v75
v_and_b32 v23, 0xffff0000, v75
v_mul_f32 v0, v0, v21
v_mul_f32 v23, v23, v21
cv v75,v0,v23
v_mul_f32 v104, v104, v21
v_mul_f32 v105, v105, v21
v_mul_f32 v106, v106, v21
v_mul_f32 v107, v107, v21
v_mul_f32 v120, v120, v21
v_mul_f32 v121, v121, v21
v_mul_f32 v122, v122, v21
v_mul_f32 v123, v123, v21
v_mul_f32 v136, v136, v21
v_mul_f32 v137, v137, v21
v_mul_f32 v138, v138, v21
v_mul_f32 v139, v139, v21
v_mul_f32 v152, v152, v21
v_mul_f32 v153, v153, v21
v_mul_f32 v154, v154, v21
v_mul_f32 v155, v155, v21
v_mul_f32 v168, v168, v21
v_mul_f32 v169, v169, v21
v_mul_f32 v170, v170, v21
v_mul_f32 v171, v171, v21
v_mul_f32 v184, v184, v21
v_mul_f32 v185, v185, v21
v_mul_f32 v186, v186, v21
v_mul_f32 v187, v187, v21
v_mul_f32 v200, v200, v21
v_mul_f32 v201, v201, v21
v_mul_f32 v202, v202, v21
v_mul_f32 v203, v203, v21
v_mul_f32 v216, v216, v21
v_mul_f32 v217, v217, v21
v_mul_f32 v218, v218, v21
v_mul_f32 v219, v219, v21
v_mul_f32 v232, v232, v21
v_mul_f32 v233, v233, v21
v_mul_f32 v234, v234, v21
v_mul_f32 v235, v235, v21
v_mul_f32 v248, v248, v21
v_mul_f32 v249, v249, v21
v_mul_f32 v250, v250, v21
v_mul_f32 v251, v251, v21
ar v23,a168
v_mul_f32 v23, v23, v21
aw a168,v23
ar v23,a169
v_mul_f32 v23, v23, v21
aw a169,v23
ar v23,a170
v_mul_f32 v23, v23, v21
aw a170,v23
ar v23,a171
v_mul_f32 v23, v23, v21
aw a171,v23
ar v23,a184
v_mul_f32 v23, v23, v21
aw a184,v23
ar v23,a185
v_mul_f32 v23, v23, v21
aw a185,v23
ar v23,a186
v_mul_f32 v23, v23, v21
aw a186,v23
ar v23,a187
v_mul_f32 v23, v23, v21
aw a187,v23
ar v23,a200
v_mul_f32 v23, v23, v21
aw a200,v23
ar v23,a201
v_mul_f32 v23, v23, v21
aw a201,v23
ar v23,a202
v_mul_f32 v23, v23, v21
aw a202,v23
ar v23,a203
v_mul_f32 v23, v23, v21
aw a203,v23
ar v23,a216
v_mul_f32 v23, v23, v21
aw a216,v23
ar v23,a217
v_mul_f32 v23, v23, v21
aw a217,v23
ar v23,a218
v_mul_f32 v23, v23, v21
aw a218,v23
ar v23,a219
v_mul_f32 v23, v23, v21
aw a219,v23
ar v23,a232
v_mul_f32 v23, v23, v21
aw a232,v23
ar v23,a233
v_mul_f32 v23, v23, v21
aw a233,v23
ar v23,a234
v_mul_f32 v23, v23, v21
aw a234,v23
ar v23,a235
v_mul_f32 v23, v23, v21
aw a235,v23
ar v23,a248
v_mul_f32 v23, v23, v21
aw a248,v23
ar v23,a249
v_mul_f32 v23, v23, v21
aw a249,v23
ar v23,a250
v_mul_f32 v23, v23, v21
aw a250,v23
ar v23,a251
v_mul_f32 v23, v23, v21
aw a251,v23
v_max3_f32 v0, v60, v61, v62
v_max3_f32 v0, v0, v63, v92
v_max3_f32 v0, v0, v93, v94
v_max_f32 v0, v0, v95
v_mov_b32 v23, v0
s_nop 1
v_permlane32_swap_b32 v0, v23
v_max_f32 v0, v0, v23
v_mov_b32 v23, v0
s_nop 1
v_permlane16_swap_b32 v0, v23
v_max_f32 v0, v0, v23
v_ceil_f32 v0, v0
v_max_f32 v0, 0, v0
v_exp_f32 v21, -v0
v_sub_f32 v44, v44, v0
v_sub_f32 v45, v45, v0
v_sub_f32 v46, v46, v0
v_sub_f32 v47, v47, v0
v_sub_f32 v60, v60, v0
v_sub_f32 v61, v61, v0
v_sub_f32 v62, v62, v0
v_sub_f32 v63, v63, v0
v_sub_f32 v92, v92, v0
v_sub_f32 v93, v93, v0
v_sub_f32 v94, v94, v0
v_sub_f32 v95, v95, v0
v_exp_f32 v60, v60
v_exp_f32 v61, v61
s_nop 0
v_add_f32 v31, v60, v61
cv v60,v60,v61
v_exp_f32 v62, v62
v_exp_f32 v63, v63
v_add_f32 v31, v62, v31
v_add_f32 v31, v63, v31
cv v61,v62,v63
v_exp_f32 v92, v92
v_exp_f32 v93, v93
v_add_f32 v31, v92, v31
v_add_f32 v31, v93, v31
cv v62,v92,v93
v_exp_f32 v94, v94
v_exp_f32 v95, v95
v_add_f32 v31, v94, v31
v_add_f32 v31, v95, v31
cv v63,v94,v95
v_mul_f32 v27, v27, v21
v_lshlrev_b32 v0, 16, v76
v_and_b32 v23, 0xffff0000, v76
v_mul_f32 v0, v0, v21
v_mul_f32 v23, v23, v21
cv v76,v0,v23
v_lshlrev_b32 v0, 16, v77
v_and_b32 v23, 0xffff0000, v77
v_mul_f32 v0, v0, v21
v_mul_f32 v23, v23, v21
cv v77,v0,v23
v_lshlrev_b32 v0, 16, v78
v_and_b32 v23, 0xffff0000, v78
v_mul_f32 v0, v0, v21
v_mul_f32 v23, v23, v21
cv v78,v0,v23
v_lshlrev_b32 v0, 16, v79
v_and_b32 v23, 0xffff0000, v79
v_mul_f32 v0, v0, v21
v_mul_f32 v23, v23, v21
cv v79,v0,v23
v_mul_f32 v108, v108, v21
v_mul_f32 v109, v109, v21
v_mul_f32 v110, v110, v21
v_mul_f32 v111, v111, v21
v_mul_f32 v124, v124, v21
v_mul_f32 v125, v125, v21
v_mul_f32 v126, v126, v21
v_mul_f32 v127, v127, v21
v_mul_f32 v140, v140, v21
v_mul_f32 v141, v141, v21
v_mul_f32 v142, v142, v21
v_mul_f32 v143, v143, v21
v_mul_f32 v156, v156, v21
v_mul_f32 v157, v157, v21
v_mul_f32 v158, v158, v21
v_mul_f32 v159, v159, v21
v_mul_f32 v172, v172, v21
v_mul_f32 v173, v173, v21
v_mul_f32 v174, v174, v21
v_mul_f32 v175, v175, v21
v_mul_f32 v188, v188, v21
v_mul_f32 v189, v189, v21
v_mul_f32 v190, v190, v21
v_mul_f32 v191, v191, v21
v_mul_f32 v204, v204, v21
v_mul_f32 v205, v205, v21
v_mul_f32 v206, v206, v21
v_mul_f32 v207, v207, v21
v_mul_f32 v220, v220, v21
v_mul_f32 v221, v221, v21
v_mul_f32 v222, v222, v21
v_mul_f32 v223, v223, v21
v_mul_f32 v236, v236, v21
v_mul_f32 v237, v237, v21
v_mul_f32 v238, v238, v21
v_mul_f32 v239, v239, v21
v_mul_f32 v252, v252, v21
v_mul_f32 v253, v253, v21
v_mul_f32 v254, v254, v21
v_mul_f32 v255, v255, v21
ar v23,a172
v_mul_f32 v23, v23, v21
aw a172,v23
ar v23,a173
v_mul_f32 v23, v23, v21
aw a173,v23
ar v23,a174
v_mul_f32 v23, v23, v21
aw a174,v23
ar v23,a175
v_mul_f32 v23, v23, v21
aw a175,v23
ar v23,a188
v_mul_f32 v23, v23, v21
aw a188,v23
ar v23,a189
v_mul_f32 v23, v23, v21
aw a189,v23
ar v23,a190
v_mul_f32 v23, v23, v21
aw a190,v23
ar v23,a191
v_mul_f32 v23, v23, v21
aw a191,v23
ar v23,a204
v_mul_f32 v23, v23, v21
aw a204,v23
ar v23,a205
v_mul_f32 v23, v23, v21
aw a205,v23
ar v23,a206
v_mul_f32 v23, v23, v21
aw a206,v23
ar v23,a207
v_mul_f32 v23, v23, v21
aw a207,v23
ar v23,a220
v_mul_f32 v23, v23, v21
aw a220,v23
ar v23,a221
v_mul_f32 v23, v23, v21
aw a221,v23
ar v23,a222
v_mul_f32 v23, v23, v21
aw a222,v23
ar v23,a223
v_mul_f32 v23, v23, v21
aw a223,v23
ar v23,a236
v_mul_f32 v23, v23, v21
aw a236,v23
ar v23,a237
v_mul_f32 v23, v23, v21
aw a237,v23
ar v23,a238
v_mul_f32 v23, v23, v21
aw a238,v23
ar v23,a239
v_mul_f32 v23, v23, v21
aw a239,v23
ar v23,a252
v_mul_f32 v23, v23, v21
aw a252,v23
ar v23,a253
v_mul_f32 v23, v23, v21
aw a253,v23
ar v23,a254
v_mul_f32 v23, v23, v21
aw a254,v23
ar v23,a255
v_mul_f32 v23, v23, v21
aw a255,v23
ar v21,a128
s_nop 3
s_setpc_b64 s[84:85]
Lslow1_a:
s_nop 15
v_bfe_u32 v0, v1, 4, 4
v_lshrrev_b32 v23, 8, v1
v_lshlrev_b32 v23, 4, v23
v_lshl_add_u32 v0, v0, 9, v23
s_add_u32 s72, s43, 0
buffer_load_dwordx4 a[128:131], v0, s[12:15], s72 offen offset:0
buffer_load_dwordx4 a[132:135], v0, s[12:15], s72 offen offset:64
buffer_load_dwordx4 a[136:139], v0, s[12:15], s72 offen offset:128
buffer_load_dwordx4 a[140:143], v0, s[12:15], s72 offen offset:192
s_waitcnt vmcnt(0)
mz v[64:67],a[128:131],a[0:3],v[32:35]
mf v[64:67],a[132:135],a[16:19]
mf v[64:67],a[136:139],a[32:35]
mf v[64:67],a[140:143],a[48:51]
mz v[68:71],a[128:131],a[4:7],v[36:39]
mf v[68:71],a[132:135],a[20:23]
mf v[68:71],a[136:139],a[36:39]
mf v[68:71],a[140:143],a[52:55]
mz v[72:75],a[128:131],a[8:11],v[40:43]
mf v[72:75],a[132:135],a[24:27]
mf v[72:75],a[136:139],a[40:43]
mf v[72:75],a[140:143],a[56:59]
mz v[76:79],a[128:131],a[12:15],v[44:47]
mf v[76:79],a[132:135],a[28:31]
mf v[76:79],a[136:139],a[44:47]
mf v[76:79],a[140:143],a[60:63]
s_nop 7
buffer_load_dwordx4 a[128:131], v0, s[12:15], s72 offen offset:256
buffer_load_dwordx4 a[132:135], v0, s[12:15], s72 offen offset:320
buffer_load_dwordx4 a[136:139], v0, s[12:15], s72 offen offset:384
buffer_load_dwordx4 a[140:143], v0, s[12:15], s72 offen offset:448
s_waitcnt vmcnt(0)
mf v[64:67],a[128:131],a[64:67]
mf v[64:67],a[132:135],a[80:83]
mf v[64:67],a[136:139],a[96:99]
mf v[64:67],a[140:143],a[112:115]
mf v[68:71],a[128:131],a[68:71]
mf v[68:71],a[132:135],a[84:87]
mf v[68:71],a[136:139],a[100:103]
mf v[68:71],a[140:143],a[116:119]
mf v[72:75],a[128:131],a[72:75]
mf v[72:75],a[132:135],a[88:91]
mf v[72:75],a[136:139],a[104:107]
mf v[72:75],a[140:143],a[120:123]
mf v[76:79],a[128:131],a[76:79]
mf v[76:79],a[132:135],a[92:95]
mf v[76:79],a[136:139],a[108:111]
mf v[76:79],a[140:143],a[124:127]
s_nop 7
s_add_u32 s72, s43, 8192
buffer_load_dwordx4 a[128:131], v0, s[12:15], s72 offen offset:0
buffer_load_dwordx4 a[132:135], v0, s[12:15], s72 offen offset:64
buffer_load_dwordx4 a[136:139], v0, s[12:15], s72 offen offset:128
buffer_load_dwordx4 a[140:143], v0, s[12:15], s72 offen offset:192
s_waitcnt vmcnt(0)
mz v[80:83],a[128:131],a[0:3],v[32:35]
mf v[80:83],a[132:135],a[16:19]
mf v[80:83],a[136:139],a[32:35]
mf v[80:83],a[140:143],a[48:51]
mz v[84:87],a[128:131],a[4:7],v[36:39]
mf v[84:87],a[132:135],a[20:23]
mf v[84:87],a[136:139],a[36:39]
mf v[84:87],a[140:143],a[52:55]
mz v[88:91],a[128:131],a[8:11],v[40:43]
mf v[88:91],a[132:135],a[24:27]
mf v[88:91],a[136:139],a[40:43]
mf v[88:91],a[140:143],a[56:59]
mz v[92:95],a[128:131],a[12:15],v[44:47]
mf v[92:95],a[132:135],a[28:31]
mf v[92:95],a[136:139],a[44:47]
mf v[92:95],a[140:143],a[60:63]
s_nop 7
buffer_load_dwordx4 a[128:131], v0, s[12:15], s72 offen offset:256
buffer_load_dwordx4 a[132:135], v0, s[12:15], s72 offen offset:320
buffer_load_dwordx4 a[136:139], v0, s[12:15], s72 offen offset:384
buffer_load_dwordx4 a[140:143], v0, s[12:15], s72 offen offset:448
s_waitcnt vmcnt(0)
mf v[80:83],a[128:131],a[64:67]
mf v[80:83],a[132:135],a[80:83]
mf v[80:83],a[136:139],a[96:99]
mf v[80:83],a[140:143],a[112:115]
mf v[84:87],a[128:131],a[68:71]
mf v[84:87],a[132:135],a[84:87]
mf v[84:87],a[136:139],a[100:103]
mf v[84:87],a[140:143],a[116:119]
mf v[88:91],a[128:131],a[72:75]
mf v[88:91],a[132:135],a[88:91]
mf v[88:91],a[136:139],a[104:107]
mf v[88:91],a[140:143],a[120:123]
mf v[92:95],a[128:131],a[76:79]
mf v[92:95],a[132:135],a[92:95]
mf v[92:95],a[136:139],a[108:111]
mf v[92:95],a[140:143],a[124:127]
s_nop 7
s_nop 15
aw a128,v21
v_max3_f32 v0, v64, v65, v66
v_max3_f32 v0, v0, v67, v80
v_max3_f32 v0, v0, v81, v82
v_max_f32 v0, v0, v83
v_mov_b32 v23, v0
s_nop 1
v_permlane32_swap_b32 v0, v23
v_max_f32 v0, v0, v23
v_mov_b32 v23, v0
s_nop 1
v_permlane16_swap_b32 v0, v23
v_max_f32 v0, v0, v23
v_ceil_f32 v0, v0
v_max_f32 v0, 0, v0
v_exp_f32 v21, -v0
v_sub_f32 v32, v32, v0
v_sub_f32 v33, v33, v0
v_sub_f32 v34, v34, v0
v_sub_f32 v35, v35, v0
v_sub_f32 v64, v64, v0
v_sub_f32 v65, v65, v0
v_sub_f32 v66, v66, v0
v_sub_f32 v67, v67, v0
v_sub_f32 v80, v80, v0
v_sub_f32 v81, v81, v0
v_sub_f32 v82, v82, v0
v_sub_f32 v83, v83, v0
v_exp_f32 v64, v64
v_exp_f32 v65, v65
s_nop 0
v_add_f32 v28, v64, v65
cv v64,v64,v65
v_exp_f32 v66, v66
v_exp_f32 v67, v67
v_add_f32 v28, v66, v28
v_add_f32 v28, v67, v28
cv v65,v66,v67
v_exp_f32 v80, v80
v_exp_f32 v81, v81
v_add_f32 v28, v80, v28
v_add_f32 v28, v81, v28
cv v66,v80,v81
v_exp_f32 v82, v82
v_exp_f32 v83, v83
v_add_f32 v28, v82, v28
v_add_f32 v28, v83, v28
cv v67,v82,v83
v_mul_f32 v24, v24, v21
v_lshlrev_b32 v0, 16, v48
v_and_b32 v23, 0xffff0000, v48
v_mul_f32 v0, v0, v21
v_mul_f32 v23, v23, v21
cv v48,v0,v23
v_lshlrev_b32 v0, 16, v49
v_and_b32 v23, 0xffff0000, v49
v_mul_f32 v0, v0, v21
v_mul_f32 v23, v23, v21
cv v49,v0,v23
v_lshlrev_b32 v0, 16, v50
v_and_b32 v23, 0xffff0000, v50
v_mul_f32 v0, v0, v21
v_mul_f32 v23, v23, v21
cv v50,v0,v23
v_lshlrev_b32 v0, 16, v51
v_and_b32 v23, 0xffff0000, v51
v_mul_f32 v0, v0, v21
v_mul_f32 v23, v23, v21
cv v51,v0,v23
v_mul_f32 v96, v96, v21
v_mul_f32 v97, v97, v21
v_mul_f32 v98, v98, v21
v_mul_f32 v99, v99, v21
v_mul_f32 v112, v112, v21
v_mul_f32 v113, v113, v21
v_mul_f32 v114, v114, v21
v_mul_f32 v115, v115, v21
v_mul_f32 v128, v128, v21
v_mul_f32 v129, v129, v21
v_mul_f32 v130, v130, v21
v_mul_f32 v131, v131, v21
v_mul_f32 v144, v144, v21
v_mul_f32 v145, v145, v21
v_mul_f32 v146, v146, v21
v_mul_f32 v147, v147, v21
v_mul_f32 v160, v160, v21
v_mul_f32 v161, v161, v21
v_mul_f32 v162, v162, v21
v_mul_f32 v163, v163, v21
v_mul_f32 v176, v176, v21
v_mul_f32 v177, v177, v21
v_mul_f32 v178, v178, v21
v_mul_f32 v179, v179, v21
v_mul_f32 v192, v192, v21
v_mul_f32 v193, v193, v21
v_mul_f32 v194, v194, v21
v_mul_f32 v195, v195, v21
v_mul_f32 v208, v208, v21
v_mul_f32 v209, v209, v21
v_mul_f32 v210, v210, v21
v_mul_f32 v211, v211, v21
v_mul_f32 v224, v224, v21
v_mul_f32 v225, v225, v21
v_mul_f32 v226, v226, v21
v_mul_f32 v227, v227, v21
v_mul_f32 v240, v240, v21
v_mul_f32 v241, v241, v21
v_mul_f32 v242, v242, v21
v_mul_f32 v243, v243, v21
ar v23,a160
v_mul_f32 v23, v23, v21
aw a160,v23
ar v23,a161
v_mul_f32 v23, v23, v21
aw a161,v23
ar v23,a162
v_mul_f32 v23, v23, v21
aw a162,v23
ar v23,a163
v_mul_f32 v23, v23, v21
aw a163,v23
ar v23,a176
v_mul_f32 v23, v23, v21
aw a176,v23
ar v23,a177
v_mul_f32 v23, v23, v21
aw a177,v23
ar v23,a178
v_mul_f32 v23, v23, v21
aw a178,v23
ar v23,a179
v_mul_f32 v23, v23, v21
aw a179,v23
ar v23,a192
v_mul_f32 v23, v23, v21
aw a192,v23
ar v23,a193
v_mul_f32 v23, v23, v21
aw a193,v23
ar v23,a194
v_mul_f32 v23, v23, v21
aw a194,v23
ar v23,a195
v_mul_f32 v23, v23, v21
aw a195,v23
ar v23,a208
v_mul_f32 v23, v23, v21
aw a208,v23
ar v23,a209
v_mul_f32 v23, v23, v21
aw a209,v23
ar v23,a210
v_mul_f32 v23, v23, v21
aw a210,v23
ar v23,a211
v_mul_f32 v23, v23, v21
aw a211,v23
ar v23,a224
v_mul_f32 v23, v23, v21
aw a224,v23
ar v23,a225
v_mul_f32 v23, v23, v21
aw a225,v23
ar v23,a226
v_mul_f32 v23, v23, v21
aw a226,v23
ar v23,a227
v_mul_f32 v23, v23, v21
aw a227,v23
ar v23,a240
v_mul_f32 v23, v23, v21
aw a240,v23
ar v23,a241
v_mul_f32 v23, v23, v21
aw a241,v23
ar v23,a242
v_mul_f32 v23, v23, v21
aw a242,v23
ar v23,a243
v_mul_f32 v23, v23, v21
aw a243,v23
v_max3_f32 v0, v68, v69, v70
v_max3_f32 v0, v0, v71, v84
v_max3_f32 v0, v0, v85, v86
v_max_f32 v0, v0, v87
v_mov_b32 v23, v0
s_nop 1
v_permlane32_swap_b32 v0, v23
v_max_f32 v0, v0, v23
v_mov_b32 v23, v0
s_nop 1
v_permlane16_swap_b32 v0, v23
v_max_f32 v0, v0, v23
v_ceil_f32 v0, v0
v_max_f32 v0, 0, v0
v_exp_f32 v21, -v0
v_sub_f32 v36, v36, v0
v_sub_f32 v37, v37, v0
v_sub_f32 v38, v38, v0
v_sub_f32 v39, v39, v0
v_sub_f32 v68, v68, v0
v_sub_f32 v69, v69, v0
v_sub_f32 v70, v70, v0
v_sub_f32 v71, v71, v0
v_sub_f32 v84, v84, v0
v_sub_f32 v85, v85, v0
v_sub_f32 v86, v86, v0
v_sub_f32 v87, v87, v0
v_exp_f32 v68, v68
v_exp_f32 v69, v69
s_nop 0
v_add_f32 v29, v68, v69
cv v68,v68,v69
v_exp_f32 v70, v70
v_exp_f32 v71, v71
v_add_f32 v29, v70, v29
v_add_f32 v29, v71, v29
cv v69,v70,v71
v_exp_f32 v84, v84
v_exp_f32 v85, v85
v_add_f32 v29, v84, v29
v_add_f32 v29, v85, v29
cv v70,v84,v85
v_exp_f32 v86, v86
v_exp_f32 v87, v87
v_add_f32 v29, v86, v29
v_add_f32 v29, v87, v29
cv v71,v86,v87
v_mul_f32 v25, v25, v21
v_lshlrev_b32 v0, 16, v52
v_and_b32 v23, 0xffff0000, v52
v_mul_f32 v0, v0, v21
v_mul_f32 v23, v23, v21
cv v52,v0,v23
v_lshlrev_b32 v0, 16, v53
v_and_b32 v23, 0xffff0000, v53
v_mul_f32 v0, v0, v21
v_mul_f32 v23, v23, v21
cv v53,v0,v23
v_lshlrev_b32 v0, 16, v54
v_and_b32 v23, 0xffff0000, v54
v_mul_f32 v0, v0, v21
v_mul_f32 v23, v23, v21
cv v54,v0,v23
v_lshlrev_b32 v0, 16, v55
v_and_b32 v23, 0xffff0000, v55
v_mul_f32 v0, v0, v21
v_mul_f32 v23, v23, v21
cv v55,v0,v23
v_mul_f32 v100, v100, v21
v_mul_f32 v101, v101, v21
v_mul_f32 v102, v102, v21
v_mul_f32 v103, v103, v21
v_mul_f32 v116, v116, v21
v_mul_f32 v117, v117, v21
v_mul_f32 v118, v118, v21
v_mul_f32 v119, v119, v21
v_mul_f32 v132, v132, v21
v_mul_f32 v133, v133, v21
v_mul_f32 v134, v134, v21
v_mul_f32 v135, v135, v21
v_mul_f32 v148, v148, v21
v_mul_f32 v149, v149, v21
v_mul_f32 v150, v150, v21
v_mul_f32 v151, v151, v21
v_mul_f32 v164, v164, v21
v_mul_f32 v165, v165, v21
v_mul_f32 v166, v166, v21
v_mul_f32 v167, v167, v21
v_mul_f32 v180, v180, v21
v_mul_f32 v181, v181, v21
v_mul_f32 v182, v182, v21
v_mul_f32 v183, v183, v21
v_mul_f32 v196, v196, v21
v_mul_f32 v197, v197, v21
v_mul_f32 v198, v198, v21
v_mul_f32 v199, v199, v21
v_mul_f32 v212, v212, v21
v_mul_f32 v213, v213, v21
v_mul_f32 v214, v214, v21
v_mul_f32 v215, v215, v21
v_mul_f32 v228, v228, v21
v_mul_f32 v229, v229, v21
v_mul_f32 v230, v230, v21
v_mul_f32 v231, v231, v21
v_mul_f32 v244, v244, v21
v_mul_f32 v245, v245, v21
v_mul_f32 v246, v246, v21
v_mul_f32 v247, v247, v21
ar v23,a164
v_mul_f32 v23, v23, v21
aw a164,v23
ar v23,a165
v_mul_f32 v23, v23, v21
aw a165,v23
ar v23,a166
v_mul_f32 v23, v23, v21
aw a166,v23
ar v23,a167
v_mul_f32 v23, v23, v21
aw a167,v23
ar v23,a180
v_mul_f32 v23, v23, v21
aw a180,v23
ar v23,a181
v_mul_f32 v23, v23, v21
aw a181,v23
ar v23,a182
v_mul_f32 v23, v23, v21
aw a182,v23
ar v23,a183
v_mul_f32 v23, v23, v21
aw a183,v23
ar v23,a196
v_mul_f32 v23, v23, v21
aw a196,v23
ar v23,a197
v_mul_f32 v23, v23, v21
aw a197,v23
ar v23,a198
v_mul_f32 v23, v23, v21
aw a198,v23
ar v23,a199
v_mul_f32 v23, v23, v21
aw a199,v23
ar v23,a212
v_mul_f32 v23, v23, v21
aw a212,v23
ar v23,a213
v_mul_f32 v23, v23, v21
aw a213,v23
ar v23,a214
v_mul_f32 v23, v23, v21
aw a214,v23
ar v23,a215
v_mul_f32 v23, v23, v21
aw a215,v23
ar v23,a228
v_mul_f32 v23, v23, v21
aw a228,v23
ar v23,a229
v_mul_f32 v23, v23, v21
aw a229,v23
ar v23,a230
v_mul_f32 v23, v23, v21
aw a230,v23
ar v23,a231
v_mul_f32 v23, v23, v21
aw a231,v23
ar v23,a244
v_mul_f32 v23, v23, v21
aw a244,v23
ar v23,a245
v_mul_f32 v23, v23, v21
aw a245,v23
ar v23,a246
v_mul_f32 v23, v23, v21
aw a246,v23
ar v23,a247
v_mul_f32 v23, v23, v21
aw a247,v23
v_max3_f32 v0, v72, v73, v74
v_max3_f32 v0, v0, v75, v88
v_max3_f32 v0, v0, v89, v90
v_max_f32 v0, v0, v91
v_mov_b32 v23, v0
s_nop 1
v_permlane32_swap_b32 v0, v23
v_max_f32 v0, v0, v23
v_mov_b32 v23, v0
s_nop 1
v_permlane16_swap_b32 v0, v23
v_max_f32 v0, v0, v23
v_ceil_f32 v0, v0
v_max_f32 v0, 0, v0
v_exp_f32 v21, -v0
v_sub_f32 v40, v40, v0
v_sub_f32 v41, v41, v0
v_sub_f32 v42, v42, v0
v_sub_f32 v43, v43, v0
v_sub_f32 v72, v72, v0
v_sub_f32 v73, v73, v0
v_sub_f32 v74, v74, v0
v_sub_f32 v75, v75, v0
v_sub_f32 v88, v88, v0
v_sub_f32 v89, v89, v0
v_sub_f32 v90, v90, v0
v_sub_f32 v91, v91, v0
v_exp_f32 v72, v72
v_exp_f32 v73, v73
s_nop 0
v_add_f32 v30, v72, v73
cv v72,v72,v73
v_exp_f32 v74, v74
v_exp_f32 v75, v75
v_add_f32 v30, v74, v30
v_add_f32 v30, v75, v30
cv v73,v74,v75
v_exp_f32 v88, v88
v_exp_f32 v89, v89
v_add_f32 v30, v88, v30
v_add_f32 v30, v89, v30
cv v74,v88,v89
v_exp_f32 v90, v90
v_exp_f32 v91, v91
v_add_f32 v30, v90, v30
v_add_f32 v30, v91, v30
cv v75,v90,v91
v_mul_f32 v26, v26, v21
v_lshlrev_b32 v0, 16, v56
v_and_b32 v23, 0xffff0000, v56
v_mul_f32 v0, v0, v21
v_mul_f32 v23, v23, v21
cv v56,v0,v23
v_lshlrev_b32 v0, 16, v57
v_and_b32 v23, 0xffff0000, v57
v_mul_f32 v0, v0, v21
v_mul_f32 v23, v23, v21
cv v57,v0,v23
v_lshlrev_b32 v0, 16, v58
v_and_b32 v23, 0xffff0000, v58
v_mul_f32 v0, v0, v21
v_mul_f32 v23, v23, v21
cv v58,v0,v23
v_lshlrev_b32 v0, 16, v59
v_and_b32 v23, 0xffff0000, v59
v_mul_f32 v0, v0, v21
v_mul_f32 v23, v23, v21
cv v59,v0,v23
v_mul_f32 v104, v104, v21
v_mul_f32 v105, v105, v21
v_mul_f32 v106, v106, v21
v_mul_f32 v107, v107, v21
v_mul_f32 v120, v120, v21
v_mul_f32 v121, v121, v21
v_mul_f32 v122, v122, v21
v_mul_f32 v123, v123, v21
v_mul_f32 v136, v136, v21
v_mul_f32 v137, v137, v21
v_mul_f32 v138, v138, v21
v_mul_f32 v139, v139, v21
v_mul_f32 v152, v152, v21
v_mul_f32 v153, v153, v21
v_mul_f32 v154, v154, v21
v_mul_f32 v155, v155, v21
v_mul_f32 v168, v168, v21
v_mul_f32 v169, v169, v21
v_mul_f32 v170, v170, v21
v_mul_f32 v171, v171, v21
v_mul_f32 v184, v184, v21
v_mul_f32 v185, v185, v21
v_mul_f32 v186, v186, v21
v_mul_f32 v187, v187, v21
v_mul_f32 v200, v200, v21
v_mul_f32 v201, v201, v21
v_mul_f32 v202, v202, v21
v_mul_f32 v203, v203, v21
v_mul_f32 v216, v216, v21
v_mul_f32 v217, v217, v21
v_mul_f32 v218, v218, v21
v_mul_f32 v219, v219, v21
v_mul_f32 v232, v232, v21
v_mul_f32 v233, v233, v21
v_mul_f32 v234, v234, v21
v_mul_f32 v235, v235, v21
v_mul_f32 v248, v248, v21
v_mul_f32 v249, v249, v21
v_mul_f32 v250, v250, v21
v_mul_f32 v251, v251, v21
ar v23,a168
v_mul_f32 v23, v23, v21
aw a168,v23
ar v23,a169
v_mul_f32 v23, v23, v21
aw a169,v23
ar v23,a170
v_mul_f32 v23, v23, v21
aw a170,v23
ar v23,a171
v_mul_f32 v23, v23, v21
aw a171,v23
ar v23,a184
v_mul_f32 v23, v23, v21
aw a184,v23
ar v23,a185
v_mul_f32 v23, v23, v21
aw a185,v23
ar v23,a186
v_mul_f32 v23, v23, v21
aw a186,v23
ar v23,a187
v_mul_f32 v23, v23, v21
aw a187,v23
ar v23,a200
v_mul_f32 v23, v23, v21
aw a200,v23
ar v23,a201
v_mul_f32 v23, v23, v21
aw a201,v23
ar v23,a202
v_mul_f32 v23, v23, v21
aw a202,v23
ar v23,a203
v_mul_f32 v23, v23, v21
aw a203,v23
ar v23,a216
v_mul_f32 v23, v23, v21
aw a216,v23
ar v23,a217
v_mul_f32 v23, v23, v21
aw a217,v23
ar v23,a218
v_mul_f32 v23, v23, v21
aw a218,v23
ar v23,a219
v_mul_f32 v23, v23, v21
aw a219,v23
ar v23,a232
v_mul_f32 v23, v23, v21
aw a232,v23
ar v23,a233
v_mul_f32 v23, v23, v21
aw a233,v23
ar v23,a234
v_mul_f32 v23, v23, v21
aw a234,v23
ar v23,a235
v_mul_f32 v23, v23, v21
aw a235,v23
ar v23,a248
v_mul_f32 v23, v23, v21
aw a248,v23
ar v23,a249
v_mul_f32 v23, v23, v21
aw a249,v23
ar v23,a250
v_mul_f32 v23, v23, v21
aw a250,v23
ar v23,a251
v_mul_f32 v23, v23, v21
aw a251,v23
v_max3_f32 v0, v76, v77, v78
v_max3_f32 v0, v0, v79, v92
v_max3_f32 v0, v0, v93, v94
v_max_f32 v0, v0, v95
v_mov_b32 v23, v0
s_nop 1
v_permlane32_swap_b32 v0, v23
v_max_f32 v0, v0, v23
v_mov_b32 v23, v0
s_nop 1
v_permlane16_swap_b32 v0, v23
v_max_f32 v0, v0, v23
v_ceil_f32 v0, v0
v_max_f32 v0, 0, v0
v_exp_f32 v21, -v0
v_sub_f32 v44, v44, v0
v_sub_f32 v45, v45, v0
v_sub_f32 v46, v46, v0
v_sub_f32 v47, v47, v0
v_sub_f32 v76, v76, v0
v_sub_f32 v77, v77, v0
v_sub_f32 v78, v78, v0
v_sub_f32 v79, v79, v0
v_sub_f32 v92, v92, v0
v_sub_f32 v93, v93, v0
v_sub_f32 v94, v94, v0
v_sub_f32 v95, v95, v0
v_exp_f32 v76, v76
v_exp_f32 v77, v77
s_nop 0
v_add_f32 v31, v76, v77
cv v76,v76,v77
v_exp_f32 v78, v78
v_exp_f32 v79, v79
v_add_f32 v31, v78, v31
v_add_f32 v31, v79, v31
cv v77,v78,v79
v_exp_f32 v92, v92
v_exp_f32 v93, v93
v_add_f32 v31, v92, v31
v_add_f32 v31, v93, v31
cv v78,v92,v93
v_exp_f32 v94, v94
v_exp_f32 v95, v95
v_add_f32 v31, v94, v31
v_add_f32 v31, v95, v31
cv v79,v94,v95
v_mul_f32 v27, v27, v21
v_lshlrev_b32 v0, 16, v60
v_and_b32 v23, 0xffff0000, v60
v_mul_f32 v0, v0, v21
v_mul_f32 v23, v23, v21
cv v60,v0,v23
v_lshlrev_b32 v0, 16, v61
v_and_b32 v23, 0xffff0000, v61
v_mul_f32 v0, v0, v21
v_mul_f32 v23, v23, v21
cv v61,v0,v23
v_lshlrev_b32 v0, 16, v62
v_and_b32 v23, 0xffff0000, v62
v_mul_f32 v0, v0, v21
v_mul_f32 v23, v23, v21
cv v62,v0,v23
v_lshlrev_b32 v0, 16, v63
v_and_b32 v23, 0xffff0000, v63
v_mul_f32 v0, v0, v21
v_mul_f32 v23, v23, v21
cv v63,v0,v23
v_mul_f32 v108, v108, v21
v_mul_f32 v109, v109, v21
v_mul_f32 v110, v110, v21
v_mul_f32 v111, v111, v21
v_mul_f32 v124, v124, v21
v_mul_f32 v125, v125, v21
v_mul_f32 v126, v126, v21
v_mul_f32 v127, v127, v21
v_mul_f32 v140, v140, v21
v_mul_f32 v141, v141, v21
v_mul_f32 v142, v142, v21
v_mul_f32 v143, v143, v21
v_mul_f32 v156, v156, v21
v_mul_f32 v157, v157, v21
v_mul_f32 v158, v158, v21
v_mul_f32 v159, v159, v21
v_mul_f32 v172, v172, v21
v_mul_f32 v173, v173, v21
v_mul_f32 v174, v174, v21
v_mul_f32 v175, v175, v21
v_mul_f32 v188, v188, v21
v_mul_f32 v189, v189, v21
v_mul_f32 v190, v190, v21
v_mul_f32 v191, v191, v21
v_mul_f32 v204, v204, v21
v_mul_f32 v205, v205, v21
v_mul_f32 v206, v206, v21
v_mul_f32 v207, v207, v21
v_mul_f32 v220, v220, v21
v_mul_f32 v221, v221, v21
v_mul_f32 v222, v222, v21
v_mul_f32 v223, v223, v21
v_mul_f32 v236, v236, v21
v_mul_f32 v237, v237, v21
v_mul_f32 v238, v238, v21
v_mul_f32 v239, v239, v21
v_mul_f32 v252, v252, v21
v_mul_f32 v253, v253, v21
v_mul_f32 v254, v254, v21
v_mul_f32 v255, v255, v21
ar v23,a172
v_mul_f32 v23, v23, v21
aw a172,v23
ar v23,a173
v_mul_f32 v23, v23, v21
aw a173,v23
ar v23,a174
v_mul_f32 v23, v23, v21
aw a174,v23
ar v23,a175
v_mul_f32 v23, v23, v21
aw a175,v23
ar v23,a188
v_mul_f32 v23, v23, v21
aw a188,v23
ar v23,a189
v_mul_f32 v23, v23, v21
aw a189,v23
ar v23,a190
v_mul_f32 v23, v23, v21
aw a190,v23
ar v23,a191
v_mul_f32 v23, v23, v21
aw a191,v23
ar v23,a204
v_mul_f32 v23, v23, v21
aw a204,v23
ar v23,a205
v_mul_f32 v23, v23, v21
aw a205,v23
ar v23,a206
v_mul_f32 v23, v23, v21
aw a206,v23
ar v23,a207
v_mul_f32 v23, v23, v21
aw a207,v23
ar v23,a220
v_mul_f32 v23, v23, v21
aw a220,v23
ar v23,a221
v_mul_f32 v23, v23, v21
aw a221,v23
ar v23,a222
v_mul_f32 v23, v23, v21
aw a222,v23
ar v23,a223
v_mul_f32 v23, v23, v21
aw a223,v23
ar v23,a236
v_mul_f32 v23, v23, v21
aw a236,v23
ar v23,a237
v_mul_f32 v23, v23, v21
aw a237,v23
ar v23,a238
v_mul_f32 v23, v23, v21
aw a238,v23
ar v23,a239
v_mul_f32 v23, v23, v21
aw a239,v23
ar v23,a252
v_mul_f32 v23, v23, v21
aw a252,v23
ar v23,a253
v_mul_f32 v23, v23, v21
aw a253,v23
ar v23,a254
v_mul_f32 v23, v23, v21
aw a254,v23
ar v23,a255
v_mul_f32 v23, v23, v21
aw a255,v23
ar v21,a128
s_nop 3
s_setpc_b64 s[84:85]
Lslowh_a:
s_nop 15
v_bfe_u32 v0, v1, 4, 4
v_lshrrev_b32 v23, 8, v1
v_lshlrev_b32 v23, 4, v23
v_lshl_add_u32 v0, v0, 9, v23
s_add_u32 s72, s43, 0
buffer_load_dwordx4 a[144:147], v0, s[12:15], s72 offen offset:0
buffer_load_dwordx4 a[148:151], v0, s[12:15], s72 offen offset:64
buffer_load_dwordx4 a[152:155], v0, s[12:15], s72 offen offset:128
buffer_load_dwordx4 a[156:159], v0, s[12:15], s72 offen offset:192
s_waitcnt vmcnt(0)
mz v[48:51],a[144:147],a[0:3],v[32:35]
mf v[48:51],a[148:151],a[16:19]
mf v[48:51],a[152:155],a[32:35]
mf v[48:51],a[156:159],a[48:51]
mz v[52:55],a[144:147],a[4:7],v[36:39]
mf v[52:55],a[148:151],a[20:23]
mf v[52:55],a[152:155],a[36:39]
mf v[52:55],a[156:159],a[52:55]
mz v[56:59],a[144:147],a[8:11],v[40:43]
mf v[56:59],a[148:151],a[24:27]
mf v[56:59],a[152:155],a[40:43]
mf v[56:59],a[156:159],a[56:59]
mz v[60:63],a[144:147],a[12:15],v[44:47]
mf v[60:63],a[148:151],a[28:31]
mf v[60:63],a[152:155],a[44:47]
mf v[60:63],a[156:159],a[60:63]
s_nop 7
buffer_load_dwordx4 a[144:147], v0, s[12:15], s72 offen offset:256
buffer_load_dwordx4 a[148:151], v0, s[12:15], s72 offen offset:320
buffer_load_dwordx4 a[152:155], v0, s[12:15], s72 offen offset:384
buffer_load_dwordx4 a[156:159], v0, s[12:15], s72 offen offset:448
s_waitcnt vmcnt(0)
mf v[48:51],a[144:147],a[64:67]
mf v[48:51],a[148:151],a[80:83]
mf v[48:51],a[152:155],a[96:99]
mf v[48:51],a[156:159],a[112:115]
mf v[52:55],a[144:147],a[68:71]
mf v[52:55],a[148:151],a[84:87]
mf v[52:55],a[152:155],a[100:103]
mf v[52:55],a[156:159],a[116:119]
mf v[56:59],a[144:147],a[72:75]
mf v[56:59],a[148:151],a[88:91]
mf v[56:59],a[152:155],a[104:107]
mf v[56:59],a[156:159],a[120:123]
mf v[60:63],a[144:147],a[76:79]
mf v[60:63],a[148:151],a[92:95]
mf v[60:63],a[152:155],a[108:111]
mf v[60:63],a[156:159],a[124:127]
s_nop 7
s_add_u32 s72, s43, 8192
buffer_load_dwordx4 a[144:147], v0, s[12:15], s72 offen offset:0
buffer_load_dwordx4 a[148:151], v0, s[12:15], s72 offen offset:64
buffer_load_dwordx4 a[152:155], v0, s[12:15], s72 offen offset:128
buffer_load_dwordx4 a[156:159], v0, s[12:15], s72 offen offset:192
s_waitcnt vmcnt(0)
mz v[80:83],a[144:147],a[0:3],v[32:35]
mf v[80:83],a[148:151],a[16:19]
mf v[80:83],a[152:155],a[32:35]
mf v[80:83],a[156:159],a[48:51]
mz v[84:87],a[144:147],a[4:7],v[36:39]
mf v[84:87],a[148:151],a[20:23]
mf v[84:87],a[152:155],a[36:39]
mf v[84:87],a[156:159],a[52:55]
mz v[88:91],a[144:147],a[8:11],v[40:43]
mf v[88:91],a[148:151],a[24:27]
mf v[88:91],a[152:155],a[40:43]
mf v[88:91],a[156:159],a[56:59]
mz v[92:95],a[144:147],a[12:15],v[44:47]
mf v[92:95],a[148:151],a[28:31]
mf v[92:95],a[152:155],a[44:47]
mf v[92:95],a[156:159],a[60:63]
s_nop 7
buffer_load_dwordx4 a[144:147], v0, s[12:15], s72 offen offset:256
buffer_load_dwordx4 a[148:151], v0, s[12:15], s72 offen offset:320
buffer_load_dwordx4 a[152:155], v0, s[12:15], s72 offen offset:384
buffer_load_dwordx4 a[156:159], v0, s[12:15], s72 offen offset:448
s_waitcnt vmcnt(0)
mf v[80:83],a[144:147],a[64:67]
mf v[80:83],a[148:151],a[80:83]
mf v[80:83],a[152:155],a[96:99]
mf v[80:83],a[156:159],a[112:115]
mf v[84:87],a[144:147],a[68:71]
mf v[84:87],a[148:151],a[84:87]
mf v[84:87],a[152:155],a[100:103]
mf v[84:87],a[156:159],a[116:119]
mf v[88:91],a[144:147],a[72:75]
mf v[88:91],a[148:151],a[88:91]
mf v[88:91],a[152:155],a[104:107]
mf v[88:91],a[156:159],a[120:123]
mf v[92:95],a[144:147],a[76:79]
mf v[92:95],a[148:151],a[92:95]
mf v[92:95],a[152:155],a[108:111]
mf v[92:95],a[156:159],a[124:127]
s_nop 7
s_nop 15
aw a144,v21
v_max3_f32 v0, v48, v49, v50
v_max3_f32 v0, v0, v51, v80
v_max3_f32 v0, v0, v81, v82
v_max_f32 v0, v0, v83
v_mov_b32 v23, v0
s_nop 1
v_permlane32_swap_b32 v0, v23
v_max_f32 v0, v0, v23
v_mov_b32 v23, v0
s_nop 1
v_permlane16_swap_b32 v0, v23
v_max_f32 v0, v0, v23
v_ceil_f32 v0, v0
v_sub_f32 v32, v32, v0
v_sub_f32 v33, v33, v0
v_sub_f32 v34, v34, v0
v_sub_f32 v35, v35, v0
v_sub_f32 v48, v48, v0
v_sub_f32 v49, v49, v0
v_sub_f32 v50, v50, v0
v_sub_f32 v51, v51, v0
v_sub_f32 v80, v80, v0
v_sub_f32 v81, v81, v0
v_sub_f32 v82, v82, v0
v_sub_f32 v83, v83, v0
v_sub_f32 v64, v64, v0
v_sub_f32 v65, v65, v0
v_sub_f32 v66, v66, v0
v_sub_f32 v67, v67, v0
v_exp_f32 v48, v48
v_exp_f32 v49, v49
s_nop 0
v_add_f32 v24, v48, v49
cv v48,v48,v49
v_exp_f32 v50, v50
v_exp_f32 v51, v51
v_add_f32 v24, v50, v24
v_add_f32 v24, v51, v24
cv v49,v50,v51
v_exp_f32 v80, v80
v_exp_f32 v81, v81
v_add_f32 v24, v80, v24
v_add_f32 v24, v81, v24
cv v50,v80,v81
v_exp_f32 v82, v82
v_exp_f32 v83, v83
v_add_f32 v24, v82, v24
v_add_f32 v24, v83, v24
cv v51,v82,v83
v_max3_f32 v0, v52, v53, v54
v_max3_f32 v0, v0, v55, v84
v_max3_f32 v0, v0, v85, v86
v_max_f32 v0, v0, v87
v_mov_b32 v23, v0
s_nop 1
v_permlane32_swap_b32 v0, v23
v_max_f32 v0, v0, v23
v_mov_b32 v23, v0
s_nop 1
v_permlane16_swap_b32 v0, v23
v_max_f32 v0, v0, v23
v_ceil_f32 v0, v0
v_sub_f32 v36, v36, v0
v_sub_f32 v37, v37, v0
v_sub_f32 v38, v38, v0
v_sub_f32 v39, v39, v0
v_sub_f32 v52, v52, v0
v_sub_f32 v53, v53, v0
v_sub_f32 v54, v54, v0
v_sub_f32 v55, v55, v0
v_sub_f32 v84, v84, v0
v_sub_f32 v85, v85, v0
v_sub_f32 v86, v86, v0
v_sub_f32 v87, v87, v0
v_sub_f32 v68, v68, v0
v_sub_f32 v69, v69, v0
v_sub_f32 v70, v70, v0
v_sub_f32 v71, v71, v0
v_exp_f32 v52, v52
v_exp_f32 v53, v53
s_nop 0
v_add_f32 v25, v52, v53
cv v52,v52,v53
v_exp_f32 v54, v54
v_exp_f32 v55, v55
v_add_f32 v25, v54, v25
v_add_f32 v25, v55, v25
cv v53,v54,v55
v_exp_f32 v84, v84
v_exp_f32 v85, v85
v_add_f32 v25, v84, v25
v_add_f32 v25, v85, v25
cv v54,v84,v85
v_exp_f32 v86, v86
v_exp_f32 v87, v87
v_add_f32 v25, v86, v25
v_add_f32 v25, v87, v25
cv v55,v86,v87
v_max3_f32 v0, v56, v57, v58
v_max3_f32 v0, v0, v59, v88
v_max3_f32 v0, v0, v89, v90
v_max_f32 v0, v0, v91
v_mov_b32 v23, v0
s_nop 1
v_permlane32_swap_b32 v0, v23
v_max_f32 v0, v0, v23
v_mov_b32 v23, v0
s_nop 1
v_permlane16_swap_b32 v0, v23
v_max_f32 v0, v0, v23
v_ceil_f32 v0, v0
v_sub_f32 v40, v40, v0
v_sub_f32 v41, v41, v0
v_sub_f32 v42, v42, v0
v_sub_f32 v43, v43, v0
v_sub_f32 v56, v56, v0
v_sub_f32 v57, v57, v0
v_sub_f32 v58, v58, v0
v_sub_f32 v59, v59, v0
v_sub_f32 v88, v88, v0
v_sub_f32 v89, v89, v0
v_sub_f32 v90, v90, v0
v_sub_f32 v91, v91, v0
v_sub_f32 v72, v72, v0
v_sub_f32 v73, v73, v0
v_sub_f32 v74, v74, v0
v_sub_f32 v75, v75, v0
v_exp_f32 v56, v56
v_exp_f32 v57, v57
s_nop 0
v_add_f32 v26, v56, v57
cv v56,v56,v57
v_exp_f32 v58, v58
v_exp_f32 v59, v59
v_add_f32 v26, v58, v26
v_add_f32 v26, v59, v26
cv v57,v58,v59
v_exp_f32 v88, v88
v_exp_f32 v89, v89
v_add_f32 v26, v88, v26
v_add_f32 v26, v89, v26
cv v58,v88,v89
v_exp_f32 v90, v90
v_exp_f32 v91, v91
v_add_f32 v26, v90, v26
v_add_f32 v26, v91, v26
cv v59,v90,v91
v_max3_f32 v0, v60, v61, v62
v_max3_f32 v0, v0, v63, v92
v_max3_f32 v0, v0, v93, v94
v_max_f32 v0, v0, v95
v_mov_b32 v23, v0
s_nop 1
v_permlane32_swap_b32 v0, v23
v_max_f32 v0, v0, v23
v_mov_b32 v23, v0
s_nop 1
v_permlane16_swap_b32 v0, v23
v_max_f32 v0, v0, v23
v_ceil_f32 v0, v0
v_sub_f32 v44, v44, v0
v_sub_f32 v45, v45, v0
v_sub_f32 v46, v46, v0
v_sub_f32 v47, v47, v0
v_sub_f32 v60, v60, v0
v_sub_f32 v61, v61, v0
v_sub_f32 v62, v62, v0
v_sub_f32 v63, v63, v0
v_sub_f32 v92, v92, v0
v_sub_f32 v93, v93, v0
v_sub_f32 v94, v94, v0
v_sub_f32 v95, v95, v0
v_sub_f32 v76, v76, v0
v_sub_f32 v77, v77, v0
v_sub_f32 v78, v78, v0
v_sub_f32 v79, v79, v0
v_exp_f32 v60, v60
v_exp_f32 v61, v61
s_nop 0
v_add_f32 v27, v60, v61
cv v60,v60,v61
v_exp_f32 v62, v62
v_exp_f32 v63, v63
v_add_f32 v27, v62, v27
v_add_f32 v27, v63, v27
cv v61,v62,v63
v_exp_f32 v92, v92
v_exp_f32 v93, v93
v_add_f32 v27, v92, v27
v_add_f32 v27, v93, v27
cv v62,v92,v93
v_exp_f32 v94, v94
v_exp_f32 v95, v95
v_add_f32 v27, v94, v27
v_add_f32 v27, v95, v27
cv v63,v94,v95
ar v21,a144
s_nop 3
s_setpc_b64 s[84:85]
L_exit:
s_endpgm
.p2align 5
L_main3:
s_add_u32 m0, s46, 16384
s_add_u32 s39, s47, 128
buffer_load_dwordx4 v13, s[8:11], s39 offen lds
s_add_u32 m0, s46, 17408
s_add_u32 s39, s47, 65664
buffer_load_dwordx4 v13, s[8:11], s39 offen lds
v_and_b32 v0, 63, v0
v_lshlrev_b32 v1, 4, v0
v_lshl_add_u32 v2, v24, 9, v37
s_lshl_b32 s33, s32, 12
v_mul_u32_u24 v28, 896, v24
v_add_u32 v3, v28, v27
v_and_b32 v28, 15, v0
v_bfe_u32 v29, v0, 2, 2
v_and_b32 v30, 3, v0
v_lshrrev_b32 v31, 3, v28
v_and_b32 v32, 7, v28
v_lshlrev_b32 v32, 7, v32
v_and_b32 v33, 6, v28
v_xor_b32 v33, v33, v26
v_lshl_add_u32 v32, v33, 4, v32
v_lshl_add_u32 v5, v31, 12, v32
v_xor_b32 v6, 64, v5
v_lshl_add_u32 v32, v31, 10, v32
v_add_u32 v21, s50, v32
v_xor_b32 v22, 64, v21
v_lshrrev_b32 v31, 1, v26
v_and_b32 v32, 1, v26
v_lshl_add_u32 v33, v32, 2, v29
v_lshlrev_b32 v34, 12, v31
v_lshl_add_u32 v34, v33, 7, v34
v_lshl_add_u32 v34, v30, 3, v34
v_lshrrev_b32 v35, 1, v33
v_lshl_add_u32 v7, v35, 5, v34
v_xor_b32 v8, 32, v7
v_xor_b32 v9, 64, v7
v_xor_b32 v10, 96, v7
v_lshrrev_b32 v35, 1, v29
v_lshl_add_u32 v35, v35, 2, v30
v_lshlrev_b32 v35, 4, v35
v_lshl_add_u32 v36, v26, 10, v35
v_lshl_add_u32 v11, v29, 7, v36
v_xor_b32 v12, 64, v11
v_lshl_add_u32 v36, v31, 10, v35
v_lshl_add_u32 v36, v33, 7, v36
s_and_b32 s74, s77, 1
v_lshl_add_u32 v15, s74, 3, v36
v_xor_b32 v16, 64, v15
v_lshl_add_u32 v36, v39, 15, v1
v_add_u32 v4, 65536, v36
s_mul_i32 s45, s32, 28672
s_mov_b32 s34, -4096
s_mov_b32 s35, -4096
s_mov_b32 s43, 0
s_mov_b32 s36, 0x53800000
s_mov_b32 s55, 0x2b800000
s_mov_b32 s37, 0x3db8aa3b
s_lshl_b32 s40, s32, 16
s_add_u32 s40, s40, s75
s_mov_b32 s41, 0
s_mov_b32 s42, 0
s_mov_b32 s24, s33
s_add_u32 s25, s33, 0x10000
s_mov_b32 s53, 0x40000000
s_mov_b32 s49, 0x40000
s_add_u32 s51, s54, 524288
s_cmp_eq_u32 s51, 3670016
s_cselect_b32 s51, 0, s51
wl
s_lshl_b32 s72, s79, 22
s_lshl_b32 s73, s77, 19
s_add_u32 s72, s72, s73
s_add_u32 s12, s62, s72
s_addc_u32 s13, s63, 0
s_and_b32 s13, s13, 0xffff
s_mov_b32 s14, 524288
s_mov_b32 s15, 0x20000
s_add_u32 s16, s64, s72
s_addc_u32 s17, s65, 0
s_and_b32 s17, s17, 0xffff
s_mov_b32 s18, 524288
s_mov_b32 s19, 0x20000
s_mul_i32 s72, s77, 458752
s_add_u32 s20, s68, s72
s_addc_u32 s21, s69, 0
s_and_b32 s21, s21, 0xffff
s_mov_b32 s22, 458752
s_mov_b32 s23, 0x20000
s_mul_i32 s72, s76, 2658304
s_add_u32 s28, s70, s72
s_addc_u32 s29, s71, 0
s_and_b32 s29, s29, 0xffff
s_mov_b32 s30, 2621440
s_mov_b32 s31, 0x20000
s_add_u32 s92, s84, 0
s_addc_u32 s93, s85, 0
s_and_b32 s93, s93, 0xffff
s_mov_b32 s94, 6881280
s_mov_b32 s95, 0x20000
s_add_u32 s96, s86, 0
s_addc_u32 s97, s87, 0
s_and_b32 s97, s97, 0xffff
s_mov_b32 s98, 256
s_mov_b32 s99, 0x20000
s_lshl_b32 s72, s77, 2
s_add_u32 s72, s72, s32
s_lshl_b32 s26, s72, 13
s_lshr_b32 s73, s72, 1
s_mul_i32 s74, s79, 15
s_add_u32 s73, s73, s74
s_mul_i32 s73, s73, 28672
s_mul_i32 s74, s78, 896
s_add_u32 s73, s73, s74
s_and_b32 s74, s72, 1
s_lshl_b32 s74, s74, 6
s_add_u32 s27, s73, s74
s_cmp_lt_u32 s72, 30
s_cselect_b32 s26, s26, 0x40000000
s_cselect_b32 s27, s27, 0x40000000
s_lshl_b32 s72, s72, 2
s_add_u32 s72, s72, 2359296
v_min_u32 v41, 1, v0
v_lshl_add_u32 v17, v41, 30, s72
s_mul_i32 s56, s79, 28672
s_lshl_b32 s68, s77, 15
s_lshl_b32 s57, s77, 4
s_add_u32 s57, s57, 2359296
s_lshl_b32 s90, s76, 2
s_getreg_b32 s72, hwreg(HW_REG_XCC_ID, 0, 3)
s_lshl_b32 s72, s72, 2
s_lshl_b32 s91, 1, s72
s_add_u32 s52, s51, 524288
s_cmp_eq_u32 s52, 3670016
s_cselect_b32 s52, 0, s52
s_add_u32 s48, s52, 524288
s_cmp_eq_u32 s48, 3670016
s_cselect_b32 s48, 0, s48
s_add_u32 s69, s48, 524288
s_cmp_eq_u32 s69, 3670016
s_cselect_b32 s69, 0, s69
s_add_u32 s70, s69, 524288
s_cmp_eq_u32 s70, 3670016
s_cselect_b32 s70, 0, s70
s_add_u32 s71, s70, 524288
s_cmp_eq_u32 s71, 3670016
s_cselect_b32 s71, 0, s71
s_and_b32 s72, s32, 1
s_lshl_b32 s72, s72, 18
s_cmp_lt_u32 s32, 2
s_cselect_b32 s44, s51, s52
s_cselect_b32 s86, s48, s69
s_cselect_b32 s87, s70, s71
s_cselect_b32 s85, s54, s51
s_add_u32 s85, s85, s72
s_add_u32 s44, s44, s72
s_add_u32 s86, s86, s72
s_add_u32 s87, s87, s72
s_lshr_b32 s38, s51, 12
s_add_u32 m0, s50, 8192
s_add_u32 s39, s38, 0
buffer_load_dwordx4 v14, s[4:7], s39 offen lds
s_add_u32 m0, s50, 9216
s_add_u32 s39, s38, 7168
buffer_load_dwordx4 v14, s[4:7], s39 offen lds
s_add_u32 m0, s50, 10240
s_add_u32 s39, s38, 14336
buffer_load_dwordx4 v14, s[4:7], s39 offen lds
s_add_u32 m0, s50, 11264
s_add_u32 s39, s38, 21504
buffer_load_dwordx4 v14, s[4:7], s39 offen lds
s_waitcnt vmcnt(12)
s_barrier
tr a[96:97],v11,0
tr a[98:99],v11,512
tr a[100:101],v11,4096
tr a[102:103],v11,4608
tr a[104:105],v11,4104
tr a[106:107],v11,4616
tr a[108:109],v11,8
tr a[110:111],v11,520
s_waitcnt vmcnt(6)
ds_read_b128 v[80:83], v21 offset:0
ds_read_b128 v[92:95], v22 offset:0
ds_read_b128 v[84:87], v21 offset:2048
ds_read_b128 v[96:99], v22 offset:2048
ds_read_b128 v[88:91], v21 offset:4096
ds_read_b128 v[100:103], v22 offset:4096
wl
mz v[32:35],a[96:99],v[80:83],0
s_add_u32 m0, s50, 12288
s_add_u32 s39, s38, 28672
buffer_load_dwordx4 v14, s[4:7], s39 offen lds
tr a[112:113],v12,0
mf v[32:35],a[100:103],v[92:95]
s_add_u32 m0, s50, 13312
s_add_u32 s39, s38, 35840
buffer_load_dwordx4 v14, s[4:7], s39 offen lds
tr a[114:115],v12,512
mz v[44:47],a[104:107],v[92:95],0
s_lshr_b32 s38, s52, 12
s_add_u32 m0, s50, 16384
tr a[116:117],v12,4096
mf v[44:47],a[108:111],v[80:83]
s_add_u32 s39, s38, 0
buffer_load_dwordx4 v14, s[4:7], s39 offen lds
tr a[118:119],v12,4608
mz v[48:51],a[108:111],v[84:87],0
s_add_u32 m0, s50, 17408
s_add_u32 s39, s38, 7168
buffer_load_dwordx4 v14, s[4:7], s39 offen lds
tr a[120:121],v12,4104
mf v[48:51],a[104:107],v[96:99]
s_add_u32 m0, s50, 18432
tr a[122:123],v12,4616
mz v[36:39],a[100:103],v[96:99],0
s_add_u32 s39, s38, 14336
buffer_load_dwordx4 v14, s[4:7], s39 offen lds
tr a[124:125],v12,8
mf v[36:39],a[96:99],v[84:87]
s_add_u32 m0, s50, 19456
s_add_u32 s39, s38, 21504
buffer_load_dwordx4 v14, s[4:7], s39 offen lds
tr a[126:127],v12,520
mz v[40:43],a[96:99],v[88:91],0
s_add_u32 m0, s50, 20480
v_min_u32 v159, 48, v1
v_lshlrev_b32 v159, 3, v159
mf v[40:43],a[100:103],v[100:103]
s_add_u32 s39, s38, 28672
buffer_load_dwordx4 v14, s[4:7], s39 offen lds
mz v[52:55],a[104:107],v[100:103],0
s_add_u32 m0, s50, 21504
s_add_u32 s39, s38, 35840
buffer_load_dwordx4 v14, s[4:7], s39 offen lds
mf v[52:55],a[108:111],v[88:91]
s_add_u32 m0, s33, 32768
v_add_u32 v152, 2688, v2
wl
mz v[76:79],a[124:127],v[88:91],0
s_add_u32 s39, s44, 0
buffer_load_dwordx4 v13, s[8:11], s39 offen lds
s_waitcnt vmcnt(13)
s_barrier
mf v[76:79],a[120:123],v[100:103]
s_add_u32 m0, s33, 33792
s_add_u32 s39, s44, 65536
buffer_load_dwordx4 v13, s[8:11], s39 offen lds
tr a[96:97],v11,16384
mz v[64:67],a[116:119],v[100:103],0
s_add_u32 m0, s33, 34816
tr a[98:99],v11,16896
mf v[64:67],a[112:115],v[88:91]
s_add_u32 s39, s44, 131072
buffer_load_dwordx4 v13, s[8:11], s39 offen lds
tr a[100:101],v11,20480
mz v[60:63],a[112:115],v[84:87],0
s_add_u32 m0, s33, 35840
s_add_u32 s39, s44, 196608
buffer_load_dwordx4 v13, s[8:11], s39 offen lds
tr a[102:103],v11,20992
mf v[60:63],a[116:119],v[96:99]
s_add_u32 m0, s33, 49152
tr a[104:105],v11,20488
mz v[72:75],a[120:123],v[96:99],0
s_add_u32 s39, s44, 128
buffer_load_dwordx4 v13, s[8:11], s39 offen lds
tr a[106:107],v11,21000
mf v[72:75],a[124:127],v[84:87]
s_add_u32 m0, s33, 50176
tr a[108:109],v11,16392
mz v[68:71],a[124:127],v[80:83],0
s_add_u32 s39, s44, 65664
buffer_load_dwordx4 v13, s[8:11], s39 offen lds
tr a[110:111],v11,16904
mf v[68:71],a[120:123],v[92:95]
s_add_u32 m0, s33, 51200
v_add_u32 v153, 1792, v2
v_add_u32 v154, 896, v2
mz v[56:59],a[116:119],v[92:95],0
s_add_u32 s39, s44, 131200
buffer_load_dwordx4 v13, s[8:11], s39 offen lds
mf v[56:59],a[112:115],v[80:83]
s_add_u32 m0, s33, 52224
v_add_u32 v155, 0, v2
wl
mz v[160:163],a[96:99],v[80:83],0
tr a[112:113],v12,16384
v_add_u32 v156, 64512, v13
mf v[160:163],a[100:103],v[92:95]
s_add_u32 s39, s44, 196736
buffer_load_dwordx4 v13, s[8:11], s39 offen lds
tr a[114:115],v12,16896
mz v[172:175],a[104:107],v[92:95],0
s_lshr_b32 s38, s48, 12
s_add_u32 m0, s50, 0
tr a[116:117],v12,20480
mf v[172:175],a[108:111],v[80:83]
s_add_u32 s39, s38, 0
buffer_load_dwordx4 v14, s[4:7], s39 offen lds
tr a[118:119],v12,20992
mz v[176:179],a[108:111],v[84:87],0
s_add_u32 m0, s50, 1024
tr a[120:121],v12,20488
mf v[176:179],a[104:107],v[96:99]
tr a[122:123],v12,21000
v_add_u32 v157, 129024, v13
mz v[164:167],a[100:103],v[96:99],0
s_add_u32 s39, s38, 7168
buffer_load_dwordx4 v14, s[4:7], s39 offen lds
tr a[124:125],v12,16392
mf v[164:167],a[96:99],v[84:87]
tr a[126:127],v12,16904
s_waitcnt vmcnt(16)
mz v[168:171],a[96:99],v[88:91],0
s_add_u32 m0, s50, 2048
s_add_u32 s39, s38, 14336
buffer_load_dwordx4 v14, s[4:7], s39 offen lds
mf v[168:171],a[100:103],v[100:103]
ds_read_b128 v[104:107], v21 offset:8192
ds_read_b128 v[116:119], v22 offset:8192
ds_read_b128 v[108:111], v21 offset:10240
ds_read_b128 v[120:123], v22 offset:10240
ds_read_b128 v[112:115], v21 offset:12288
ds_read_b128 v[124:127], v22 offset:12288
mz v[180:183],a[104:107],v[100:103],0
s_add_u32 m0, s50, 3072
s_add_u32 s39, s38, 21504
buffer_load_dwordx4 v14, s[4:7], s39 offen lds
mf v[180:183],a[108:111],v[88:91]
s_add_u32 m0, s50, 4096
v_add_u32 v158, 193536, v13
wl
mz v[204:207],a[124:127],v[88:91],0
s_sub_u32 s60, s12, 2688
s_subb_u32 s61, s13, 0
s_mov_b32 s62, 526976
s_mov_b32 s63, 0x20000
s_waitcnt vmcnt(8)
s_barrier
mf v[204:207],a[120:123],v[100:103]
s_add_u32 s39, s38, 28672
buffer_load_dwordx4 v14, s[4:7], s39 offen lds
tr a[96:97],v11,32768
mz v[192:195],a[116:119],v[100:103],0
s_add_u32 m0, s50, 5120
tr a[98:99],v11,33280
mf v[192:195],a[112:115],v[88:91]
s_add_u32 s39, s38, 35840
buffer_load_dwordx4 v14, s[4:7], s39 offen lds
tr a[100:101],v11,36864
mz v[188:191],a[112:115],v[84:87],0
s_sub_u32 s64, s16, 2688
s_subb_u32 s65, s17, 0
s_mov_b32 s66, 526976
s_mov_b32 s67, 0x20000
tr a[102:103],v11,37376
mf v[188:191],a[116:119],v[96:99]
tr a[104:105],v11,40960
mz v[200:203],a[120:123],v[96:99],0
tr a[106:107],v11,41472
mf v[200:203],a[124:127],v[84:87]
tr a[108:109],v11,45056
mz v[196:199],a[124:127],v[80:83],0
tr a[110:111],v11,45568
s_waitcnt vmcnt(14)
mf v[196:199],a[120:123],v[92:95]
ds_read_b128 v[128:131], v21 offset:16384
ds_read_b128 v[140:143], v22 offset:16384
ds_read_b128 v[132:135], v21 offset:18432
ds_read_b128 v[144:147], v22 offset:18432
ds_read_b128 v[136:139], v21 offset:20480
ds_read_b128 v[148:151], v22 offset:20480
mz v[184:187],a[116:119],v[92:95],0
s_add_u32 m0, s33, 0
mf v[184:187],a[112:115],v[80:83]
wl
mf v[32:35],a[96:99],v[104:107]
s_add_u32 s39, s86, 0
buffer_load_dwordx4 v13, s[8:11], s39 offen lds
tr a[112:113],v11,32776
mf v[32:35],a[100:103],v[116:119]
s_add_u32 m0, s33, 1024
tr a[114:115],v11,33288
mf v[32:35],a[104:107],v[128:131]
s_add_u32 s39, s86, 65536
buffer_load_dwordx4 v13, s[8:11], s39 offen lds
tr a[116:117],v11,36872
mf v[32:35],a[108:111],v[140:143]
s_add_u32 m0, s33, 2048
tr a[118:119],v11,37384
mf v[36:39],a[108:111],v[144:147]
tr a[120:121],v11,40968
mf v[36:39],a[104:107],v[132:135]
s_add_u32 s39, s86, 131072
buffer_load_dwordx4 v13, s[8:11], s39 offen lds
tr a[122:123],v11,41480
mf v[36:39],a[100:103],v[120:123]
s_add_u32 m0, s33, 3072
tr a[124:125],v11,45064
mf v[36:39],a[96:99],v[108:111]
s_add_u32 s39, s86, 196608
buffer_load_dwordx4 v13, s[8:11], s39 offen lds
tr a[126:127],v11,45576
mf v[40:43],a[96:99],v[112:115]
s_lshr_b32 s38, s69, 12
s_add_u32 m0, s50, 8192
mf v[40:43],a[100:103],v[124:127]
mf v[40:43],a[104:107],v[136:139]
s_add_u32 s39, s38, 0
buffer_load_dwordx4 v14, s[4:7], s39 offen lds
mf v[40:43],a[108:111],v[148:151]
s_add_u32 m0, s50, 9216
wl
mf v[52:55],a[124:127],v[148:151]
s_add_u32 s39, s38, 7168
buffer_load_dwordx4 v14, s[4:7], s39 offen lds
tr a[96:97],v12,32768
mf v[52:55],a[120:123],v[136:139]
s_add_u32 m0, s50, 10240
tr a[98:99],v12,33280
mf v[52:55],a[116:119],v[124:127]
tr a[100:101],v12,36864
mf v[52:55],a[112:115],v[112:115]
s_add_u32 s39, s38, 14336
buffer_load_dwordx4 v14, s[4:7], s39 offen lds
tr a[102:103],v12,37376
mf v[48:51],a[112:115],v[108:111]
s_add_u32 m0, s50, 11264
tr a[104:105],v12,40960
mf v[48:51],a[116:119],v[120:123]
tr a[106:107],v12,41472
mf v[48:51],a[120:123],v[132:135]
s_add_u32 s39, s38, 21504
buffer_load_dwordx4 v14, s[4:7], s39 offen lds
tr a[108:109],v12,45056
mf v[48:51],a[124:127],v[144:147]
s_add_u32 m0, s50, 12288
tr a[110:111],v12,45568
mf v[44:47],a[124:127],v[140:143]
s_add_u32 s39, s38, 28672
buffer_load_dwordx4 v14, s[4:7], s39 offen lds
mf v[44:47],a[120:123],v[128:131]
s_add_u32 m0, s50, 13312
mf v[44:47],a[116:119],v[116:119]
mf v[44:47],a[112:115],v[104:107]
s_add_u32 s39, s38, 35840
buffer_load_dwordx4 v14, s[4:7], s39 offen lds
wl
mf v[56:59],a[96:99],v[104:107]
s_add_u32 m0, s33, 16384
tr a[112:113],v12,32776
mf v[56:59],a[100:103],v[116:119]
s_add_u32 s39, s86, 128
buffer_load_dwordx4 v13, s[8:11], s39 offen lds
tr a[114:115],v12,33288
mf v[56:59],a[104:107],v[128:131]
s_add_u32 m0, s33, 17408
tr a[116:117],v12,36872
mf v[56:59],a[108:111],v[140:143]
tr a[118:119],v12,37384
mf v[60:63],a[108:111],v[144:147]
s_add_u32 s39, s86, 65664
buffer_load_dwordx4 v13, s[8:11], s39 offen lds
tr a[120:121],v12,40968
mf v[60:63],a[104:107],v[132:135]
s_add_u32 m0, s33, 18432
tr a[122:123],v12,41480
mf v[60:63],a[100:103],v[120:123]
s_add_u32 s39, s86, 131200
buffer_load_dwordx4 v13, s[8:11], s39 offen lds
tr a[124:125],v12,45064
mf v[60:63],a[96:99],v[108:111]
s_add_u32 m0, s33, 19456
tr a[126:127],v12,45576
mf v[64:67],a[96:99],v[112:115]
mf v[64:67],a[100:103],v[124:127]
s_add_u32 s39, s86, 196736
buffer_load_dwordx4 v13, s[8:11], s39 offen lds
mf v[64:67],a[104:107],v[136:139]
mf v[64:67],a[108:111],v[148:151]
s_add_u32 m0, s33, 32768
wl
mf v[76:79],a[124:127],v[148:151]
s_waitcnt vmcnt(20)
s_barrier
mf v[76:79],a[120:123],v[136:139]
s_add_u32 s39, s87, 0
buffer_load_dwordx4 v13, s[8:11], s39 offen lds
tr a[96:97],v11,49152
mf v[76:79],a[116:119],v[124:127]
s_add_u32 m0, s33, 33792
tr a[98:99],v11,49664
mf v[76:79],a[112:115],v[112:115]
tr a[100:101],v11,53248
mf v[72:75],a[112:115],v[108:111]
tr a[102:103],v11,53760
mf v[72:75],a[116:119],v[120:123]
s_add_u32 s39, s87, 65536
buffer_load_dwordx4 v13, s[8:11], s39 offen lds
tr a[104:105],v11,57344
mf v[72:75],a[120:123],v[132:135]
s_mov_b32 s72, 425984
buffer_load_dword v20, v159, s[16:19], s72 offen
tr a[106:107],v11,57856
mf v[72:75],a[124:127],v[144:147]
s_add_u32 m0, s33, 34816
tr a[108:109],v11,61440
mf v[68:71],a[124:127],v[140:143]
tr a[110:111],v11,61952
mf v[68:71],a[120:123],v[128:131]
s_mov_b32 s72, 425984
buffer_load_dword v20, v159, s[12:15], s72 offen
mf v[68:71],a[116:119],v[116:119]
s_add_u32 s39, s87, 131072
buffer_load_dwordx4 v13, s[8:11], s39 offen lds
mf v[68:71],a[112:115],v[104:107]
s_add_u32 m0, s33, 35840
wl
mf v[160:163],a[96:99],v[104:107]
tr a[112:113],v11,49160
mf v[160:163],a[100:103],v[116:119]
tr a[114:115],v11,49672
mf v[160:163],a[104:107],v[128:131]
tr a[116:117],v11,53256
mf v[160:163],a[108:111],v[140:143]
s_mov_b32 s72, 409600
buffer_load_dword v20, v159, s[16:19], s72 offen
s_add_u32 s39, s87, 196608
buffer_load_dwordx4 v13, s[8:11], s39 offen lds
tr a[118:119],v11,53768
mf v[164:167],a[108:111],v[144:147]
s_lshr_b32 s38, s70, 12
s_add_u32 m0, s50, 16384
tr a[120:121],v11,57352
mf v[164:167],a[104:107],v[132:135]
tr a[122:123],v11,57864
mf v[164:167],a[100:103],v[120:123]
tr a[124:125],v11,61448
mf v[164:167],a[96:99],v[108:111]
s_mov_b32 s72, 409600
buffer_load_dword v20, v159, s[12:15], s72 offen
s_add_u32 s39, s38, 0
buffer_load_dwordx4 v14, s[4:7], s39 offen lds
tr a[126:127],v11,61960
mf v[168:171],a[96:99],v[112:115]
s_waitcnt vmcnt(23)
ds_read_b128 a[128:131], v21 offset:0
mf v[168:171],a[100:103],v[124:127]
ds_read_b128 a[140:143], v22 offset:0
ds_read_b128 a[132:135], v21 offset:2048
ds_read_b128 a[144:147], v22 offset:2048
ds_read_b128 a[136:139], v21 offset:4096
ds_read_b128 a[148:151], v22 offset:4096
mf v[168:171],a[104:107],v[136:139]
s_add_u32 m0, s50, 17408
mf v[168:171],a[108:111],v[148:151]
s_mov_b32 s72, 393216
buffer_load_dword v20, v159, s[16:19], s72 offen
wl
mf v[180:183],a[124:127],v[148:151]
s_add_u32 s39, s38, 7168
buffer_load_dwordx4 v14, s[4:7], s39 offen lds
tr a[96:97],v12,49152
mf v[180:183],a[120:123],v[136:139]
s_add_u32 m0, s50, 18432
tr a[98:99],v12,49664
mf v[180:183],a[116:119],v[124:127]
tr a[100:101],v12,53248
mf v[180:183],a[112:115],v[112:115]
s_mov_b32 s72, 393216
buffer_load_dword v20, v159, s[12:15], s72 offen
tr a[102:103],v12,53760
mf v[176:179],a[112:115],v[108:111]
tr a[104:105],v12,57344
mf v[176:179],a[116:119],v[120:123]
s_add_u32 s39, s38, 14336
buffer_load_dwordx4 v14, s[4:7], s39 offen lds
tr a[106:107],v12,57856
mf v[176:179],a[120:123],v[132:135]
s_add_u32 m0, s50, 19456
tr a[108:109],v12,61440
mf v[176:179],a[124:127],v[144:147]
s_mov_b32 s72, 376832
buffer_load_dword v20, v159, s[16:19], s72 offen
tr a[110:111],v12,61952
mf v[172:175],a[124:127],v[140:143]
s_mov_b32 s72, 376832
buffer_load_dword v20, v159, s[12:15], s72 offen
mf v[172:175],a[120:123],v[128:131]
s_add_u32 s39, s38, 21504
buffer_load_dwordx4 v14, s[4:7], s39 offen lds
mf v[172:175],a[116:119],v[116:119]
s_add_u32 m0, s50, 20480
v_min_u32 v159, 112, v1
v_lshlrev_b32 v159, 3, v159
mf v[172:175],a[112:115],v[104:107]
wl
mf v[184:187],a[96:99],v[104:107]
tr a[112:113],v12,49160
mf v[184:187],a[100:103],v[116:119]
tr a[114:115],v12,49672
mf v[184:187],a[104:107],v[128:131]
s_add_u32 s39, s38, 28672
buffer_load_dwordx4 v14, s[4:7], s39 offen lds
tr a[116:117],v12,53256
mf v[184:187],a[108:111],v[140:143]
s_add_u32 m0, s50, 21504
tr a[118:119],v12,53768
mf v[188:191],a[108:111],v[144:147]
tr a[120:121],v12,57352
mf v[188:191],a[104:107],v[132:135]
s_mov_b32 s72, 360448
buffer_load_dword v20, v159, s[16:19], s72 offen
tr a[122:123],v12,57864
mf v[188:191],a[100:103],v[120:123]
tr a[124:125],v12,61448
mf v[188:191],a[96:99],v[108:111]
s_add_u32 s39, s38, 35840
buffer_load_dwordx4 v14, s[4:7], s39 offen lds
tr a[126:127],v12,61960
mf v[192:195],a[96:99],v[112:115]
s_waitcnt vmcnt(23)
ds_read_b128 a[152:155], v21 offset:8192
mf v[192:195],a[100:103],v[124:127]
ds_read_b128 a[164:167], v22 offset:8192
ds_read_b128 a[156:159], v21 offset:10240
ds_read_b128 a[168:171], v22 offset:10240
ds_read_b128 a[160:163], v21 offset:12288
ds_read_b128 a[172:175], v22 offset:12288
mf v[192:195],a[104:107],v[136:139]
s_mov_b32 s72, 360448
buffer_load_dword v20, v159, s[12:15], s72 offen
mf v[192:195],a[108:111],v[148:151]
s_add_u32 m0, s33, 49152
wl
mf v[204:207],a[124:127],v[148:151]
s_waitcnt vmcnt(30)
s_barrier
mf v[204:207],a[120:123],v[136:139]
s_add_u32 s39, s87, 128
buffer_load_dwordx4 v13, s[8:11], s39 offen lds
tr a[96:97],v11,0
mf v[204:207],a[116:119],v[124:127]
s_add_u32 m0, s33, 50176
tr a[98:99],v11,512
mf v[204:207],a[112:115],v[112:115]
tr a[100:101],v11,4096
mf v[200:203],a[112:115],v[108:111]
tr a[102:103],v11,4608
mf v[200:203],a[116:119],v[120:123]
s_add_u32 s39, s87, 65664
buffer_load_dwordx4 v13, s[8:11], s39 offen lds
tr a[104:105],v11,8192
mf v[200:203],a[120:123],v[132:135]
s_add_u32 m0, s33, 51200
tr a[106:107],v11,8704
mf v[200:203],a[124:127],v[144:147]
s_mov_b32 s72, 344064
buffer_load_dword v20, v159, s[16:19], s72 offen
tr a[108:109],v11,12288
mf v[196:199],a[124:127],v[140:143]
tr a[110:111],v11,12800
mf v[196:199],a[120:123],v[128:131]
mf v[196:199],a[116:119],v[116:119]
s_add_u32 s39, s87, 131200
buffer_load_dwordx4 v13, s[8:11], s39 offen lds
mf v[196:199],a[112:115],v[104:107]
s_add_u32 m0, s33, 52224
wl
mf v[32:35],a[96:99],a[128:131]
tr a[112:113],v11,8
mf v[32:35],a[100:103],a[140:143]
tr a[114:115],v11,520
mf v[32:35],a[104:107],a[152:155]
s_mov_b32 s72, 344064
buffer_load_dword v20, v159, s[12:15], s72 offen
tr a[116:117],v11,4104
mf v[32:35],a[108:111],a[164:167]
s_add_u32 s39, s87, 196736
buffer_load_dwordx4 v13, s[8:11], s39 offen lds
tr a[118:119],v11,4616
mf v[36:39],a[108:111],a[168:171]
s_lshr_b32 s38, s71, 12
s_add_u32 m0, s50, 0
tr a[120:121],v11,8200
mf v[36:39],a[104:107],a[156:159]
tr a[122:123],v11,8712
mf v[36:39],a[100:103],a[144:147]
tr a[124:125],v11,12296
mf v[36:39],a[96:99],a[132:135]
s_add_u32 s39, s38, 0
buffer_load_dwordx4 v14, s[4:7], s39 offen lds
tr a[126:127],v11,12808
mf v[40:43],a[96:99],a[136:139]
s_add_u32 m0, s50, 1024
mf v[40:43],a[100:103],a[148:151]
s_mov_b32 s72, 327680
buffer_load_dword v20, v159, s[16:19], s72 offen
mf v[40:43],a[104:107],a[160:163]
mf v[40:43],a[108:111],a[172:175]
wl
mf v[52:55],a[124:127],a[172:175]
s_add_u32 s39, s38, 7168
buffer_load_dwordx4 v14, s[4:7], s39 offen lds
tr a[96:97],v12,0
mf v[52:55],a[120:123],a[160:163]
s_add_u32 m0, s50, 2048
tr a[98:99],v12,512
mf v[52:55],a[116:119],a[148:151]
tr a[100:101],v12,4096
mf v[52:55],a[112:115],a[136:139]
tr a[102:103],v12,4608
mf v[48:51],a[112:115],a[132:135]
s_mov_b32 s72, 327680
buffer_load_dword v20, v159, s[12:15], s72 offen
tr a[104:105],v12,8192
mf v[48:51],a[116:119],a[144:147]
s_add_u32 s39, s38, 14336
buffer_load_dwordx4 v14, s[4:7], s39 offen lds
tr a[106:107],v12,8704
mf v[48:51],a[120:123],a[156:159]
s_add_u32 m0, s50, 3072
tr a[108:109],v12,12288
mf v[48:51],a[124:127],a[168:171]
tr a[110:111],v12,12800
v_min_u32 v159, 176, v1
mf v[44:47],a[124:127],a[164:167]
v_lshlrev_b32 v159, 3, v159
mf v[44:47],a[120:123],a[152:155]
s_add_u32 s39, s38, 21504
buffer_load_dwordx4 v14, s[4:7], s39 offen lds
mf v[44:47],a[116:119],a[140:143]
s_add_u32 m0, s50, 4096
mf v[44:47],a[112:115],a[128:131]
wl
mf v[56:59],a[96:99],a[128:131]
s_mov_b32 s72, 311296
buffer_load_dword v20, v159, s[16:19], s72 offen
tr a[112:113],v12,8
mf v[56:59],a[100:103],a[140:143]
tr a[114:115],v12,520
mf v[56:59],a[104:107],a[152:155]
s_add_u32 s39, s38, 28672
buffer_load_dwordx4 v14, s[4:7], s39 offen lds
tr a[116:117],v12,4104
mf v[56:59],a[108:111],a[164:167]
s_add_u32 m0, s50, 5120
tr a[118:119],v12,4616
mf v[60:63],a[108:111],a[168:171]
tr a[120:121],v12,8200
mf v[60:63],a[104:107],a[156:159]
tr a[122:123],v12,8712
mf v[60:63],a[100:103],a[144:147]
tr a[124:125],v12,12296
mf v[60:63],a[96:99],a[132:135]
s_add_u32 s39, s38, 35840
buffer_load_dwordx4 v14, s[4:7], s39 offen lds
tr a[126:127],v12,12808
mf v[64:67],a[96:99],a[136:139]
s_waitcnt vmcnt(16)
ds_read_b128 a[176:179], v21 offset:16384
mf v[64:67],a[100:103],a[148:151]
ds_read_b128 a[188:191], v22 offset:16384
ds_read_b128 a[180:183], v21 offset:18432
ds_read_b128 a[192:195], v22 offset:18432
ds_read_b128 a[184:187], v21 offset:20480
ds_read_b128 a[196:199], v22 offset:20480
mf v[64:67],a[104:107],a[160:163]
s_mov_b32 s72, 311296
buffer_load_dword v20, v159, s[12:15], s72 offen
mf v[64:67],a[108:111],a[172:175]
s_mov_b32 m0, 0
v_min_u32 v159, 240, v1
wl
mf v[76:79],a[124:127],a[172:175]
s_waitcnt vmcnt(36)
v_lshlrev_b32 v159, 3, v159
s_barrier
mf v[76:79],a[120:123],a[160:163]
s_add_u32 s39, s54, 256
buffer_load_dwordx4 v13, s[8:11], s39 offen offset:0  lds
tr a[96:97],v11,16384
mf v[76:79],a[116:119],a[148:151]
tr a[98:99],v11,16896
mf v[76:79],a[112:115],a[136:139]
tr a[100:101],v11,20480
buffer_load_dwordx4 v156, s[8:11], s39 offen offset:1024  lds
mf v[72:75],a[112:115],a[132:135]
tr a[102:103],v11,20992
mf v[72:75],a[116:119],a[144:147]
tr a[104:105],v11,24576
buffer_load_dwordx4 v157, s[8:11], s39 offen offset:2048  lds
mf v[72:75],a[120:123],a[156:159]
tr a[106:107],v11,25088
mf v[72:75],a[124:127],a[168:171]
tr a[108:109],v11,28672
buffer_load_dwordx4 v158, s[8:11], s39 offen offset:3072  lds
mf v[68:71],a[124:127],a[164:167]
s_mov_b32 m0, 4096
tr a[110:111],v11,29184
mf v[68:71],a[120:123],a[152:155]
s_mov_b32 s72, 294912
buffer_load_dword v20, v159, s[16:19], s72 offen
s_add_u32 s39, s54, 262400
buffer_load_dwordx4 v13, s[8:11], s39 offen offset:0  lds
mf v[68:71],a[116:119],a[140:143]
mf v[68:71],a[112:115],a[128:131]
wl
buffer_load_dwordx4 v156, s[8:11], s39 offen offset:1024  lds
mf v[160:163],a[96:99],a[128:131]
tr a[112:113],v11,16392
mf v[160:163],a[100:103],a[140:143]
tr a[114:115],v11,16904
buffer_load_dwordx4 v157, s[8:11], s39 offen offset:2048  lds
mf v[160:163],a[104:107],a[152:155]
tr a[116:117],v11,20488
mf v[160:163],a[108:111],a[164:167]
tr a[118:119],v11,21000
buffer_load_dwordx4 v158, s[8:11], s39 offen offset:3072  lds
mf v[164:167],a[108:111],a[168:171]
s_mov_b32 m0, 8192
tr a[120:121],v11,24584
mf v[164:167],a[104:107],a[156:159]
s_add_u32 s39, s51, 256
buffer_load_dwordx4 v13, s[8:11], s39 offen offset:0  lds
tr a[122:123],v11,25096
mf v[164:167],a[100:103],a[144:147]
tr a[124:125],v11,28680
mf v[164:167],a[96:99],a[132:135]
tr a[126:127],v11,29192
buffer_load_dwordx4 v156, s[8:11], s39 offen offset:1024  lds
mf v[168:171],a[96:99],a[136:139]
s_mov_b32 s72, 294912
buffer_load_dword v20, v159, s[12:15], s72 offen
mf v[168:171],a[100:103],a[148:151]
buffer_load_dwordx4 v157, s[8:11], s39 offen offset:2048  lds
mf v[168:171],a[104:107],a[160:163]
v_min_u32 v159, 304, v1
v_lshlrev_b32 v159, 3, v159
mf v[168:171],a[108:111],a[172:175]
wl
buffer_load_dwordx4 v158, s[8:11], s39 offen offset:3072  lds
mf v[180:183],a[124:127],a[172:175]
s_mov_b32 m0, 12288
tr a[96:97],v12,16384
mf v[180:183],a[120:123],a[160:163]
s_add_u32 s39, s51, 262400
buffer_load_dwordx4 v13, s[8:11], s39 offen offset:0  lds
tr a[98:99],v12,16896
mf v[180:183],a[116:119],a[148:151]
tr a[100:101],v12,20480
mf v[180:183],a[112:115],a[136:139]
tr a[102:103],v12,20992
buffer_load_dwordx4 v156, s[8:11], s39 offen offset:1024  lds
mf v[176:179],a[112:115],a[132:135]
tr a[104:105],v12,24576
mf v[176:179],a[116:119],a[144:147]
tr a[106:107],v12,25088
buffer_load_dwordx4 v157, s[8:11], s39 offen offset:2048  lds
mf v[176:179],a[120:123],a[156:159]
tr a[108:109],v12,28672
mf v[176:179],a[124:127],a[168:171]
tr a[110:111],v12,29184
buffer_load_dwordx4 v158, s[8:11], s39 offen offset:3072  lds
mf v[172:175],a[124:127],a[164:167]
mf v[172:175],a[120:123],a[152:155]
s_mov_b32 s72, 278528
buffer_load_dword v20, v159, s[16:19], s72 offen
mf v[172:175],a[116:119],a[140:143]
mf v[172:175],a[112:115],a[128:131]
wl
mf v[184:187],a[96:99],a[128:131]
tr a[112:113],v12,16392
mf v[184:187],a[100:103],a[140:143]
tr a[114:115],v12,16904
mf v[184:187],a[104:107],a[152:155]
tr a[116:117],v12,20488
mf v[184:187],a[108:111],a[164:167]
tr a[118:119],v12,21000
mf v[188:191],a[108:111],a[168:171]
tr a[120:121],v12,24584
mf v[188:191],a[104:107],a[156:159]
tr a[122:123],v12,25096
mf v[188:191],a[100:103],a[144:147]
tr a[124:125],v12,28680
mf v[188:191],a[96:99],a[132:135]
tr a[126:127],v12,29192
s_waitcnt vmcnt(20)
mf v[192:195],a[96:99],a[136:139]
s_mov_b32 m0, 16384
ds_read_b128 a[200:203], v21 offset:0
mf v[192:195],a[100:103],a[148:151]
ds_read_b128 a[212:215], v22 offset:0
ds_read_b128 a[204:207], v21 offset:2048
ds_read_b128 a[216:219], v22 offset:2048
ds_read_b128 a[208:211], v21 offset:4096
ds_read_b128 a[220:223], v22 offset:4096
mf v[192:195],a[104:107],a[160:163]
mf v[192:195],a[108:111],a[172:175]
wl
mf v[204:207],a[124:127],a[172:175]
s_waitcnt vmcnt(48)
s_barrier
mf v[204:207],a[120:123],a[160:163]
s_add_u32 s39, s52, 256
buffer_load_dwordx4 v13, s[8:11], s39 offen offset:0  lds
tr a[96:97],v11,32768
mf v[204:207],a[116:119],a[148:151]
tr a[98:99],v11,33280
mf v[204:207],a[112:115],a[136:139]
s_mov_b32 s72, 278528
buffer_load_dword v20, v159, s[12:15], s72 offen
tr a[100:101],v11,36864
buffer_load_dwordx4 v156, s[8:11], s39 offen offset:1024  lds
mf v[200:203],a[112:115],a[132:135]
tr a[102:103],v11,37376
v_min_u32 v159, 432, v1
mf v[200:203],a[116:119],a[144:147]
tr a[104:105],v11,40960
buffer_load_dwordx4 v157, s[8:11], s39 offen offset:2048  lds
mf v[200:203],a[120:123],a[156:159]
tr a[106:107],v11,41472
v_lshlrev_b32 v159, 3, v159
mf v[200:203],a[124:127],a[168:171]
tr a[108:109],v11,45056
buffer_load_dwordx4 v158, s[8:11], s39 offen offset:3072  lds
mf v[196:199],a[124:127],a[164:167]
s_mov_b32 m0, 20480
tr a[110:111],v11,45568
mf v[196:199],a[120:123],a[152:155]
s_add_u32 s39, s52, 262400
buffer_load_dwordx4 v13, s[8:11], s39 offen offset:0  lds
mf v[196:199],a[116:119],a[140:143]
mf v[196:199],a[112:115],a[128:131]
wl
buffer_load_dwordx4 v156, s[8:11], s39 offen offset:1024  lds
mf v[32:35],a[96:99],a[176:179]
tr a[112:113],v11,32776
v_mov_b32 v0, 0
mf v[32:35],a[100:103],a[188:191]
tr a[114:115],v11,33288
buffer_load_dwordx4 v157, s[8:11], s39 offen offset:2048  lds
mf v[32:35],a[104:107],a[200:203]
tr a[116:117],v11,36872
v_lshrrev_b32 v23, 2, v1
mf v[32:35],a[108:111],a[212:215]
tr a[118:119],v11,37384
buffer_load_dwordx4 v158, s[8:11], s39 offen offset:3072  lds
mf v[36:39],a[108:111],a[216:219]
tr a[120:121],v11,40968
mf v[36:39],a[104:107],a[204:207]
tr a[122:123],v11,41480
mf v[36:39],a[100:103],a[192:195]
tr a[124:125],v11,45064
mf v[36:39],a[96:99],a[180:183]
tr a[126:127],v11,45576
mf v[40:43],a[96:99],a[184:187]
s_mov_b32 s72, 262144
buffer_load_dword v20, v159, s[16:19], s72 offen
mf v[40:43],a[100:103],a[196:199]
s_mov_b64 exec, 15
buffer_store_dword v0, v23, s[28:31], s57 offen sc1
s_mov_b64 exec, -1
mf v[40:43],a[104:107],a[208:211]
v_mul_f32 v32, s37, v32
v_mul_f32 v33, s37, v33
mf v[40:43],a[108:111],a[220:223]
wl
v_mul_f32 v34, s37, v34
v_mul_f32 v35, s37, v35
mf v[52:55],a[124:127],a[220:223]
tr a[96:97],v12,32768
cv v32,v32,v33
mf v[52:55],a[120:123],a[208:211]
tr a[98:99],v12,33280
cv v34,v34,v35
mf v[52:55],a[116:119],a[196:199]
tr a[100:101],v12,36864
aw a0,v32
mf v[52:55],a[112:115],a[184:187]
tr a[102:103],v12,37376
aw a1,v34
mf v[48:51],a[112:115],a[180:183]
tr a[104:105],v12,40960
v_mul_f32 v36, s37, v36
mf v[48:51],a[116:119],a[192:195]
tr a[106:107],v12,41472
v_mul_f32 v37, s37, v37
mf v[48:51],a[120:123],a[204:207]
tr a[108:109],v12,45056
v_mul_f32 v38, s37, v38
mf v[48:51],a[124:127],a[216:219]
tr a[110:111],v12,45568
v_mul_f32 v39, s37, v39
mf v[44:47],a[124:127],a[212:215]
cv v36,v36,v37
cv v38,v38,v39
mf v[44:47],a[120:123],a[200:203]
aw a4,v36
aw a5,v38
mf v[44:47],a[116:119],a[188:191]
v_mul_f32 v40, s37, v40
v_mul_f32 v41, s37, v41
mf v[44:47],a[112:115],a[176:179]
wl
v_mul_f32 v42, s37, v42
v_mul_f32 v43, s37, v43
mf v[56:59],a[96:99],a[176:179]
tr a[112:113],v12,32776
cv v40,v40,v41
mf v[56:59],a[100:103],a[188:191]
tr a[114:115],v12,33288
cv v42,v42,v43
mf v[56:59],a[104:107],a[200:203]
tr a[116:117],v12,36872
aw a8,v40
mf v[56:59],a[108:111],a[212:215]
tr a[118:119],v12,37384
aw a9,v42
mf v[60:63],a[108:111],a[216:219]
tr a[120:121],v12,40968
v_mul_f32 v52, s37, v52
mf v[60:63],a[104:107],a[204:207]
tr a[122:123],v12,41480
v_mul_f32 v53, s37, v53
mf v[60:63],a[100:103],a[192:195]
s_mov_b32 s72, 262144
buffer_load_dword v20, v159, s[12:15], s72 offen
tr a[124:125],v12,45064
mf v[60:63],a[96:99],a[180:183]
s_mov_b32 m0, 32768
tr a[126:127],v12,45576
mf v[64:67],a[96:99],a[184:187]
v_min_u32 v159, 496, v1
v_lshlrev_b32 v159, 3, v159
mf v[64:67],a[100:103],a[196:199]
v_mul_f32 v54, s37, v54
v_mul_f32 v55, s37, v55
mf v[64:67],a[104:107],a[208:211]
cv v52,v52,v53
cv v54,v54,v55
mf v[64:67],a[108:111],a[220:223]
wl
aw a10,v52
aw a11,v54
mf v[76:79],a[124:127],a[220:223]
s_waitcnt vmcnt(41)
v_mul_f32 v48, s37, v48
s_barrier
mf v[76:79],a[120:123],a[208:211]
s_add_u32 s39, s48, 256
buffer_load_dwordx4 v13, s[8:11], s39 offen offset:0  lds
tr a[96:97],v11,49152
mf v[76:79],a[116:119],a[196:199]
tr a[98:99],v11,49664
v_mul_f32 v49, s37, v49
mf v[76:79],a[112:115],a[184:187]
tr a[100:101],v11,53248
buffer_load_dwordx4 v156, s[8:11], s39 offen offset:1024  lds
mf v[72:75],a[112:115],a[180:183]
tr a[102:103],v11,53760
v_mul_f32 v50, s37, v50
mf v[72:75],a[116:119],a[192:195]
tr a[104:105],v11,57344
buffer_load_dwordx4 v157, s[8:11], s39 offen offset:2048  lds
mf v[72:75],a[120:123],a[204:207]
tr a[106:107],v11,57856
v_mul_f32 v51, s37, v51
mf v[72:75],a[124:127],a[216:219]
tr a[108:109],v11,61440
buffer_load_dwordx4 v158, s[8:11], s39 offen offset:3072  lds
mf v[68:71],a[124:127],a[212:215]
s_mov_b32 m0, 36864
tr a[110:111],v11,61952
mf v[68:71],a[120:123],a[200:203]
s_add_u32 s39, s48, 262400
buffer_load_dwordx4 v13, s[8:11], s39 offen offset:0  lds
mf v[68:71],a[116:119],a[188:191]
cv v48,v48,v49
cv v50,v50,v51
mf v[68:71],a[112:115],a[176:179]
wl
buffer_load_dwordx4 v156, s[8:11], s39 offen offset:1024  lds
mf v[160:163],a[96:99],a[176:179]
tr a[112:113],v11,49160
aw a6,v48
mf v[160:163],a[100:103],a[188:191]
tr a[114:115],v11,49672
buffer_load_dwordx4 v157, s[8:11], s39 offen offset:2048  lds
mf v[160:163],a[104:107],a[200:203]
tr a[116:117],v11,53256
aw a7,v50
mf v[160:163],a[108:111],a[212:215]
tr a[118:119],v11,53768
buffer_load_dwordx4 v158, s[8:11], s39 offen offset:3072  lds
mf v[164:167],a[108:111],a[216:219]
s_mov_b32 s72, 245760
buffer_load_dword v20, v159, s[16:19], s72 offen
tr a[120:121],v11,57352
mf v[164:167],a[104:107],a[204:207]
s_mov_b32 m0, 40960
s_add_u32 s39, s69, 256
buffer_load_dwordx4 v13, s[8:11], s39 offen offset:0  lds
tr a[122:123],v11,57864
mf v[164:167],a[100:103],a[192:195]
tr a[124:125],v11,61448
v_mul_f32 v44, s37, v44
mf v[164:167],a[96:99],a[180:183]
tr a[126:127],v11,61960
buffer_load_dwordx4 v156, s[8:11], s39 offen offset:1024  lds
mf v[168:171],a[96:99],a[184:187]
v_mul_f32 v45, s37, v45
v_mul_f32 v46, s37, v46
mf v[168:171],a[100:103],a[196:199]
buffer_load_dwordx4 v157, s[8:11], s39 offen offset:2048  lds
mf v[168:171],a[104:107],a[208:211]
v_mul_f32 v47, s37, v47
cv v44,v44,v45
mf v[168:171],a[108:111],a[220:223]
wl
buffer_load_dwordx4 v158, s[8:11], s39 offen offset:3072  lds
mf v[180:183],a[124:127],a[220:223]
s_mov_b32 m0, 45056
tr a[96:97],v12,49152
mf v[180:183],a[120:123],a[208:211]
s_add_u32 s39, s69, 262400
buffer_load_dwordx4 v13, s[8:11], s39 offen offset:0  lds
tr a[98:99],v12,49664
mf v[180:183],a[116:119],a[196:199]
tr a[100:101],v12,53248
cv v46,v46,v47
mf v[180:183],a[112:115],a[184:187]
tr a[102:103],v12,53760
buffer_load_dwordx4 v156, s[8:11], s39 offen offset:1024  lds
mf v[176:179],a[112:115],a[180:183]
tr a[104:105],v12,57344
aw a2,v44
mf v[176:179],a[116:119],a[192:195]
tr a[106:107],v12,57856
buffer_load_dwordx4 v157, s[8:11], s39 offen offset:2048  lds
mf v[176:179],a[120:123],a[204:207]
tr a[108:109],v12,61440
aw a3,v46
mf v[176:179],a[124:127],a[216:219]
tr a[110:111],v12,61952
buffer_load_dwordx4 v158, s[8:11], s39 offen offset:3072  lds
mf v[172:175],a[124:127],a[212:215]
v_mul_f32 v56, s37, v56
v_mul_f32 v57, s37, v57
mf v[172:175],a[120:123],a[200:203]
v_mul_f32 v58, s37, v58
v_mul_f32 v59, s37, v59
mf v[172:175],a[116:119],a[188:191]
cv v56,v56,v57
cv v58,v58,v59
mf v[172:175],a[112:115],a[176:179]
wl
aw a12,v56
aw a13,v58
mf v[184:187],a[96:99],a[176:179]
tr a[112:113],v12,49160
v_mul_f32 v60, s37, v60
mf v[184:187],a[100:103],a[188:191]
tr a[114:115],v12,49672
v_mul_f32 v61, s37, v61
mf v[184:187],a[104:107],a[200:203]
tr a[116:117],v12,53256
v_mul_f32 v62, s37, v62
mf v[184:187],a[108:111],a[212:215]
s_mov_b32 s72, 245760
buffer_load_dword v20, v159, s[12:15], s72 offen
tr a[118:119],v12,53768
mf v[188:191],a[108:111],a[216:219]
tr a[120:121],v12,57352
v_min_u32 v159, 560, v1
mf v[188:191],a[104:107],a[204:207]
tr a[122:123],v12,57864
v_lshlrev_b32 v159, 3, v159
mf v[188:191],a[100:103],a[192:195]
tr a[124:125],v12,61448
v_mul_f32 v63, s37, v63
mf v[188:191],a[96:99],a[180:183]
s_mov_b32 m0, 49152
tr a[126:127],v12,61960
mf v[192:195],a[96:99],a[184:187]
cv v60,v60,v61
cv v62,v62,v63
mf v[192:195],a[100:103],a[196:199]
aw a16,v60
aw a17,v62
mf v[192:195],a[104:107],a[208:211]
v_mul_f32 v64, s37, v64
v_mul_f32 v65, s37, v65
mf v[192:195],a[108:111],a[220:223]
wl
v_mul_f32 v66, s37, v66
v_mul_f32 v67, s37, v67
mf v[204:207],a[124:127],a[220:223]
s_waitcnt vmcnt(31)
cv v64,v64,v65
s_barrier
mf v[204:207],a[120:123],a[208:211]
s_add_u32 s39, s70, 256
buffer_load_dwordx4 v13, s[8:11], s39 offen offset:0  lds
tr a[96:97],v11,0
mf v[204:207],a[116:119],a[196:199]
tr a[98:99],v11,512
cv v66,v66,v67
mf v[204:207],a[112:115],a[184:187]
tr a[100:101],v11,4096
buffer_load_dwordx4 v156, s[8:11], s39 offen offset:1024  lds
mf v[200:203],a[112:115],a[180:183]
tr a[102:103],v11,4608
aw a20,v64
mf v[200:203],a[116:119],a[192:195]
tr a[104:105],v11,8192
buffer_load_dwordx4 v157, s[8:11], s39 offen offset:2048  lds
mf v[200:203],a[120:123],a[204:207]
tr a[106:107],v11,8704
aw a21,v66
mf v[200:203],a[124:127],a[216:219]
tr a[108:109],v11,12288
buffer_load_dwordx4 v158, s[8:11], s39 offen offset:3072  lds
mf v[196:199],a[124:127],a[212:215]
s_mov_b32 m0, 53248
tr a[110:111],v11,12800
mf v[196:199],a[120:123],a[200:203]
s_add_u32 s39, s70, 262400
buffer_load_dwordx4 v13, s[8:11], s39 offen offset:0  lds
mf v[196:199],a[116:119],a[188:191]
v_mul_f32 v76, s37, v76
v_mul_f32 v77, s37, v77
mf v[196:199],a[112:115],a[176:179]
wl
buffer_load_dwordx4 v156, s[8:11], s39 offen offset:1024  lds
mz v[32:35],a[96:99],v[80:83],0
tr a[112:113],v11,8
v_mul_f32 v78, s37, v78
mf v[32:35],a[100:103],v[92:95]
tr a[114:115],v11,520
buffer_load_dwordx4 v157, s[8:11], s39 offen offset:2048  lds
mf v[32:35],a[104:107],v[104:107]
tr a[116:117],v11,4104
v_mul_f32 v79, s37, v79
mf v[32:35],a[108:111],v[116:119]
s_mov_b32 s72, 229376
buffer_load_dword v20, v159, s[16:19], s72 offen
tr a[118:119],v11,4616
buffer_load_dwordx4 v158, s[8:11], s39 offen offset:3072  lds
mz v[36:39],a[108:111],v[120:123],0
s_mov_b32 m0, 57344
tr a[120:121],v11,8200
mf v[36:39],a[104:107],v[108:111]
s_add_u32 s39, s71, 256
buffer_load_dwordx4 v13, s[8:11], s39 offen offset:0  lds
tr a[122:123],v11,8712
mf v[36:39],a[100:103],v[96:99]
tr a[124:125],v11,12296
cv v76,v76,v77
mf v[36:39],a[96:99],v[84:87]
tr a[126:127],v11,12808
buffer_load_dwordx4 v156, s[8:11], s39 offen offset:1024  lds
mz v[40:43],a[96:99],v[88:91],0
cv v78,v78,v79
aw a22,v76
mf v[40:43],a[100:103],v[100:103]
buffer_load_dwordx4 v157, s[8:11], s39 offen offset:2048  lds
mf v[40:43],a[104:107],v[112:115]
aw a23,v78
v_mul_f32 v72, s37, v72
mf v[40:43],a[108:111],v[124:127]
wl
buffer_load_dwordx4 v158, s[8:11], s39 offen offset:3072  lds
mz v[52:55],a[124:127],v[124:127],0
s_mov_b32 m0, 61440
tr a[96:97],v12,0
mf v[52:55],a[120:123],v[112:115]
s_add_u32 s39, s71, 262400
buffer_load_dwordx4 v13, s[8:11], s39 offen offset:0  lds
tr a[98:99],v12,512
mf v[52:55],a[116:119],v[100:103]
tr a[100:101],v12,4096
v_mul_f32 v73, s37, v73
mf v[52:55],a[112:115],v[88:91]
tr a[102:103],v12,4608
buffer_load_dwordx4 v156, s[8:11], s39 offen offset:1024  lds
mz v[48:51],a[112:115],v[84:87],0
tr a[104:105],v12,8192
v_mul_f32 v74, s37, v74
mf v[48:51],a[116:119],v[96:99]
tr a[106:107],v12,8704
buffer_load_dwordx4 v157, s[8:11], s39 offen offset:2048  lds
mf v[48:51],a[120:123],v[108:111]
tr a[108:109],v12,12288
v_mul_f32 v75, s37, v75
mf v[48:51],a[124:127],v[120:123]
tr a[110:111],v12,12800
buffer_load_dwordx4 v158, s[8:11], s39 offen offset:3072  lds
mz v[44:47],a[124:127],v[116:119],0
cv v72,v72,v73
cv v74,v74,v75
mf v[44:47],a[120:123],v[104:107]
aw a18,v72
aw a19,v74
v_mul_f32 v68, s37, v68
v_mul_f32 v69, s37, v69
v_mul_f32 v70, s37, v70
v_mul_f32 v71, s37, v71
cv v68,v68,v69
cv v70,v70,v71
aw a14,v68
aw a15,v70
mf v[44:47],a[116:119],v[92:95]
v_mul_f32 v160, s37, v160
v_mul_f32 v161, s37, v161
mf v[44:47],a[112:115],v[80:83]
wl
v_mul_f32 v162, s37, v162
v_mul_f32 v163, s37, v163
mz v[56:59],a[96:99],v[80:83],0
tr a[112:113],v12,8
cv v160,v160,v161
mf v[56:59],a[100:103],v[92:95]
tr a[114:115],v12,520
cv v162,v162,v163
mf v[56:59],a[104:107],v[104:107]
tr a[116:117],v12,4104
aw a24,v160
mf v[56:59],a[108:111],v[116:119]
tr a[118:119],v12,4616
aw a25,v162
mz v[60:63],a[108:111],v[120:123],0
s_mov_b32 s72, 229376
buffer_load_dword v20, v159, s[12:15], s72 offen
tr a[120:121],v12,8200
mf v[60:63],a[104:107],v[108:111]
tr a[122:123],v12,8712
v_min_u32 v159, 624, v1
mf v[60:63],a[100:103],v[96:99]
tr a[124:125],v12,12296
v_lshlrev_b32 v159, 3, v159
mf v[60:63],a[96:99],v[84:87]
s_mov_b32 m0, 0
tr a[126:127],v12,12808
mz v[64:67],a[96:99],v[88:91],0
v_mul_f32 v164, s37, v164
v_mul_f32 v165, s37, v165
mf v[64:67],a[100:103],v[100:103]
v_mul_f32 v166, s37, v166
v_mul_f32 v167, s37, v167
mf v[64:67],a[104:107],v[112:115]
cv v164,v164,v165
cv v166,v166,v167
mf v[64:67],a[108:111],v[124:127]
wl
aw a28,v164
aw a29,v166
mz v[76:79],a[124:127],v[124:127],0
s_waitcnt vmcnt(39)
v_mul_f32 v168, s37, v168
s_barrier
mf v[76:79],a[120:123],v[112:115]
s_add_u32 s39, s54, 384
buffer_load_dwordx4 v13, s[8:11], s39 offen offset:0  lds
tr a[96:97],v11,16384
mf v[76:79],a[116:119],v[100:103]
tr a[98:99],v11,16896
buffer_load_dwordx4 v156, s[8:11], s39 offen offset:1024  lds
mf v[76:79],a[112:115],v[88:91]
tr a[100:101],v11,20480
v_mul_f32 v169, s37, v169
mz v[72:75],a[112:115],v[84:87],0
tr a[102:103],v11,20992
buffer_load_dwordx4 v157, s[8:11], s39 offen offset:2048  lds
mf v[72:75],a[116:119],v[96:99]
tr a[104:105],v11,20488
v_mul_f32 v170, s37, v170
mf v[72:75],a[120:123],v[108:111]
tr a[106:107],v11,21000
buffer_load_dwordx4 v158, s[8:11], s39 offen offset:3072  lds
mf v[72:75],a[124:127],v[120:123]
s_mov_b32 m0, 4096
s_add_u32 s39, s54, 262528
buffer_load_dwordx4 v13, s[8:11], s39 offen offset:0  lds
tr a[108:109],v11,16392
mz v[68:71],a[124:127],v[116:119],0
tr a[110:111],v11,16904
v_mul_f32 v171, s37, v171
mf v[68:71],a[120:123],v[104:107]
buffer_load_dwordx4 v156, s[8:11], s39 offen offset:1024  lds
mf v[68:71],a[116:119],v[92:95]
cv v168,v168,v169
cv v170,v170,v171
mf v[68:71],a[112:115],v[80:83]
wl
buffer_load_dwordx4 v157, s[8:11], s39 offen offset:2048  lds
mf v[32:35],a[96:99],v[128:131]
tr a[112:113],v12,16384
buffer_load_dwordx4 v158, s[8:11], s39 offen offset:3072  lds
mf v[32:35],a[100:103],v[140:143]
s_mov_b32 m0, 8192
tr a[114:115],v12,16896
mf v[44:47],a[104:107],v[140:143]
s_add_u32 s39, s51, 384
buffer_load_dwordx4 v13, s[8:11], s39 offen offset:0  lds
tr a[116:117],v12,20480
mf v[44:47],a[108:111],v[128:131]
s_waitcnt vmcnt(46)
tr a[118:119],v12,20992
mf v[48:51],a[108:111],v[132:135]
tr a[120:121],v12,20488
buffer_load_dwordx4 v156, s[8:11], s39 offen offset:1024  lds
mf v[48:51],a[104:107],v[144:147]
tr a[122:123],v12,21000
buffer_load_dwordx4 v157, s[8:11], s39 offen offset:2048  lds
mf v[36:39],a[100:103],v[144:147]
s_mov_b32 s72, 212992
buffer_load_dword v20, v159, s[16:19], s72 offen
tr a[124:125],v12,16392
mf v[36:39],a[96:99],v[132:135]
tr a[126:127],v12,16904
buffer_load_dwordx4 v158, s[8:11], s39 offen offset:3072  lds
mf v[40:43],a[96:99],v[136:139]
s_mov_b32 m0, 12288
aw a32,v168
v_mov_b32 v0, s91
mf v[40:43],a[100:103],v[148:151]
s_add_u32 s39, s51, 262528
buffer_load_dwordx4 v13, s[8:11], s39 offen offset:0  lds
mf v[52:55],a[104:107],v[148:151]
buffer_load_dwordx4 v156, s[8:11], s39 offen offset:1024  lds
mf v[52:55],a[108:111],v[136:139]
wl
s_mov_b64 exec, 1
buffer_atomic_add v0, v23, s[96:99], s90 offen sc1
s_mov_b64 exec, -1
mf v[76:79],a[124:127],v[136:139]
s_waitcnt vmcnt(35)
buffer_load_dwordx4 v157, s[8:11], s39 offen offset:2048  lds
s_barrier
mf v[76:79],a[120:123],v[148:151]
tr a[96:97],v11,32768
aw a33,v170
mf v[64:67],a[116:119],v[148:151]
tr a[98:99],v11,33280
buffer_load_dwordx4 v158, s[8:11], s39 offen offset:3072  lds
mf v[64:67],a[112:115],v[136:139]
s_mov_b32 m0, 16384
s_add_u32 s39, s52, 384
buffer_load_dwordx4 v13, s[8:11], s39 offen offset:0  lds
tr a[100:101],v11,36864
mf v[60:63],a[112:115],v[132:135]
tr a[102:103],v11,37376
v_mul_f32 v180, s37, v180
mf v[60:63],a[116:119],v[144:147]
tr a[104:105],v11,40960
buffer_load_dwordx4 v156, s[8:11], s39 offen offset:1024  lds
mf v[72:75],a[120:123],v[144:147]
tr a[106:107],v11,41472
v_mul_f32 v181, s37, v181
mf v[72:75],a[124:127],v[132:135]
tr a[108:109],v11,45056
buffer_load_dwordx4 v157, s[8:11], s39 offen offset:2048  lds
mf v[68:71],a[124:127],v[128:131]
tr a[110:111],v11,45568
v_mul_f32 v182, s37, v182
mf v[68:71],a[120:123],v[140:143]
buffer_load_dwordx4 v158, s[8:11], s39 offen offset:3072  lds
mf v[56:59],a[116:119],v[140:143]
s_mov_b32 m0, 20480
v_mul_f32 v183, s37, v183
cv v180,v180,v181
mf v[56:59],a[112:115],v[128:131]
s_add_u32 s39, s52, 262528
buffer_load_dwordx4 v13, s[8:11], s39 offen offset:0  lds
wl
mf v[32:35],a[96:99],a[128:131]
tr a[112:113],v11,32776
cv v182,v182,v183
mf v[32:35],a[100:103],a[140:143]
tr a[114:115],v11,33288
buffer_load_dwordx4 v156, s[8:11], s39 offen offset:1024  lds
mf v[32:35],a[104:107],a[152:155]
tr a[116:117],v11,36872
aw a34,v180
mf v[32:35],a[108:111],a[164:167]
tr a[118:119],v11,37384
buffer_load_dwordx4 v157, s[8:11], s39 offen offset:2048  lds
mf v[36:39],a[108:111],a[168:171]
tr a[120:121],v11,40968
aw a35,v182
mf v[36:39],a[104:107],a[156:159]
tr a[122:123],v11,41480
buffer_load_dwordx4 v158, s[8:11], s39 offen offset:3072  lds
mf v[36:39],a[100:103],a[144:147]
tr a[124:125],v11,45064
v_mul_f32 v176, s37, v176
mf v[36:39],a[96:99],a[132:135]
tr a[126:127],v11,45576
v_mul_f32 v177, s37, v177
mf v[40:43],a[96:99],a[136:139]
s_mov_b32 s72, 212992
buffer_load_dword v20, v159, s[12:15], s72 offen
mf v[40:43],a[100:103],a[148:151]
v_min_u32 v159, 688, v1
v_lshlrev_b32 v159, 3, v159
mf v[40:43],a[104:107],a[160:163]
v_mul_f32 v178, s37, v178
v_mul_f32 v179, s37, v179
mf v[40:43],a[108:111],a[172:175]
wl
cv v176,v176,v177
cv v178,v178,v179
mf v[52:55],a[124:127],a[172:175]
tr a[96:97],v12,32768
aw a30,v176
mf v[52:55],a[120:123],a[160:163]
tr a[98:99],v12,33280
aw a31,v178
mf v[52:55],a[116:119],a[148:151]
tr a[100:101],v12,36864
v_mul_f32 v172, s37, v172
mf v[52:55],a[112:115],a[136:139]
tr a[102:103],v12,37376
v_mul_f32 v173, s37, v173
mf v[48:51],a[112:115],a[132:135]
tr a[104:105],v12,40960
v_mul_f32 v174, s37, v174
mf v[48:51],a[116:119],a[144:147]
tr a[106:107],v12,41472
v_mul_f32 v175, s37, v175
mf v[48:51],a[120:123],a[156:159]
tr a[108:109],v12,45056
cv v172,v172,v173
mf v[48:51],a[124:127],a[168:171]
tr a[110:111],v12,45568
cv v174,v174,v175
mf v[44:47],a[124:127],a[164:167]
aw a26,v172
aw a27,v174
mf v[44:47],a[120:123],a[152:155]
v_mul_f32 v184, s37, v184
v_mul_f32 v185, s37, v185
mf v[44:47],a[116:119],a[140:143]
v_mul_f32 v186, s37, v186
v_mul_f32 v187, s37, v187
mf v[44:47],a[112:115],a[128:131]
wl
cv v184,v184,v185
cv v186,v186,v187
mf v[56:59],a[96:99],a[128:131]
tr a[112:113],v12,32776
aw a36,v184
mf v[56:59],a[100:103],a[140:143]
tr a[114:115],v12,33288
aw a37,v186
mf v[56:59],a[104:107],a[152:155]
tr a[116:117],v12,36872
v_mul_f32 v188, s37, v188
mf v[56:59],a[108:111],a[164:167]
tr a[118:119],v12,37384
v_mul_f32 v189, s37, v189
mf v[60:63],a[108:111],a[168:171]
tr a[120:121],v12,40968
v_mul_f32 v190, s37, v190
mf v[60:63],a[104:107],a[156:159]
tr a[122:123],v12,41480
v_mul_f32 v191, s37, v191
mf v[60:63],a[100:103],a[144:147]
tr a[124:125],v12,45064
cv v188,v188,v189
mf v[60:63],a[96:99],a[132:135]
s_mov_b32 m0, 32768
tr a[126:127],v12,45576
mf v[64:67],a[96:99],a[136:139]
cv v190,v190,v191
aw a40,v188
mf v[64:67],a[100:103],a[148:151]
aw a41,v190
v_mul_f32 v192, s37, v192
mf v[64:67],a[104:107],a[160:163]
s_mov_b32 s72, 196608
buffer_load_dword v20, v159, s[16:19], s72 offen
mf v[64:67],a[108:111],a[172:175]
wl
v_mul_f32 v193, s37, v193
v_mul_f32 v194, s37, v194
mf v[76:79],a[124:127],a[172:175]
s_waitcnt vmcnt(29)
v_mul_f32 v195, s37, v195
s_barrier
mf v[76:79],a[120:123],a[160:163]
s_add_u32 s39, s48, 384
buffer_load_dwordx4 v13, s[8:11], s39 offen offset:0  lds
tr a[96:97],v11,49152
mf v[76:79],a[116:119],a[148:151]
tr a[98:99],v11,49664
cv v192,v192,v193
mf v[76:79],a[112:115],a[136:139]
tr a[100:101],v11,53248
buffer_load_dwordx4 v156, s[8:11], s39 offen offset:1024  lds
mf v[72:75],a[112:115],a[132:135]
tr a[102:103],v11,53760
cv v194,v194,v195
mf v[72:75],a[116:119],a[144:147]
tr a[104:105],v11,57344
buffer_load_dwordx4 v157, s[8:11], s39 offen offset:2048  lds
mf v[72:75],a[120:123],a[156:159]
tr a[106:107],v11,57856
aw a44,v192
mf v[72:75],a[124:127],a[168:171]
tr a[108:109],v11,61440
buffer_load_dwordx4 v158, s[8:11], s39 offen offset:3072  lds
mf v[68:71],a[124:127],a[164:167]
s_mov_b32 m0, 36864
tr a[110:111],v11,61952
mf v[68:71],a[120:123],a[152:155]
s_add_u32 s39, s48, 262528
buffer_load_dwordx4 v13, s[8:11], s39 offen offset:0  lds
mf v[68:71],a[116:119],a[140:143]
aw a45,v194
v_mul_f32 v204, s37, v204
mf v[68:71],a[112:115],a[128:131]
wl
buffer_load_dwordx4 v156, s[8:11], s39 offen offset:1024  lds
mf v[32:35],a[96:99],a[176:179]
tr a[112:113],v11,49160
v_mul_f32 v205, s37, v205
mf v[32:35],a[100:103],a[188:191]
tr a[114:115],v11,49672
buffer_load_dwordx4 v157, s[8:11], s39 offen offset:2048  lds
mf v[32:35],a[104:107],a[200:203]
tr a[116:117],v11,53256
v_mul_f32 v206, s37, v206
mf v[32:35],a[108:111],a[212:215]
tr a[118:119],v11,53768
buffer_load_dwordx4 v158, s[8:11], s39 offen offset:3072  lds
mf v[36:39],a[108:111],a[216:219]
s_mov_b32 m0, 40960
tr a[120:121],v11,57352
mf v[36:39],a[104:107],a[204:207]
s_add_u32 s39, s69, 384
buffer_load_dwordx4 v13, s[8:11], s39 offen offset:0  lds
tr a[122:123],v11,57864
mf v[36:39],a[100:103],a[192:195]
tr a[124:125],v11,61448
v_mul_f32 v207, s37, v207
mf v[36:39],a[96:99],a[180:183]
tr a[126:127],v11,61960
buffer_load_dwordx4 v156, s[8:11], s39 offen offset:1024  lds
mf v[40:43],a[96:99],a[184:187]
cv v204,v204,v205
cv v206,v206,v207
mf v[40:43],a[100:103],a[196:199]
aw a46,v204
aw a47,v206
buffer_load_dwordx4 v157, s[8:11], s39 offen offset:2048  lds
mf v[40:43],a[104:107],a[208:211]
v_mul_f32 v200, s37, v200
v_mul_f32 v201, s37, v201
mf v[40:43],a[108:111],a[220:223]
wl
buffer_load_dwordx4 v158, s[8:11], s39 offen offset:3072  lds
mf v[52:55],a[124:127],a[220:223]
s_mov_b32 m0, 45056
tr a[96:97],v12,49152
mf v[52:55],a[120:123],a[208:211]
s_add_u32 s39, s69, 262528
buffer_load_dwordx4 v13, s[8:11], s39 offen offset:0  lds
tr a[98:99],v12,49664
v_mul_f32 v202, s37, v202
v_mul_f32 v203, s37, v203
cv v200,v200,v201
cv v202,v202,v203
aw a42,v200
aw a43,v202
mf v[52:55],a[116:119],a[196:199]
tr a[100:101],v12,53248
v_mul_f32 v196, s37, v196
mf v[52:55],a[112:115],a[184:187]
tr a[102:103],v12,53760
buffer_load_dwordx4 v156, s[8:11], s39 offen offset:1024  lds
mf v[48:51],a[112:115],a[180:183]
tr a[104:105],v12,57344
v_mul_f32 v197, s37, v197
mf v[48:51],a[116:119],a[192:195]
tr a[106:107],v12,57856
v_mul_f32 v198, s37, v198
v_mul_f32 v199, s37, v199
cv v196,v196,v197
cv v198,v198,v199
aw a38,v196
aw a39,v198
buffer_load_dwordx4 v157, s[8:11], s39 offen offset:2048  lds
mf v[48:51],a[120:123],a[204:207]
s_mov_b32 s72, 196608
buffer_load_dword v20, v159, s[12:15], s72 offen
tr a[108:109],v12,61440
mf v[48:51],a[124:127],a[216:219]
tr a[110:111],v12,61952
buffer_load_dwordx4 v158, s[8:11], s39 offen offset:3072  lds
mf v[44:47],a[124:127],a[212:215]
v_mul_f32 v32, s37, v32
v_mul_f32 v33, s37, v33
mf v[44:47],a[120:123],a[200:203]
v_mul_f32 v34, s37, v34
v_mul_f32 v35, s37, v35
mf v[44:47],a[116:119],a[188:191]
cv v32,v32,v33
cv v34,v34,v35
mf v[44:47],a[112:115],a[176:179]
wl
aw a48,v32
aw a49,v34
mf v[56:59],a[96:99],a[176:179]
tr a[112:113],v12,49160
v_min_u32 v159, 752, v1
mf v[56:59],a[100:103],a[188:191]
tr a[114:115],v12,49672
v_lshlrev_b32 v159, 3, v159
mf v[56:59],a[104:107],a[200:203]
tr a[116:117],v12,53256
v_mul_f32 v36, s37, v36
mf v[56:59],a[108:111],a[212:215]
tr a[118:119],v12,53768
v_mul_f32 v37, s37, v37
mf v[60:63],a[108:111],a[216:219]
tr a[120:121],v12,57352
v_mul_f32 v38, s37, v38
mf v[60:63],a[104:107],a[204:207]
tr a[122:123],v12,57864
v_mul_f32 v39, s37, v39
mf v[60:63],a[100:103],a[192:195]
tr a[124:125],v12,61448
cv v36,v36,v37
mf v[60:63],a[96:99],a[180:183]
s_mov_b32 m0, 49152
tr a[126:127],v12,61960
mf v[64:67],a[96:99],a[184:187]
cv v38,v38,v39
aw a52,v36
mf v[64:67],a[100:103],a[196:199]
aw a53,v38
v_mul_f32 v40, s37, v40
mf v[64:67],a[104:107],a[208:211]
v_mul_f32 v41, s37, v41
v_mul_f32 v42, s37, v42
mf v[64:67],a[108:111],a[220:223]
wl
v_mul_f32 v43, s37, v43
cv v40,v40,v41
mf v[76:79],a[124:127],a[220:223]
s_waitcnt vmcnt(27)
cv v42,v42,v43
s_barrier
mf v[76:79],a[120:123],a[208:211]
s_add_u32 s39, s70, 384
buffer_load_dwordx4 v13, s[8:11], s39 offen offset:0  lds
tr a[96:97],v11,0
mf v[76:79],a[116:119],a[196:199]
tr a[98:99],v11,512
aw a56,v40
mf v[76:79],a[112:115],a[184:187]
tr a[100:101],v11,4096
buffer_load_dwordx4 v156, s[8:11], s39 offen offset:1024  lds
mf v[72:75],a[112:115],a[180:183]
tr a[102:103],v11,4608
aw a57,v42
mf v[72:75],a[116:119],a[192:195]
tr a[104:105],v11,8192
buffer_load_dwordx4 v157, s[8:11], s39 offen offset:2048  lds
mf v[72:75],a[120:123],a[204:207]
tr a[106:107],v11,8704
v_mul_f32 v52, s37, v52
mf v[72:75],a[124:127],a[216:219]
tr a[108:109],v11,12288
buffer_load_dwordx4 v158, s[8:11], s39 offen offset:3072  lds
mf v[68:71],a[124:127],a[212:215]
s_mov_b32 m0, 53248
tr a[110:111],v11,12800
mf v[68:71],a[120:123],a[200:203]
s_add_u32 s39, s70, 262528
buffer_load_dwordx4 v13, s[8:11], s39 offen offset:0  lds
mf v[68:71],a[116:119],a[188:191]
s_mov_b32 s72, 180224
buffer_load_dword v20, v159, s[16:19], s72 offen
mf v[68:71],a[112:115],a[176:179]
wl
buffer_load_dwordx4 v156, s[8:11], s39 offen offset:1024  lds
mz v[32:35],a[96:99],v[80:83],0
tr a[112:113],v11,8
v_mul_f32 v53, s37, v53
mf v[32:35],a[100:103],v[92:95]
tr a[114:115],v11,520
buffer_load_dwordx4 v157, s[8:11], s39 offen offset:2048  lds
mf v[32:35],a[104:107],v[104:107]
tr a[116:117],v11,4104
v_mul_f32 v54, s37, v54
mf v[32:35],a[108:111],v[116:119]
tr a[118:119],v11,4616
buffer_load_dwordx4 v158, s[8:11], s39 offen offset:3072  lds
mz v[36:39],a[108:111],v[120:123],0
s_mov_b32 m0, 57344
tr a[120:121],v11,8200
mf v[36:39],a[104:107],v[108:111]
s_add_u32 s39, s71, 384
buffer_load_dwordx4 v13, s[8:11], s39 offen offset:0  lds
tr a[122:123],v11,8712
mf v[36:39],a[100:103],v[96:99]
tr a[124:125],v11,12296
v_mul_f32 v55, s37, v55
mf v[36:39],a[96:99],v[84:87]
tr a[126:127],v11,12808
buffer_load_dwordx4 v156, s[8:11], s39 offen offset:1024  lds
mz v[40:43],a[96:99],v[88:91],0
cv v52,v52,v53
cv v54,v54,v55
mf v[40:43],a[100:103],v[100:103]
aw a58,v52
aw a59,v54
buffer_load_dwordx4 v157, s[8:11], s39 offen offset:2048  lds
mf v[40:43],a[104:107],v[112:115]
v_mul_f32 v48, s37, v48
v_mul_f32 v49, s37, v49
mf v[40:43],a[108:111],v[124:127]
wl
buffer_load_dwordx4 v158, s[8:11], s39 offen offset:3072  lds
mz v[52:55],a[124:127],v[124:127],0
s_mov_b32 m0, 61440
tr a[96:97],v12,0
mf v[52:55],a[120:123],v[112:115]
s_add_u32 s39, s71, 262528
buffer_load_dwordx4 v13, s[8:11], s39 offen offset:0  lds
tr a[98:99],v12,512
v_mul_f32 v50, s37, v50
v_mul_f32 v51, s37, v51
cv v48,v48,v49
cv v50,v50,v51
aw a54,v48
aw a55,v50
mf v[52:55],a[116:119],v[100:103]
tr a[100:101],v12,4096
v_mul_f32 v44, s37, v44
mf v[52:55],a[112:115],v[88:91]
tr a[102:103],v12,4608
buffer_load_dwordx4 v156, s[8:11], s39 offen offset:1024  lds
mz v[48:51],a[112:115],v[84:87],0
tr a[104:105],v12,8192
v_mul_f32 v45, s37, v45
mf v[48:51],a[116:119],v[96:99]
tr a[106:107],v12,8704
v_mul_f32 v46, s37, v46
v_mul_f32 v47, s37, v47
cv v44,v44,v45
cv v46,v46,v47
aw a50,v44
aw a51,v46
buffer_load_dwordx4 v157, s[8:11], s39 offen offset:2048  lds
mf v[48:51],a[120:123],v[108:111]
tr a[108:109],v12,12288
v_mul_f32 v56, s37, v56
mf v[48:51],a[124:127],v[120:123]
tr a[110:111],v12,12800
buffer_load_dwordx4 v158, s[8:11], s39 offen offset:3072  lds
mz v[44:47],a[124:127],v[116:119],0
v_mul_f32 v57, s37, v57
v_mul_f32 v58, s37, v58
mf v[44:47],a[120:123],v[104:107]
v_mul_f32 v59, s37, v59
cv v56,v56,v57
cv v58,v58,v59
aw a60,v56
aw a61,v58
mf v[44:47],a[116:119],v[92:95]
v_mul_f32 v60, s37, v60
v_mul_f32 v61, s37, v61
mf v[44:47],a[112:115],v[80:83]
wl
v_mul_f32 v62, s37, v62
v_mul_f32 v63, s37, v63
mz v[56:59],a[96:99],v[80:83],0
tr a[112:113],v12,8
cv v60,v60,v61
mf v[56:59],a[100:103],v[92:95]
tr a[114:115],v12,520
cv v62,v62,v63
aw a64,v60
aw a65,v62
mf v[56:59],a[104:107],v[104:107]
tr a[116:117],v12,4104
v_mul_f32 v64, s37, v64
mf v[56:59],a[108:111],v[116:119]
tr a[118:119],v12,4616
v_mul_f32 v65, s37, v65
mz v[60:63],a[108:111],v[120:123],0
tr a[120:121],v12,8200
v_mul_f32 v66, s37, v66
mf v[60:63],a[104:107],v[108:111]
tr a[122:123],v12,8712
v_mul_f32 v67, s37, v67
cv v64,v64,v65
cv v66,v66,v67
aw a68,v64
aw a69,v66
mf v[60:63],a[100:103],v[96:99]
tr a[124:125],v12,12296
v_mul_f32 v76, s37, v76
mf v[60:63],a[96:99],v[84:87]
s_mov_b32 s72, 180224
buffer_load_dword v20, v159, s[12:15], s72 offen
tr a[126:127],v12,12808
mz v[64:67],a[96:99],v[88:91],0
s_mov_b32 m0, 0
v_mul_f32 v77, s37, v77
v_mul_f32 v78, s37, v78
mf v[64:67],a[100:103],v[100:103]
v_mul_f32 v79, s37, v79
cv v76,v76,v77
cv v78,v78,v79
aw a70,v76
aw a71,v78
mf v[64:67],a[104:107],v[112:115]
v_mul_f32 v72, s37, v72
v_mul_f32 v73, s37, v73
mf v[64:67],a[108:111],v[124:127]
wl
v_mul_f32 v74, s37, v74
v_mul_f32 v75, s37, v75
mz v[76:79],a[124:127],v[124:127],0
s_waitcnt vmcnt(37)
cv v72,v72,v73
s_barrier
mf v[76:79],a[120:123],v[112:115]
s_add_u32 s39, s54, 512
buffer_load_dwordx4 v13, s[8:11], s39 offen offset:0  lds
tr a[96:97],v11,16384
cv v74,v74,v75
aw a66,v72
aw a67,v74
mf v[76:79],a[116:119],v[100:103]
tr a[98:99],v11,16896
buffer_load_dwordx4 v156, s[8:11], s39 offen offset:1024  lds
mf v[76:79],a[112:115],v[88:91]
tr a[100:101],v11,20480
v_mul_f32 v68, s37, v68
mz v[72:75],a[112:115],v[84:87],0
tr a[102:103],v11,20992
buffer_load_dwordx4 v157, s[8:11], s39 offen offset:2048  lds
mf v[72:75],a[116:119],v[96:99]
tr a[104:105],v11,20488
v_mul_f32 v69, s37, v69
v_mul_f32 v70, s37, v70
v_mul_f32 v71, s37, v71
cv v68,v68,v69
cv v70,v70,v71
aw a62,v68
aw a63,v70
mf v[72:75],a[120:123],v[108:111]
tr a[106:107],v11,21000
buffer_load_dwordx4 v158, s[8:11], s39 offen offset:3072  lds
mf v[72:75],a[124:127],v[120:123]
s_mov_b32 m0, 4096
s_add_u32 s39, s54, 262656
buffer_load_dwordx4 v13, s[8:11], s39 offen offset:0  lds
tr a[108:109],v11,16392
mz v[68:71],a[124:127],v[116:119],0
tr a[110:111],v11,16904
mf v[68:71],a[120:123],v[104:107]
buffer_load_dwordx4 v156, s[8:11], s39 offen offset:1024  lds
mf v[68:71],a[116:119],v[92:95]
mf v[68:71],a[112:115],v[80:83]
wl
buffer_load_dwordx4 v157, s[8:11], s39 offen offset:2048  lds
mf v[32:35],a[96:99],v[128:131]
tr a[112:113],v12,16384
buffer_load_dwordx4 v158, s[8:11], s39 offen offset:3072  lds
mf v[32:35],a[100:103],v[140:143]
s_mov_b32 m0, 8192
tr a[114:115],v12,16896
mf v[44:47],a[104:107],v[140:143]
s_add_u32 s39, s51, 512
buffer_load_dwordx4 v13, s[8:11], s39 offen offset:0  lds
tr a[116:117],v12,20480
mf v[44:47],a[108:111],v[128:131]
tr a[118:119],v12,20992
mf v[48:51],a[108:111],v[132:135]
tr a[120:121],v12,20488
buffer_load_dwordx4 v156, s[8:11], s39 offen offset:1024  lds
mf v[48:51],a[104:107],v[144:147]
tr a[122:123],v12,21000
buffer_load_dwordx4 v157, s[8:11], s39 offen offset:2048  lds
mf v[36:39],a[100:103],v[144:147]
tr a[124:125],v12,16392
mf v[36:39],a[96:99],v[132:135]
tr a[126:127],v12,16904
buffer_load_dwordx4 v158, s[8:11], s39 offen offset:3072  lds
mf v[40:43],a[96:99],v[136:139]
s_mov_b32 m0, 12288
mf v[40:43],a[100:103],v[148:151]
s_add_u32 s39, s51, 262656
buffer_load_dwordx4 v13, s[8:11], s39 offen offset:0  lds
mf v[52:55],a[104:107],v[148:151]
buffer_load_dwordx4 v156, s[8:11], s39 offen offset:1024  lds
mf v[52:55],a[108:111],v[136:139]
wl
mf v[76:79],a[124:127],v[136:139]
s_waitcnt vmcnt(32)
buffer_load_dwordx4 v157, s[8:11], s39 offen offset:2048  lds
s_barrier
mf v[76:79],a[120:123],v[148:151]
tr a[96:97],v11,32768
mf v[64:67],a[116:119],v[148:151]
s_mov_b32 s72, 163840
buffer_load_dword v20, v159, s[16:19], s72 offen
tr a[98:99],v11,33280
buffer_load_dwordx4 v158, s[8:11], s39 offen offset:3072  lds
mf v[64:67],a[112:115],v[136:139]
s_mov_b32 m0, 16384
s_add_u32 s39, s52, 512
buffer_load_dwordx4 v13, s[8:11], s39 offen offset:0  lds
tr a[100:101],v11,36864
mf v[60:63],a[112:115],v[132:135]
tr a[102:103],v11,37376
mf v[60:63],a[116:119],v[144:147]
tr a[104:105],v11,40960
buffer_load_dwordx4 v156, s[8:11], s39 offen offset:1024  lds
mf v[72:75],a[120:123],v[144:147]
tr a[106:107],v11,41472
mf v[72:75],a[124:127],v[132:135]
tr a[108:109],v11,45056
buffer_load_dwordx4 v157, s[8:11], s39 offen offset:2048  lds
mf v[68:71],a[124:127],v[128:131]
tr a[110:111],v11,45568
mf v[68:71],a[120:123],v[140:143]
buffer_load_dwordx4 v158, s[8:11], s39 offen offset:3072  lds
mf v[56:59],a[116:119],v[140:143]
s_mov_b32 m0, 20480
mf v[56:59],a[112:115],v[128:131]
s_add_u32 s39, s52, 262656
buffer_load_dwordx4 v13, s[8:11], s39 offen offset:0  lds
wl
mf v[32:35],a[96:99],a[128:131]
tr a[112:113],v11,32776
mf v[32:35],a[100:103],a[140:143]
tr a[114:115],v11,33288
buffer_load_dwordx4 v156, s[8:11], s39 offen offset:1024  lds
mf v[32:35],a[104:107],a[152:155]
tr a[116:117],v11,36872
mf v[32:35],a[108:111],a[164:167]
tr a[118:119],v11,37384
buffer_load_dwordx4 v157, s[8:11], s39 offen offset:2048  lds
mf v[36:39],a[108:111],a[168:171]
tr a[120:121],v11,40968
mf v[36:39],a[104:107],a[156:159]
tr a[122:123],v11,41480
buffer_load_dwordx4 v158, s[8:11], s39 offen offset:3072  lds
mf v[36:39],a[100:103],a[144:147]
tr a[124:125],v11,45064
mf v[36:39],a[96:99],a[132:135]
tr a[126:127],v11,45576
mf v[40:43],a[96:99],a[136:139]
mf v[40:43],a[100:103],a[148:151]
mf v[40:43],a[104:107],a[160:163]
mf v[40:43],a[108:111],a[172:175]
wl
mf v[52:55],a[124:127],a[172:175]
tr a[96:97],v12,32768
mf v[52:55],a[120:123],a[160:163]
tr a[98:99],v12,33280
mf v[52:55],a[116:119],a[148:151]
tr a[100:101],v12,36864
mf v[52:55],a[112:115],a[136:139]
tr a[102:103],v12,37376
mf v[48:51],a[112:115],a[132:135]
tr a[104:105],v12,40960
mf v[48:51],a[116:119],a[144:147]
tr a[106:107],v12,41472
mf v[48:51],a[120:123],a[156:159]
tr a[108:109],v12,45056
mf v[48:51],a[124:127],a[168:171]
tr a[110:111],v12,45568
mf v[44:47],a[124:127],a[164:167]
s_mov_b32 s72, 163840
buffer_load_dword v20, v159, s[12:15], s72 offen
mf v[44:47],a[120:123],a[152:155]
v_min_u32 v159, 816, v1
v_lshlrev_b32 v159, 3, v159
mf v[44:47],a[116:119],a[140:143]
mf v[44:47],a[112:115],a[128:131]
wl
mf v[56:59],a[96:99],a[128:131]
tr a[112:113],v12,32776
v_lshl_add_u32 v21, v1, 3, s3
mf v[56:59],a[100:103],a[140:143]
tr a[114:115],v12,33288
v_min_u32 v21, L_end-L_main4, v21
mf v[56:59],a[104:107],a[152:155]
tr a[116:117],v12,36872
mf v[56:59],a[108:111],a[164:167]
tr a[118:119],v12,37384
mf v[60:63],a[108:111],a[168:171]
tr a[120:121],v12,40968
mf v[60:63],a[104:107],a[156:159]
tr a[122:123],v12,41480
mf v[60:63],a[100:103],a[144:147]
tr a[124:125],v12,45064
mf v[60:63],a[96:99],a[132:135]
s_mov_b32 m0, 32768
tr a[126:127],v12,45576
mf v[64:67],a[96:99],a[136:139]
global_load_dword v20, v21, s[58:59]
mf v[64:67],a[100:103],a[148:151]
mf v[64:67],a[104:107],a[160:163]
mf v[64:67],a[108:111],a[172:175]
wl
mf v[76:79],a[124:127],a[172:175]
s_waitcnt vmcnt(28)
s_barrier
mf v[76:79],a[120:123],a[160:163]
s_add_u32 s39, s48, 512
buffer_load_dwordx4 v13, s[8:11], s39 offen offset:0  lds
tr a[96:97],v11,49152
mf v[76:79],a[116:119],a[148:151]
tr a[98:99],v11,49664
mf v[76:79],a[112:115],a[136:139]
tr a[100:101],v11,53248
buffer_load_dwordx4 v156, s[8:11], s39 offen offset:1024  lds
mf v[72:75],a[112:115],a[132:135]
tr a[102:103],v11,53760
mf v[72:75],a[116:119],a[144:147]
tr a[104:105],v11,57344
buffer_load_dwordx4 v157, s[8:11], s39 offen offset:2048  lds
mf v[72:75],a[120:123],a[156:159]
tr a[106:107],v11,57856
mf v[72:75],a[124:127],a[168:171]
tr a[108:109],v11,61440
buffer_load_dwordx4 v158, s[8:11], s39 offen offset:3072  lds
mf v[68:71],a[124:127],a[164:167]
s_mov_b32 m0, 36864
tr a[110:111],v11,61952
mf v[68:71],a[120:123],a[152:155]
s_add_u32 s39, s48, 262656
buffer_load_dwordx4 v13, s[8:11], s39 offen offset:0  lds
mf v[68:71],a[116:119],a[140:143]
mf v[68:71],a[112:115],a[128:131]
wl
buffer_load_dwordx4 v156, s[8:11], s39 offen offset:1024  lds
mf v[32:35],a[96:99],a[176:179]
tr a[112:113],v11,49160
mf v[32:35],a[100:103],a[188:191]
tr a[114:115],v11,49672
buffer_load_dwordx4 v157, s[8:11], s39 offen offset:2048  lds
mf v[32:35],a[104:107],a[200:203]
tr a[116:117],v11,53256
mf v[32:35],a[108:111],a[212:215]
s_mov_b32 s72, 147456
buffer_load_dword v20, v159, s[16:19], s72 offen
tr a[118:119],v11,53768
buffer_load_dwordx4 v158, s[8:11], s39 offen offset:3072  lds
mf v[36:39],a[108:111],a[216:219]
s_mov_b32 m0, 40960
tr a[120:121],v11,57352
mf v[36:39],a[104:107],a[204:207]
s_add_u32 s39, s69, 512
buffer_load_dwordx4 v13, s[8:11], s39 offen offset:0  lds
tr a[122:123],v11,57864
mf v[36:39],a[100:103],a[192:195]
tr a[124:125],v11,61448
mf v[36:39],a[96:99],a[180:183]
tr a[126:127],v11,61960
buffer_load_dwordx4 v156, s[8:11], s39 offen offset:1024  lds
mf v[40:43],a[96:99],a[184:187]
mf v[40:43],a[100:103],a[196:199]
buffer_load_dwordx4 v157, s[8:11], s39 offen offset:2048  lds
mf v[40:43],a[104:107],a[208:211]
v_mul_f32 v32, s37, v32
v_mul_f32 v33, s37, v33
mf v[40:43],a[108:111],a[220:223]
wl
buffer_load_dwordx4 v158, s[8:11], s39 offen offset:3072  lds
mf v[52:55],a[124:127],a[220:223]
s_mov_b32 m0, 45056
tr a[96:97],v12,49152
mf v[52:55],a[120:123],a[208:211]
s_add_u32 s39, s69, 262656
buffer_load_dwordx4 v13, s[8:11], s39 offen offset:0  lds
tr a[98:99],v12,49664
mf v[52:55],a[116:119],a[196:199]
tr a[100:101],v12,53248
v_mul_f32 v34, s37, v34
mf v[52:55],a[112:115],a[184:187]
tr a[102:103],v12,53760
buffer_load_dwordx4 v156, s[8:11], s39 offen offset:1024  lds
mf v[48:51],a[112:115],a[180:183]
tr a[104:105],v12,57344
v_mul_f32 v35, s37, v35
mf v[48:51],a[116:119],a[192:195]
tr a[106:107],v12,57856
buffer_load_dwordx4 v157, s[8:11], s39 offen offset:2048  lds
mf v[48:51],a[120:123],a[204:207]
tr a[108:109],v12,61440
cv v32,v32,v33
mf v[48:51],a[124:127],a[216:219]
tr a[110:111],v12,61952
buffer_load_dwordx4 v158, s[8:11], s39 offen offset:3072  lds
mf v[44:47],a[124:127],a[212:215]
cv v34,v34,v35
aw a72,v32
mf v[44:47],a[120:123],a[200:203]
aw a73,v34
v_mul_f32 v36, s37, v36
mf v[44:47],a[116:119],a[188:191]
v_mul_f32 v37, s37, v37
v_mul_f32 v38, s37, v38
mf v[44:47],a[112:115],a[176:179]
wl
v_mul_f32 v39, s37, v39
cv v36,v36,v37
mf v[56:59],a[96:99],a[176:179]
tr a[112:113],v12,49160
cv v38,v38,v39
mf v[56:59],a[100:103],a[188:191]
tr a[114:115],v12,49672
aw a76,v36
mf v[56:59],a[104:107],a[200:203]
tr a[116:117],v12,53256
aw a77,v38
mf v[56:59],a[108:111],a[212:215]
tr a[118:119],v12,53768
v_mul_f32 v40, s37, v40
mf v[60:63],a[108:111],a[216:219]
tr a[120:121],v12,57352
v_mul_f32 v41, s37, v41
mf v[60:63],a[104:107],a[204:207]
tr a[122:123],v12,57864
v_mul_f32 v42, s37, v42
mf v[60:63],a[100:103],a[192:195]
tr a[124:125],v12,61448
v_mul_f32 v43, s37, v43
mf v[60:63],a[96:99],a[180:183]
s_mov_b32 m0, 49152
tr a[126:127],v12,61960
mf v[64:67],a[96:99],a[184:187]
cv v40,v40,v41
cv v42,v42,v43
mf v[64:67],a[100:103],a[196:199]
s_mov_b32 s72, 147456
buffer_load_dword v20, v159, s[12:15], s72 offen
mf v[64:67],a[104:107],a[208:211]
aw a80,v40
aw a81,v42
mf v[64:67],a[108:111],a[220:223]
wl
v_mul_f32 v52, s37, v52
v_mul_f32 v53, s37, v53
mf v[76:79],a[124:127],a[220:223]
s_waitcnt vmcnt(28)
v_mul_f32 v54, s37, v54
s_barrier
mf v[76:79],a[120:123],a[208:211]
s_add_u32 s39, s70, 512
buffer_load_dwordx4 v13, s[8:11], s39 offen offset:0  lds
tr a[96:97],v11,0
mf v[76:79],a[116:119],a[196:199]
tr a[98:99],v11,512
v_mul_f32 v55, s37, v55
mf v[76:79],a[112:115],a[184:187]
tr a[100:101],v11,4096
buffer_load_dwordx4 v156, s[8:11], s39 offen offset:1024  lds
mf v[72:75],a[112:115],a[180:183]
tr a[102:103],v11,4608
cv v52,v52,v53
mf v[72:75],a[116:119],a[192:195]
tr a[104:105],v11,8192
buffer_load_dwordx4 v157, s[8:11], s39 offen offset:2048  lds
mf v[72:75],a[120:123],a[204:207]
tr a[106:107],v11,8704
cv v54,v54,v55
mf v[72:75],a[124:127],a[216:219]
tr a[108:109],v11,12288
buffer_load_dwordx4 v158, s[8:11], s39 offen offset:3072  lds
mf v[68:71],a[124:127],a[212:215]
s_mov_b32 m0, 53248
tr a[110:111],v11,12800
mf v[68:71],a[120:123],a[200:203]
s_add_u32 s39, s70, 262656
buffer_load_dwordx4 v13, s[8:11], s39 offen offset:0  lds
mf v[68:71],a[116:119],a[188:191]
aw a82,v52
aw a83,v54
mf v[68:71],a[112:115],a[176:179]
wl
buffer_load_dwordx4 v156, s[8:11], s39 offen offset:1024  lds
mz v[32:35],a[96:99],v[80:83],0
tr a[112:113],v11,8
v_mul_f32 v48, s37, v48
mf v[32:35],a[100:103],v[92:95]
tr a[114:115],v11,520
buffer_load_dwordx4 v157, s[8:11], s39 offen offset:2048  lds
mf v[32:35],a[104:107],v[104:107]
tr a[116:117],v11,4104
v_mul_f32 v49, s37, v49
mf v[32:35],a[108:111],v[116:119]
tr a[118:119],v11,4616
buffer_load_dwordx4 v158, s[8:11], s39 offen offset:3072  lds
mz v[36:39],a[108:111],v[120:123],0
s_mov_b32 m0, 57344
tr a[120:121],v11,8200
mf v[36:39],a[104:107],v[108:111]
s_add_u32 s39, s71, 512
buffer_load_dwordx4 v13, s[8:11], s39 offen offset:0  lds
tr a[122:123],v11,8712
mf v[36:39],a[100:103],v[96:99]
tr a[124:125],v11,12296
v_mul_f32 v50, s37, v50
mf v[36:39],a[96:99],v[84:87]
tr a[126:127],v11,12808
buffer_load_dwordx4 v156, s[8:11], s39 offen offset:1024  lds
mz v[40:43],a[96:99],v[88:91],0
v_mul_f32 v51, s37, v51
cv v48,v48,v49
mf v[40:43],a[100:103],v[100:103]
buffer_load_dwordx4 v157, s[8:11], s39 offen offset:2048  lds
mf v[40:43],a[104:107],v[112:115]
cv v50,v50,v51
aw a78,v48
mf v[40:43],a[108:111],v[124:127]
wl
buffer_load_dwordx4 v158, s[8:11], s39 offen offset:3072  lds
mz v[52:55],a[124:127],v[124:127],0
s_mov_b32 m0, 61440
tr a[96:97],v12,0
mf v[52:55],a[120:123],v[112:115]
s_add_u32 s39, s71, 262656
buffer_load_dwordx4 v13, s[8:11], s39 offen offset:0  lds
tr a[98:99],v12,512
aw a79,v50
mf v[52:55],a[116:119],v[100:103]
tr a[100:101],v12,4096
v_mul_f32 v44, s37, v44
mf v[52:55],a[112:115],v[88:91]
tr a[102:103],v12,4608
buffer_load_dwordx4 v156, s[8:11], s39 offen offset:1024  lds
mz v[48:51],a[112:115],v[84:87],0
tr a[104:105],v12,8192
v_mul_f32 v45, s37, v45
mf v[48:51],a[116:119],v[96:99]
tr a[106:107],v12,8704
v_mul_f32 v46, s37, v46
v_mul_f32 v47, s37, v47
cv v44,v44,v45
cv v46,v46,v47
aw a74,v44
aw a75,v46
buffer_load_dwordx4 v157, s[8:11], s39 offen offset:2048  lds
mf v[48:51],a[120:123],v[108:111]
tr a[108:109],v12,12288
v_mul_f32 v56, s37, v56
mf v[48:51],a[124:127],v[120:123]
tr a[110:111],v12,12800
buffer_load_dwordx4 v158, s[8:11], s39 offen offset:3072  lds
mz v[44:47],a[124:127],v[116:119],0
s_mov_b32 s72, 131072
buffer_load_dword v20, v159, s[16:19], s72 offen
mf v[44:47],a[120:123],v[104:107]
v_mul_f32 v57, s37, v57
v_mul_f32 v58, s37, v58
v_mul_f32 v59, s37, v59
cv v56,v56,v57
cv v58,v58,v59
aw a84,v56
aw a85,v58
mf v[44:47],a[116:119],v[92:95]
v_mul_f32 v60, s37, v60
v_mul_f32 v61, s37, v61
mf v[44:47],a[112:115],v[80:83]
wl
v_mul_f32 v62, s37, v62
v_mul_f32 v63, s37, v63
mz v[56:59],a[96:99],v[80:83],0
tr a[112:113],v12,8
cv v60,v60,v61
mf v[56:59],a[100:103],v[92:95]
tr a[114:115],v12,520
cv v62,v62,v63
aw a88,v60
aw a89,v62
mf v[56:59],a[104:107],v[104:107]
tr a[116:117],v12,4104
v_mul_f32 v64, s37, v64
mf v[56:59],a[108:111],v[116:119]
tr a[118:119],v12,4616
v_mul_f32 v65, s37, v65
mz v[60:63],a[108:111],v[120:123],0
tr a[120:121],v12,8200
v_mul_f32 v66, s37, v66
mf v[60:63],a[104:107],v[108:111]
tr a[122:123],v12,8712
v_mul_f32 v67, s37, v67
cv v64,v64,v65
cv v66,v66,v67
aw a92,v64
aw a93,v66
mf v[60:63],a[100:103],v[96:99]
tr a[124:125],v12,12296
v_mul_f32 v76, s37, v76
mf v[60:63],a[96:99],v[84:87]
s_mov_b32 m0, 0
tr a[126:127],v12,12808
mz v[64:67],a[96:99],v[88:91],0
v_mul_f32 v77, s37, v77
v_mul_f32 v78, s37, v78
mf v[64:67],a[100:103],v[100:103]
v_mul_f32 v79, s37, v79
cv v76,v76,v77
cv v78,v78,v79
aw a94,v76
aw a95,v78
mf v[64:67],a[104:107],v[112:115]
v_mul_f32 v72, s37, v72
v_mul_f32 v73, s37, v73
mf v[64:67],a[108:111],v[124:127]
wl
v_mul_f32 v74, s37, v74
v_mul_f32 v75, s37, v75
mz v[76:79],a[124:127],v[124:127],0
s_waitcnt vmcnt(37)
cv v72,v72,v73
s_barrier
mf v[76:79],a[120:123],v[112:115]
s_add_u32 s39, s54, 640
buffer_load_dwordx4 v13, s[8:11], s39 offen offset:0  lds
tr a[96:97],v11,16384
cv v74,v74,v75
aw a90,v72
aw a91,v74
mf v[76:79],a[116:119],v[100:103]
tr a[98:99],v11,16896
buffer_load_dwordx4 v156, s[8:11], s39 offen offset:1024  lds
mf v[76:79],a[112:115],v[88:91]
tr a[100:101],v11,20480
v_mul_f32 v68, s37, v68
mz v[72:75],a[112:115],v[84:87],0
tr a[102:103],v11,20992
buffer_load_dwordx4 v157, s[8:11], s39 offen offset:2048  lds
mf v[72:75],a[116:119],v[96:99]
tr a[104:105],v11,20488
v_mul_f32 v69, s37, v69
v_mul_f32 v70, s37, v70
v_mul_f32 v71, s37, v71
cv v68,v68,v69
cv v70,v70,v71
aw a86,v68
aw a87,v70
mf v[72:75],a[120:123],v[108:111]
tr a[106:107],v11,21000
buffer_load_dwordx4 v158, s[8:11], s39 offen offset:3072  lds
mf v[72:75],a[124:127],v[120:123]
s_mov_b32 m0, 4096
s_add_u32 s39, s54, 262784
buffer_load_dwordx4 v13, s[8:11], s39 offen offset:0  lds
tr a[108:109],v11,16392
mz v[68:71],a[124:127],v[116:119],0
tr a[110:111],v11,16904
mf v[68:71],a[120:123],v[104:107]
buffer_load_dwordx4 v156, s[8:11], s39 offen offset:1024  lds
mf v[68:71],a[116:119],v[92:95]
mf v[68:71],a[112:115],v[80:83]
wl
buffer_load_dwordx4 v157, s[8:11], s39 offen offset:2048  lds
mf v[32:35],a[96:99],v[128:131]
tr a[112:113],v12,16384
buffer_load_dwordx4 v158, s[8:11], s39 offen offset:3072  lds
mf v[32:35],a[100:103],v[140:143]
s_mov_b32 m0, 8192
tr a[114:115],v12,16896
mf v[44:47],a[104:107],v[140:143]
s_add_u32 s39, s51, 640
buffer_load_dwordx4 v13, s[8:11], s39 offen offset:0  lds
tr a[116:117],v12,20480
mf v[44:47],a[108:111],v[128:131]
tr a[118:119],v12,20992
mf v[48:51],a[108:111],v[132:135]
s_mov_b32 s72, 131072
buffer_load_dword v20, v159, s[12:15], s72 offen
tr a[120:121],v12,20488
buffer_load_dwordx4 v156, s[8:11], s39 offen offset:1024  lds
mf v[48:51],a[104:107],v[144:147]
tr a[122:123],v12,21000
buffer_load_dwordx4 v157, s[8:11], s39 offen offset:2048  lds
mf v[36:39],a[100:103],v[144:147]
tr a[124:125],v12,16392
mf v[36:39],a[96:99],v[132:135]
tr a[126:127],v12,16904
buffer_load_dwordx4 v158, s[8:11], s39 offen offset:3072  lds
mf v[40:43],a[96:99],v[136:139]
s_mov_b32 m0, 12288
mf v[40:43],a[100:103],v[148:151]
s_add_u32 s39, s51, 262784
buffer_load_dwordx4 v13, s[8:11], s39 offen offset:0  lds
mf v[52:55],a[104:107],v[148:151]
buffer_load_dwordx4 v156, s[8:11], s39 offen offset:1024  lds
mf v[52:55],a[108:111],v[136:139]
wl
mf v[76:79],a[124:127],v[136:139]
s_waitcnt vmcnt(33)
buffer_load_dwordx4 v157, s[8:11], s39 offen offset:2048  lds
s_barrier
mf v[76:79],a[120:123],v[148:151]
tr a[96:97],v11,32768
mf v[64:67],a[116:119],v[148:151]
tr a[98:99],v11,33280
buffer_load_dwordx4 v158, s[8:11], s39 offen offset:3072  lds
mf v[64:67],a[112:115],v[136:139]
s_mov_b32 m0, 16384
s_add_u32 s39, s52, 640
buffer_load_dwordx4 v13, s[8:11], s39 offen offset:0  lds
tr a[100:101],v11,36864
mf v[60:63],a[112:115],v[132:135]
tr a[102:103],v11,37376
mf v[60:63],a[116:119],v[144:147]
tr a[104:105],v11,40960
buffer_load_dwordx4 v156, s[8:11], s39 offen offset:1024  lds
mf v[72:75],a[120:123],v[144:147]
tr a[106:107],v11,41472
mf v[72:75],a[124:127],v[132:135]
tr a[108:109],v11,45056
buffer_load_dwordx4 v157, s[8:11], s39 offen offset:2048  lds
mf v[68:71],a[124:127],v[128:131]
tr a[110:111],v11,45568
mf v[68:71],a[120:123],v[140:143]
buffer_load_dwordx4 v158, s[8:11], s39 offen offset:3072  lds
mf v[56:59],a[116:119],v[140:143]
s_mov_b32 m0, 20480
mf v[56:59],a[112:115],v[128:131]
s_add_u32 s39, s52, 262784
buffer_load_dwordx4 v13, s[8:11], s39 offen offset:0  lds
wl
mf v[32:35],a[96:99],a[128:131]
tr a[112:113],v11,32776
mf v[32:35],a[100:103],a[140:143]
tr a[114:115],v11,33288
buffer_load_dwordx4 v156, s[8:11], s39 offen offset:1024  lds
mf v[32:35],a[104:107],a[152:155]
tr a[116:117],v11,36872
mf v[32:35],a[108:111],a[164:167]
tr a[118:119],v11,37384
buffer_load_dwordx4 v157, s[8:11], s39 offen offset:2048  lds
mf v[36:39],a[108:111],a[168:171]
tr a[120:121],v11,40968
mf v[36:39],a[104:107],a[156:159]
tr a[122:123],v11,41480
buffer_load_dwordx4 v158, s[8:11], s39 offen offset:3072  lds
mf v[36:39],a[100:103],a[144:147]
tr a[124:125],v11,45064
mf v[36:39],a[96:99],a[132:135]
tr a[126:127],v11,45576
mf v[40:43],a[96:99],a[136:139]
s_mov_b32 s72, 114688
buffer_load_dword v20, v159, s[16:19], s72 offen
mf v[40:43],a[100:103],a[148:151]
mf v[40:43],a[104:107],a[160:163]
mf v[40:43],a[108:111],a[172:175]
wl
mf v[52:55],a[124:127],a[172:175]
tr a[96:97],v12,32768
mf v[52:55],a[120:123],a[160:163]
tr a[98:99],v12,33280
mf v[52:55],a[116:119],a[148:151]
tr a[100:101],v12,36864
mf v[52:55],a[112:115],a[136:139]
tr a[102:103],v12,37376
mf v[48:51],a[112:115],a[132:135]
tr a[104:105],v12,40960
mf v[48:51],a[116:119],a[144:147]
tr a[106:107],v12,41472
mf v[48:51],a[120:123],a[156:159]
tr a[108:109],v12,45056
mf v[48:51],a[124:127],a[168:171]
tr a[110:111],v12,45568
mf v[44:47],a[124:127],a[164:167]
mf v[44:47],a[120:123],a[152:155]
mf v[44:47],a[116:119],a[140:143]
mf v[44:47],a[112:115],a[128:131]
wl
mf v[56:59],a[96:99],a[128:131]
tr a[112:113],v12,32776
mf v[56:59],a[100:103],a[140:143]
tr a[114:115],v12,33288
mf v[56:59],a[104:107],a[152:155]
tr a[116:117],v12,36872
mf v[56:59],a[108:111],a[164:167]
tr a[118:119],v12,37384
mf v[60:63],a[108:111],a[168:171]
tr a[120:121],v12,40968
mf v[60:63],a[104:107],a[156:159]
tr a[122:123],v12,41480
mf v[60:63],a[100:103],a[144:147]
tr a[124:125],v12,45064
mf v[60:63],a[96:99],a[132:135]
s_mov_b32 m0, 32768
tr a[126:127],v12,45576
mf v[64:67],a[96:99],a[136:139]
mf v[64:67],a[100:103],a[148:151]
mf v[64:67],a[104:107],a[160:163]
mf v[64:67],a[108:111],a[172:175]
wl
mf v[76:79],a[124:127],a[172:175]
s_waitcnt vmcnt(27)
s_barrier
mf v[76:79],a[120:123],a[160:163]
s_add_u32 s39, s48, 640
buffer_load_dwordx4 v13, s[8:11], s39 offen offset:0  lds
tr a[96:97],v11,49152
mf v[76:79],a[116:119],a[148:151]
tr a[98:99],v11,49664
mf v[76:79],a[112:115],a[136:139]
tr a[100:101],v11,53248
buffer_load_dwordx4 v156, s[8:11], s39 offen offset:1024  lds
mf v[72:75],a[112:115],a[132:135]
tr a[102:103],v11,53760
mf v[72:75],a[116:119],a[144:147]
tr a[104:105],v11,57344
buffer_load_dwordx4 v157, s[8:11], s39 offen offset:2048  lds
mf v[72:75],a[120:123],a[156:159]
s_mov_b32 s72, 114688
buffer_load_dword v20, v159, s[12:15], s72 offen
tr a[106:107],v11,57856
mf v[72:75],a[124:127],a[168:171]
tr a[108:109],v11,61440
buffer_load_dwordx4 v158, s[8:11], s39 offen offset:3072  lds
mf v[68:71],a[124:127],a[164:167]
s_mov_b32 m0, 36864
tr a[110:111],v11,61952
mf v[68:71],a[120:123],a[152:155]
s_add_u32 s39, s48, 262784
buffer_load_dwordx4 v13, s[8:11], s39 offen offset:0  lds
mf v[68:71],a[116:119],a[140:143]
mf v[68:71],a[112:115],a[128:131]
wl
buffer_load_dwordx4 v156, s[8:11], s39 offen offset:1024  lds
mf v[32:35],a[96:99],a[176:179]
tr a[112:113],v11,49160
mf v[32:35],a[100:103],a[188:191]
tr a[114:115],v11,49672
buffer_load_dwordx4 v157, s[8:11], s39 offen offset:2048  lds
mf v[32:35],a[104:107],a[200:203]
tr a[116:117],v11,53256
mf v[32:35],a[108:111],a[212:215]
tr a[118:119],v11,53768
buffer_load_dwordx4 v158, s[8:11], s39 offen offset:3072  lds
mf v[36:39],a[108:111],a[216:219]
s_mov_b32 m0, 40960
tr a[120:121],v11,57352
mf v[36:39],a[104:107],a[204:207]
s_add_u32 s39, s69, 640
buffer_load_dwordx4 v13, s[8:11], s39 offen offset:0  lds
tr a[122:123],v11,57864
mf v[36:39],a[100:103],a[192:195]
tr a[124:125],v11,61448
mf v[36:39],a[96:99],a[180:183]
tr a[126:127],v11,61960
buffer_load_dwordx4 v156, s[8:11], s39 offen offset:1024  lds
mf v[40:43],a[96:99],a[184:187]
mf v[40:43],a[100:103],a[196:199]
buffer_load_dwordx4 v157, s[8:11], s39 offen offset:2048  lds
mf v[40:43],a[104:107],a[208:211]
v_mul_f32 v32, s37, v32
v_mul_f32 v33, s37, v33
mf v[40:43],a[108:111],a[220:223]
wl
buffer_load_dwordx4 v158, s[8:11], s39 offen offset:3072  lds
mf v[52:55],a[124:127],a[220:223]
s_mov_b32 m0, 45056
tr a[96:97],v12,49152
mf v[52:55],a[120:123],a[208:211]
s_add_u32 s39, s69, 262784
buffer_load_dwordx4 v13, s[8:11], s39 offen offset:0  lds
tr a[98:99],v12,49664
mf v[52:55],a[116:119],a[196:199]
tr a[100:101],v12,53248
v_mul_f32 v34, s37, v34
mf v[52:55],a[112:115],a[184:187]
tr a[102:103],v12,53760
buffer_load_dwordx4 v156, s[8:11], s39 offen offset:1024  lds
mf v[48:51],a[112:115],a[180:183]
tr a[104:105],v12,57344
v_mul_f32 v35, s37, v35
mf v[48:51],a[116:119],a[192:195]
tr a[106:107],v12,57856
buffer_load_dwordx4 v157, s[8:11], s39 offen offset:2048  lds
mf v[48:51],a[120:123],a[204:207]
tr a[108:109],v12,61440
cv v160,v32,v33
mf v[48:51],a[124:127],a[216:219]
tr a[110:111],v12,61952
buffer_load_dwordx4 v158, s[8:11], s39 offen offset:3072  lds
mf v[44:47],a[124:127],a[212:215]
cv v161,v34,v35
v_mul_f32 v36, s37, v36
mf v[44:47],a[120:123],a[200:203]
v_mul_f32 v37, s37, v37
v_mul_f32 v38, s37, v38
mf v[44:47],a[116:119],a[188:191]
v_mul_f32 v39, s37, v39
cv v164,v36,v37
mf v[44:47],a[112:115],a[176:179]
wl
cv v165,v38,v39
v_mul_f32 v40, s37, v40
mf v[56:59],a[96:99],a[176:179]
tr a[112:113],v12,49160
v_mul_f32 v41, s37, v41
mf v[56:59],a[100:103],a[188:191]
tr a[114:115],v12,49672
v_mul_f32 v42, s37, v42
mf v[56:59],a[104:107],a[200:203]
s_mov_b32 s72, 98304
buffer_load_dword v20, v159, s[16:19], s72 offen
tr a[116:117],v12,53256
mf v[56:59],a[108:111],a[212:215]
tr a[118:119],v12,53768
v_mul_f32 v43, s37, v43
mf v[60:63],a[108:111],a[216:219]
tr a[120:121],v12,57352
cv v168,v40,v41
mf v[60:63],a[104:107],a[204:207]
tr a[122:123],v12,57864
cv v169,v42,v43
mf v[60:63],a[100:103],a[192:195]
tr a[124:125],v12,61448
v_mul_f32 v52, s37, v52
mf v[60:63],a[96:99],a[180:183]
s_mov_b32 m0, 49152
tr a[126:127],v12,61960
mf v[64:67],a[96:99],a[184:187]
v_mul_f32 v53, s37, v53
v_mul_f32 v54, s37, v54
mf v[64:67],a[100:103],a[196:199]
v_mul_f32 v55, s37, v55
cv v170,v52,v53
mf v[64:67],a[104:107],a[208:211]
cv v171,v54,v55
v_mul_f32 v48, s37, v48
mf v[64:67],a[108:111],a[220:223]
wl
v_mul_f32 v49, s37, v49
v_mul_f32 v50, s37, v50
mf v[76:79],a[124:127],a[220:223]
s_waitcnt vmcnt(27)
v_mul_f32 v51, s37, v51
s_barrier
mf v[76:79],a[120:123],a[208:211]
s_add_u32 s39, s70, 640
buffer_load_dwordx4 v13, s[8:11], s39 offen offset:0  lds
tr a[96:97],v11,0
mf v[76:79],a[116:119],a[196:199]
tr a[98:99],v11,512
cv v166,v48,v49
mf v[76:79],a[112:115],a[184:187]
tr a[100:101],v11,4096
buffer_load_dwordx4 v156, s[8:11], s39 offen offset:1024  lds
mf v[72:75],a[112:115],a[180:183]
tr a[102:103],v11,4608
cv v167,v50,v51
mf v[72:75],a[116:119],a[192:195]
tr a[104:105],v11,8192
buffer_load_dwordx4 v157, s[8:11], s39 offen offset:2048  lds
mf v[72:75],a[120:123],a[204:207]
tr a[106:107],v11,8704
v_mul_f32 v44, s37, v44
mf v[72:75],a[124:127],a[216:219]
tr a[108:109],v11,12288
buffer_load_dwordx4 v158, s[8:11], s39 offen offset:3072  lds
mf v[68:71],a[124:127],a[212:215]
s_mov_b32 m0, 53248
tr a[110:111],v11,12800
mf v[68:71],a[120:123],a[200:203]
s_add_u32 s39, s70, 262784
buffer_load_dwordx4 v13, s[8:11], s39 offen offset:0  lds
mf v[68:71],a[116:119],a[188:191]
v_mul_f32 v45, s37, v45
v_mul_f32 v46, s37, v46
mf v[68:71],a[112:115],a[176:179]
wl
buffer_load_dwordx4 v156, s[8:11], s39 offen offset:1024  lds
mz v[32:35],a[96:99],v[80:83],0
tr a[112:113],v11,8
v_mul_f32 v47, s37, v47
mf v[32:35],a[100:103],v[92:95]
tr a[114:115],v11,520
buffer_load_dwordx4 v157, s[8:11], s39 offen offset:2048  lds
mf v[32:35],a[104:107],v[104:107]
tr a[116:117],v11,4104
cv v162,v44,v45
mf v[32:35],a[108:111],v[116:119]
tr a[118:119],v11,4616
buffer_load_dwordx4 v158, s[8:11], s39 offen offset:3072  lds
mz v[36:39],a[108:111],v[120:123],0
s_mov_b32 m0, 57344
tr a[120:121],v11,8200
mf v[36:39],a[104:107],v[108:111]
s_add_u32 s39, s71, 640
buffer_load_dwordx4 v13, s[8:11], s39 offen offset:0  lds
tr a[122:123],v11,8712
mf v[36:39],a[100:103],v[96:99]
tr a[124:125],v11,12296
cv v163,v46,v47
mf v[36:39],a[96:99],v[84:87]
tr a[126:127],v11,12808
buffer_load_dwordx4 v156, s[8:11], s39 offen offset:1024  lds
mz v[40:43],a[96:99],v[88:91],0
s_mov_b32 s72, 98304
buffer_load_dword v20, v159, s[12:15], s72 offen
mf v[40:43],a[100:103],v[100:103]
buffer_load_dwordx4 v157, s[8:11], s39 offen offset:2048  lds
mf v[40:43],a[104:107],v[112:115]
v_mul_f32 v56, s37, v56
v_mul_f32 v57, s37, v57
mf v[40:43],a[108:111],v[124:127]
wl
buffer_load_dwordx4 v158, s[8:11], s39 offen offset:3072  lds
mz v[52:55],a[124:127],v[124:127],0
s_mov_b32 m0, 61440
tr a[96:97],v12,0
mf v[52:55],a[120:123],v[112:115]
s_add_u32 s39, s71, 262784
buffer_load_dwordx4 v13, s[8:11], s39 offen offset:0  lds
tr a[98:99],v12,512
mf v[52:55],a[116:119],v[100:103]
tr a[100:101],v12,4096
v_mul_f32 v58, s37, v58
mf v[52:55],a[112:115],v[88:91]
tr a[102:103],v12,4608
buffer_load_dwordx4 v156, s[8:11], s39 offen offset:1024  lds
mz v[48:51],a[112:115],v[84:87],0
tr a[104:105],v12,8192
v_mul_f32 v59, s37, v59
mf v[48:51],a[116:119],v[96:99]
tr a[106:107],v12,8704
buffer_load_dwordx4 v157, s[8:11], s39 offen offset:2048  lds
mf v[48:51],a[120:123],v[108:111]
tr a[108:109],v12,12288
cv v172,v56,v57
mf v[48:51],a[124:127],v[120:123]
tr a[110:111],v12,12800
buffer_load_dwordx4 v158, s[8:11], s39 offen offset:3072  lds
mz v[44:47],a[124:127],v[116:119],0
cv v173,v58,v59
v_mul_f32 v60, s37, v60
mf v[44:47],a[120:123],v[104:107]
v_mul_f32 v61, s37, v61
v_mul_f32 v62, s37, v62
mf v[44:47],a[116:119],v[92:95]
v_mul_f32 v63, s37, v63
cv v176,v60,v61
mf v[44:47],a[112:115],v[80:83]
wl
cv v177,v62,v63
v_mul_f32 v64, s37, v64
mz v[56:59],a[96:99],v[80:83],0
tr a[112:113],v12,8
v_mul_f32 v65, s37, v65
mf v[56:59],a[100:103],v[92:95]
tr a[114:115],v12,520
v_mul_f32 v66, s37, v66
mf v[56:59],a[104:107],v[104:107]
tr a[116:117],v12,4104
v_mul_f32 v67, s37, v67
mf v[56:59],a[108:111],v[116:119]
tr a[118:119],v12,4616
cv v180,v64,v65
mz v[60:63],a[108:111],v[120:123],0
tr a[120:121],v12,8200
cv v181,v66,v67
mf v[60:63],a[104:107],v[108:111]
tr a[122:123],v12,8712
v_mul_f32 v76, s37, v76
mf v[60:63],a[100:103],v[96:99]
tr a[124:125],v12,12296
v_mul_f32 v77, s37, v77
mf v[60:63],a[96:99],v[84:87]
s_mov_b32 m0, 0
tr a[126:127],v12,12808
mz v[64:67],a[96:99],v[88:91],0
v_mul_f32 v78, s37, v78
v_mul_f32 v79, s37, v79
mf v[64:67],a[100:103],v[100:103]
cv v182,v76,v77
cv v183,v78,v79
mf v[64:67],a[104:107],v[112:115]
v_mul_f32 v72, s37, v72
v_mul_f32 v73, s37, v73
mf v[64:67],a[108:111],v[124:127]
wl
v_mul_f32 v74, s37, v74
v_mul_f32 v75, s37, v75
mz v[76:79],a[124:127],v[124:127],0
s_waitcnt vmcnt(36)
cv v178,v72,v73
s_barrier
mf v[76:79],a[120:123],v[112:115]
s_add_u32 s39, s54, 768
buffer_load_dwordx4 v13, s[8:11], s39 offen offset:0  lds
tr a[96:97],v11,16384
cv v179,v74,v75
mf v[76:79],a[116:119],v[100:103]
tr a[98:99],v11,16896
buffer_load_dwordx4 v156, s[8:11], s39 offen offset:1024  lds
mf v[76:79],a[112:115],v[88:91]
s_mov_b32 s72, 81920
buffer_load_dword v20, v159, s[16:19], s72 offen
tr a[100:101],v11,20480
mz v[72:75],a[112:115],v[84:87],0
tr a[102:103],v11,20992
buffer_load_dwordx4 v157, s[8:11], s39 offen offset:2048  lds
mf v[72:75],a[116:119],v[96:99]
tr a[104:105],v11,20488
v_mul_f32 v68, s37, v68
v_mul_f32 v69, s37, v69
v_mul_f32 v70, s37, v70
v_mul_f32 v71, s37, v71
cv v174,v68,v69
cv v175,v70,v71
mf v[72:75],a[120:123],v[108:111]
tr a[106:107],v11,21000
buffer_load_dwordx4 v158, s[8:11], s39 offen offset:3072  lds
mf v[72:75],a[124:127],v[120:123]
s_mov_b32 m0, 4096
s_add_u32 s39, s54, 262912
buffer_load_dwordx4 v13, s[8:11], s39 offen offset:0  lds
tr a[108:109],v11,16392
mz v[68:71],a[124:127],v[116:119],0
tr a[110:111],v11,16904
mf v[68:71],a[120:123],v[104:107]
buffer_load_dwordx4 v156, s[8:11], s39 offen offset:1024  lds
mf v[68:71],a[116:119],v[92:95]
mf v[68:71],a[112:115],v[80:83]
wl
buffer_load_dwordx4 v157, s[8:11], s39 offen offset:2048  lds
mf v[32:35],a[96:99],v[128:131]
tr a[112:113],v12,16384
buffer_load_dwordx4 v158, s[8:11], s39 offen offset:3072  lds
mf v[32:35],a[100:103],v[140:143]
s_mov_b32 m0, 8192
tr a[114:115],v12,16896
mf v[44:47],a[104:107],v[140:143]
s_add_u32 s39, s51, 768
buffer_load_dwordx4 v13, s[8:11], s39 offen offset:0  lds
tr a[116:117],v12,20480
mf v[44:47],a[108:111],v[128:131]
tr a[118:119],v12,20992
mf v[48:51],a[108:111],v[132:135]
tr a[120:121],v12,20488
buffer_load_dwordx4 v156, s[8:11], s39 offen offset:1024  lds
mf v[48:51],a[104:107],v[144:147]
tr a[122:123],v12,21000
buffer_load_dwordx4 v157, s[8:11], s39 offen offset:2048  lds
mf v[36:39],a[100:103],v[144:147]
tr a[124:125],v12,16392
mf v[36:39],a[96:99],v[132:135]
tr a[126:127],v12,16904
buffer_load_dwordx4 v158, s[8:11], s39 offen offset:3072  lds
mf v[40:43],a[96:99],v[136:139]
s_mov_b32 m0, 12288
mf v[40:43],a[100:103],v[148:151]
s_add_u32 s39, s51, 262912
buffer_load_dwordx4 v13, s[8:11], s39 offen offset:0  lds
mf v[52:55],a[104:107],v[148:151]
buffer_load_dwordx4 v156, s[8:11], s39 offen offset:1024  lds
mf v[52:55],a[108:111],v[136:139]
wl
mf v[76:79],a[124:127],v[136:139]
s_waitcnt vmcnt(33)
buffer_load_dwordx4 v157, s[8:11], s39 offen offset:2048  lds
s_barrier
mf v[76:79],a[120:123],v[148:151]
tr a[96:97],v11,32768
mf v[64:67],a[116:119],v[148:151]
tr a[98:99],v11,33280
buffer_load_dwordx4 v158, s[8:11], s39 offen offset:3072  lds
mf v[64:67],a[112:115],v[136:139]
s_mov_b32 m0, 16384
s_add_u32 s39, s52, 768
buffer_load_dwordx4 v13, s[8:11], s39 offen offset:0  lds
tr a[100:101],v11,36864
mf v[60:63],a[112:115],v[132:135]
tr a[102:103],v11,37376
mf v[60:63],a[116:119],v[144:147]
tr a[104:105],v11,40960
buffer_load_dwordx4 v156, s[8:11], s39 offen offset:1024  lds
mf v[72:75],a[120:123],v[144:147]
tr a[106:107],v11,41472
mf v[72:75],a[124:127],v[132:135]
tr a[108:109],v11,45056
buffer_load_dwordx4 v157, s[8:11], s39 offen offset:2048  lds
mf v[68:71],a[124:127],v[128:131]
tr a[110:111],v11,45568
mf v[68:71],a[120:123],v[140:143]
buffer_load_dwordx4 v158, s[8:11], s39 offen offset:3072  lds
mf v[56:59],a[116:119],v[140:143]
s_mov_b32 s72, 81920
buffer_load_dword v20, v159, s[12:15], s72 offen
mf v[56:59],a[112:115],v[128:131]
s_mov_b32 m0, 20480
s_add_u32 s39, s52, 262912
buffer_load_dwordx4 v13, s[8:11], s39 offen offset:0  lds
wl
mf v[32:35],a[96:99],a[128:131]
tr a[112:113],v11,32776
v_lshl_add_u32 v21, v1, 3, s3
mf v[32:35],a[100:103],a[140:143]
tr a[114:115],v11,33288
buffer_load_dwordx4 v156, s[8:11], s39 offen offset:1024  lds
mf v[32:35],a[104:107],a[152:155]
tr a[116:117],v11,36872
v_min_u32 v21, L_end-L_main4, v21
mf v[32:35],a[108:111],a[164:167]
tr a[118:119],v11,37384
buffer_load_dwordx4 v157, s[8:11], s39 offen offset:2048  lds
mf v[36:39],a[108:111],a[168:171]
tr a[120:121],v11,40968
v_min_u32 v159, 752, v1
mf v[36:39],a[104:107],a[156:159]
tr a[122:123],v11,41480
buffer_load_dwordx4 v158, s[8:11], s39 offen offset:3072  lds
mf v[36:39],a[100:103],a[144:147]
tr a[124:125],v11,45064
v_lshlrev_b32 v159, 3, v159
mf v[36:39],a[96:99],a[132:135]
tr a[126:127],v11,45576
mf v[40:43],a[96:99],a[136:139]
global_load_dword v20, v21, s[58:59]
mf v[40:43],a[100:103],a[148:151]
mf v[40:43],a[104:107],a[160:163]
mf v[40:43],a[108:111],a[172:175]
wl
mf v[52:55],a[124:127],a[172:175]
tr a[96:97],v12,32768
mf v[52:55],a[120:123],a[160:163]
tr a[98:99],v12,33280
mf v[52:55],a[116:119],a[148:151]
tr a[100:101],v12,36864
mf v[52:55],a[112:115],a[136:139]
tr a[102:103],v12,37376
mf v[48:51],a[112:115],a[132:135]
tr a[104:105],v12,40960
mf v[48:51],a[116:119],a[144:147]
tr a[106:107],v12,41472
mf v[48:51],a[120:123],a[156:159]
tr a[108:109],v12,45056
mf v[48:51],a[124:127],a[168:171]
tr a[110:111],v12,45568
mf v[44:47],a[124:127],a[164:167]
mf v[44:47],a[120:123],a[152:155]
mf v[44:47],a[116:119],a[140:143]
mf v[44:47],a[112:115],a[128:131]
wl
mf v[56:59],a[96:99],a[128:131]
tr a[112:113],v12,32776
mf v[56:59],a[100:103],a[140:143]
tr a[114:115],v12,33288
mf v[56:59],a[104:107],a[152:155]
tr a[116:117],v12,36872
mf v[56:59],a[108:111],a[164:167]
s_mov_b32 s72, 65536
buffer_load_dword v20, v159, s[16:19], s72 offen
tr a[118:119],v12,37384
mf v[60:63],a[108:111],a[168:171]
tr a[120:121],v12,40968
mf v[60:63],a[104:107],a[156:159]
tr a[122:123],v12,41480
mf v[60:63],a[100:103],a[144:147]
tr a[124:125],v12,45064
mf v[60:63],a[96:99],a[132:135]
s_mov_b32 m0, 32768
tr a[126:127],v12,45576
mf v[64:67],a[96:99],a[136:139]
mf v[64:67],a[100:103],a[148:151]
mf v[64:67],a[104:107],a[160:163]
mf v[64:67],a[108:111],a[172:175]
wl
mf v[76:79],a[124:127],a[172:175]
s_waitcnt vmcnt(28)
s_barrier
mf v[76:79],a[120:123],a[160:163]
s_add_u32 s39, s48, 768
buffer_load_dwordx4 v13, s[8:11], s39 offen offset:0  lds
tr a[96:97],v11,49152
mf v[76:79],a[116:119],a[148:151]
tr a[98:99],v11,49664
mf v[76:79],a[112:115],a[136:139]
tr a[100:101],v11,53248
buffer_load_dwordx4 v156, s[8:11], s39 offen offset:1024  lds
mf v[72:75],a[112:115],a[132:135]
tr a[102:103],v11,53760
mf v[72:75],a[116:119],a[144:147]
tr a[104:105],v11,57344
buffer_load_dwordx4 v157, s[8:11], s39 offen offset:2048  lds
mf v[72:75],a[120:123],a[156:159]
tr a[106:107],v11,57856
mf v[72:75],a[124:127],a[168:171]
tr a[108:109],v11,61440
buffer_load_dwordx4 v158, s[8:11], s39 offen offset:3072  lds
mf v[68:71],a[124:127],a[164:167]
s_mov_b32 m0, 36864
tr a[110:111],v11,61952
mf v[68:71],a[120:123],a[152:155]
s_add_u32 s39, s48, 262912
buffer_load_dwordx4 v13, s[8:11], s39 offen offset:0  lds
mf v[68:71],a[116:119],a[140:143]
mf v[68:71],a[112:115],a[128:131]
wl
buffer_load_dwordx4 v156, s[8:11], s39 offen offset:1024  lds
mf v[32:35],a[96:99],a[176:179]
tr a[112:113],v11,49160
mf v[32:35],a[100:103],a[188:191]
tr a[114:115],v11,49672
buffer_load_dwordx4 v157, s[8:11], s39 offen offset:2048  lds
mf v[32:35],a[104:107],a[200:203]
tr a[116:117],v11,53256
mf v[32:35],a[108:111],a[212:215]
tr a[118:119],v11,53768
buffer_load_dwordx4 v158, s[8:11], s39 offen offset:3072  lds
mf v[36:39],a[108:111],a[216:219]
s_mov_b32 m0, 40960
tr a[120:121],v11,57352
mf v[36:39],a[104:107],a[204:207]
s_add_u32 s39, s69, 768
buffer_load_dwordx4 v13, s[8:11], s39 offen offset:0  lds
tr a[122:123],v11,57864
mf v[36:39],a[100:103],a[192:195]
tr a[124:125],v11,61448
mf v[36:39],a[96:99],a[180:183]
s_mov_b32 s72, 65536
buffer_load_dword v20, v159, s[12:15], s72 offen
tr a[126:127],v11,61960
buffer_load_dwordx4 v156, s[8:11], s39 offen offset:1024  lds
mf v[40:43],a[96:99],a[184:187]
v_min_u32 v159, 688, v1
v_lshlrev_b32 v159, 3, v159
mf v[40:43],a[100:103],a[196:199]
buffer_load_dwordx4 v157, s[8:11], s39 offen offset:2048  lds
mf v[40:43],a[104:107],a[208:211]
v_mul_f32 v32, s37, v32
v_mul_f32 v33, s37, v33
mf v[40:43],a[108:111],a[220:223]
wl
buffer_load_dwordx4 v158, s[8:11], s39 offen offset:3072  lds
mf v[52:55],a[124:127],a[220:223]
s_mov_b32 m0, 45056
tr a[96:97],v12,49152
mf v[52:55],a[120:123],a[208:211]
s_add_u32 s39, s69, 262912
buffer_load_dwordx4 v13, s[8:11], s39 offen offset:0  lds
tr a[98:99],v12,49664
mf v[52:55],a[116:119],a[196:199]
tr a[100:101],v12,53248
v_mul_f32 v34, s37, v34
mf v[52:55],a[112:115],a[184:187]
tr a[102:103],v12,53760
buffer_load_dwordx4 v156, s[8:11], s39 offen offset:1024  lds
mf v[48:51],a[112:115],a[180:183]
tr a[104:105],v12,57344
v_mul_f32 v35, s37, v35
mf v[48:51],a[116:119],a[192:195]
tr a[106:107],v12,57856
buffer_load_dwordx4 v157, s[8:11], s39 offen offset:2048  lds
mf v[48:51],a[120:123],a[204:207]
tr a[108:109],v12,61440
cv v184,v32,v33
mf v[48:51],a[124:127],a[216:219]
tr a[110:111],v12,61952
buffer_load_dwordx4 v158, s[8:11], s39 offen offset:3072  lds
mf v[44:47],a[124:127],a[212:215]
cv v185,v34,v35
v_mul_f32 v36, s37, v36
mf v[44:47],a[120:123],a[200:203]
v_mul_f32 v37, s37, v37
v_mul_f32 v38, s37, v38
mf v[44:47],a[116:119],a[188:191]
v_mul_f32 v39, s37, v39
cv v188,v36,v37
mf v[44:47],a[112:115],a[176:179]
wl
cv v189,v38,v39
v_mul_f32 v40, s37, v40
mf v[56:59],a[96:99],a[176:179]
tr a[112:113],v12,49160
v_mul_f32 v41, s37, v41
mf v[56:59],a[100:103],a[188:191]
tr a[114:115],v12,49672
v_mul_f32 v42, s37, v42
mf v[56:59],a[104:107],a[200:203]
tr a[116:117],v12,53256
v_mul_f32 v43, s37, v43
mf v[56:59],a[108:111],a[212:215]
tr a[118:119],v12,53768
cv v192,v40,v41
mf v[60:63],a[108:111],a[216:219]
tr a[120:121],v12,57352
cv v193,v42,v43
mf v[60:63],a[104:107],a[204:207]
tr a[122:123],v12,57864
v_mul_f32 v52, s37, v52
mf v[60:63],a[100:103],a[192:195]
tr a[124:125],v12,61448
v_mul_f32 v53, s37, v53
mf v[60:63],a[96:99],a[180:183]
s_mov_b32 m0, 49152
tr a[126:127],v12,61960
mf v[64:67],a[96:99],a[184:187]
s_mov_b32 s72, 49152
buffer_load_dword v20, v159, s[16:19], s72 offen
mf v[64:67],a[100:103],a[196:199]
v_mul_f32 v54, s37, v54
v_mul_f32 v55, s37, v55
mf v[64:67],a[104:107],a[208:211]
cv v194,v52,v53
cv v195,v54,v55
mf v[64:67],a[108:111],a[220:223]
wl
v_mul_f32 v48, s37, v48
v_mul_f32 v49, s37, v49
mf v[76:79],a[124:127],a[220:223]
s_waitcnt vmcnt(29)
v_mul_f32 v50, s37, v50
s_barrier
mf v[76:79],a[120:123],a[208:211]
s_add_u32 s39, s70, 768
buffer_load_dwordx4 v13, s[8:11], s39 offen offset:0  lds
tr a[96:97],v11,0
mf v[76:79],a[116:119],a[196:199]
tr a[98:99],v11,512
v_mul_f32 v51, s37, v51
mf v[76:79],a[112:115],a[184:187]
tr a[100:101],v11,4096
buffer_load_dwordx4 v156, s[8:11], s39 offen offset:1024  lds
mf v[72:75],a[112:115],a[180:183]
tr a[102:103],v11,4608
cv v190,v48,v49
mf v[72:75],a[116:119],a[192:195]
tr a[104:105],v11,8192
buffer_load_dwordx4 v157, s[8:11], s39 offen offset:2048  lds
mf v[72:75],a[120:123],a[204:207]
tr a[106:107],v11,8704
cv v191,v50,v51
mf v[72:75],a[124:127],a[216:219]
tr a[108:109],v11,12288
buffer_load_dwordx4 v158, s[8:11], s39 offen offset:3072  lds
mf v[68:71],a[124:127],a[212:215]
s_mov_b32 m0, 53248
tr a[110:111],v11,12800
mf v[68:71],a[120:123],a[200:203]
s_add_u32 s39, s70, 262912
buffer_load_dwordx4 v13, s[8:11], s39 offen offset:0  lds
mf v[68:71],a[116:119],a[188:191]
v_mul_f32 v44, s37, v44
v_mul_f32 v45, s37, v45
mf v[68:71],a[112:115],a[176:179]
wl
buffer_load_dwordx4 v156, s[8:11], s39 offen offset:1024  lds
mz v[32:35],a[96:99],v[80:83],0
tr a[112:113],v11,8
v_mul_f32 v46, s37, v46
mf v[32:35],a[100:103],v[92:95]
tr a[114:115],v11,520
buffer_load_dwordx4 v157, s[8:11], s39 offen offset:2048  lds
mf v[32:35],a[104:107],v[104:107]
tr a[116:117],v11,4104
v_mul_f32 v47, s37, v47
mf v[32:35],a[108:111],v[116:119]
tr a[118:119],v11,4616
buffer_load_dwordx4 v158, s[8:11], s39 offen offset:3072  lds
mz v[36:39],a[108:111],v[120:123],0
s_mov_b32 m0, 57344
tr a[120:121],v11,8200
mf v[36:39],a[104:107],v[108:111]
s_add_u32 s39, s71, 768
buffer_load_dwordx4 v13, s[8:11], s39 offen offset:0  lds
tr a[122:123],v11,8712
mf v[36:39],a[100:103],v[96:99]
tr a[124:125],v11,12296
cv v186,v44,v45
mf v[36:39],a[96:99],v[84:87]
tr a[126:127],v11,12808
buffer_load_dwordx4 v156, s[8:11], s39 offen offset:1024  lds
mz v[40:43],a[96:99],v[88:91],0
s_mov_b32 s72, 49152
buffer_load_dword v20, v159, s[12:15], s72 offen
mf v[40:43],a[100:103],v[100:103]
buffer_load_dwordx4 v157, s[8:11], s39 offen offset:2048  lds
mf v[40:43],a[104:107],v[112:115]
cv v187,v46,v47
v_mul_f32 v56, s37, v56
mf v[40:43],a[108:111],v[124:127]
wl
buffer_load_dwordx4 v158, s[8:11], s39 offen offset:3072  lds
mz v[52:55],a[124:127],v[124:127],0
s_mov_b32 m0, 61440
tr a[96:97],v12,0
mf v[52:55],a[120:123],v[112:115]
s_add_u32 s39, s71, 262912
buffer_load_dwordx4 v13, s[8:11], s39 offen offset:0  lds
tr a[98:99],v12,512
mf v[52:55],a[116:119],v[100:103]
tr a[100:101],v12,4096
v_mul_f32 v57, s37, v57
mf v[52:55],a[112:115],v[88:91]
tr a[102:103],v12,4608
buffer_load_dwordx4 v156, s[8:11], s39 offen offset:1024  lds
mz v[48:51],a[112:115],v[84:87],0
tr a[104:105],v12,8192
v_mul_f32 v58, s37, v58
mf v[48:51],a[116:119],v[96:99]
tr a[106:107],v12,8704
buffer_load_dwordx4 v157, s[8:11], s39 offen offset:2048  lds
mf v[48:51],a[120:123],v[108:111]
tr a[108:109],v12,12288
v_mul_f32 v59, s37, v59
mf v[48:51],a[124:127],v[120:123]
tr a[110:111],v12,12800
buffer_load_dwordx4 v158, s[8:11], s39 offen offset:3072  lds
mz v[44:47],a[124:127],v[116:119],0
cv v196,v56,v57
cv v197,v58,v59
mf v[44:47],a[120:123],v[104:107]
v_mul_f32 v60, s37, v60
v_mul_f32 v61, s37, v61
mf v[44:47],a[116:119],v[92:95]
v_mul_f32 v62, s37, v62
v_mul_f32 v63, s37, v63
mf v[44:47],a[112:115],v[80:83]
wl
cv v200,v60,v61
cv v201,v62,v63
mz v[56:59],a[96:99],v[80:83],0
tr a[112:113],v12,8
v_mul_f32 v64, s37, v64
mf v[56:59],a[100:103],v[92:95]
tr a[114:115],v12,520
v_mul_f32 v65, s37, v65
mf v[56:59],a[104:107],v[104:107]
tr a[116:117],v12,4104
v_mul_f32 v66, s37, v66
mf v[56:59],a[108:111],v[116:119]
tr a[118:119],v12,4616
v_mul_f32 v67, s37, v67
mz v[60:63],a[108:111],v[120:123],0
tr a[120:121],v12,8200
cv v204,v64,v65
mf v[60:63],a[104:107],v[108:111]
tr a[122:123],v12,8712
cv v205,v66,v67
mf v[60:63],a[100:103],v[96:99]
tr a[124:125],v12,12296
v_mul_f32 v76, s37, v76
mf v[60:63],a[96:99],v[84:87]
s_mov_b32 m0, 0
tr a[126:127],v12,12808
mz v[64:67],a[96:99],v[88:91],0
v_mul_f32 v77, s37, v77
v_mul_f32 v78, s37, v78
mf v[64:67],a[100:103],v[100:103]
v_mul_f32 v79, s37, v79
cv v206,v76,v77
cv v207,v78,v79
mf v[64:67],a[104:107],v[112:115]
s_mov_b32 s72, 32768
buffer_load_dword v20, v159, s[16:19], s72 offen
mf v[64:67],a[108:111],v[124:127]
wl
v_mul_f32 v72, s37, v72
v_mul_f32 v73, s37, v73
mz v[76:79],a[124:127],v[124:127],0
s_waitcnt vmcnt(38)
v_mul_f32 v74, s37, v74
s_barrier
mf v[76:79],a[120:123],v[112:115]
s_add_u32 s39, s54, 896
buffer_load_dwordx4 v13, s[8:11], s39 offen offset:0  lds
tr a[96:97],v11,16384
v_mul_f32 v75, s37, v75
cv v202,v72,v73
cv v203,v74,v75
mf v[76:79],a[116:119],v[100:103]
tr a[98:99],v11,16896
buffer_load_dwordx4 v156, s[8:11], s39 offen offset:1024  lds
mf v[76:79],a[112:115],v[88:91]
tr a[100:101],v11,20480
v_mul_f32 v68, s37, v68
mz v[72:75],a[112:115],v[84:87],0
tr a[102:103],v11,20992
buffer_load_dwordx4 v157, s[8:11], s39 offen offset:2048  lds
mf v[72:75],a[116:119],v[96:99]
tr a[104:105],v11,20488
v_mul_f32 v69, s37, v69
v_mul_f32 v70, s37, v70
v_mul_f32 v71, s37, v71
cv v198,v68,v69
cv v199,v70,v71
mf v[72:75],a[120:123],v[108:111]
tr a[106:107],v11,21000
buffer_load_dwordx4 v158, s[8:11], s39 offen offset:3072  lds
mf v[72:75],a[124:127],v[120:123]
s_mov_b32 m0, 4096
s_add_u32 s39, s54, 263040
buffer_load_dwordx4 v13, s[8:11], s39 offen offset:0  lds
tr a[108:109],v11,16392
mz v[68:71],a[124:127],v[116:119],0
tr a[110:111],v11,16904
mf v[68:71],a[120:123],v[104:107]
buffer_load_dwordx4 v156, s[8:11], s39 offen offset:1024  lds
mf v[68:71],a[116:119],v[92:95]
mf v[68:71],a[112:115],v[80:83]
wl
buffer_load_dwordx4 v157, s[8:11], s39 offen offset:2048  lds
mf v[32:35],a[96:99],v[128:131]
tr a[112:113],v12,16384
buffer_load_dwordx4 v158, s[8:11], s39 offen offset:3072  lds
mf v[32:35],a[100:103],v[140:143]
s_mov_b32 m0, 8192
tr a[114:115],v12,16896
mf v[44:47],a[104:107],v[140:143]
s_add_u32 s39, s51, 896
buffer_load_dwordx4 v13, s[8:11], s39 offen offset:0  lds
tr a[116:117],v12,20480
mf v[44:47],a[108:111],v[128:131]
tr a[118:119],v12,20992
mf v[48:51],a[108:111],v[132:135]
tr a[120:121],v12,20488
buffer_load_dwordx4 v156, s[8:11], s39 offen offset:1024  lds
mf v[48:51],a[104:107],v[144:147]
tr a[122:123],v12,21000
buffer_load_dwordx4 v157, s[8:11], s39 offen offset:2048  lds
mf v[36:39],a[100:103],v[144:147]
tr a[124:125],v12,16392
mf v[36:39],a[96:99],v[132:135]
tr a[126:127],v12,16904
buffer_load_dwordx4 v158, s[8:11], s39 offen offset:3072  lds
mf v[40:43],a[96:99],v[136:139]
s_mov_b32 m0, 12288
mf v[40:43],a[100:103],v[148:151]
s_add_u32 s39, s51, 263040
buffer_load_dwordx4 v13, s[8:11], s39 offen offset:0  lds
mf v[52:55],a[104:107],v[148:151]
buffer_load_dwordx4 v156, s[8:11], s39 offen offset:1024  lds
mf v[52:55],a[108:111],v[136:139]
wl
mf v[76:79],a[124:127],v[136:139]
s_waitcnt vmcnt(33)
buffer_load_dwordx4 v157, s[8:11], s39 offen offset:2048  lds
s_barrier
mf v[76:79],a[120:123],v[148:151]
s_mov_b32 s72, 32768
buffer_load_dword v20, v159, s[12:15], s72 offen
tr a[96:97],v11,32768
mf v[64:67],a[116:119],v[148:151]
tr a[98:99],v11,33280
buffer_load_dwordx4 v158, s[8:11], s39 offen offset:3072  lds
mf v[64:67],a[112:115],v[136:139]
s_mov_b32 m0, 16384
s_add_u32 s39, s52, 896
buffer_load_dwordx4 v13, s[8:11], s39 offen offset:0  lds
tr a[100:101],v11,36864
mf v[60:63],a[112:115],v[132:135]
tr a[102:103],v11,37376
v_min_u32 v159, 752, v1
mf v[60:63],a[116:119],v[144:147]
tr a[104:105],v11,40960
buffer_load_dwordx4 v156, s[8:11], s39 offen offset:1024  lds
mf v[72:75],a[120:123],v[144:147]
tr a[106:107],v11,41472
v_lshlrev_b32 v159, 3, v159
mf v[72:75],a[124:127],v[132:135]
tr a[108:109],v11,45056
buffer_load_dwordx4 v157, s[8:11], s39 offen offset:2048  lds
mf v[68:71],a[124:127],v[128:131]
tr a[110:111],v11,45568
mf v[68:71],a[120:123],v[140:143]
buffer_load_dwordx4 v158, s[8:11], s39 offen offset:3072  lds
mf v[56:59],a[116:119],v[140:143]
s_mov_b32 m0, 20480
mf v[56:59],a[112:115],v[128:131]
s_add_u32 s39, s52, 263040
buffer_load_dwordx4 v13, s[8:11], s39 offen offset:0  lds
wl
mf v[32:35],a[96:99],a[128:131]
tr a[112:113],v11,32776
mf v[32:35],a[100:103],a[140:143]
tr a[114:115],v11,33288
buffer_load_dwordx4 v156, s[8:11], s39 offen offset:1024  lds
mf v[32:35],a[104:107],a[152:155]
tr a[116:117],v11,36872
mf v[32:35],a[108:111],a[164:167]
tr a[118:119],v11,37384
buffer_load_dwordx4 v157, s[8:11], s39 offen offset:2048  lds
mf v[36:39],a[108:111],a[168:171]
tr a[120:121],v11,40968
mf v[36:39],a[104:107],a[156:159]
tr a[122:123],v11,41480
buffer_load_dwordx4 v158, s[8:11], s39 offen offset:3072  lds
mf v[36:39],a[100:103],a[144:147]
tr a[124:125],v11,45064
mf v[36:39],a[96:99],a[132:135]
tr a[126:127],v11,45576
mf v[40:43],a[96:99],a[136:139]
mf v[40:43],a[100:103],a[148:151]
mf v[40:43],a[104:107],a[160:163]
mf v[40:43],a[108:111],a[172:175]
wl
mf v[52:55],a[124:127],a[172:175]
tr a[96:97],v12,32768
mf v[52:55],a[120:123],a[160:163]
tr a[98:99],v12,33280
mf v[52:55],a[116:119],a[148:151]
tr a[100:101],v12,36864
mf v[52:55],a[112:115],a[136:139]
tr a[102:103],v12,37376
mf v[48:51],a[112:115],a[132:135]
s_mov_b32 s72, 16384
buffer_load_dword v20, v159, s[16:19], s72 offen
tr a[104:105],v12,40960
mf v[48:51],a[116:119],a[144:147]
tr a[106:107],v12,41472
mf v[48:51],a[120:123],a[156:159]
tr a[108:109],v12,45056
mf v[48:51],a[124:127],a[168:171]
tr a[110:111],v12,45568
mf v[44:47],a[124:127],a[164:167]
mf v[44:47],a[120:123],a[152:155]
mf v[44:47],a[116:119],a[140:143]
mf v[44:47],a[112:115],a[128:131]
wl
mf v[56:59],a[96:99],a[128:131]
tr a[112:113],v12,32776
mf v[56:59],a[100:103],a[140:143]
tr a[114:115],v12,33288
mf v[56:59],a[104:107],a[152:155]
tr a[116:117],v12,36872
mf v[56:59],a[108:111],a[164:167]
tr a[118:119],v12,37384
mf v[60:63],a[108:111],a[168:171]
tr a[120:121],v12,40968
mf v[60:63],a[104:107],a[156:159]
tr a[122:123],v12,41480
mf v[60:63],a[100:103],a[144:147]
tr a[124:125],v12,45064
mf v[60:63],a[96:99],a[132:135]
s_mov_b32 m0, 32768
tr a[126:127],v12,45576
mf v[64:67],a[96:99],a[136:139]
mf v[64:67],a[100:103],a[148:151]
mf v[64:67],a[104:107],a[160:163]
mf v[64:67],a[108:111],a[172:175]
wl
mf v[76:79],a[124:127],a[172:175]
s_waitcnt vmcnt(27)
s_barrier
mf v[76:79],a[120:123],a[160:163]
s_add_u32 s39, s48, 896
buffer_load_dwordx4 v13, s[8:11], s39 offen offset:0  lds
tr a[96:97],v11,49152
mf v[76:79],a[116:119],a[148:151]
tr a[98:99],v11,49664
mf v[76:79],a[112:115],a[136:139]
tr a[100:101],v11,53248
buffer_load_dwordx4 v156, s[8:11], s39 offen offset:1024  lds
mf v[72:75],a[112:115],a[132:135]
tr a[102:103],v11,53760
mf v[72:75],a[116:119],a[144:147]
tr a[104:105],v11,57344
buffer_load_dwordx4 v157, s[8:11], s39 offen offset:2048  lds
mf v[72:75],a[120:123],a[156:159]
tr a[106:107],v11,57856
mf v[72:75],a[124:127],a[168:171]
s_mov_b32 s72, 16384
buffer_load_dword v20, v159, s[12:15], s72 offen
tr a[108:109],v11,61440
buffer_load_dwordx4 v158, s[8:11], s39 offen offset:3072  lds
mf v[68:71],a[124:127],a[164:167]
s_mov_b32 m0, 36864
tr a[110:111],v11,61952
mf v[68:71],a[120:123],a[152:155]
s_add_u32 s39, s48, 263040
buffer_load_dwordx4 v13, s[8:11], s39 offen offset:0  lds
mf v[68:71],a[116:119],a[140:143]
mf v[68:71],a[112:115],a[128:131]
wl
buffer_load_dwordx4 v156, s[8:11], s39 offen offset:1024  lds
mf v[32:35],a[96:99],a[176:179]
tr a[112:113],v11,49160
mf v[32:35],a[100:103],a[188:191]
tr a[114:115],v11,49672
buffer_load_dwordx4 v157, s[8:11], s39 offen offset:2048  lds
mf v[32:35],a[104:107],a[200:203]
tr a[116:117],v11,53256
mf v[32:35],a[108:111],a[212:215]
tr a[118:119],v11,53768
buffer_load_dwordx4 v158, s[8:11], s39 offen offset:3072  lds
mf v[36:39],a[108:111],a[216:219]
s_mov_b32 m0, 40960
tr a[120:121],v11,57352
mf v[36:39],a[104:107],a[204:207]
s_add_u32 s39, s69, 896
buffer_load_dwordx4 v13, s[8:11], s39 offen offset:0  lds
tr a[122:123],v11,57864
mf v[36:39],a[100:103],a[192:195]
tr a[124:125],v11,61448
mf v[36:39],a[96:99],a[180:183]
tr a[126:127],v11,61960
buffer_load_dwordx4 v156, s[8:11], s39 offen offset:1024  lds
mf v[40:43],a[96:99],a[184:187]
mf v[40:43],a[100:103],a[196:199]
buffer_load_dwordx4 v157, s[8:11], s39 offen offset:2048  lds
mf v[40:43],a[104:107],a[208:211]
v_mul_f32 v32, s37, v32
v_mul_f32 v33, s37, v33
mf v[40:43],a[108:111],a[220:223]
wl
buffer_load_dwordx4 v158, s[8:11], s39 offen offset:3072  lds
mf v[52:55],a[124:127],a[220:223]
s_mov_b32 m0, 45056
tr a[96:97],v12,49152
mf v[52:55],a[120:123],a[208:211]
s_add_u32 s39, s69, 263040
buffer_load_dwordx4 v13, s[8:11], s39 offen offset:0  lds
tr a[98:99],v12,49664
mf v[52:55],a[116:119],a[196:199]
tr a[100:101],v12,53248
v_mul_f32 v34, s37, v34
mf v[52:55],a[112:115],a[184:187]
tr a[102:103],v12,53760
buffer_load_dwordx4 v156, s[8:11], s39 offen offset:1024  lds
mf v[48:51],a[112:115],a[180:183]
tr a[104:105],v12,57344
v_mul_f32 v35, s37, v35
mf v[48:51],a[116:119],a[192:195]
tr a[106:107],v12,57856
buffer_load_dwordx4 v157, s[8:11], s39 offen offset:2048  lds
mf v[48:51],a[120:123],a[204:207]
tr a[108:109],v12,61440
cv v208,v32,v33
mf v[48:51],a[124:127],a[216:219]
tr a[110:111],v12,61952
buffer_load_dwordx4 v158, s[8:11], s39 offen offset:3072  lds
mf v[44:47],a[124:127],a[212:215]
s_mov_b32 s72, 0
buffer_load_dword v20, v159, s[16:19], s72 offen
mf v[44:47],a[120:123],a[200:203]
cv v209,v34,v35
v_mul_f32 v36, s37, v36
mf v[44:47],a[116:119],a[188:191]
v_mul_f32 v37, s37, v37
v_mul_f32 v38, s37, v38
mf v[44:47],a[112:115],a[176:179]
wl
v_mul_f32 v39, s37, v39
cv v212,v36,v37
mf v[56:59],a[96:99],a[176:179]
tr a[112:113],v12,49160
cv v213,v38,v39
mf v[56:59],a[100:103],a[188:191]
tr a[114:115],v12,49672
v_mul_f32 v40, s37, v40
mf v[56:59],a[104:107],a[200:203]
tr a[116:117],v12,53256
v_mul_f32 v41, s37, v41
mf v[56:59],a[108:111],a[212:215]
tr a[118:119],v12,53768
v_mul_f32 v42, s37, v42
mf v[60:63],a[108:111],a[216:219]
tr a[120:121],v12,57352
v_mul_f32 v43, s37, v43
mf v[60:63],a[104:107],a[204:207]
tr a[122:123],v12,57864
cv v216,v40,v41
mf v[60:63],a[100:103],a[192:195]
tr a[124:125],v12,61448
cv v217,v42,v43
mf v[60:63],a[96:99],a[180:183]
s_mov_b32 m0, 49152
tr a[126:127],v12,61960
mf v[64:67],a[96:99],a[184:187]
v_mul_f32 v52, s37, v52
v_mul_f32 v53, s37, v53
mf v[64:67],a[100:103],a[196:199]
v_mul_f32 v54, s37, v54
v_mul_f32 v55, s37, v55
mf v[64:67],a[104:107],a[208:211]
cv v218,v52,v53
cv v219,v54,v55
mf v[64:67],a[108:111],a[220:223]
wl
v_mul_f32 v48, s37, v48
v_mul_f32 v49, s37, v49
mf v[76:79],a[124:127],a[220:223]
s_waitcnt vmcnt(27)
v_mul_f32 v50, s37, v50
s_barrier
mf v[76:79],a[120:123],a[208:211]
s_add_u32 s39, s70, 896
buffer_load_dwordx4 v13, s[8:11], s39 offen offset:0  lds
tr a[96:97],v11,0
mf v[76:79],a[116:119],a[196:199]
tr a[98:99],v11,512
v_mul_f32 v51, s37, v51
mf v[76:79],a[112:115],a[184:187]
tr a[100:101],v11,4096
buffer_load_dwordx4 v156, s[8:11], s39 offen offset:1024  lds
mf v[72:75],a[112:115],a[180:183]
tr a[102:103],v11,4608
cv v214,v48,v49
mf v[72:75],a[116:119],a[192:195]
tr a[104:105],v11,8192
buffer_load_dwordx4 v157, s[8:11], s39 offen offset:2048  lds
mf v[72:75],a[120:123],a[204:207]
tr a[106:107],v11,8704
cv v215,v50,v51
mf v[72:75],a[124:127],a[216:219]
tr a[108:109],v11,12288
buffer_load_dwordx4 v158, s[8:11], s39 offen offset:3072  lds
mf v[68:71],a[124:127],a[212:215]
s_mov_b32 m0, 53248
tr a[110:111],v11,12800
mf v[68:71],a[120:123],a[200:203]
s_add_u32 s39, s70, 263040
buffer_load_dwordx4 v13, s[8:11], s39 offen offset:0  lds
mf v[68:71],a[116:119],a[188:191]
s_mov_b32 s72, 0
buffer_load_dword v20, v159, s[12:15], s72 offen
mf v[68:71],a[112:115],a[176:179]
wl
buffer_load_dwordx4 v156, s[8:11], s39 offen offset:1024  lds
mz v[32:35],a[96:99],v[80:83],0
tr a[112:113],v11,8
v_mul_f32 v44, s37, v44
mf v[32:35],a[100:103],v[92:95]
tr a[114:115],v11,520
buffer_load_dwordx4 v157, s[8:11], s39 offen offset:2048  lds
mf v[32:35],a[104:107],v[104:107]
tr a[116:117],v11,4104
v_mul_f32 v45, s37, v45
mf v[32:35],a[108:111],v[116:119]
tr a[118:119],v11,4616
buffer_load_dwordx4 v158, s[8:11], s39 offen offset:3072  lds
mz v[36:39],a[108:111],v[120:123],0
s_mov_b32 m0, 57344
tr a[120:121],v11,8200
mf v[36:39],a[104:107],v[108:111]
s_add_u32 s39, s71, 896
buffer_load_dwordx4 v13, s[8:11], s39 offen offset:0  lds
tr a[122:123],v11,8712
mf v[36:39],a[100:103],v[96:99]
tr a[124:125],v11,12296
v_mul_f32 v46, s37, v46
mf v[36:39],a[96:99],v[84:87]
tr a[126:127],v11,12808
buffer_load_dwordx4 v156, s[8:11], s39 offen offset:1024  lds
mz v[40:43],a[96:99],v[88:91],0
v_mul_f32 v47, s37, v47
cv v210,v44,v45
mf v[40:43],a[100:103],v[100:103]
buffer_load_dwordx4 v157, s[8:11], s39 offen offset:2048  lds
mf v[40:43],a[104:107],v[112:115]
cv v211,v46,v47
v_mul_f32 v56, s37, v56
mf v[40:43],a[108:111],v[124:127]
wl
buffer_load_dwordx4 v158, s[8:11], s39 offen offset:3072  lds
mz v[52:55],a[124:127],v[124:127],0
s_mov_b32 m0, 61440
tr a[96:97],v12,0
mf v[52:55],a[120:123],v[112:115]
s_add_u32 s39, s71, 263040
buffer_load_dwordx4 v13, s[8:11], s39 offen offset:0  lds
tr a[98:99],v12,512
mf v[52:55],a[116:119],v[100:103]
tr a[100:101],v12,4096
v_mul_f32 v57, s37, v57
mf v[52:55],a[112:115],v[88:91]
tr a[102:103],v12,4608
buffer_load_dwordx4 v156, s[8:11], s39 offen offset:1024  lds
mz v[48:51],a[112:115],v[84:87],0
tr a[104:105],v12,8192
v_mul_f32 v58, s37, v58
mf v[48:51],a[116:119],v[96:99]
tr a[106:107],v12,8704
buffer_load_dwordx4 v157, s[8:11], s39 offen offset:2048  lds
mf v[48:51],a[120:123],v[108:111]
tr a[108:109],v12,12288
v_mul_f32 v59, s37, v59
mf v[48:51],a[124:127],v[120:123]
tr a[110:111],v12,12800
buffer_load_dwordx4 v158, s[8:11], s39 offen offset:3072  lds
mz v[44:47],a[124:127],v[116:119],0
cv v220,v56,v57
cv v221,v58,v59
mf v[44:47],a[120:123],v[104:107]
v_lshl_add_u32 v21, v1, 3, s3
v_min_u32 v21, L_end-L_main4, v21
mf v[44:47],a[116:119],v[92:95]
global_load_dword v20, v21, s[58:59]
mf v[44:47],a[112:115],v[80:83]
wl
v_mul_f32 v60, s37, v60
v_mul_f32 v61, s37, v61
mz v[56:59],a[96:99],v[80:83],0
tr a[112:113],v12,8
v_mul_f32 v62, s37, v62
mf v[56:59],a[100:103],v[92:95]
tr a[114:115],v12,520
v_mul_f32 v63, s37, v63
cv v224,v60,v61
cv v225,v62,v63
mf v[56:59],a[104:107],v[104:107]
tr a[116:117],v12,4104
v_mul_f32 v64, s37, v64
mf v[56:59],a[108:111],v[116:119]
tr a[118:119],v12,4616
v_mul_f32 v65, s37, v65
mz v[60:63],a[108:111],v[120:123],0
tr a[120:121],v12,8200
v_mul_f32 v66, s37, v66
mf v[60:63],a[104:107],v[108:111]
tr a[122:123],v12,8712
v_mul_f32 v67, s37, v67
cv v228,v64,v65
cv v229,v66,v67
mf v[60:63],a[100:103],v[96:99]
tr a[124:125],v12,12296
v_mul_f32 v76, s37, v76
mf v[60:63],a[96:99],v[84:87]
tr a[126:127],v12,12808
v_mul_f32 v77, s37, v77
mz v[64:67],a[96:99],v[88:91],0
s_mov_b32 m0, 0
v_mul_f32 v78, s37, v78
v_mul_f32 v79, s37, v79
mf v[64:67],a[100:103],v[100:103]
cv v230,v76,v77
cv v231,v78,v79
mf v[64:67],a[104:107],v[112:115]
v_mul_f32 v72, s37, v72
v_mul_f32 v73, s37, v73
mf v[64:67],a[108:111],v[124:127]
wl
v_mul_f32 v74, s37, v74
v_mul_f32 v75, s37, v75
mz v[76:79],a[124:127],v[124:127],0
s_waitcnt vmcnt(37)
cv v226,v72,v73
s_barrier
mf v[76:79],a[120:123],v[112:115]
tr a[96:97],v11,16384
cv v227,v74,v75
mf v[76:79],a[116:119],v[100:103]
s_add_u32 s34, s34, 4096
buffer_load_dwordx4 v152, s[60:63], s34 offen offset:0 nt lds
tr a[98:99],v11,16896
mf v[76:79],a[112:115],v[88:91]
tr a[100:101],v11,20480
v_mul_f32 v68, s37, v68
mz v[72:75],a[112:115],v[84:87],0
tr a[102:103],v11,20992
buffer_load_dwordx4 v153, s[60:63], s34 offen offset:1024 nt lds
mf v[72:75],a[116:119],v[96:99]
tr a[104:105],v11,20488
v_mul_f32 v69, s37, v69
v_mul_f32 v70, s37, v70
v_mul_f32 v71, s37, v71
cv v222,v68,v69
cv v223,v70,v71
mf v[72:75],a[120:123],v[108:111]
tr a[106:107],v11,21000
mf v[72:75],a[124:127],v[120:123]
tr a[108:109],v11,16392
buffer_load_dwordx4 v154, s[60:63], s34 offen offset:2048 nt lds
mz v[68:71],a[124:127],v[116:119],0
tr a[110:111],v11,16904
mf v[68:71],a[120:123],v[104:107]
buffer_load_dwordx4 v155, s[60:63], s34 offen offset:3072 nt lds
mf v[68:71],a[116:119],v[92:95]
s_mov_b32 m0, 4096
mf v[68:71],a[112:115],v[80:83]
wl
mf v[32:35],a[96:99],v[128:131]
s_add_u32 s34, s34, 4096
buffer_load_dwordx4 v152, s[60:63], s34 offen offset:0 nt lds
tr a[112:113],v12,16384
mf v[32:35],a[100:103],v[140:143]
tr a[114:115],v12,16896
mf v[44:47],a[104:107],v[140:143]
tr a[116:117],v12,20480
buffer_load_dwordx4 v153, s[60:63], s34 offen offset:1024 nt lds
mf v[44:47],a[108:111],v[128:131]
tr a[118:119],v12,20992
mf v[48:51],a[108:111],v[132:135]
tr a[120:121],v12,20488
mf v[48:51],a[104:107],v[144:147]
tr a[122:123],v12,21000
buffer_load_dwordx4 v154, s[60:63], s34 offen offset:2048 nt lds
mf v[36:39],a[100:103],v[144:147]
tr a[124:125],v12,16392
mf v[36:39],a[96:99],v[132:135]
tr a[126:127],v12,16904
buffer_load_dwordx4 v155, s[60:63], s34 offen offset:3072 nt lds
mf v[40:43],a[96:99],v[136:139]
s_mov_b32 m0, 8192
mf v[40:43],a[100:103],v[148:151]
mf v[52:55],a[104:107],v[148:151]
s_add_u32 s34, s34, 4096
buffer_load_dwordx4 v152, s[60:63], s34 offen offset:0 nt lds
mf v[52:55],a[108:111],v[136:139]
wl
mf v[76:79],a[124:127],v[136:139]
s_waitcnt vmcnt(28)
buffer_load_dwordx4 v153, s[60:63], s34 offen offset:1024 nt lds
s_barrier
mf v[76:79],a[120:123],v[148:151]
tr a[96:97],v11,32768
mf v[64:67],a[116:119],v[148:151]
tr a[98:99],v11,33280
mf v[64:67],a[112:115],v[136:139]
tr a[100:101],v11,36864
buffer_load_dwordx4 v154, s[60:63], s34 offen offset:2048 nt lds
mf v[60:63],a[112:115],v[132:135]
tr a[102:103],v11,37376
mf v[60:63],a[116:119],v[144:147]
tr a[104:105],v11,40960
buffer_load_dwordx4 v155, s[60:63], s34 offen offset:3072 nt lds
mf v[72:75],a[120:123],v[144:147]
s_mov_b32 m0, 12288
tr a[106:107],v11,41472
mf v[72:75],a[124:127],v[132:135]
tr a[108:109],v11,45056
mf v[68:71],a[124:127],v[128:131]
s_add_u32 s34, s34, 4096
buffer_load_dwordx4 v152, s[60:63], s34 offen offset:0 nt lds
tr a[110:111],v11,45568
mf v[68:71],a[120:123],v[140:143]
mf v[56:59],a[116:119],v[140:143]
buffer_load_dwordx4 v153, s[60:63], s34 offen offset:1024 nt lds
mf v[56:59],a[112:115],v[128:131]
wl
mf v[32:35],a[96:99],a[128:131]
tr a[112:113],v11,32776
mf v[32:35],a[100:103],a[140:143]
tr a[114:115],v11,33288
buffer_load_dwordx4 v154, s[60:63], s34 offen offset:2048 nt lds
mf v[32:35],a[104:107],a[152:155]
tr a[116:117],v11,36872
mf v[32:35],a[108:111],a[164:167]
tr a[118:119],v11,37384
buffer_load_dwordx4 v155, s[60:63], s34 offen offset:3072 nt lds
mf v[36:39],a[108:111],a[168:171]
s_mov_b32 m0, 16384
tr a[120:121],v11,40968
mf v[36:39],a[104:107],a[156:159]
tr a[122:123],v11,41480
mf v[36:39],a[100:103],a[144:147]
s_add_u32 s34, s34, 4096
buffer_load_dwordx4 v152, s[60:63], s34 offen offset:0 nt lds
tr a[124:125],v11,45064
mf v[36:39],a[96:99],a[132:135]
tr a[126:127],v11,45576
mf v[40:43],a[96:99],a[136:139]
buffer_load_dwordx4 v153, s[60:63], s34 offen offset:1024 nt lds
mf v[40:43],a[100:103],a[148:151]
mf v[40:43],a[104:107],a[160:163]
buffer_load_dwordx4 v154, s[60:63], s34 offen offset:2048 nt lds
mf v[40:43],a[108:111],a[172:175]
wl
mf v[52:55],a[124:127],a[172:175]
tr a[96:97],v12,32768
mf v[52:55],a[120:123],a[160:163]
tr a[98:99],v12,33280
buffer_load_dwordx4 v155, s[60:63], s34 offen offset:3072 nt lds
mf v[52:55],a[116:119],a[148:151]
s_mov_b32 m0, 20480
tr a[100:101],v12,36864
mf v[52:55],a[112:115],a[136:139]
s_add_u32 s34, s34, 4096
buffer_load_dwordx4 v152, s[60:63], s34 offen offset:0 nt lds
tr a[102:103],v12,37376
mf v[48:51],a[112:115],a[132:135]
tr a[104:105],v12,40960
mf v[48:51],a[116:119],a[144:147]
tr a[106:107],v12,41472
mf v[48:51],a[120:123],a[156:159]
tr a[108:109],v12,45056
buffer_load_dwordx4 v153, s[60:63], s34 offen offset:1024 nt lds
mf v[48:51],a[124:127],a[168:171]
tr a[110:111],v12,45568
mf v[44:47],a[124:127],a[164:167]
buffer_load_dwordx4 v154, s[60:63], s34 offen offset:2048 nt lds
mf v[44:47],a[120:123],a[152:155]
mf v[44:47],a[116:119],a[140:143]
mf v[44:47],a[112:115],a[128:131]
wl
buffer_load_dwordx4 v155, s[60:63], s34 offen offset:3072 nt lds
mf v[56:59],a[96:99],a[128:131]
s_mov_b32 m0, 24576
tr a[112:113],v12,32776
mf v[56:59],a[100:103],a[140:143]
s_add_u32 s34, s34, 4096
buffer_load_dwordx4 v152, s[60:63], s34 offen offset:0 nt lds
tr a[114:115],v12,33288
mf v[56:59],a[104:107],a[152:155]
tr a[116:117],v12,36872
mf v[56:59],a[108:111],a[164:167]
tr a[118:119],v12,37384
buffer_load_dwordx4 v153, s[60:63], s34 offen offset:1024 nt lds
mf v[60:63],a[108:111],a[168:171]
tr a[120:121],v12,40968
mf v[60:63],a[104:107],a[156:159]
tr a[122:123],v12,41480
mf v[60:63],a[100:103],a[144:147]
tr a[124:125],v12,45064
buffer_load_dwordx4 v154, s[60:63], s34 offen offset:2048 nt lds
mf v[60:63],a[96:99],a[132:135]
tr a[126:127],v12,45576
mf v[64:67],a[96:99],a[136:139]
buffer_load_dwordx4 v155, s[60:63], s34 offen offset:3072 nt lds
mf v[64:67],a[100:103],a[148:151]
s_mov_b32 m0, 28672
mf v[64:67],a[104:107],a[160:163]
mf v[64:67],a[108:111],a[172:175]
s_add_u32 s34, s34, 4096
buffer_load_dwordx4 v152, s[60:63], s34 offen offset:0 nt lds
wl
mf v[76:79],a[124:127],a[172:175]
s_waitcnt vmcnt(30)
s_barrier
mf v[76:79],a[120:123],a[160:163]
tr a[96:97],v11,49152
buffer_load_dwordx4 v153, s[60:63], s34 offen offset:1024 nt lds
mf v[76:79],a[116:119],a[148:151]
tr a[98:99],v11,49664
mf v[76:79],a[112:115],a[136:139]
tr a[100:101],v11,53248
mf v[72:75],a[112:115],a[132:135]
tr a[102:103],v11,53760
buffer_load_dwordx4 v154, s[60:63], s34 offen offset:2048 nt lds
mf v[72:75],a[116:119],a[144:147]
tr a[104:105],v11,57344
mf v[72:75],a[120:123],a[156:159]
tr a[106:107],v11,57856
buffer_load_dwordx4 v155, s[60:63], s34 offen offset:3072 nt lds
mf v[72:75],a[124:127],a[168:171]
s_mov_b32 m0, 32768
tr a[108:109],v11,61440
mf v[68:71],a[124:127],a[164:167]
tr a[110:111],v11,61952
mf v[68:71],a[120:123],a[152:155]
s_add_u32 s35, s35, 4096
buffer_load_dwordx4 v152, s[64:67], s35 offen offset:0 nt lds
mf v[68:71],a[116:119],a[140:143]
mf v[68:71],a[112:115],a[128:131]
wl
buffer_load_dwordx4 v153, s[64:67], s35 offen offset:1024 nt lds
mf v[32:35],a[96:99],a[176:179]
tr a[112:113],v11,49160
mf v[32:35],a[100:103],a[188:191]
tr a[114:115],v11,49672
buffer_load_dwordx4 v154, s[64:67], s35 offen offset:2048 nt lds
mf v[32:35],a[104:107],a[200:203]
tr a[116:117],v11,53256
mf v[32:35],a[108:111],a[212:215]
tr a[118:119],v11,53768
buffer_load_dwordx4 v155, s[64:67], s35 offen offset:3072 nt lds
mf v[36:39],a[108:111],a[216:219]
s_mov_b32 m0, 36864
tr a[120:121],v11,57352
mf v[36:39],a[104:107],a[204:207]
tr a[122:123],v11,57864
mf v[36:39],a[100:103],a[192:195]
s_add_u32 s35, s35, 4096
buffer_load_dwordx4 v152, s[64:67], s35 offen offset:0 nt lds
tr a[124:125],v11,61448
mf v[36:39],a[96:99],a[180:183]
tr a[126:127],v11,61960
mf v[40:43],a[96:99],a[184:187]
buffer_load_dwordx4 v153, s[64:67], s35 offen offset:1024 nt lds
mf v[40:43],a[100:103],a[196:199]
v_mul_f32 v32, s37, v32
v_mul_f32 v33, s37, v33
mf v[40:43],a[104:107],a[208:211]
buffer_load_dwordx4 v154, s[64:67], s35 offen offset:2048 nt lds
mf v[40:43],a[108:111],a[220:223]
wl
v_mul_f32 v34, s37, v34
v_mul_f32 v35, s37, v35
mf v[44:47],a[112:115],a[176:179]
tr a[96:97],v12,49152
cv v232,v32,v33
mf v[44:47],a[116:119],a[188:191]
tr a[98:99],v12,49664
buffer_load_dwordx4 v155, s[64:67], s35 offen offset:3072 nt lds
mf v[44:47],a[120:123],a[200:203]
s_mov_b32 m0, 40960
tr a[100:101],v12,53248
mf v[44:47],a[124:127],a[212:215]
s_add_u32 s35, s35, 4096
buffer_load_dwordx4 v152, s[64:67], s35 offen offset:0 nt lds
tr a[102:103],v12,53760
mf v[48:51],a[124:127],a[216:219]
tr a[104:105],v12,57344
cv v233,v34,v35
mf v[48:51],a[120:123],a[204:207]
tr a[106:107],v12,57856
buffer_load_dwordx4 v153, s[64:67], s35 offen offset:1024 nt lds
mf v[48:51],a[116:119],a[192:195]
tr a[108:109],v12,61440
v_mul_f32 v36, s37, v36
mf v[48:51],a[112:115],a[180:183]
tr a[110:111],v12,61952
v_mul_f32 v37, s37, v37
mf v[52:55],a[112:115],a[184:187]
buffer_load_dwordx4 v154, s[64:67], s35 offen offset:2048 nt lds
mf v[52:55],a[116:119],a[196:199]
v_mul_f32 v38, s37, v38
v_mul_f32 v39, s37, v39
mf v[52:55],a[120:123],a[208:211]
buffer_load_dwordx4 v155, s[64:67], s35 offen offset:3072 nt lds
mf v[52:55],a[124:127],a[220:223]
s_mov_b32 m0, 45056
cv v236,v36,v37
wl
mf v[56:59],a[96:99],a[176:179]
s_add_u32 s35, s35, 4096
buffer_load_dwordx4 v152, s[64:67], s35 offen offset:0 nt lds
tr a[112:113],v12,49160
mf v[56:59],a[100:103],a[188:191]
tr a[114:115],v12,49672
cv v237,v38,v39
mf v[56:59],a[104:107],a[200:203]
tr a[116:117],v12,53256
v_mul_f32 v40, s37, v40
mf v[56:59],a[108:111],a[212:215]
tr a[118:119],v12,53768
buffer_load_dwordx4 v153, s[64:67], s35 offen offset:1024 nt lds
mf v[60:63],a[108:111],a[216:219]
tr a[120:121],v12,57352
v_mul_f32 v41, s37, v41
mf v[60:63],a[104:107],a[204:207]
tr a[122:123],v12,57864
buffer_load_dwordx4 v154, s[64:67], s35 offen offset:2048 nt lds
mf v[60:63],a[100:103],a[192:195]
tr a[124:125],v12,61448
v_mul_f32 v42, s37, v42
mf v[60:63],a[96:99],a[180:183]
tr a[126:127],v12,61960
buffer_load_dwordx4 v155, s[64:67], s35 offen offset:3072 nt lds
mf v[64:67],a[96:99],a[184:187]
s_mov_b32 m0, 49152
v_mul_f32 v43, s37, v43
cv v240,v40,v41
mf v[64:67],a[100:103],a[196:199]
cv v241,v42,v43
v_mul_f32 v44, s37, v44
mf v[64:67],a[104:107],a[208:211]
v_mul_f32 v45, s37, v45
v_mul_f32 v46, s37, v46
mf v[64:67],a[108:111],a[220:223]
wl
v_mul_f32 v47, s37, v47
cv v234,v44,v45
mf v[68:71],a[112:115],a[176:179]
s_waitcnt vmcnt(32)
cv v235,v46,v47
s_barrier
mf v[68:71],a[116:119],a[188:191]
s_add_u32 s34, s34, 4096
buffer_load_dwordx4 v152, s[60:63], s34 offen offset:0 nt lds
ds_read_b128 a[96:99], v5 offset:0
mf v[68:71],a[120:123],a[200:203]
ds_read_b128 a[100:103], v6 offset:0
v_mul_f32 v48, s37, v48
mf v[68:71],a[124:127],a[212:215]
ds_read_b128 a[104:107], v5 offset:1024
buffer_load_dwordx4 v153, s[60:63], s34 offen offset:1024 nt lds
mf v[72:75],a[124:127],a[216:219]
ds_read_b128 a[108:111], v6 offset:1024
v_mul_f32 v49, s37, v49
mf v[72:75],a[120:123],a[204:207]
buffer_load_dwordx4 v154, s[60:63], s34 offen offset:2048 nt lds
mf v[72:75],a[116:119],a[192:195]
v_mul_f32 v50, s37, v50
v_mul_f32 v51, s37, v51
mf v[72:75],a[112:115],a[180:183]
buffer_load_dwordx4 v155, s[60:63], s34 offen offset:3072 nt lds
mf v[76:79],a[112:115],a[184:187]
s_mov_b32 m0, 53248
cv v238,v48,v49
cv v239,v50,v51
mf v[76:79],a[116:119],a[196:199]
s_add_u32 s34, s34, 4096
buffer_load_dwordx4 v152, s[60:63], s34 offen offset:0 nt lds
mf v[76:79],a[120:123],a[208:211]
v_mul_f32 v52, s37, v52
v_mul_f32 v53, s37, v53
mf v[76:79],a[124:127],a[220:223]
wl
buffer_load_dwordx4 v153, s[60:63], s34 offen offset:1024 nt lds
mz v[44:47],a[96:99],a[0:3],0
ds_read_b128 a[112:115], v5 offset:2048
v_mul_f32 v54, s37, v54
mf v[44:47],a[100:103],a[12:15]
ds_read_b128 a[116:119], v6 offset:2048
buffer_load_dwordx4 v154, s[60:63], s34 offen offset:2048 nt lds
mf v[44:47],a[104:107],a[24:27]
ds_read_b128 a[120:123], v5 offset:3072
v_mul_f32 v55, s37, v55
mf v[44:47],a[108:111],a[36:39]
ds_read_b128 a[124:127], v6 offset:3072
buffer_load_dwordx4 v155, s[60:63], s34 offen offset:3072 nt lds
mz v[48:51],a[108:111],a[40:43],0
s_mov_b32 m0, 57344
cv v242,v52,v53
cv v243,v54,v55
mf v[48:51],a[104:107],a[28:31]
s_add_u32 s34, s34, 4096
buffer_load_dwordx4 v152, s[60:63], s34 offen offset:0 nt lds
mf v[48:51],a[100:103],a[16:19]
v_mul_f32 v56, s37, v56
v_mul_f32 v57, s37, v57
mf v[48:51],a[96:99],a[4:7]
buffer_load_dwordx4 v153, s[60:63], s34 offen offset:1024 nt lds
mz v[52:55],a[96:99],a[8:11],0
v_mul_f32 v58, s37, v58
v_mul_f32 v59, s37, v59
mf v[52:55],a[100:103],a[20:23]
cv v244,v56,v57
cv v245,v58,v59
buffer_load_dwordx4 v154, s[60:63], s34 offen offset:2048 nt lds
mf v[52:55],a[104:107],a[32:35]
v_mul_f32 v60, s37, v60
v_mul_f32 v61, s37, v61
mf v[52:55],a[108:111],a[44:47]
wl
buffer_load_dwordx4 v155, s[60:63], s34 offen offset:3072 nt lds
mf v[52:55],a[124:127],a[92:95]
s_mov_b32 m0, 61440
ds_read_b128 a[96:99], v5 offset:10240
mf v[52:55],a[120:123],a[80:83]
s_add_u32 s34, s34, 4096
buffer_load_dwordx4 v152, s[60:63], s34 offen offset:0 nt lds
ds_read_b128 a[100:103], v6 offset:10240
v_mul_f32 v62, s37, v62
v_mul_f32 v63, s37, v63
cv v248,v60,v61
cv v249,v62,v63
mf v[52:55],a[116:119],a[68:71]
ds_read_b128 a[104:107], v5 offset:11264
v_mul_f32 v64, s37, v64
mf v[52:55],a[112:115],a[56:59]
ds_read_b128 a[108:111], v6 offset:11264
buffer_load_dwordx4 v153, s[60:63], s34 offen offset:1024 nt lds
mf v[48:51],a[112:115],a[52:55]
v_mul_f32 v65, s37, v65
v_mul_f32 v66, s37, v66
mf v[48:51],a[116:119],a[64:67]
v_mul_f32 v67, s37, v67
cv v252,v64,v65
cv v253,v66,v67
buffer_load_dwordx4 v154, s[60:63], s34 offen offset:2048 nt lds
mf v[48:51],a[120:123],a[76:79]
v_mul_f32 v68, s37, v68
v_mul_f32 v69, s37, v69
mf v[48:51],a[124:127],a[88:91]
buffer_load_dwordx4 v155, s[60:63], s34 offen offset:3072 nt lds
mf v[44:47],a[124:127],a[84:87]
v_mul_f32 v70, s37, v70
v_mul_f32 v71, s37, v71
mf v[44:47],a[120:123],a[72:75]
cv v246,v68,v69
cv v247,v70,v71
mf v[44:47],a[116:119],a[60:63]
v_exp_f32 v52, v52
mf v[44:47],a[112:115],a[48:51]
wl
v_exp_f32 v53, v53
mz v[68:71],a[96:99],a[48:51],0
ds_read_b128 a[112:115], v5 offset:8192
v_add_f32 v26, v52, v53
mf v[68:71],a[100:103],a[60:63]
ds_read_b128 a[116:119], v6 offset:8192
v_mul_f32 v72, s37, v72
v_mul_f32 v73, s37, v73
v_mul_f32 v74, s37, v74
v_mul_f32 v75, s37, v75
cv v250,v72,v73
cv v251,v74,v75
mf v[68:71],a[104:107],a[72:75]
ds_read_b128 a[120:123], v5 offset:9216
cv v52,v52,v53
mf v[68:71],a[108:111],a[84:87]
ds_read_b128 a[124:127], v6 offset:9216
v_mul_f32 v76, s37, v76
mz v[72:75],a[108:111],a[88:91],0
v_exp_f32 v54, v54
mf v[72:75],a[104:107],a[76:79]
v_mul_f32 v77, s37, v77
v_mul_f32 v78, s37, v78
v_mul_f32 v79, s37, v79
cv v254,v76,v77
cv v255,v78,v79
mf v[72:75],a[100:103],a[64:67]
v_exp_f32 v55, v55
mf v[72:75],a[96:99],a[52:55]
s_mov_b32 m0, 0
v_exp_f32 v48, v48
mz v[76:79],a[96:99],a[56:59],0
v_exp_f32 v49, v49
mf v[76:79],a[100:103],a[68:71]
v_exp_f32 v50, v50
mf v[76:79],a[104:107],a[80:83]
v_exp_f32 v51, v51
mf v[76:79],a[108:111],a[92:95]
wl
v_exp_f32 v44, v44
mf v[76:79],a[124:127],a[44:47]
s_waitcnt vmcnt(32)
v_add_f32 v26, v54, v26
s_barrier
mf v[76:79],a[120:123],a[32:35]
s_add_u32 s35, s35, 4096
buffer_load_dwordx4 v152, s[64:67], s35 offen offset:0 nt lds
ds_read_b128 a[96:99], v5 offset:16384
mf v[76:79],a[116:119],a[20:23]
ds_read_b128 a[100:103], v6 offset:16384
v_add_f32 v26, v55, v26
mf v[76:79],a[112:115],a[8:11]
ds_read_b128 a[104:107], v5 offset:17408
buffer_load_dwordx4 v153, s[64:67], s35 offen offset:1024 nt lds
mf v[72:75],a[112:115],a[4:7]
ds_read_b128 a[108:111], v6 offset:17408
cv v53,v54,v55
mf v[72:75],a[116:119],a[16:19]
buffer_load_dwordx4 v154, s[64:67], s35 offen offset:2048 nt lds
mf v[72:75],a[120:123],a[28:31]
v_exp_f32 v45, v45
mf v[72:75],a[124:127],a[40:43]
buffer_load_dwordx4 v155, s[64:67], s35 offen offset:3072 nt lds
mf v[68:71],a[124:127],a[36:39]
s_mov_b32 m0, 4096
v_exp_f32 v46, v46
mf v[68:71],a[120:123],a[24:27]
s_add_u32 s35, s35, 4096
buffer_load_dwordx4 v152, s[64:67], s35 offen offset:0 nt lds
mf v[68:71],a[116:119],a[12:15]
v_exp_f32 v47, v47
mf v[68:71],a[112:115],a[0:3]
wl
buffer_load_dwordx4 v153, s[64:67], s35 offen offset:1024 nt lds
mz v[56:59],a[96:99],a[0:3],0
ds_read_b128 a[112:115], v5 offset:18432
v_add_f32 v25, v48, v49
mf v[56:59],a[100:103],a[12:15]
ds_read_b128 a[116:119], v6 offset:18432
buffer_load_dwordx4 v154, s[64:67], s35 offen offset:2048 nt lds
mf v[56:59],a[104:107],a[24:27]
ds_read_b128 a[120:123], v5 offset:19456
cv v48,v48,v49
mf v[56:59],a[108:111],a[36:39]
ds_read_b128 a[124:127], v6 offset:19456
buffer_load_dwordx4 v155, s[64:67], s35 offen offset:3072 nt lds
mz v[60:63],a[108:111],a[40:43],0
s_mov_b32 m0, 8192
v_exp_f32 v76, v76
mf v[60:63],a[104:107],a[28:31]
s_add_u32 s35, s35, 4096
buffer_load_dwordx4 v152, s[64:67], s35 offen offset:0 nt lds
mf v[60:63],a[100:103],a[16:19]
v_exp_f32 v77, v77
mf v[60:63],a[96:99],a[4:7]
buffer_load_dwordx4 v153, s[64:67], s35 offen offset:1024 nt lds
mz v[64:67],a[96:99],a[8:11],0
v_exp_f32 v78, v78
mf v[64:67],a[100:103],a[20:23]
buffer_load_dwordx4 v154, s[64:67], s35 offen offset:2048 nt lds
mf v[64:67],a[104:107],a[32:35]
v_exp_f32 v79, v79
mf v[64:67],a[108:111],a[44:47]
wl
buffer_load_dwordx4 v155, s[64:67], s35 offen offset:3072 nt lds
mf v[64:67],a[124:127],a[92:95]
s_mov_b32 m0, 12288
ds_read_b128 a[96:99], v5 offset:26624
mf v[64:67],a[120:123],a[80:83]
s_add_u32 s35, s35, 4096
buffer_load_dwordx4 v152, s[64:67], s35 offen offset:0 nt lds
ds_read_b128 a[100:103], v6 offset:26624
mf v[64:67],a[116:119],a[68:71]
ds_read_b128 a[104:107], v5 offset:27648
v_add_f32 v26, v76, v26
mf v[64:67],a[112:115],a[56:59]
ds_read_b128 a[108:111], v6 offset:27648
buffer_load_dwordx4 v153, s[64:67], s35 offen offset:1024 nt lds
mf v[60:63],a[112:115],a[52:55]
v_exp_f32 v72, v72
v_exp_f32 v73, v73
v_exp_f32 v74, v74
v_exp_f32 v75, v75
v_exp_f32 v68, v68
v_exp_f32 v69, v69
v_exp_f32 v70, v70
v_exp_f32 v71, v71
mf v[60:63],a[116:119],a[64:67]
v_add_f32 v24, v44, v45
cv v44,v44,v45
v_add_f32 v24, v46, v24
v_add_f32 v24, v47, v24
cv v45,v46,v47
v_add_f32 v24, v68, v24
v_add_f32 v24, v69, v24
cv v46,v68,v69
v_add_f32 v24, v70, v24
v_add_f32 v24, v71, v24
cv v47,v70,v71
v_add_f32 v25, v50, v25
v_add_f32 v25, v51, v25
cv v49,v50,v51
v_add_f32 v25, v72, v25
v_add_f32 v25, v73, v25
cv v50,v72,v73
v_add_f32 v25, v74, v25
v_add_f32 v25, v75, v25
cv v51,v74,v75
v_add_f32 v26, v77, v26
cv v54,v76,v77
v_add_f32 v26, v78, v26
v_add_f32 v26, v79, v26
cv v55,v78,v79
buffer_load_dwordx4 v154, s[64:67], s35 offen offset:2048 nt lds
mf v[60:63],a[120:123],a[76:79]
v_min3_f32 v0, v24, v25, v26
v_cmp_gt_f32 s[72:73], s55, v0
mf v[60:63],a[124:127],a[88:91]
buffer_load_dwordx4 v155, s[64:67], s35 offen offset:3072 nt lds
mf v[56:59],a[124:127],a[84:87]
v_mov_b32 v32, 0
v_mov_b32 v33, 0
v_mov_b32 v34, 0
v_mov_b32 v35, 0
v_mov_b32 v36, 0
v_mov_b32 v37, 0
v_mov_b32 v38, 0
v_mov_b32 v39, 0
v_mov_b32 v40, 0
v_mov_b32 v41, 0
v_mov_b32 v42, 0
v_mov_b32 v43, 0
mf v[56:59],a[120:123],a[72:75]
v_max3_f32 v0, v24, v25, v26
v_cmp_lt_f32 vcc, s36, v0
mf v[56:59],a[116:119],a[60:63]
mf v[56:59],a[112:115],a[48:51]
wl
s_or_b64 s[72:73], s[72:73], vcc
s_cbranch_scc1 Lslow_fronth_b
Lret_fronth_b:
mz v[68:71],a[96:99],a[48:51],v[32:35]
s_add_u32 s43, s43, 16384
ds_read_b128 a[112:115], v5 offset:24576
mf v[68:71],a[100:103],a[60:63]
ds_read_b128 a[116:119], v6 offset:24576
mf v[68:71],a[104:107],a[72:75]
ds_read_b128 a[120:123], v5 offset:25600
mf v[68:71],a[108:111],a[84:87]
ds_read_b128 a[124:127], v6 offset:25600
mz v[72:75],a[108:111],a[88:91],v[36:39]
v_exp_f32 v64, v64
mf v[72:75],a[104:107],a[76:79]
v_exp_f32 v65, v65
mf v[72:75],a[100:103],a[64:67]
v_exp_f32 v66, v66
mf v[72:75],a[96:99],a[52:55]
s_mov_b32 m0, 16384
v_exp_f32 v67, v67
mz v[76:79],a[96:99],a[56:59],v[40:43]
v_exp_f32 v60, v60
mf v[76:79],a[100:103],a[68:71]
v_exp_f32 v61, v61
mf v[76:79],a[104:107],a[80:83]
v_exp_f32 v62, v62
mf v[76:79],a[108:111],a[92:95]
wl
v_exp_f32 v63, v63
mf v[76:79],a[124:127],a[44:47]
s_waitcnt vmcnt(32)
v_add_f32 v30, v64, v65
s_barrier
mf v[76:79],a[120:123],a[32:35]
s_add_u32 s34, s34, 4096
buffer_load_dwordx4 v152, s[60:63], s34 offen offset:0 nt lds
tr a[96:97],v7,32768
mf v[76:79],a[116:119],a[20:23]
tr a[98:99],v7,40960
cv v64,v64,v65
mf v[76:79],a[112:115],a[8:11]
tr a[100:101],v8,32768
buffer_load_dwordx4 v153, s[60:63], s34 offen offset:1024 nt lds
mf v[72:75],a[112:115],a[4:7]
tr a[102:103],v8,40960
v_add_f32 v30, v66, v30
mf v[72:75],a[116:119],a[16:19]
tr a[104:105],v9,32768
buffer_load_dwordx4 v154, s[60:63], s34 offen offset:2048 nt lds
mf v[72:75],a[120:123],a[28:31]
tr a[106:107],v9,40960
v_add_f32 v30, v67, v30
mf v[72:75],a[124:127],a[40:43]
tr a[108:109],v10,32768
buffer_load_dwordx4 v155, s[60:63], s34 offen offset:3072 nt lds
mf v[68:71],a[124:127],a[36:39]
s_mov_b32 m0, 20480
tr a[110:111],v10,40960
mf v[68:71],a[120:123],a[24:27]
s_add_u32 s34, s34, 4096
buffer_load_dwordx4 v152, s[60:63], s34 offen offset:0 nt lds
mf v[68:71],a[116:119],a[12:15]
v_exp_f32 v56, v56
mf v[68:71],a[112:115],a[0:3]
wl
buffer_load_dwordx4 v153, s[60:63], s34 offen offset:1024 nt lds
mz v[80:83],a[96:99],v[44:47],0
tr a[112:113],v7,33792
cv v65,v66,v67
mz v[84:87],a[96:99],v[48:51],0
tr a[114:115],v7,41984
buffer_load_dwordx4 v154, s[60:63], s34 offen offset:2048 nt lds
mz v[88:91],a[96:99],v[52:55],0
tr a[116:117],v8,33792
v_add_f32 v29, v60, v61
mz v[92:95],a[100:103],v[44:47],0
tr a[118:119],v8,41984
buffer_load_dwordx4 v155, s[60:63], s34 offen offset:3072 nt lds
mz v[96:99],a[100:103],v[48:51],0
s_mov_b32 m0, 24576
tr a[120:121],v9,33792
mz v[100:103],a[100:103],v[52:55],0
s_add_u32 s34, s34, 4096
buffer_load_dwordx4 v152, s[60:63], s34 offen offset:0 nt lds
tr a[122:123],v9,41984
mz v[104:107],a[104:107],v[44:47],0
tr a[124:125],v10,33792
cv v60,v60,v61
mz v[108:111],a[104:107],v[48:51],0
tr a[126:127],v10,41984
buffer_load_dwordx4 v153, s[60:63], s34 offen offset:1024 nt lds
mz v[112:115],a[104:107],v[52:55],0
v_exp_f32 v57, v57
mz v[116:119],a[108:111],v[44:47],0
buffer_load_dwordx4 v154, s[60:63], s34 offen offset:2048 nt lds
mz v[120:123],a[108:111],v[48:51],0
v_exp_f32 v58, v58
mz v[124:127],a[108:111],v[52:55],0
wl
buffer_load_dwordx4 v155, s[60:63], s34 offen offset:3072 nt lds
mz v[128:131],a[112:115],v[44:47],0
s_mov_b32 m0, 28672
tr a[96:97],v7,34816
mz v[132:135],a[112:115],v[48:51],0
s_add_u32 s34, s34, 4096
buffer_load_dwordx4 v152, s[60:63], s34 offen offset:0 nt lds
tr a[98:99],v7,43008
mz v[136:139],a[112:115],v[52:55],0
tr a[100:101],v8,34816
v_add_f32 v29, v62, v29
mz v[140:143],a[116:119],v[44:47],0
tr a[102:103],v8,43008
buffer_load_dwordx4 v153, s[60:63], s34 offen offset:1024 nt lds
mz v[144:147],a[116:119],v[48:51],0
tr a[104:105],v9,34816
v_add_f32 v29, v63, v29
mz v[148:151],a[116:119],v[52:55],0
tr a[106:107],v9,43008
buffer_load_dwordx4 v154, s[60:63], s34 offen offset:2048 nt lds
mz a[128:131],a[120:123],v[44:47],0
tr a[108:109],v10,34816
cv v61,v62,v63
mz a[132:135],a[120:123],v[48:51],0
tr a[110:111],v10,43008
buffer_load_dwordx4 v155, s[60:63], s34 offen offset:3072 nt lds
mz a[136:139],a[120:123],v[52:55],0
v_exp_f32 v59, v59
mz a[140:143],a[124:127],v[44:47],0
v_exp_f32 v76, v76
mz a[144:147],a[124:127],v[48:51],0
v_exp_f32 v77, v77
mz a[148:151],a[124:127],v[52:55],0
wl
v_exp_f32 v78, v78
mz a[152:155],a[96:99],v[44:47],0
tr a[112:113],v7,35840
v_add_f32 v30, v76, v30
mz a[156:159],a[96:99],v[48:51],0
tr a[114:115],v7,44032
v_add_f32 v30, v77, v30
mz a[160:163],a[96:99],v[52:55],0
tr a[116:117],v8,35840
cv v66,v76,v77
mz a[164:167],a[100:103],v[44:47],0
tr a[118:119],v8,44032
v_add_f32 v30, v78, v30
mz a[168:171],a[100:103],v[48:51],0
tr a[120:121],v9,35840
v_add_f32 v28, v56, v57
mz a[172:175],a[100:103],v[52:55],0
tr a[122:123],v9,44032
cv v56,v56,v57
mz a[176:179],a[104:107],v[44:47],0
tr a[124:125],v10,35840
v_exp_f32 v79, v79
v_exp_f32 v72, v72
v_exp_f32 v73, v73
v_exp_f32 v74, v74
v_exp_f32 v75, v75
v_exp_f32 v68, v68
v_exp_f32 v69, v69
v_exp_f32 v70, v70
v_exp_f32 v71, v71
mz a[180:183],a[104:107],v[48:51],0
tr a[126:127],v10,44032
v_add_f32 v28, v58, v28
v_add_f32 v28, v59, v28
cv v57,v58,v59
v_add_f32 v28, v68, v28
v_add_f32 v28, v69, v28
cv v58,v68,v69
v_add_f32 v28, v70, v28
v_add_f32 v28, v71, v28
cv v59,v70,v71
v_add_f32 v29, v72, v29
v_add_f32 v29, v73, v29
cv v62,v72,v73
v_add_f32 v29, v74, v29
v_add_f32 v29, v75, v29
cv v63,v74,v75
v_add_f32 v30, v79, v30
cv v67,v78,v79
mz a[184:187],a[104:107],v[52:55],0
s_mov_b32 m0, 32768
v_max3_f32 v0, v28, v29, v30
v_cmp_lt_f32 vcc, s36, v0
mz a[188:191],a[108:111],v[44:47],0
mz a[192:195],a[108:111],v[48:51],0
mz a[196:199],a[108:111],v[52:55],0
wl
mz a[200:203],a[112:115],v[44:47],0
s_cbranch_vccnz Lslow_front_b
Lret_front_b:
mz a[204:207],a[112:115],v[48:51],0
s_waitcnt vmcnt(32)
v_add_f32 v24, v24, v28
s_barrier
mz a[208:211],a[112:115],v[52:55],0
s_add_u32 s35, s35, 4096
buffer_load_dwordx4 v152, s[64:67], s35 offen offset:0 nt lds
buffer_load_dwordx4 v153, s[64:67], s35 offen offset:1024 nt lds
buffer_load_dwordx4 v154, s[64:67], s35 offen offset:2048 nt lds
ds_read_b128 a[96:99], v5 offset:49152
mz a[212:215],a[116:119],v[44:47],0
ds_read_b128 a[100:103], v6 offset:49152
buffer_load_dwordx4 v155, s[64:67], s35 offen offset:3072 nt lds
s_mov_b32 m0, 36864
s_add_u32 s35, s35, 4096
buffer_load_dwordx4 v152, s[64:67], s35 offen offset:0 nt lds
mz a[216:219],a[116:119],v[48:51],0
ds_read_b128 a[104:107], v5 offset:50176
buffer_load_dwordx4 v153, s[64:67], s35 offen offset:1024 nt lds
buffer_load_dwordx4 v154, s[64:67], s35 offen offset:2048 nt lds
mz a[220:223],a[116:119],v[52:55],0
ds_read_b128 a[108:111], v6 offset:50176
buffer_load_dwordx4 v155, s[64:67], s35 offen offset:3072 nt lds
s_mov_b32 m0, 40960
s_add_u32 s35, s35, 4096
buffer_load_dwordx4 v152, s[64:67], s35 offen offset:0 nt lds
buffer_load_dwordx4 v153, s[64:67], s35 offen offset:1024 nt lds
mz a[224:227],a[120:123],v[44:47],0
s_add_u32 s43, s43, 16384
buffer_load_dwordx4 v154, s[64:67], s35 offen offset:2048 nt lds
buffer_load_dwordx4 v155, s[64:67], s35 offen offset:3072 nt lds
mz a[228:231],a[120:123],v[48:51],0
s_mov_b32 m0, 45056
s_add_u32 s35, s35, 4096
buffer_load_dwordx4 v152, s[64:67], s35 offen offset:0 nt lds
buffer_load_dwordx4 v153, s[64:67], s35 offen offset:1024 nt lds
mz a[232:235],a[120:123],v[52:55],0
buffer_load_dwordx4 v154, s[64:67], s35 offen offset:2048 nt lds
buffer_load_dwordx4 v155, s[64:67], s35 offen offset:3072 nt lds
mz a[236:239],a[124:127],v[44:47],0
v_add_f32 v25, v25, v29
v_add_f32 v26, v26, v30
mz a[240:243],a[124:127],v[48:51],0
mz a[244:247],a[124:127],v[52:55],0
wl
.p2align 5
Lloop_b:
mz v[44:47],a[96:99],a[0:3],v[32:35]
ds_read_b128 a[112:115], v5 offset:51200
mf v[44:47],a[100:103],a[12:15]
ds_read_b128 a[116:119], v6 offset:51200
mf v[44:47],a[104:107],a[24:27]
ds_read_b128 a[120:123], v5 offset:52224
mf v[44:47],a[108:111],a[36:39]
ds_read_b128 a[124:127], v6 offset:52224
mz v[48:51],a[108:111],a[40:43],v[36:39]
mf v[48:51],a[104:107],a[28:31]
s_cmp_eq_u32 s41, 4
s_cbranch_scc0 Lnotouch_b
v_lshl_add_u32 v21, v1, 3, s3
v_min_u32 v21, L_end-L_main4, v21
global_load_dword v20, v21, s[58:59]
Lnotouch_b:
mf v[48:51],a[100:103],a[16:19]
mf v[48:51],a[96:99],a[4:7]
mz v[52:55],a[96:99],a[8:11],v[40:43]
mf v[52:55],a[100:103],a[20:23]
mf v[52:55],a[104:107],a[32:35]
mf v[52:55],a[108:111],a[44:47]
wl
mf v[52:55],a[124:127],a[92:95]
ds_read_b128 a[96:99], v5 offset:59392
mf v[52:55],a[120:123],a[80:83]
ds_read_b128 a[100:103], v6 offset:59392
mf v[52:55],a[116:119],a[68:71]
ds_read_b128 a[104:107], v5 offset:60416
mf v[52:55],a[112:115],a[56:59]
ds_read_b128 a[108:111], v6 offset:60416
mf v[48:51],a[112:115],a[52:55]
mf v[48:51],a[116:119],a[64:67]
mf v[48:51],a[120:123],a[76:79]
mf v[48:51],a[124:127],a[88:91]
mf v[44:47],a[124:127],a[84:87]
mf v[44:47],a[120:123],a[72:75]
mf v[44:47],a[116:119],a[60:63]
v_exp_f32 v52, v52
mf v[44:47],a[112:115],a[48:51]
wl
v_exp_f32 v53, v53
mz v[68:71],a[96:99],a[48:51],v[32:35]
ds_read_b128 a[112:115], v5 offset:57344
v_add_f32 v30, v52, v53
mf v[68:71],a[100:103],a[60:63]
ds_read_b128 a[116:119], v6 offset:57344
cv v52,v52,v53
mf v[68:71],a[104:107],a[72:75]
ds_read_b128 a[120:123], v5 offset:58368
mf v[68:71],a[108:111],a[84:87]
ds_read_b128 a[124:127], v6 offset:58368
mz v[72:75],a[108:111],a[88:91],v[36:39]
v_exp_f32 v54, v54
mf v[72:75],a[104:107],a[76:79]
v_exp_f32 v55, v55
mf v[72:75],a[100:103],a[64:67]
v_exp_f32 v48, v48
mf v[72:75],a[96:99],a[52:55]
s_mov_b32 m0, 49152
v_exp_f32 v49, v49
mz v[76:79],a[96:99],a[56:59],v[40:43]
v_exp_f32 v50, v50
mf v[76:79],a[100:103],a[68:71]
v_exp_f32 v51, v51
mf v[76:79],a[104:107],a[80:83]
v_exp_f32 v44, v44
mf v[76:79],a[108:111],a[92:95]
wl
v_exp_f32 v45, v45
mf v[76:79],a[124:127],a[44:47]
s_waitcnt vmcnt(32)
v_add_f32 v30, v54, v30
s_barrier
mf v[76:79],a[120:123],a[32:35]
s_add_u32 s34, s34, 4096
buffer_load_dwordx4 v152, s[60:63], s34 offen offset:0 nt lds
tr a[96:97],v7,0
mf v[76:79],a[116:119],a[20:23]
tr a[98:99],v7,8192
v_add_f32 v30, v55, v30
mf v[76:79],a[112:115],a[8:11]
tr a[100:101],v8,0
buffer_load_dwordx4 v153, s[60:63], s34 offen offset:1024 nt lds
mf v[72:75],a[112:115],a[4:7]
tr a[102:103],v8,8192
cv v53,v54,v55
mf v[72:75],a[116:119],a[16:19]
tr a[104:105],v9,0
buffer_load_dwordx4 v154, s[60:63], s34 offen offset:2048 nt lds
mf v[72:75],a[120:123],a[28:31]
tr a[106:107],v9,8192
v_add_f32 v29, v48, v49
mf v[72:75],a[124:127],a[40:43]
tr a[108:109],v10,0
buffer_load_dwordx4 v155, s[60:63], s34 offen offset:3072 nt lds
mf v[68:71],a[124:127],a[36:39]
s_mov_b32 m0, 53248
tr a[110:111],v10,8192
mf v[68:71],a[120:123],a[24:27]
s_add_u32 s34, s34, 4096
buffer_load_dwordx4 v152, s[60:63], s34 offen offset:0 nt lds
mf v[68:71],a[116:119],a[12:15]
v_exp_f32 v46, v46
mf v[68:71],a[112:115],a[0:3]
wl
buffer_load_dwordx4 v153, s[60:63], s34 offen offset:1024 nt lds
mf v[80:83],a[96:99],v[56:59]
tr a[112:113],v7,1024
cv v48,v48,v49
mf v[84:87],a[96:99],v[60:63]
tr a[114:115],v7,9216
buffer_load_dwordx4 v154, s[60:63], s34 offen offset:2048 nt lds
mf v[88:91],a[96:99],v[64:67]
tr a[116:117],v8,1024
v_add_f32 v29, v50, v29
mf v[100:103],a[100:103],v[64:67]
tr a[118:119],v8,9216
buffer_load_dwordx4 v155, s[60:63], s34 offen offset:3072 nt lds
mf v[96:99],a[100:103],v[60:63]
s_mov_b32 m0, 57344
tr a[120:121],v9,1024
mf v[92:95],a[100:103],v[56:59]
s_add_u32 s34, s34, 4096
buffer_load_dwordx4 v152, s[60:63], s34 offen offset:0 nt lds
tr a[122:123],v9,9216
mf v[104:107],a[104:107],v[56:59]
tr a[124:125],v10,1024
v_add_f32 v29, v51, v29
mf v[108:111],a[104:107],v[60:63]
tr a[126:127],v10,9216
buffer_load_dwordx4 v153, s[60:63], s34 offen offset:1024 nt lds
mf v[112:115],a[104:107],v[64:67]
v_exp_f32 v47, v47
mf v[124:127],a[108:111],v[64:67]
buffer_load_dwordx4 v154, s[60:63], s34 offen offset:2048 nt lds
mf v[120:123],a[108:111],v[60:63]
v_exp_f32 v76, v76
mf v[116:119],a[108:111],v[56:59]
wl
buffer_load_dwordx4 v155, s[60:63], s34 offen offset:3072 nt lds
mf v[128:131],a[112:115],v[56:59]
s_mov_b32 m0, 61440
tr a[96:97],v7,2048
mf v[132:135],a[112:115],v[60:63]
s_add_u32 s34, s34, 4096
buffer_load_dwordx4 v152, s[60:63], s34 offen offset:0 nt lds
tr a[98:99],v7,10240
mf v[136:139],a[112:115],v[64:67]
tr a[100:101],v8,2048
v_add_f32 v30, v76, v30
mf v[148:151],a[116:119],v[64:67]
tr a[102:103],v8,10240
buffer_load_dwordx4 v153, s[60:63], s34 offen offset:1024 nt lds
mf v[144:147],a[116:119],v[60:63]
tr a[104:105],v9,2048
cv v49,v50,v51
mf v[140:143],a[116:119],v[56:59]
tr a[106:107],v9,10240
buffer_load_dwordx4 v154, s[60:63], s34 offen offset:2048 nt lds
mf a[128:131],a[120:123],v[56:59]
tr a[108:109],v10,2048
v_add_f32 v28, v44, v45
mf a[132:135],a[120:123],v[60:63]
tr a[110:111],v10,10240
buffer_load_dwordx4 v155, s[60:63], s34 offen offset:3072 nt lds
mf a[136:139],a[120:123],v[64:67]
v_exp_f32 v77, v77
mf a[148:151],a[124:127],v[64:67]
v_exp_f32 v78, v78
mf a[144:147],a[124:127],v[60:63]
v_exp_f32 v79, v79
mf a[140:143],a[124:127],v[56:59]
wl
v_exp_f32 v72, v72
mf a[152:155],a[96:99],v[56:59]
tr a[112:113],v7,3072
v_add_f32 v30, v77, v30
mf a[156:159],a[96:99],v[60:63]
tr a[114:115],v7,11264
cv v54,v76,v77
mf a[160:163],a[96:99],v[64:67]
tr a[116:117],v8,3072
v_add_f32 v30, v78, v30
mf a[172:175],a[100:103],v[64:67]
tr a[118:119],v8,11264
v_add_f32 v30, v79, v30
mf a[168:171],a[100:103],v[60:63]
tr a[120:121],v9,3072
cv v55,v78,v79
mf a[164:167],a[100:103],v[56:59]
tr a[122:123],v9,11264
v_add_f32 v29, v72, v29
mf a[176:179],a[104:107],v[56:59]
tr a[124:125],v10,3072
v_exp_f32 v73, v73
v_exp_f32 v74, v74
v_exp_f32 v75, v75
v_exp_f32 v68, v68
v_exp_f32 v69, v69
v_exp_f32 v70, v70
v_exp_f32 v71, v71
mf a[180:183],a[104:107],v[60:63]
tr a[126:127],v10,11264
cv v44,v44,v45
v_add_f32 v28, v46, v28
v_add_f32 v28, v47, v28
cv v45,v46,v47
v_add_f32 v28, v68, v28
v_add_f32 v28, v69, v28
cv v46,v68,v69
v_add_f32 v28, v70, v28
v_add_f32 v28, v71, v28
cv v47,v70,v71
v_add_f32 v29, v73, v29
cv v50,v72,v73
v_add_f32 v29, v74, v29
v_add_f32 v29, v75, v29
cv v51,v74,v75
mf a[184:187],a[104:107],v[64:67]
s_mov_b32 m0, 0
v_max3_f32 v0, v28, v29, v30
v_cmp_lt_f32 vcc, s36, v0
mf a[196:199],a[108:111],v[64:67]
mf a[192:195],a[108:111],v[60:63]
mf a[188:191],a[108:111],v[56:59]
wl
mf a[200:203],a[112:115],v[56:59]
s_cbranch_vccnz Lslow_lp0_b
Lret_lp0_b:
mf a[204:207],a[112:115],v[60:63]
s_waitcnt vmcnt(32)
v_add_f32 v24, v24, v28
s_barrier
mf a[208:211],a[112:115],v[64:67]
s_add_u32 s35, s35, 4096
buffer_load_dwordx4 v152, s[64:67], s35 offen offset:0 nt lds
buffer_load_dwordx4 v153, s[64:67], s35 offen offset:1024 nt lds
buffer_load_dwordx4 v154, s[64:67], s35 offen offset:2048 nt lds
ds_read_b128 a[96:99], v5 offset:16384
mf a[220:223],a[116:119],v[64:67]
ds_read_b128 a[100:103], v6 offset:16384
buffer_load_dwordx4 v155, s[64:67], s35 offen offset:3072 nt lds
s_mov_b32 m0, 4096
s_add_u32 s35, s35, 4096
buffer_load_dwordx4 v152, s[64:67], s35 offen offset:0 nt lds
mf a[216:219],a[116:119],v[60:63]
ds_read_b128 a[104:107], v5 offset:17408
buffer_load_dwordx4 v153, s[64:67], s35 offen offset:1024 nt lds
buffer_load_dwordx4 v154, s[64:67], s35 offen offset:2048 nt lds
mf a[212:215],a[116:119],v[56:59]
ds_read_b128 a[108:111], v6 offset:17408
buffer_load_dwordx4 v155, s[64:67], s35 offen offset:3072 nt lds
s_mov_b32 m0, 8192
s_add_u32 s35, s35, 4096
buffer_load_dwordx4 v152, s[64:67], s35 offen offset:0 nt lds
buffer_load_dwordx4 v153, s[64:67], s35 offen offset:1024 nt lds
mf a[224:227],a[120:123],v[56:59]
s_add_u32 s43, s43, 16384
buffer_load_dwordx4 v154, s[64:67], s35 offen offset:2048 nt lds
buffer_load_dwordx4 v155, s[64:67], s35 offen offset:3072 nt lds
mf a[228:231],a[120:123],v[60:63]
s_mov_b32 m0, 12288
s_add_u32 s35, s35, 4096
buffer_load_dwordx4 v152, s[64:67], s35 offen offset:0 nt lds
buffer_load_dwordx4 v153, s[64:67], s35 offen offset:1024 nt lds
mf a[232:235],a[120:123],v[64:67]
buffer_load_dwordx4 v154, s[64:67], s35 offen offset:2048 nt lds
buffer_load_dwordx4 v155, s[64:67], s35 offen offset:3072 nt lds
mf a[244:247],a[124:127],v[64:67]
v_add_f32 v25, v25, v29
v_add_f32 v26, v26, v30
mf a[240:243],a[124:127],v[60:63]
mf a[236:239],a[124:127],v[56:59]
wl
mz v[56:59],a[96:99],a[0:3],v[32:35]
ds_read_b128 a[112:115], v5 offset:18432
mf v[56:59],a[100:103],a[12:15]
ds_read_b128 a[116:119], v6 offset:18432
mf v[56:59],a[104:107],a[24:27]
ds_read_b128 a[120:123], v5 offset:19456
mf v[56:59],a[108:111],a[36:39]
ds_read_b128 a[124:127], v6 offset:19456
mz v[60:63],a[108:111],a[40:43],v[36:39]
mf v[60:63],a[104:107],a[28:31]
mf v[60:63],a[100:103],a[16:19]
mf v[60:63],a[96:99],a[4:7]
mz v[64:67],a[96:99],a[8:11],v[40:43]
mf v[64:67],a[100:103],a[20:23]
mf v[64:67],a[104:107],a[32:35]
mf v[64:67],a[108:111],a[44:47]
wl
mf v[64:67],a[124:127],a[92:95]
ds_read_b128 a[96:99], v5 offset:26624
mf v[64:67],a[120:123],a[80:83]
ds_read_b128 a[100:103], v6 offset:26624
mf v[64:67],a[116:119],a[68:71]
ds_read_b128 a[104:107], v5 offset:27648
mf v[64:67],a[112:115],a[56:59]
ds_read_b128 a[108:111], v6 offset:27648
mf v[60:63],a[112:115],a[52:55]
mf v[60:63],a[116:119],a[64:67]
mf v[60:63],a[120:123],a[76:79]
mf v[60:63],a[124:127],a[88:91]
mf v[56:59],a[124:127],a[84:87]
mf v[56:59],a[120:123],a[72:75]
mf v[56:59],a[116:119],a[60:63]
v_exp_f32 v64, v64
mf v[56:59],a[112:115],a[48:51]
wl
v_exp_f32 v65, v65
mz v[68:71],a[96:99],a[48:51],v[32:35]
ds_read_b128 a[112:115], v5 offset:24576
v_add_f32 v30, v64, v65
mf v[68:71],a[100:103],a[60:63]
ds_read_b128 a[116:119], v6 offset:24576
cv v64,v64,v65
mf v[68:71],a[104:107],a[72:75]
ds_read_b128 a[120:123], v5 offset:25600
mf v[68:71],a[108:111],a[84:87]
ds_read_b128 a[124:127], v6 offset:25600
mz v[72:75],a[108:111],a[88:91],v[36:39]
v_exp_f32 v66, v66
mf v[72:75],a[104:107],a[76:79]
v_exp_f32 v67, v67
mf v[72:75],a[100:103],a[64:67]
v_exp_f32 v60, v60
mf v[72:75],a[96:99],a[52:55]
s_mov_b32 m0, 16384
v_exp_f32 v61, v61
mz v[76:79],a[96:99],a[56:59],v[40:43]
v_exp_f32 v62, v62
mf v[76:79],a[100:103],a[68:71]
v_exp_f32 v63, v63
mf v[76:79],a[104:107],a[80:83]
v_exp_f32 v56, v56
mf v[76:79],a[108:111],a[92:95]
wl
v_exp_f32 v57, v57
mf v[76:79],a[124:127],a[44:47]
s_waitcnt vmcnt(32)
v_add_f32 v30, v66, v30
s_barrier
mf v[76:79],a[120:123],a[32:35]
s_add_u32 s34, s34, 4096
buffer_load_dwordx4 v152, s[60:63], s34 offen offset:0 nt lds
tr a[96:97],v7,32768
mf v[76:79],a[116:119],a[20:23]
tr a[98:99],v7,40960
v_add_f32 v30, v67, v30
mf v[76:79],a[112:115],a[8:11]
tr a[100:101],v8,32768
buffer_load_dwordx4 v153, s[60:63], s34 offen offset:1024 nt lds
mf v[72:75],a[112:115],a[4:7]
tr a[102:103],v8,40960
cv v65,v66,v67
mf v[72:75],a[116:119],a[16:19]
tr a[104:105],v9,32768
buffer_load_dwordx4 v154, s[60:63], s34 offen offset:2048 nt lds
mf v[72:75],a[120:123],a[28:31]
tr a[106:107],v9,40960
v_add_f32 v29, v60, v61
mf v[72:75],a[124:127],a[40:43]
tr a[108:109],v10,32768
buffer_load_dwordx4 v155, s[60:63], s34 offen offset:3072 nt lds
mf v[68:71],a[124:127],a[36:39]
s_mov_b32 m0, 20480
tr a[110:111],v10,40960
mf v[68:71],a[120:123],a[24:27]
s_add_u32 s34, s34, 4096
buffer_load_dwordx4 v152, s[60:63], s34 offen offset:0 nt lds
mf v[68:71],a[116:119],a[12:15]
v_exp_f32 v58, v58
mf v[68:71],a[112:115],a[0:3]
wl
buffer_load_dwordx4 v153, s[60:63], s34 offen offset:1024 nt lds
mf v[80:83],a[96:99],v[44:47]
tr a[112:113],v7,33792
cv v60,v60,v61
mf v[84:87],a[96:99],v[48:51]
tr a[114:115],v7,41984
buffer_load_dwordx4 v154, s[60:63], s34 offen offset:2048 nt lds
mf v[88:91],a[96:99],v[52:55]
tr a[116:117],v8,33792
v_add_f32 v29, v62, v29
mf v[100:103],a[100:103],v[52:55]
tr a[118:119],v8,41984
buffer_load_dwordx4 v155, s[60:63], s34 offen offset:3072 nt lds
mf v[96:99],a[100:103],v[48:51]
s_mov_b32 m0, 24576
tr a[120:121],v9,33792
mf v[92:95],a[100:103],v[44:47]
s_add_u32 s34, s34, 4096
buffer_load_dwordx4 v152, s[60:63], s34 offen offset:0 nt lds
tr a[122:123],v9,41984
mf v[104:107],a[104:107],v[44:47]
tr a[124:125],v10,33792
v_add_f32 v29, v63, v29
mf v[108:111],a[104:107],v[48:51]
tr a[126:127],v10,41984
buffer_load_dwordx4 v153, s[60:63], s34 offen offset:1024 nt lds
mf v[112:115],a[104:107],v[52:55]
v_exp_f32 v59, v59
mf v[124:127],a[108:111],v[52:55]
buffer_load_dwordx4 v154, s[60:63], s34 offen offset:2048 nt lds
mf v[120:123],a[108:111],v[48:51]
v_exp_f32 v76, v76
mf v[116:119],a[108:111],v[44:47]
wl
buffer_load_dwordx4 v155, s[60:63], s34 offen offset:3072 nt lds
mf v[128:131],a[112:115],v[44:47]
s_mov_b32 m0, 28672
tr a[96:97],v7,34816
mf v[132:135],a[112:115],v[48:51]
s_add_u32 s34, s34, 4096
buffer_load_dwordx4 v152, s[60:63], s34 offen offset:0 nt lds
tr a[98:99],v7,43008
mf v[136:139],a[112:115],v[52:55]
tr a[100:101],v8,34816
v_add_f32 v30, v76, v30
mf v[148:151],a[116:119],v[52:55]
tr a[102:103],v8,43008
buffer_load_dwordx4 v153, s[60:63], s34 offen offset:1024 nt lds
mf v[144:147],a[116:119],v[48:51]
tr a[104:105],v9,34816
cv v61,v62,v63
mf v[140:143],a[116:119],v[44:47]
tr a[106:107],v9,43008
buffer_load_dwordx4 v154, s[60:63], s34 offen offset:2048 nt lds
mf a[128:131],a[120:123],v[44:47]
tr a[108:109],v10,34816
v_add_f32 v28, v56, v57
mf a[132:135],a[120:123],v[48:51]
tr a[110:111],v10,43008
buffer_load_dwordx4 v155, s[60:63], s34 offen offset:3072 nt lds
mf a[136:139],a[120:123],v[52:55]
v_exp_f32 v77, v77
mf a[148:151],a[124:127],v[52:55]
v_exp_f32 v78, v78
mf a[144:147],a[124:127],v[48:51]
v_exp_f32 v79, v79
mf a[140:143],a[124:127],v[44:47]
wl
v_exp_f32 v72, v72
mf a[152:155],a[96:99],v[44:47]
tr a[112:113],v7,35840
v_add_f32 v30, v77, v30
mf a[156:159],a[96:99],v[48:51]
tr a[114:115],v7,44032
cv v66,v76,v77
mf a[160:163],a[96:99],v[52:55]
tr a[116:117],v8,35840
v_add_f32 v30, v78, v30
mf a[172:175],a[100:103],v[52:55]
tr a[118:119],v8,44032
v_add_f32 v30, v79, v30
mf a[168:171],a[100:103],v[48:51]
tr a[120:121],v9,35840
cv v67,v78,v79
mf a[164:167],a[100:103],v[44:47]
tr a[122:123],v9,44032
v_add_f32 v29, v72, v29
mf a[176:179],a[104:107],v[44:47]
tr a[124:125],v10,35840
v_exp_f32 v73, v73
v_exp_f32 v74, v74
v_exp_f32 v75, v75
v_exp_f32 v68, v68
v_exp_f32 v69, v69
v_exp_f32 v70, v70
v_exp_f32 v71, v71
mf a[180:183],a[104:107],v[48:51]
tr a[126:127],v10,44032
cv v56,v56,v57
v_add_f32 v28, v58, v28
v_add_f32 v28, v59, v28
cv v57,v58,v59
v_add_f32 v28, v68, v28
v_add_f32 v28, v69, v28
cv v58,v68,v69
v_add_f32 v28, v70, v28
v_add_f32 v28, v71, v28
cv v59,v70,v71
v_add_f32 v29, v73, v29
cv v62,v72,v73
v_add_f32 v29, v74, v29
v_add_f32 v29, v75, v29
cv v63,v74,v75
mf a[184:187],a[104:107],v[52:55]
s_mov_b32 m0, 32768
v_max3_f32 v0, v28, v29, v30
v_cmp_lt_f32 vcc, s36, v0
mf a[196:199],a[108:111],v[52:55]
mf a[192:195],a[108:111],v[48:51]
mf a[188:191],a[108:111],v[44:47]
wl
mf a[200:203],a[112:115],v[44:47]
s_cbranch_vccnz Lslow_lp1_b
Lret_lp1_b:
mf a[204:207],a[112:115],v[48:51]
s_waitcnt vmcnt(32)
v_add_f32 v24, v24, v28
s_barrier
mf a[208:211],a[112:115],v[52:55]
s_add_u32 s35, s35, 4096
buffer_load_dwordx4 v152, s[64:67], s35 offen offset:0 nt lds
buffer_load_dwordx4 v153, s[64:67], s35 offen offset:1024 nt lds
buffer_load_dwordx4 v154, s[64:67], s35 offen offset:2048 nt lds
ds_read_b128 a[96:99], v5 offset:49152
mf a[220:223],a[116:119],v[52:55]
ds_read_b128 a[100:103], v6 offset:49152
buffer_load_dwordx4 v155, s[64:67], s35 offen offset:3072 nt lds
s_mov_b32 m0, 36864
s_add_u32 s35, s35, 4096
buffer_load_dwordx4 v152, s[64:67], s35 offen offset:0 nt lds
mf a[216:219],a[116:119],v[48:51]
ds_read_b128 a[104:107], v5 offset:50176
buffer_load_dwordx4 v153, s[64:67], s35 offen offset:1024 nt lds
buffer_load_dwordx4 v154, s[64:67], s35 offen offset:2048 nt lds
mf a[212:215],a[116:119],v[44:47]
ds_read_b128 a[108:111], v6 offset:50176
buffer_load_dwordx4 v155, s[64:67], s35 offen offset:3072 nt lds
s_mov_b32 m0, 40960
s_add_u32 s35, s35, 4096
buffer_load_dwordx4 v152, s[64:67], s35 offen offset:0 nt lds
buffer_load_dwordx4 v153, s[64:67], s35 offen offset:1024 nt lds
mf a[224:227],a[120:123],v[44:47]
s_add_u32 s43, s43, 16384
buffer_load_dwordx4 v154, s[64:67], s35 offen offset:2048 nt lds
buffer_load_dwordx4 v155, s[64:67], s35 offen offset:3072 nt lds
mf a[228:231],a[120:123],v[48:51]
s_mov_b32 m0, 45056
s_add_u32 s35, s35, 4096
buffer_load_dwordx4 v152, s[64:67], s35 offen offset:0 nt lds
buffer_load_dwordx4 v153, s[64:67], s35 offen offset:1024 nt lds
mf a[232:235],a[120:123],v[52:55]
buffer_load_dwordx4 v154, s[64:67], s35 offen offset:2048 nt lds
buffer_load_dwordx4 v155, s[64:67], s35 offen offset:3072 nt lds
mf a[244:247],a[124:127],v[52:55]
v_add_f32 v25, v25, v29
v_add_f32 v26, v26, v30
mf a[240:243],a[124:127],v[48:51]
s_add_u32 s41, s41, 1
s_cmp_lt_u32 s41, 6
mf a[236:239],a[124:127],v[44:47]
wl
s_cbranch_scc1 Lloop_b
mz v[44:47],a[96:99],a[0:3],v[32:35]
s_xor_b32 s38, s42, 1
ds_read_b128 a[112:115], v5 offset:51200
mf v[44:47],a[100:103],a[12:15]
s_lshl_b32 s38, s38, 30
ds_read_b128 a[116:119], v6 offset:51200
mf v[44:47],a[104:107],a[24:27]
ds_read_b128 a[120:123], v5 offset:52224
v_min_u32 v159, 496, v1
mf v[44:47],a[108:111],a[36:39]
ds_read_b128 a[124:127], v6 offset:52224
v_lshl_add_u32 v159, v159, 3, s38
mz v[48:51],a[108:111],a[40:43],v[36:39]
s_add_u32 s38, s56, 0
buffer_load_dword v20, v159, s[20:23], s38 offen
mf v[48:51],a[104:107],a[28:31]
mf v[48:51],a[100:103],a[16:19]
mf v[48:51],a[96:99],a[4:7]
mz v[52:55],a[96:99],a[8:11],v[40:43]
mf v[52:55],a[100:103],a[20:23]
mf v[52:55],a[104:107],a[32:35]
mf v[52:55],a[108:111],a[44:47]
wl
mf v[52:55],a[124:127],a[92:95]
ds_read_b128 a[96:99], v5 offset:59392
mf v[52:55],a[120:123],a[80:83]
ds_read_b128 a[100:103], v6 offset:59392
mf v[52:55],a[116:119],a[68:71]
ds_read_b128 a[104:107], v5 offset:60416
mf v[52:55],a[112:115],a[56:59]
ds_read_b128 a[108:111], v6 offset:60416
mf v[48:51],a[112:115],a[52:55]
s_add_u32 s38, s56, 4096
buffer_load_dword v20, v159, s[20:23], s38 offen
mf v[48:51],a[116:119],a[64:67]
mf v[48:51],a[120:123],a[76:79]
mf v[48:51],a[124:127],a[88:91]
mf v[44:47],a[124:127],a[84:87]
mf v[44:47],a[120:123],a[72:75]
mf v[44:47],a[116:119],a[60:63]
v_exp_f32 v52, v52
mf v[44:47],a[112:115],a[48:51]
wl
v_exp_f32 v53, v53
mz v[68:71],a[96:99],a[48:51],v[32:35]
ds_read_b128 a[112:115], v5 offset:57344
v_add_f32 v30, v52, v53
mf v[68:71],a[100:103],a[60:63]
ds_read_b128 a[116:119], v6 offset:57344
cv v52,v52,v53
mf v[68:71],a[104:107],a[72:75]
ds_read_b128 a[120:123], v5 offset:58368
mf v[68:71],a[108:111],a[84:87]
ds_read_b128 a[124:127], v6 offset:58368
mz v[72:75],a[108:111],a[88:91],v[36:39]
s_add_u32 s38, s56, 8192
buffer_load_dword v20, v159, s[20:23], s38 offen
mf v[72:75],a[104:107],a[76:79]
v_exp_f32 v54, v54
mf v[72:75],a[100:103],a[64:67]
v_exp_f32 v55, v55
mf v[72:75],a[96:99],a[52:55]
s_mov_b32 m0, 49152
v_exp_f32 v48, v48
mz v[76:79],a[96:99],a[56:59],v[40:43]
v_exp_f32 v49, v49
mf v[76:79],a[100:103],a[68:71]
v_exp_f32 v50, v50
mf v[76:79],a[104:107],a[80:83]
v_exp_f32 v51, v51
mf v[76:79],a[108:111],a[92:95]
wl
v_exp_f32 v44, v44
mf v[76:79],a[124:127],a[44:47]
s_waitcnt vmcnt(35)
v_add_f32 v30, v54, v30
s_barrier
mf v[76:79],a[120:123],a[32:35]
s_add_u32 s35, s35, 4096
buffer_load_dwordx4 v152, s[64:67], s35 offen offset:0 nt lds
tr a[96:97],v7,0
mf v[76:79],a[116:119],a[20:23]
tr a[98:99],v7,8192
v_add_f32 v30, v55, v30
mf v[76:79],a[112:115],a[8:11]
tr a[100:101],v8,0
buffer_load_dwordx4 v153, s[64:67], s35 offen offset:1024 nt lds
mf v[72:75],a[112:115],a[4:7]
s_add_u32 s38, s56, 12288
buffer_load_dword v20, v159, s[20:23], s38 offen
tr a[102:103],v8,8192
mf v[72:75],a[116:119],a[16:19]
tr a[104:105],v9,0
buffer_load_dwordx4 v154, s[64:67], s35 offen offset:2048 nt lds
mf v[72:75],a[120:123],a[28:31]
tr a[106:107],v9,8192
cv v53,v54,v55
mf v[72:75],a[124:127],a[40:43]
tr a[108:109],v10,0
buffer_load_dwordx4 v155, s[64:67], s35 offen offset:3072 nt lds
mf v[68:71],a[124:127],a[36:39]
s_mov_b32 m0, 53248
tr a[110:111],v10,8192
mf v[68:71],a[120:123],a[24:27]
s_add_u32 s35, s35, 4096
buffer_load_dwordx4 v152, s[64:67], s35 offen offset:0 nt lds
mf v[68:71],a[116:119],a[12:15]
v_exp_f32 v45, v45
mf v[68:71],a[112:115],a[0:3]
wl
buffer_load_dwordx4 v153, s[64:67], s35 offen offset:1024 nt lds
mf v[80:83],a[96:99],v[56:59]
tr a[112:113],v7,1024
v_add_f32 v29, v48, v49
mf v[84:87],a[96:99],v[60:63]
tr a[114:115],v7,9216
buffer_load_dwordx4 v154, s[64:67], s35 offen offset:2048 nt lds
mf v[88:91],a[96:99],v[64:67]
tr a[116:117],v8,1024
cv v48,v48,v49
mf v[100:103],a[100:103],v[64:67]
tr a[118:119],v8,9216
buffer_load_dwordx4 v155, s[64:67], s35 offen offset:3072 nt lds
mf v[96:99],a[100:103],v[60:63]
s_add_u32 s38, s56, 16384
buffer_load_dword v20, v159, s[20:23], s38 offen
tr a[120:121],v9,1024
mf v[92:95],a[100:103],v[56:59]
s_mov_b32 m0, 57344
s_add_u32 s35, s35, 4096
buffer_load_dwordx4 v152, s[64:67], s35 offen offset:0 nt lds
tr a[122:123],v9,9216
mf v[104:107],a[104:107],v[56:59]
tr a[124:125],v10,1024
v_add_f32 v29, v50, v29
mf v[108:111],a[104:107],v[60:63]
tr a[126:127],v10,9216
buffer_load_dwordx4 v153, s[64:67], s35 offen offset:1024 nt lds
mf v[112:115],a[104:107],v[64:67]
v_exp_f32 v46, v46
mf v[124:127],a[108:111],v[64:67]
buffer_load_dwordx4 v154, s[64:67], s35 offen offset:2048 nt lds
mf v[120:123],a[108:111],v[60:63]
v_exp_f32 v47, v47
mf v[116:119],a[108:111],v[56:59]
wl
buffer_load_dwordx4 v155, s[64:67], s35 offen offset:3072 nt lds
mf v[128:131],a[112:115],v[56:59]
s_mov_b32 m0, 61440
tr a[96:97],v7,2048
mf v[132:135],a[112:115],v[60:63]
s_add_u32 s35, s35, 4096
buffer_load_dwordx4 v152, s[64:67], s35 offen offset:0 nt lds
tr a[98:99],v7,10240
mf v[136:139],a[112:115],v[64:67]
tr a[100:101],v8,2048
v_add_f32 v29, v51, v29
mf v[148:151],a[116:119],v[64:67]
tr a[102:103],v8,10240
buffer_load_dwordx4 v153, s[64:67], s35 offen offset:1024 nt lds
mf v[144:147],a[116:119],v[60:63]
s_add_u32 s38, s56, 20480
buffer_load_dword v20, v159, s[20:23], s38 offen
tr a[104:105],v9,2048
mf v[140:143],a[116:119],v[56:59]
tr a[106:107],v9,10240
buffer_load_dwordx4 v154, s[64:67], s35 offen offset:2048 nt lds
mf a[128:131],a[120:123],v[56:59]
tr a[108:109],v10,2048
cv v49,v50,v51
mf a[132:135],a[120:123],v[60:63]
tr a[110:111],v10,10240
buffer_load_dwordx4 v155, s[64:67], s35 offen offset:3072 nt lds
mf a[136:139],a[120:123],v[64:67]
v_exp_f32 v76, v76
mf a[148:151],a[124:127],v[64:67]
v_exp_f32 v77, v77
mf a[144:147],a[124:127],v[60:63]
v_exp_f32 v78, v78
mf a[140:143],a[124:127],v[56:59]
wl
v_exp_f32 v79, v79
mf a[152:155],a[96:99],v[56:59]
tr a[112:113],v7,3072
v_add_f32 v30, v76, v30
mf a[156:159],a[96:99],v[60:63]
tr a[114:115],v7,11264
v_add_f32 v30, v77, v30
mf a[160:163],a[96:99],v[64:67]
tr a[116:117],v8,3072
cv v54,v76,v77
mf a[172:175],a[100:103],v[64:67]
tr a[118:119],v8,11264
v_add_f32 v30, v78, v30
mf a[168:171],a[100:103],v[60:63]
s_add_u32 s38, s56, 24576
buffer_load_dword v20, v159, s[20:23], s38 offen
tr a[120:121],v9,3072
mf a[164:167],a[100:103],v[56:59]
tr a[122:123],v9,11264
v_add_f32 v30, v79, v30
mf a[176:179],a[104:107],v[56:59]
tr a[124:125],v10,3072
v_exp_f32 v72, v72
v_exp_f32 v73, v73
v_exp_f32 v74, v74
v_exp_f32 v75, v75
v_exp_f32 v68, v68
v_exp_f32 v69, v69
v_exp_f32 v70, v70
v_exp_f32 v71, v71
mf a[180:183],a[104:107],v[60:63]
tr a[126:127],v10,11264
v_add_f32 v28, v44, v45
cv v44,v44,v45
v_add_f32 v28, v46, v28
v_add_f32 v28, v47, v28
cv v45,v46,v47
v_add_f32 v28, v68, v28
v_add_f32 v28, v69, v28
cv v46,v68,v69
v_add_f32 v28, v70, v28
v_add_f32 v28, v71, v28
cv v47,v70,v71
v_add_f32 v29, v72, v29
v_add_f32 v29, v73, v29
cv v50,v72,v73
v_add_f32 v29, v74, v29
v_add_f32 v29, v75, v29
cv v51,v74,v75
cv v55,v78,v79
mf a[184:187],a[104:107],v[64:67]
v_max3_f32 v0, v28, v29, v30
v_cmp_lt_f32 vcc, s36, v0
mf a[196:199],a[108:111],v[64:67]
mf a[192:195],a[108:111],v[60:63]
mf a[188:191],a[108:111],v[56:59]
wl
mf a[200:203],a[112:115],v[56:59]
s_cbranch_vccnz Lslow_it14_b
Lret_it14_b:
mf a[204:207],a[112:115],v[60:63]
s_waitcnt vmcnt(39)
v_add_f32 v24, v24, v28
s_barrier
mf a[208:211],a[112:115],v[64:67]
ds_read_b128 a[96:99], v5 offset:16384
v_add_f32 v25, v25, v29
mf a[220:223],a[116:119],v[64:67]
ds_read_b128 a[100:103], v6 offset:16384
v_add_f32 v26, v26, v30
mf a[216:219],a[116:119],v[60:63]
ds_read_b128 a[104:107], v5 offset:17408
mf a[212:215],a[116:119],v[56:59]
ds_read_b128 a[108:111], v6 offset:17408
s_add_u32 s43, s43, 16384
mf a[224:227],a[120:123],v[56:59]
mf a[228:231],a[120:123],v[60:63]
mf a[232:235],a[120:123],v[64:67]
mf a[244:247],a[124:127],v[64:67]
mf a[240:243],a[124:127],v[60:63]
s_cmp_eq_u32 s42, 1
mf a[236:239],a[124:127],v[56:59]
wl
s_cbranch_scc1 Ltail2_b
mz v[56:59],a[96:99],a[0:3],v[32:35]
s_mov_b32 m0, 0
s_add_u32 s34, s34, 4096
buffer_load_dwordx4 v152, s[60:63], s34 offen offset:0 nt lds
ds_read_b128 a[112:115], v5 offset:18432
mf v[56:59],a[100:103],a[12:15]
ds_read_b128 a[116:119], v6 offset:18432
v_mov_b32 v21, 0
mf v[56:59],a[104:107],a[24:27]
ds_read_b128 a[120:123], v5 offset:19456
buffer_load_dwordx4 v153, s[60:63], s34 offen offset:1024 nt lds
mf v[56:59],a[108:111],a[36:39]
ds_read_b128 a[124:127], v6 offset:19456
mz v[60:63],a[108:111],a[40:43],v[36:39]
buffer_load_dwordx4 v154, s[60:63], s34 offen offset:2048 nt lds
mf v[60:63],a[104:107],a[28:31]
buffer_load_dword v23, v21, s[96:99], s90 offen sc1
mf v[60:63],a[100:103],a[16:19]
buffer_load_dwordx4 v155, s[60:63], s34 offen offset:3072 nt lds
mf v[60:63],a[96:99],a[4:7]
s_mov_b32 m0, 4096
mz v[64:67],a[96:99],a[8:11],v[40:43]
s_add_u32 s34, s34, 4096
buffer_load_dwordx4 v152, s[60:63], s34 offen offset:0 nt lds
mf v[64:67],a[100:103],a[20:23]
mf v[64:67],a[104:107],a[32:35]
buffer_load_dwordx4 v153, s[60:63], s34 offen offset:1024 nt lds
mf v[64:67],a[108:111],a[44:47]
wl
mf v[64:67],a[124:127],a[92:95]
ds_read_b128 a[96:99], v5 offset:26624
buffer_load_dwordx4 v154, s[60:63], s34 offen offset:2048 nt lds
mf v[64:67],a[120:123],a[80:83]
ds_read_b128 a[100:103], v6 offset:26624
mf v[64:67],a[116:119],a[68:71]
ds_read_b128 a[104:107], v5 offset:27648
buffer_load_dwordx4 v155, s[60:63], s34 offen offset:3072 nt lds
mf v[64:67],a[112:115],a[56:59]
s_mov_b32 m0, 8192
ds_read_b128 a[108:111], v6 offset:27648
mf v[60:63],a[112:115],a[52:55]
s_add_u32 s34, s34, 4096
buffer_load_dwordx4 v152, s[60:63], s34 offen offset:0 nt lds
mf v[60:63],a[116:119],a[64:67]
mf v[60:63],a[120:123],a[76:79]
buffer_load_dwordx4 v153, s[60:63], s34 offen offset:1024 nt lds
mf v[60:63],a[124:127],a[88:91]
mf v[56:59],a[124:127],a[84:87]
buffer_load_dwordx4 v154, s[60:63], s34 offen offset:2048 nt lds
mf v[56:59],a[120:123],a[72:75]
mf v[56:59],a[116:119],a[60:63]
buffer_load_dwordx4 v155, s[60:63], s34 offen offset:3072 nt lds
mf v[56:59],a[112:115],a[48:51]
s_mov_b32 m0, 12288
wl
mz v[68:71],a[96:99],a[48:51],v[32:35]
s_add_u32 s34, s34, 4096
buffer_load_dwordx4 v152, s[60:63], s34 offen offset:0 nt lds
ds_read_b128 a[112:115], v5 offset:24576
mf v[68:71],a[100:103],a[60:63]
ds_read_b128 a[116:119], v6 offset:24576
mf v[68:71],a[104:107],a[72:75]
ds_read_b128 a[120:123], v5 offset:25600
buffer_load_dwordx4 v153, s[60:63], s34 offen offset:1024 nt lds
mf v[68:71],a[108:111],a[84:87]
ds_read_b128 a[124:127], v6 offset:25600
mz v[72:75],a[108:111],a[88:91],v[36:39]
buffer_load_dwordx4 v154, s[60:63], s34 offen offset:2048 nt lds
mf v[72:75],a[104:107],a[76:79]
v_exp_f32 v64, v64
mf v[72:75],a[100:103],a[64:67]
buffer_load_dwordx4 v155, s[60:63], s34 offen offset:3072 nt lds
mf v[72:75],a[96:99],a[52:55]
s_mov_b32 m0, 16384
v_exp_f32 v65, v65
mz v[76:79],a[96:99],a[56:59],v[40:43]
v_exp_f32 v66, v66
mf v[76:79],a[100:103],a[68:71]
v_exp_f32 v67, v67
mf v[76:79],a[104:107],a[80:83]
v_exp_f32 v60, v60
mf v[76:79],a[108:111],a[92:95]
wl
v_exp_f32 v61, v61
mf v[76:79],a[124:127],a[44:47]
s_waitcnt vmcnt(40)
v_add_f32 v30, v64, v65
s_barrier
mf v[76:79],a[120:123],a[32:35]
s_add_u32 s34, s34, 4096
buffer_load_dwordx4 v152, s[60:63], s34 offen offset:0 nt lds
tr a[96:97],v7,32768
mf v[76:79],a[116:119],a[20:23]
tr a[98:99],v7,40960
cv v64,v64,v65
mf v[76:79],a[112:115],a[8:11]
tr a[100:101],v8,32768
buffer_load_dwordx4 v153, s[60:63], s34 offen offset:1024 nt lds
mf v[72:75],a[112:115],a[4:7]
tr a[102:103],v8,40960
v_add_f32 v30, v66, v30
mf v[72:75],a[116:119],a[16:19]
tr a[104:105],v9,32768
buffer_load_dwordx4 v154, s[60:63], s34 offen offset:2048 nt lds
mf v[72:75],a[120:123],a[28:31]
tr a[106:107],v9,40960
v_add_f32 v30, v67, v30
mf v[72:75],a[124:127],a[40:43]
tr a[108:109],v10,32768
buffer_load_dwordx4 v155, s[60:63], s34 offen offset:3072 nt lds
mf v[68:71],a[124:127],a[36:39]
s_mov_b32 m0, 20480
tr a[110:111],v10,40960
mf v[68:71],a[120:123],a[24:27]
s_add_u32 s34, s34, 4096
buffer_load_dwordx4 v152, s[60:63], s34 offen offset:0 nt lds
mf v[68:71],a[116:119],a[12:15]
v_exp_f32 v62, v62
mf v[68:71],a[112:115],a[0:3]
wl
buffer_load_dwordx4 v153, s[60:63], s34 offen offset:1024 nt lds
mf v[80:83],a[96:99],v[44:47]
tr a[112:113],v7,33792
cv v65,v66,v67
mf v[84:87],a[96:99],v[48:51]
tr a[114:115],v7,41984
buffer_load_dwordx4 v154, s[60:63], s34 offen offset:2048 nt lds
mf v[88:91],a[96:99],v[52:55]
tr a[116:117],v8,33792
v_add_f32 v29, v60, v61
mf v[100:103],a[100:103],v[52:55]
tr a[118:119],v8,41984
buffer_load_dwordx4 v155, s[60:63], s34 offen offset:3072 nt lds
mf v[96:99],a[100:103],v[48:51]
s_mov_b32 m0, 24576
tr a[120:121],v9,33792
mf v[92:95],a[100:103],v[44:47]
s_add_u32 s34, s34, 4096
buffer_load_dwordx4 v152, s[60:63], s34 offen offset:0 nt lds
tr a[122:123],v9,41984
mf v[104:107],a[104:107],v[44:47]
tr a[124:125],v10,33792
cv v60,v60,v61
mf v[108:111],a[104:107],v[48:51]
tr a[126:127],v10,41984
buffer_load_dwordx4 v153, s[60:63], s34 offen offset:1024 nt lds
mf v[112:115],a[104:107],v[52:55]
v_exp_f32 v63, v63
mf v[124:127],a[108:111],v[52:55]
buffer_load_dwordx4 v154, s[60:63], s34 offen offset:2048 nt lds
mf v[120:123],a[108:111],v[48:51]
v_exp_f32 v56, v56
mf v[116:119],a[108:111],v[44:47]
wl
buffer_load_dwordx4 v155, s[60:63], s34 offen offset:3072 nt lds
mf v[128:131],a[112:115],v[44:47]
s_mov_b32 m0, 28672
tr a[96:97],v7,34816
mf v[132:135],a[112:115],v[48:51]
s_add_u32 s34, s34, 4096
buffer_load_dwordx4 v152, s[60:63], s34 offen offset:0 nt lds
tr a[98:99],v7,43008
mf v[136:139],a[112:115],v[52:55]
tr a[100:101],v8,34816
v_add_f32 v29, v62, v29
mf v[148:151],a[116:119],v[52:55]
tr a[102:103],v8,43008
buffer_load_dwordx4 v153, s[60:63], s34 offen offset:1024 nt lds
mf v[144:147],a[116:119],v[48:51]
tr a[104:105],v9,34816
v_add_f32 v29, v63, v29
mf v[140:143],a[116:119],v[44:47]
tr a[106:107],v9,43008
buffer_load_dwordx4 v154, s[60:63], s34 offen offset:2048 nt lds
mf a[128:131],a[120:123],v[44:47]
tr a[108:109],v10,34816
cv v61,v62,v63
mf a[132:135],a[120:123],v[48:51]
tr a[110:111],v10,43008
buffer_load_dwordx4 v155, s[60:63], s34 offen offset:3072 nt lds
mf a[136:139],a[120:123],v[52:55]
s_waitcnt vmcnt(29)
v_exp_f32 v57, v57
mf a[148:151],a[124:127],v[52:55]
v_exp_f32 v58, v58
mf a[144:147],a[124:127],v[48:51]
v_exp_f32 v59, v59
mf a[140:143],a[124:127],v[44:47]
wl
v_exp_f32 v76, v76
mf a[152:155],a[96:99],v[44:47]
tr a[112:113],v7,35840
v_readfirstlane_b32 s54, v23
mf a[156:159],a[96:99],v[48:51]
tr a[114:115],v7,44032
v_add_f32 v30, v76, v30
mf a[160:163],a[96:99],v[52:55]
tr a[116:117],v8,35840
v_add_f32 v28, v56, v57
mf a[172:175],a[100:103],v[52:55]
tr a[118:119],v8,44032
cv v56,v56,v57
mf a[168:171],a[100:103],v[48:51]
tr a[120:121],v9,35840
v_add_f32 v28, v58, v28
mf a[164:167],a[100:103],v[44:47]
tr a[122:123],v9,44032
v_add_f32 v28, v59, v28
mf a[176:179],a[104:107],v[44:47]
tr a[124:125],v10,35840
v_exp_f32 v77, v77
v_exp_f32 v78, v78
v_exp_f32 v79, v79
v_exp_f32 v72, v72
v_exp_f32 v73, v73
v_exp_f32 v74, v74
v_exp_f32 v75, v75
v_exp_f32 v68, v68
v_exp_f32 v69, v69
v_exp_f32 v70, v70
v_exp_f32 v71, v71
mf a[180:183],a[104:107],v[48:51]
tr a[126:127],v10,44032
cv v57,v58,v59
v_add_f32 v28, v68, v28
v_add_f32 v28, v69, v28
cv v58,v68,v69
v_add_f32 v28, v70, v28
v_add_f32 v28, v71, v28
cv v59,v70,v71
v_add_f32 v29, v72, v29
v_add_f32 v29, v73, v29
cv v62,v72,v73
v_add_f32 v29, v74, v29
v_add_f32 v29, v75, v29
cv v63,v74,v75
v_add_f32 v30, v77, v30
cv v66,v76,v77
v_add_f32 v30, v78, v30
v_add_f32 v30, v79, v30
cv v67,v78,v79
mf a[184:187],a[104:107],v[52:55]
s_mov_b32 m0, 32768
v_max3_f32 v0, v28, v29, v30
v_cmp_lt_f32 vcc, s36, v0
mf a[196:199],a[108:111],v[52:55]
s_and_b32 s73, s54, 0x0f0f0f0f
s_lshr_b32 s72, s54, 4
s_and_b32 s72, s72, 0x0f0f0f0f
s_add_u32 s73, s73, s72
s_mul_i32 s73, s73, 0x01010101
s_lshr_b32 s73, s73, 24
mf a[192:195],a[108:111],v[48:51]
s_cmp_lt_u32 s73, 8
s_cbranch_scc1 Lmodewait_b
Lmodeok_b:
mf a[188:191],a[108:111],v[44:47]
wl
mf a[200:203],a[112:115],v[44:47]
s_cbranch_vccnz Lslow_mid15_b
Lret_mid15_b:
mf a[204:207],a[112:115],v[48:51]
s_waitcnt vmcnt(34)
v_add_f32 v24, v24, v28
s_barrier
mf a[208:211],a[112:115],v[52:55]
s_add_u32 s35, s35, 4096
buffer_load_dwordx4 v152, s[64:67], s35 offen offset:0 nt lds
tr a[96:97],v7,49152
mf a[220:223],a[116:119],v[52:55]
tr a[98:99],v7,57344
buffer_load_dwordx4 v153, s[64:67], s35 offen offset:1024 nt lds
mf a[216:219],a[116:119],v[48:51]
tr a[100:101],v8,49152
buffer_load_dwordx4 v154, s[64:67], s35 offen offset:2048 nt lds
mf a[212:215],a[116:119],v[44:47]
tr a[102:103],v8,57344
v_add_f32 v25, v25, v29
mf a[224:227],a[120:123],v[44:47]
tr a[104:105],v9,49152
buffer_load_dwordx4 v155, s[64:67], s35 offen offset:3072 nt lds
mf a[228:231],a[120:123],v[48:51]
s_mov_b32 m0, 36864
s_add_u32 s35, s35, 4096
buffer_load_dwordx4 v152, s[64:67], s35 offen offset:0 nt lds
tr a[106:107],v9,57344
mf a[232:235],a[120:123],v[52:55]
tr a[108:109],v10,49152
buffer_load_dwordx4 v153, s[64:67], s35 offen offset:1024 nt lds
mf a[244:247],a[124:127],v[52:55]
tr a[110:111],v10,57344
s_add_u32 s43, s43, 16384
mf a[240:243],a[124:127],v[48:51]
buffer_load_dwordx4 v154, s[64:67], s35 offen offset:2048 nt lds
mf a[236:239],a[124:127],v[44:47]
wl
v_add_f32 v26, v26, v30
buffer_load_dwordx4 v155, s[64:67], s35 offen offset:3072 nt lds
mf v[80:83],a[96:99],v[56:59]
s_mov_b32 m0, 40960
tr a[112:113],v7,50176
mf v[84:87],a[96:99],v[60:63]
s_add_u32 s35, s35, 4096
buffer_load_dwordx4 v152, s[64:67], s35 offen offset:0 nt lds
tr a[114:115],v7,58368
mf v[88:91],a[96:99],v[64:67]
tr a[116:117],v8,50176
buffer_load_dwordx4 v153, s[64:67], s35 offen offset:1024 nt lds
mf v[92:95],a[100:103],v[56:59]
tr a[118:119],v8,58368
buffer_load_dwordx4 v154, s[64:67], s35 offen offset:2048 nt lds
mf v[96:99],a[100:103],v[60:63]
tr a[120:121],v9,50176
v_mov_b32 v11, v24
mf v[100:103],a[100:103],v[64:67]
tr a[122:123],v9,58368
buffer_load_dwordx4 v155, s[64:67], s35 offen offset:3072 nt lds
mf v[104:107],a[104:107],v[56:59]
s_mov_b32 m0, 45056
s_add_u32 s35, s35, 4096
buffer_load_dwordx4 v152, s[64:67], s35 offen offset:0 nt lds
tr a[124:125],v10,50176
mf v[108:111],a[104:107],v[60:63]
tr a[126:127],v10,58368
buffer_load_dwordx4 v153, s[64:67], s35 offen offset:1024 nt lds
mf v[112:115],a[104:107],v[64:67]
v_mov_b32 v12, v25
v_mov_b32 v13, v26
mf v[116:119],a[108:111],v[56:59]
buffer_load_dwordx4 v154, s[64:67], s35 offen offset:2048 nt lds
mf v[120:123],a[108:111],v[60:63]
buffer_load_dwordx4 v155, s[64:67], s35 offen offset:3072 nt lds
mf v[124:127],a[108:111],v[64:67]
wl
aw a0,v160
aw a1,v161
mf v[128:131],a[112:115],v[56:59]
tr a[96:97],v7,51200
aw a2,v162
mf v[132:135],a[112:115],v[60:63]
tr a[98:99],v7,59392
aw a3,v163
mf v[136:139],a[112:115],v[64:67]
tr a[100:101],v8,51200
aw a4,v164
mf v[140:143],a[116:119],v[56:59]
tr a[102:103],v8,59392
aw a5,v165
mf v[144:147],a[116:119],v[60:63]
tr a[104:105],v9,51200
aw a6,v166
mf v[148:151],a[116:119],v[64:67]
tr a[106:107],v9,59392
aw a7,v167
mf a[128:131],a[120:123],v[56:59]
tr a[108:109],v10,51200
aw a8,v168
mf a[132:135],a[120:123],v[60:63]
tr a[110:111],v10,59392
aw a9,v169
mf a[136:139],a[120:123],v[64:67]
aw a10,v170
aw a11,v171
mf a[140:143],a[124:127],v[56:59]
aw a12,v172
aw a13,v173
mf a[144:147],a[124:127],v[60:63]
aw a14,v174
aw a15,v175
mf a[148:151],a[124:127],v[64:67]
wl
aw a16,v176
aw a17,v177
mf a[152:155],a[96:99],v[56:59]
tr a[112:113],v7,52224
aw a18,v178
mf a[156:159],a[96:99],v[60:63]
tr a[114:115],v7,60416
aw a19,v179
mf a[160:163],a[96:99],v[64:67]
tr a[116:117],v8,52224
aw a20,v180
mf a[164:167],a[100:103],v[56:59]
tr a[118:119],v8,60416
aw a21,v181
mf a[168:171],a[100:103],v[60:63]
tr a[120:121],v9,52224
aw a22,v182
mf a[172:175],a[100:103],v[64:67]
tr a[122:123],v9,60416
aw a23,v183
mf a[176:179],a[104:107],v[56:59]
tr a[124:125],v10,52224
aw a24,v184
mf a[180:183],a[104:107],v[60:63]
s_mov_b32 m0, 49152
tr a[126:127],v10,60416
mf a[184:187],a[104:107],v[64:67]
aw a25,v185
aw a26,v186
mf a[188:191],a[108:111],v[56:59]
aw a27,v187
aw a28,v188
mf a[192:195],a[108:111],v[60:63]
aw a29,v189
aw a30,v190
mf a[196:199],a[108:111],v[64:67]
wl
aw a31,v191
aw a32,v192
mf a[200:203],a[112:115],v[56:59]
s_waitcnt vmcnt(32)
aw a33,v193
s_barrier
mf a[204:207],a[112:115],v[60:63]
s_add_u32 s34, s34, 4096
buffer_load_dwordx4 v152, s[60:63], s34 offen offset:0 nt lds
ds_read_b128 a[96:99], v5 offset:0
mf a[208:211],a[112:115],v[64:67]
ds_read_b128 a[100:103], v6 offset:0
aw a34,v194
mf a[212:215],a[116:119],v[56:59]
ds_read_b128 a[104:107], v5 offset:1024
buffer_load_dwordx4 v153, s[60:63], s34 offen offset:1024 nt lds
mf a[216:219],a[116:119],v[60:63]
ds_read_b128 a[108:111], v6 offset:1024
aw a35,v195
mf a[220:223],a[116:119],v[64:67]
buffer_load_dwordx4 v154, s[60:63], s34 offen offset:2048 nt lds
mf a[224:227],a[120:123],v[56:59]
aw a36,v196
aw a37,v197
mf a[228:231],a[120:123],v[60:63]
buffer_load_dwordx4 v155, s[60:63], s34 offen offset:3072 nt lds
mf a[232:235],a[120:123],v[64:67]
aw a38,v198
aw a39,v199
aw a40,v200
aw a41,v201
aw a42,v202
aw a43,v203
aw a44,v204
aw a45,v205
aw a46,v206
aw a47,v207
mf a[236:239],a[124:127],v[56:59]
s_mov_b32 m0, 53248
s_add_u32 s34, s34, 4096
buffer_load_dwordx4 v152, s[60:63], s34 offen offset:0 nt lds
mf a[240:243],a[124:127],v[60:63]
aw a48,v208
aw a49,v209
mf a[244:247],a[124:127],v[64:67]
wl
buffer_load_dwordx4 v153, s[60:63], s34 offen offset:1024 nt lds
mz v[44:47],a[96:99],a[0:3],v[32:35]
ds_read_b128 a[112:115], v5 offset:2048
aw a50,v210
mf v[44:47],a[100:103],a[12:15]
ds_read_b128 a[116:119], v6 offset:2048
buffer_load_dwordx4 v154, s[60:63], s34 offen offset:2048 nt lds
mf v[44:47],a[104:107],a[24:27]
ds_read_b128 a[120:123], v5 offset:3072
aw a51,v211
mf v[44:47],a[108:111],a[36:39]
ds_read_b128 a[124:127], v6 offset:3072
buffer_load_dwordx4 v155, s[60:63], s34 offen offset:3072 nt lds
mz v[48:51],a[108:111],a[40:43],v[36:39]
s_mov_b32 m0, 57344
aw a52,v212
aw a53,v213
mf v[48:51],a[104:107],a[28:31]
s_add_u32 s34, s34, 4096
buffer_load_dwordx4 v152, s[60:63], s34 offen offset:0 nt lds
mf v[48:51],a[100:103],a[16:19]
aw a54,v214
aw a55,v215
mf v[48:51],a[96:99],a[4:7]
buffer_load_dwordx4 v153, s[60:63], s34 offen offset:1024 nt lds
mz v[52:55],a[96:99],a[8:11],v[40:43]
aw a56,v216
aw a57,v217
aw a58,v218
aw a59,v219
aw a60,v220
aw a61,v221
aw a62,v222
aw a63,v223
aw a64,v224
aw a65,v225
aw a66,v226
aw a67,v227
aw a68,v228
aw a69,v229
aw a70,v230
aw a71,v231
aw a72,v232
aw a73,v233
aw a74,v234
aw a75,v235
aw a76,v236
aw a77,v237
aw a78,v238
aw a79,v239
aw a80,v240
aw a81,v241
aw a82,v242
aw a83,v243
aw a84,v244
aw a85,v245
aw a86,v246
aw a87,v247
aw a88,v248
aw a89,v249
aw a90,v250
aw a91,v251
aw a92,v252
aw a93,v253
aw a94,v254
aw a95,v255
mf v[52:55],a[100:103],a[20:23]
buffer_load_dwordx4 v154, s[60:63], s34 offen offset:2048 nt lds
mf v[52:55],a[104:107],a[32:35]
cv v160,v80,v81
cv v161,v82,v83
mf v[52:55],a[108:111],a[44:47]
wl
buffer_load_dwordx4 v155, s[60:63], s34 offen offset:3072 nt lds
mf v[52:55],a[124:127],a[92:95]
s_mov_b32 m0, 61440
ds_read_b128 a[96:99], v5 offset:10240
mf v[52:55],a[120:123],a[80:83]
s_add_u32 s34, s34, 4096
buffer_load_dwordx4 v152, s[60:63], s34 offen offset:0 nt lds
ds_read_b128 a[100:103], v6 offset:10240
mf v[52:55],a[116:119],a[68:71]
ds_read_b128 a[104:107], v5 offset:11264
cv v162,v92,v93
mf v[52:55],a[112:115],a[56:59]
ds_read_b128 a[108:111], v6 offset:11264
buffer_load_dwordx4 v153, s[60:63], s34 offen offset:1024 nt lds
mf v[48:51],a[112:115],a[52:55]
cv v163,v94,v95
cv v164,v84,v85
mf v[48:51],a[116:119],a[64:67]
buffer_load_dwordx4 v154, s[60:63], s34 offen offset:2048 nt lds
mf v[48:51],a[120:123],a[76:79]
cv v165,v86,v87
cv v166,v96,v97
mf v[48:51],a[124:127],a[88:91]
buffer_load_dwordx4 v155, s[60:63], s34 offen offset:3072 nt lds
mf v[44:47],a[124:127],a[84:87]
cv v167,v98,v99
cv v168,v88,v89
mf v[44:47],a[120:123],a[72:75]
cv v169,v90,v91
cv v170,v100,v101
mf v[44:47],a[116:119],a[60:63]
v_exp_f32 v52, v52
mf v[44:47],a[112:115],a[48:51]
wl
v_exp_f32 v53, v53
mz v[68:71],a[96:99],a[48:51],v[32:35]
ds_read_b128 a[112:115], v5 offset:8192
v_add_f32 v26, v52, v53
mf v[68:71],a[100:103],a[60:63]
ds_read_b128 a[116:119], v6 offset:8192
cv v52,v52,v53
mf v[68:71],a[104:107],a[72:75]
ds_read_b128 a[120:123], v5 offset:9216
cv v171,v102,v103
mf v[68:71],a[108:111],a[84:87]
ds_read_b128 a[124:127], v6 offset:9216
cv v172,v104,v105
mz v[72:75],a[108:111],a[88:91],v[36:39]
v_exp_f32 v54, v54
mf v[72:75],a[104:107],a[76:79]
v_exp_f32 v55, v55
mf v[72:75],a[100:103],a[64:67]
v_exp_f32 v48, v48
mf v[72:75],a[96:99],a[52:55]
s_mov_b32 m0, 0
v_exp_f32 v49, v49
mz v[76:79],a[96:99],a[56:59],v[40:43]
v_exp_f32 v50, v50
mf v[76:79],a[100:103],a[68:71]
v_exp_f32 v51, v51
mf v[76:79],a[104:107],a[80:83]
v_exp_f32 v44, v44
mf v[76:79],a[108:111],a[92:95]
wl
v_exp_f32 v45, v45
mf v[76:79],a[124:127],a[44:47]
s_waitcnt vmcnt(32)
v_add_f32 v26, v54, v26
s_barrier
mf v[76:79],a[120:123],a[32:35]
s_add_u32 s35, s35, 4096
buffer_load_dwordx4 v152, s[64:67], s35 offen offset:0 nt lds
ds_read_b128 a[96:99], v5 offset:16384
mf v[76:79],a[116:119],a[20:23]
ds_read_b128 a[100:103], v6 offset:16384
v_add_f32 v26, v55, v26
mf v[76:79],a[112:115],a[8:11]
ds_read_b128 a[104:107], v5 offset:17408
buffer_load_dwordx4 v153, s[64:67], s35 offen offset:1024 nt lds
mf v[72:75],a[112:115],a[4:7]
ds_read_b128 a[108:111], v6 offset:17408
cv v53,v54,v55
mf v[72:75],a[116:119],a[16:19]
buffer_load_dwordx4 v154, s[64:67], s35 offen offset:2048 nt lds
mf v[72:75],a[120:123],a[28:31]
v_exp_f32 v46, v46
mf v[72:75],a[124:127],a[40:43]
buffer_load_dwordx4 v155, s[64:67], s35 offen offset:3072 nt lds
mf v[68:71],a[124:127],a[36:39]
s_mov_b32 m0, 4096
v_exp_f32 v47, v47
mf v[68:71],a[120:123],a[24:27]
s_add_u32 s35, s35, 4096
buffer_load_dwordx4 v152, s[64:67], s35 offen offset:0 nt lds
mf v[68:71],a[116:119],a[12:15]
v_exp_f32 v76, v76
mf v[68:71],a[112:115],a[0:3]
wl
buffer_load_dwordx4 v153, s[64:67], s35 offen offset:1024 nt lds
mz v[56:59],a[96:99],a[0:3],v[32:35]
ds_read_b128 a[112:115], v5 offset:18432
v_add_f32 v26, v76, v26
mf v[56:59],a[100:103],a[12:15]
ds_read_b128 a[116:119], v6 offset:18432
buffer_load_dwordx4 v154, s[64:67], s35 offen offset:2048 nt lds
mf v[56:59],a[104:107],a[24:27]
ds_read_b128 a[120:123], v5 offset:19456
v_add_f32 v25, v48, v49
mf v[56:59],a[108:111],a[36:39]
ds_read_b128 a[124:127], v6 offset:19456
buffer_load_dwordx4 v155, s[64:67], s35 offen offset:3072 nt lds
mz v[60:63],a[108:111],a[40:43],v[36:39]
s_mov_b32 m0, 8192
v_exp_f32 v77, v77
mf v[60:63],a[104:107],a[28:31]
s_add_u32 s35, s35, 4096
buffer_load_dwordx4 v152, s[64:67], s35 offen offset:0 nt lds
mf v[60:63],a[100:103],a[16:19]
v_exp_f32 v78, v78
mf v[60:63],a[96:99],a[4:7]
buffer_load_dwordx4 v153, s[64:67], s35 offen offset:1024 nt lds
mz v[64:67],a[96:99],a[8:11],v[40:43]
v_exp_f32 v79, v79
mf v[64:67],a[100:103],a[20:23]
buffer_load_dwordx4 v154, s[64:67], s35 offen offset:2048 nt lds
mf v[64:67],a[104:107],a[32:35]
v_exp_f32 v72, v72
mf v[64:67],a[108:111],a[44:47]
wl
buffer_load_dwordx4 v155, s[64:67], s35 offen offset:3072 nt lds
mf v[64:67],a[124:127],a[92:95]
s_mov_b32 m0, 12288
ds_read_b128 a[96:99], v5 offset:26624
mf v[64:67],a[120:123],a[80:83]
s_add_u32 s35, s35, 4096
buffer_load_dwordx4 v152, s[64:67], s35 offen offset:0 nt lds
ds_read_b128 a[100:103], v6 offset:26624
mf v[64:67],a[116:119],a[68:71]
ds_read_b128 a[104:107], v5 offset:27648
v_add_f32 v26, v77, v26
mf v[64:67],a[112:115],a[56:59]
ds_read_b128 a[108:111], v6 offset:27648
buffer_load_dwordx4 v153, s[64:67], s35 offen offset:1024 nt lds
mf v[60:63],a[112:115],a[52:55]
v_exp_f32 v73, v73
v_exp_f32 v74, v74
v_exp_f32 v75, v75
v_exp_f32 v68, v68
v_exp_f32 v69, v69
v_exp_f32 v70, v70
v_exp_f32 v71, v71
mf v[60:63],a[116:119],a[64:67]
v_add_f32 v24, v44, v45
cv v44,v44,v45
v_add_f32 v24, v46, v24
v_add_f32 v24, v47, v24
cv v45,v46,v47
v_add_f32 v24, v68, v24
v_add_f32 v24, v69, v24
cv v46,v68,v69
v_add_f32 v24, v70, v24
v_add_f32 v24, v71, v24
cv v47,v70,v71
cv v48,v48,v49
v_add_f32 v25, v50, v25
v_add_f32 v25, v51, v25
cv v49,v50,v51
v_add_f32 v25, v72, v25
v_add_f32 v25, v73, v25
cv v50,v72,v73
v_add_f32 v25, v74, v25
v_add_f32 v25, v75, v25
cv v51,v74,v75
cv v54,v76,v77
v_add_f32 v26, v78, v26
v_add_f32 v26, v79, v26
cv v55,v78,v79
buffer_load_dwordx4 v154, s[64:67], s35 offen offset:2048 nt lds
mf v[60:63],a[120:123],a[76:79]
v_min3_f32 v0, v24, v25, v26
v_cmp_gt_f32 s[72:73], s55, v0
mf v[60:63],a[124:127],a[88:91]
buffer_load_dwordx4 v155, s[64:67], s35 offen offset:3072 nt lds
mf v[56:59],a[124:127],a[84:87]
v_max3_f32 v0, v24, v25, v26
v_cmp_lt_f32 vcc, s36, v0
mf v[56:59],a[120:123],a[72:75]
cv v173,v106,v107
cv v174,v116,v117
mf v[56:59],a[116:119],a[60:63]
cv v175,v118,v119
cv v176,v108,v109
mf v[56:59],a[112:115],a[48:51]
wl
s_or_b64 s[72:73], s[72:73], vcc
s_cbranch_scc1 Lslow_midh_b
Lret_midh_b:
mz v[68:71],a[96:99],a[48:51],v[32:35]
s_add_u32 s43, s43, 16384
ds_read_b128 a[112:115], v5 offset:24576
mf v[68:71],a[100:103],a[60:63]
ds_read_b128 a[116:119], v6 offset:24576
cv v177,v110,v111
mf v[68:71],a[104:107],a[72:75]
ds_read_b128 a[120:123], v5 offset:25600
cv v178,v120,v121
mf v[68:71],a[108:111],a[84:87]
ds_read_b128 a[124:127], v6 offset:25600
cv v179,v122,v123
mz v[72:75],a[108:111],a[88:91],v[36:39]
v_exp_f32 v64, v64
mf v[72:75],a[104:107],a[76:79]
v_exp_f32 v65, v65
mf v[72:75],a[100:103],a[64:67]
v_exp_f32 v66, v66
mf v[72:75],a[96:99],a[52:55]
s_mov_b32 m0, 16384
v_exp_f32 v67, v67
mz v[76:79],a[96:99],a[56:59],v[40:43]
v_exp_f32 v60, v60
mf v[76:79],a[100:103],a[68:71]
v_exp_f32 v61, v61
mf v[76:79],a[104:107],a[80:83]
v_exp_f32 v62, v62
mf v[76:79],a[108:111],a[92:95]
wl
v_exp_f32 v63, v63
mf v[76:79],a[124:127],a[44:47]
s_waitcnt vmcnt(32)
v_add_f32 v30, v64, v65
s_barrier
mf v[76:79],a[120:123],a[32:35]
s_add_u32 s34, s34, 4096
buffer_load_dwordx4 v152, s[60:63], s34 offen offset:0 nt lds
tr a[96:97],v7,32768
mf v[76:79],a[116:119],a[20:23]
tr a[98:99],v7,40960
cv v64,v64,v65
mf v[76:79],a[112:115],a[8:11]
tr a[100:101],v8,32768
buffer_load_dwordx4 v153, s[60:63], s34 offen offset:1024 nt lds
mf v[72:75],a[112:115],a[4:7]
tr a[102:103],v8,40960
v_add_f32 v30, v66, v30
mf v[72:75],a[116:119],a[16:19]
tr a[104:105],v9,32768
buffer_load_dwordx4 v154, s[60:63], s34 offen offset:2048 nt lds
mf v[72:75],a[120:123],a[28:31]
tr a[106:107],v9,40960
v_add_f32 v30, v67, v30
mf v[72:75],a[124:127],a[40:43]
tr a[108:109],v10,32768
buffer_load_dwordx4 v155, s[60:63], s34 offen offset:3072 nt lds
mf v[68:71],a[124:127],a[36:39]
s_mov_b32 m0, 20480
tr a[110:111],v10,40960
mf v[68:71],a[120:123],a[24:27]
s_add_u32 s34, s34, 4096
buffer_load_dwordx4 v152, s[60:63], s34 offen offset:0 nt lds
mf v[68:71],a[116:119],a[12:15]
v_exp_f32 v56, v56
mf v[68:71],a[112:115],a[0:3]
wl
buffer_load_dwordx4 v153, s[60:63], s34 offen offset:1024 nt lds
mz v[80:83],a[96:99],v[44:47],0
tr a[112:113],v7,33792
cv v65,v66,v67
mz v[84:87],a[96:99],v[48:51],0
tr a[114:115],v7,41984
buffer_load_dwordx4 v154, s[60:63], s34 offen offset:2048 nt lds
mz v[88:91],a[96:99],v[52:55],0
tr a[116:117],v8,33792
v_add_f32 v29, v60, v61
mz v[92:95],a[100:103],v[44:47],0
tr a[118:119],v8,41984
buffer_load_dwordx4 v155, s[60:63], s34 offen offset:3072 nt lds
mz v[96:99],a[100:103],v[48:51],0
s_mov_b32 m0, 24576
tr a[120:121],v9,33792
mz v[100:103],a[100:103],v[52:55],0
s_add_u32 s34, s34, 4096
buffer_load_dwordx4 v152, s[60:63], s34 offen offset:0 nt lds
tr a[122:123],v9,41984
cv v180,v112,v113
cv v181,v114,v115
cv v182,v124,v125
cv v183,v126,v127
mz v[104:107],a[104:107],v[44:47],0
tr a[124:125],v10,33792
cv v60,v60,v61
mz v[108:111],a[104:107],v[48:51],0
tr a[126:127],v10,41984
buffer_load_dwordx4 v153, s[60:63], s34 offen offset:1024 nt lds
mz v[112:115],a[104:107],v[52:55],0
v_exp_f32 v57, v57
mz v[116:119],a[108:111],v[44:47],0
cv v184,v128,v129
cv v185,v130,v131
cv v186,v140,v141
cv v187,v142,v143
buffer_load_dwordx4 v154, s[60:63], s34 offen offset:2048 nt lds
mz v[120:123],a[108:111],v[48:51],0
cv v188,v132,v133
cv v189,v134,v135
cv v190,v144,v145
cv v191,v146,v147
mz v[124:127],a[108:111],v[52:55],0
wl
cv v192,v136,v137
cv v193,v138,v139
cv v194,v148,v149
cv v195,v150,v151
buffer_load_dwordx4 v155, s[60:63], s34 offen offset:3072 nt lds
mz v[128:131],a[112:115],v[44:47],0
s_mov_b32 m0, 28672
tr a[96:97],v7,34816
mz v[132:135],a[112:115],v[48:51],0
s_add_u32 s34, s34, 4096
buffer_load_dwordx4 v152, s[60:63], s34 offen offset:0 nt lds
tr a[98:99],v7,43008
mz v[136:139],a[112:115],v[52:55],0
tr a[100:101],v8,34816
v_add_f32 v29, v62, v29
mz v[140:143],a[116:119],v[44:47],0
tr a[102:103],v8,43008
ar v21,a128
ar v22,a129
cv v196,v21,v22
ar v21,a130
ar v22,a131
cv v197,v21,v22
ar v21,a140
ar v22,a141
cv v198,v21,v22
ar v21,a142
ar v22,a143
cv v199,v21,v22
buffer_load_dwordx4 v153, s[60:63], s34 offen offset:1024 nt lds
mz v[144:147],a[116:119],v[48:51],0
tr a[104:105],v9,34816
ar v21,a132
ar v22,a133
cv v200,v21,v22
ar v21,a134
ar v22,a135
cv v201,v21,v22
ar v21,a144
ar v22,a145
cv v202,v21,v22
ar v21,a146
ar v22,a147
cv v203,v21,v22
mz v[148:151],a[116:119],v[52:55],0
tr a[106:107],v9,43008
ar v21,a136
ar v22,a137
cv v204,v21,v22
ar v21,a138
ar v22,a139
cv v205,v21,v22
ar v21,a148
ar v22,a149
cv v206,v21,v22
ar v21,a150
ar v22,a151
cv v207,v21,v22
buffer_load_dwordx4 v154, s[60:63], s34 offen offset:2048 nt lds
mz a[128:131],a[120:123],v[44:47],0
tr a[108:109],v10,34816
v_add_f32 v29, v63, v29
mz a[132:135],a[120:123],v[48:51],0
tr a[110:111],v10,43008
buffer_load_dwordx4 v155, s[60:63], s34 offen offset:3072 nt lds
mz a[136:139],a[120:123],v[52:55],0
v_exp_f32 v58, v58
mz a[140:143],a[124:127],v[44:47],0
ar v21,a152
ar v22,a153
cv v208,v21,v22
ar v21,a154
ar v22,a155
cv v209,v21,v22
ar v21,a164
ar v22,a165
cv v210,v21,v22
ar v21,a166
ar v22,a167
cv v211,v21,v22
mz a[144:147],a[124:127],v[48:51],0
ar v21,a156
ar v22,a157
cv v212,v21,v22
ar v21,a158
ar v22,a159
cv v213,v21,v22
ar v21,a168
ar v22,a169
cv v214,v21,v22
ar v21,a170
ar v22,a171
cv v215,v21,v22
mz a[148:151],a[124:127],v[52:55],0
wl
ar v21,a160
ar v22,a161
cv v216,v21,v22
ar v21,a162
ar v22,a163
cv v217,v21,v22
ar v21,a172
ar v22,a173
cv v218,v21,v22
ar v21,a174
ar v22,a175
cv v219,v21,v22
mz a[152:155],a[96:99],v[44:47],0
tr a[112:113],v7,35840
cv v61,v62,v63
mz a[156:159],a[96:99],v[48:51],0
tr a[114:115],v7,44032
v_add_f32 v28, v56, v57
mz a[160:163],a[96:99],v[52:55],0
tr a[116:117],v8,35840
cv v56,v56,v57
mz a[164:167],a[100:103],v[44:47],0
tr a[118:119],v8,44032
ar v21,a176
ar v22,a177
cv v220,v21,v22
ar v21,a178
ar v22,a179
cv v221,v21,v22
ar v21,a188
ar v22,a189
cv v222,v21,v22
ar v21,a190
ar v22,a191
cv v223,v21,v22
mz a[168:171],a[100:103],v[48:51],0
tr a[120:121],v9,35840
ar v21,a180
ar v22,a181
cv v224,v21,v22
ar v21,a182
ar v22,a183
cv v225,v21,v22
ar v21,a192
ar v22,a193
cv v226,v21,v22
ar v21,a194
ar v22,a195
cv v227,v21,v22
mz a[172:175],a[100:103],v[52:55],0
tr a[122:123],v9,44032
ar v21,a184
ar v22,a185
cv v228,v21,v22
ar v21,a186
ar v22,a187
cv v229,v21,v22
ar v21,a196
ar v22,a197
cv v230,v21,v22
ar v21,a198
ar v22,a199
cv v231,v21,v22
mz a[176:179],a[104:107],v[44:47],0
tr a[124:125],v10,35840
v_exp_f32 v59, v59
v_exp_f32 v76, v76
v_exp_f32 v77, v77
v_exp_f32 v78, v78
v_exp_f32 v79, v79
v_exp_f32 v72, v72
v_exp_f32 v73, v73
v_exp_f32 v74, v74
v_exp_f32 v75, v75
v_exp_f32 v68, v68
v_exp_f32 v69, v69
v_exp_f32 v70, v70
v_exp_f32 v71, v71
mz a[180:183],a[104:107],v[48:51],0
tr a[126:127],v10,44032
ar v21,a200
ar v22,a201
cv v232,v21,v22
ar v21,a202
ar v22,a203
cv v233,v21,v22
ar v21,a212
ar v22,a213
cv v234,v21,v22
ar v21,a214
ar v22,a215
cv v235,v21,v22
ar v21,a204
ar v22,a205
cv v236,v21,v22
ar v21,a206
ar v22,a207
cv v237,v21,v22
ar v21,a216
ar v22,a217
cv v238,v21,v22
ar v21,a218
ar v22,a219
cv v239,v21,v22
ar v21,a208
ar v22,a209
cv v240,v21,v22
ar v21,a210
ar v22,a211
cv v241,v21,v22
ar v21,a220
ar v22,a221
cv v242,v21,v22
ar v21,a222
ar v22,a223
cv v243,v21,v22
ar v21,a224
ar v22,a225
cv v244,v21,v22
ar v21,a226
ar v22,a227
cv v245,v21,v22
ar v21,a236
ar v22,a237
cv v246,v21,v22
ar v21,a238
ar v22,a239
cv v247,v21,v22
ar v21,a228
ar v22,a229
cv v248,v21,v22
ar v21,a230
ar v22,a231
cv v249,v21,v22
ar v21,a240
ar v22,a241
cv v250,v21,v22
ar v21,a242
ar v22,a243
cv v251,v21,v22
ar v21,a232
ar v22,a233
cv v252,v21,v22
ar v21,a234
ar v22,a235
cv v253,v21,v22
ar v21,a244
ar v22,a245
cv v254,v21,v22
ar v21,a246
ar v22,a247
cv v255,v21,v22
v_add_f32 v28, v58, v28
v_add_f32 v28, v59, v28
cv v57,v58,v59
v_add_f32 v28, v68, v28
v_add_f32 v28, v69, v28
cv v58,v68,v69
v_add_f32 v28, v70, v28
v_add_f32 v28, v71, v28
cv v59,v70,v71
v_add_f32 v29, v72, v29
v_add_f32 v29, v73, v29
cv v62,v72,v73
v_add_f32 v29, v74, v29
v_add_f32 v29, v75, v29
cv v63,v74,v75
v_add_f32 v30, v76, v30
v_add_f32 v30, v77, v30
cv v66,v76,v77
v_add_f32 v30, v78, v30
v_add_f32 v30, v79, v30
cv v67,v78,v79
mz a[184:187],a[104:107],v[52:55],0
s_mov_b32 m0, 32768
v_max3_f32 v0, v28, v29, v30
v_cmp_lt_f32 vcc, s36, v0
mz a[188:191],a[108:111],v[44:47],0
mz a[192:195],a[108:111],v[48:51],0
mz a[196:199],a[108:111],v[52:55],0
wl
mz a[200:203],a[112:115],v[44:47],0
s_cbranch_vccnz Lslow_mid_b
Lret_mid_b:
mz a[204:207],a[112:115],v[48:51],0
s_waitcnt vmcnt(32)
v_add_f32 v24, v24, v28
s_barrier
mz a[208:211],a[112:115],v[52:55],0
s_add_u32 s35, s35, 4096
buffer_load_dwordx4 v152, s[64:67], s35 offen offset:0 nt lds
buffer_load_dwordx4 v153, s[64:67], s35 offen offset:1024 nt lds
buffer_load_dwordx4 v154, s[64:67], s35 offen offset:2048 nt lds
ds_read_b128 a[96:99], v5 offset:49152
mz a[212:215],a[116:119],v[44:47],0
ds_read_b128 a[100:103], v6 offset:49152
buffer_load_dwordx4 v155, s[64:67], s35 offen offset:3072 nt lds
s_mov_b32 m0, 36864
s_add_u32 s35, s35, 4096
buffer_load_dwordx4 v152, s[64:67], s35 offen offset:0 nt lds
mz a[216:219],a[116:119],v[48:51],0
ds_read_b128 a[104:107], v5 offset:50176
buffer_load_dwordx4 v153, s[64:67], s35 offen offset:1024 nt lds
buffer_load_dwordx4 v154, s[64:67], s35 offen offset:2048 nt lds
mz a[220:223],a[116:119],v[52:55],0
ds_read_b128 a[108:111], v6 offset:50176
buffer_load_dwordx4 v155, s[64:67], s35 offen offset:3072 nt lds
s_mov_b32 m0, 40960
s_add_u32 s35, s35, 4096
buffer_load_dwordx4 v152, s[64:67], s35 offen offset:0 nt lds
buffer_load_dwordx4 v153, s[64:67], s35 offen offset:1024 nt lds
mz a[224:227],a[120:123],v[44:47],0
s_add_u32 s43, s43, 16384
buffer_load_dwordx4 v154, s[64:67], s35 offen offset:2048 nt lds
buffer_load_dwordx4 v155, s[64:67], s35 offen offset:3072 nt lds
mz a[228:231],a[120:123],v[48:51],0
s_mov_b32 m0, 45056
s_add_u32 s35, s35, 4096
buffer_load_dwordx4 v152, s[64:67], s35 offen offset:0 nt lds
buffer_load_dwordx4 v153, s[64:67], s35 offen offset:1024 nt lds
mz a[232:235],a[120:123],v[52:55],0
buffer_load_dwordx4 v154, s[64:67], s35 offen offset:2048 nt lds
buffer_load_dwordx4 v155, s[64:67], s35 offen offset:3072 nt lds
mz a[236:239],a[124:127],v[44:47],0
v_add_f32 v25, v25, v29
v_add_f32 v26, v26, v30
mz a[240:243],a[124:127],v[48:51],0
s_mov_b32 s42, 1
s_mov_b32 s41, 0
mz a[244:247],a[124:127],v[52:55],0
wl
s_branch Lloop_b
.p2align 5
Ltail2_b:
s_and_b32 s72, s54, 0x88888888
s_cbranch_scc0 Loslow_b
mz v[56:59],a[96:99],a[0:3],v[32:35]
ds_read_b128 a[112:115], v5 offset:18432
v_mov_b32 v21, v11
mf v[56:59],a[100:103],a[12:15]
ds_read_b128 a[116:119], v6 offset:18432
v_add_u32 v152, 6144, v3
mf v[56:59],a[104:107],a[24:27]
ds_read_b128 a[120:123], v5 offset:19456
v_add_u32 v153, 12288, v3
mf v[56:59],a[108:111],a[36:39]
ds_read_b128 a[124:127], v6 offset:19456
v_add_u32 v154, 18432, v3
mz v[60:63],a[108:111],a[40:43],v[36:39]
s_add_u32 s38, s68, 0
buffer_load_dword v20, v159, s[28:31], s38 offen
mf v[60:63],a[104:107],a[28:31]
s_add_u32 m0, s24, 0
v_permlane32_swap_b32 v11, v21
mf v[60:63],a[100:103],a[16:19]
s_add_u32 s39, s45, 0
buffer_load_dwordx4 v3, s[20:23], s39 offen  lds
mf v[60:63],a[96:99],a[4:7]
s_add_u32 m0, s24, 1024
v_add_f32 v11, v11, v21
v_mov_b32 v21, v11
mz v[64:67],a[96:99],a[8:11],v[40:43]
s_add_u32 s39, s45, 7168
buffer_load_dwordx4 v3, s[20:23], s39 offen  lds
mf v[64:67],a[100:103],a[20:23]
s_add_u32 m0, s24, 2048
v_permlane16_swap_b32 v11, v21
mf v[64:67],a[104:107],a[32:35]
s_add_u32 s39, s45, 14336
buffer_load_dwordx4 v3, s[20:23], s39 offen  lds
mf v[64:67],a[108:111],a[44:47]
wl
v_lshl_add_u32 v22, v1, 3, s3
v_add_f32 v11, v11, v21
mf v[64:67],a[124:127],a[92:95]
ds_read_b128 a[96:99], v5 offset:26624
v_min_u32 v22, L_end-L_main4, v22
mf v[64:67],a[120:123],a[80:83]
s_add_u32 m0, s24, 3072
ds_read_b128 a[100:103], v6 offset:26624
mf v[64:67],a[116:119],a[68:71]
ds_read_b128 a[104:107], v5 offset:27648
mf v[64:67],a[112:115],a[56:59]
ds_read_b128 a[108:111], v6 offset:27648
mf v[60:63],a[112:115],a[52:55]
s_add_u32 s39, s45, 21504
buffer_load_dwordx4 v3, s[20:23], s39 offen  lds
mf v[60:63],a[116:119],a[64:67]
v_rcp_f32 v11, v11
mf v[60:63],a[120:123],a[76:79]
v_mov_b32 v21, v12
mf v[60:63],a[124:127],a[88:91]
s_add_u32 s38, s68, 4096
buffer_load_dword v20, v159, s[28:31], s38 offen
mf v[56:59],a[124:127],a[84:87]
v_permlane32_swap_b32 v12, v21
mf v[56:59],a[120:123],a[72:75]
v_add_f32 v12, v12, v21
v_mov_b32 v21, v12
mf v[56:59],a[116:119],a[60:63]
v_exp_f32 v64, v64
mf v[56:59],a[112:115],a[48:51]
wl
v_exp_f32 v65, v65
mz v[68:71],a[96:99],a[48:51],v[32:35]
ds_read_b128 a[112:115], v5 offset:24576
global_load_dword v20, v22, s[58:59]
mf v[68:71],a[100:103],a[60:63]
ds_read_b128 a[116:119], v6 offset:24576
v_add_f32 v30, v64, v65
mf v[68:71],a[104:107],a[72:75]
ds_read_b128 a[120:123], v5 offset:25600
cv v64,v64,v65
mf v[68:71],a[108:111],a[84:87]
ds_read_b128 a[124:127], v6 offset:25600
mz v[72:75],a[108:111],a[88:91],v[36:39]
v_exp_f32 v66, v66
mf v[72:75],a[104:107],a[76:79]
v_exp_f32 v67, v67
mf v[72:75],a[100:103],a[64:67]
v_exp_f32 v60, v60
mf v[72:75],a[96:99],a[52:55]
s_add_u32 m0, s24, 16384
v_exp_f32 v61, v61
mz v[76:79],a[96:99],a[56:59],v[40:43]
v_exp_f32 v62, v62
mf v[76:79],a[100:103],a[68:71]
v_exp_f32 v63, v63
mf v[76:79],a[104:107],a[80:83]
v_exp_f32 v56, v56
mf v[76:79],a[108:111],a[92:95]
wl
v_exp_f32 v57, v57
mf v[76:79],a[124:127],a[44:47]
s_waitcnt vmcnt(30)
v_add_f32 v30, v66, v30
s_barrier
mf v[76:79],a[120:123],a[32:35]
tr a[96:97],v7,32768
v_add_f32 v30, v67, v30
mf v[76:79],a[116:119],a[20:23]
tr a[98:99],v7,40960
cv v65,v66,v67
mf v[76:79],a[112:115],a[8:11]
tr a[100:101],v8,32768
v_add_f32 v29, v60, v61
mf v[72:75],a[112:115],a[4:7]
tr a[102:103],v8,40960
cv v60,v60,v61
mf v[72:75],a[116:119],a[16:19]
tr a[104:105],v9,32768
v_add_f32 v29, v62, v29
mf v[72:75],a[120:123],a[28:31]
tr a[106:107],v9,40960
v_add_f32 v29, v63, v29
mf v[72:75],a[124:127],a[40:43]
s_add_u32 s38, s68, 8192
buffer_load_dword v20, v159, s[28:31], s38 offen
tr a[108:109],v10,32768
mf v[68:71],a[124:127],a[36:39]
tr a[110:111],v10,40960
cv v61,v62,v63
mf v[68:71],a[120:123],a[24:27]
s_add_u32 s39, s45, 114688
buffer_load_dwordx4 v3, s[20:23], s39 offen  lds
mf v[68:71],a[116:119],a[12:15]
s_add_u32 m0, s24, 17408
v_exp_f32 v58, v58
mf v[68:71],a[112:115],a[0:3]
wl
v_exp_f32 v59, v59
mf v[80:83],a[96:99],v[44:47]
tr a[112:113],v7,33792
v_add_f32 v28, v56, v57
mf v[84:87],a[96:99],v[48:51]
tr a[114:115],v7,41984
cv v56,v56,v57
mf v[88:91],a[96:99],v[52:55]
tr a[116:117],v8,33792
v_add_f32 v28, v58, v28
mf v[100:103],a[100:103],v[52:55]
tr a[118:119],v8,41984
v_add_f32 v28, v59, v28
mf v[96:99],a[100:103],v[48:51]
tr a[120:121],v9,33792
cv v57,v58,v59
mf v[92:95],a[100:103],v[44:47]
tr a[122:123],v9,41984
v_xor_b32 v5, 8, v15
mf v[104:107],a[104:107],v[44:47]
tr a[124:125],v10,33792
v_xor_b32 v6, 8, v16
mf v[108:111],a[104:107],v[48:51]
tr a[126:127],v10,41984
mf v[112:115],a[104:107],v[52:55]
s_add_u32 s39, s45, 121856
buffer_load_dwordx4 v3, s[20:23], s39 offen  lds
mf v[124:127],a[108:111],v[52:55]
s_add_u32 m0, s24, 18432
v_exp_f32 v76, v76
mf v[120:123],a[108:111],v[48:51]
s_add_u32 s39, s45, 129024
buffer_load_dwordx4 v3, s[20:23], s39 offen  lds
mf v[116:119],a[108:111],v[44:47]
wl
v_exp_f32 v77, v77
mf v[128:131],a[112:115],v[44:47]
tr a[96:97],v7,34816
v_add_f32 v30, v76, v30
mf v[132:135],a[112:115],v[48:51]
tr a[98:99],v7,43008
v_add_f32 v30, v77, v30
mf v[136:139],a[112:115],v[52:55]
s_add_u32 s38, s68, 12288
buffer_load_dword v20, v159, s[28:31], s38 offen
tr a[100:101],v8,34816
mf v[148:151],a[116:119],v[52:55]
tr a[102:103],v8,43008
cv v66,v76,v77
mf v[144:147],a[116:119],v[48:51]
s_add_u32 m0, s24, 19456
tr a[104:105],v9,34816
mf v[140:143],a[116:119],v[44:47]
tr a[106:107],v9,43008
mf a[128:131],a[120:123],v[44:47]
tr a[108:109],v10,34816
mf a[132:135],a[120:123],v[48:51]
tr a[110:111],v10,43008
mf a[136:139],a[120:123],v[52:55]
s_add_u32 s39, s45, 136192
buffer_load_dwordx4 v3, s[20:23], s39 offen  lds
mf a[148:151],a[124:127],v[52:55]
v_exp_f32 v78, v78
mf a[144:147],a[124:127],v[48:51]
v_exp_f32 v79, v79
mf a[140:143],a[124:127],v[44:47]
wl
v_exp_f32 v72, v72
mf a[152:155],a[96:99],v[44:47]
tr a[112:113],v7,35840
v_add_f32 v30, v78, v30
mf a[156:159],a[96:99],v[48:51]
tr a[114:115],v7,44032
v_add_f32 v30, v79, v30
mf a[160:163],a[96:99],v[52:55]
tr a[116:117],v8,35840
cv v67,v78,v79
mf a[172:175],a[100:103],v[52:55]
tr a[118:119],v8,44032
v_add_f32 v29, v72, v29
mf a[168:171],a[100:103],v[48:51]
tr a[120:121],v9,35840
mf a[164:167],a[100:103],v[44:47]
tr a[122:123],v9,44032
mf a[176:179],a[104:107],v[44:47]
tr a[124:125],v10,35840
v_exp_f32 v73, v73
v_exp_f32 v74, v74
v_exp_f32 v75, v75
v_exp_f32 v68, v68
v_exp_f32 v69, v69
v_exp_f32 v70, v70
v_exp_f32 v71, v71
mf a[180:183],a[104:107],v[48:51]
tr a[126:127],v10,44032
v_permlane16_swap_b32 v12, v21
v_add_f32 v12, v12, v21
v_rcp_f32 v12, v12
v_mov_b32 v21, v13
v_add_f32 v28, v68, v28
v_add_f32 v28, v69, v28
cv v58,v68,v69
v_add_f32 v28, v70, v28
v_add_f32 v28, v71, v28
cv v59,v70,v71
v_add_f32 v29, v73, v29
cv v62,v72,v73
v_add_f32 v29, v74, v29
v_add_f32 v29, v75, v29
cv v63,v74,v75
mf a[184:187],a[104:107],v[52:55]
s_add_u32 s38, s68, 16384
buffer_load_dword v20, v159, s[28:31], s38 offen
mf a[196:199],a[108:111],v[52:55]
v_permlane32_swap_b32 v13, v21
v_add_f32 v13, v13, v21
v_mov_b32 v21, v13
v_max3_f32 v0, v28, v29, v30
mf a[192:195],a[108:111],v[48:51]
s_add_u32 m0, s24, 32768
v_cmp_lt_f32 vcc, s36, v0
mf a[188:191],a[108:111],v[44:47]
wl
v_permlane16_swap_b32 v13, v21
v_add_f32 v13, v13, v21
v_rcp_f32 v13, v13
mf a[200:203],a[112:115],v[44:47]
s_cbranch_vccnz Lslow_endf15_b
Lret_endf15_b:
mf a[204:207],a[112:115],v[48:51]
s_waitcnt vmcnt(15)
v_add_f32 v24, v24, v28
s_barrier
mf a[208:211],a[112:115],v[52:55]
tr a[96:97],v7,49152
v_add_f32 v25, v25, v29
mf a[220:223],a[116:119],v[52:55]
tr a[98:99],v7,57344
v_add_f32 v26, v26, v30
mf a[216:219],a[116:119],v[48:51]
tr a[100:101],v8,49152
v_bfe_u32 v0, v1, 4, 4
mf a[212:215],a[116:119],v[44:47]
tr a[102:103],v8,57344
v_lshrrev_b32 v2, 8, v1
mf a[224:227],a[120:123],v[44:47]
tr a[104:105],v9,49152
v_mul_u32_u24 v0, 1792, v0
mf a[228:231],a[120:123],v[48:51]
tr a[106:107],v9,57344
v_lshl_add_u32 v2, v2, 4, v0
mf a[232:235],a[120:123],v[52:55]
tr a[108:109],v10,49152
v_bfe_u32 v0, v1, 4, 5
mf a[244:247],a[124:127],v[52:55]
tr a[110:111],v10,57344
s_add_u32 s43, s43, 16384
mf a[240:243],a[124:127],v[48:51]
s_add_u32 s39, s45, 229376
buffer_load_dwordx4 v3, s[20:23], s39 offen  lds
mf a[236:239],a[124:127],v[44:47]
s_add_u32 m0, s24, 33792
wl
v_lshlrev_b32 v0, 2, v0
mf v[80:83],a[96:99],v[56:59]
tr a[112:113],v7,50176
v_mov_b32 v29, v25
v_mov_b32 v28, v24
mf v[84:87],a[96:99],v[60:63]
tr a[114:115],v7,58368
v_mov_b32 v30, v26
mf v[88:91],a[96:99],v[64:67]
tr a[116:117],v8,50176
v_permlane32_swap_b32 v24, v28
mf v[92:95],a[100:103],v[56:59]
tr a[118:119],v8,58368
v_add_f32 v24, v24, v28
v_mov_b32 v28, v24
mf v[96:99],a[100:103],v[60:63]
tr a[120:121],v9,50176
v_permlane32_swap_b32 v25, v29
mf v[100:103],a[100:103],v[64:67]
s_add_u32 s38, s68, 20480
buffer_load_dword v20, v159, s[28:31], s38 offen
tr a[122:123],v9,58368
mf v[104:107],a[104:107],v[56:59]
tr a[124:125],v10,50176
v_add_f32 v25, v25, v29
v_mov_b32 v29, v25
mf v[108:111],a[104:107],v[60:63]
tr a[126:127],v10,58368
v_permlane32_swap_b32 v26, v30
mf v[112:115],a[104:107],v[64:67]
s_add_u32 s39, s45, 236544
buffer_load_dwordx4 v3, s[20:23], s39 offen  lds
v_add_f32 v26, v26, v30
mf v[116:119],a[108:111],v[56:59]
s_add_u32 m0, s24, 34816
v_permlane16_swap_b32 v24, v28
v_mov_b32 v30, v26
mf v[120:123],a[108:111],v[60:63]
s_add_u32 s39, s45, 243712
buffer_load_dwordx4 v3, s[20:23], s39 offen  lds
v_add_f32 v24, v24, v28
mf v[124:127],a[108:111],v[64:67]
s_add_u32 m0, s24, 35840
v_permlane16_swap_b32 v25, v29
wl
mf v[128:131],a[112:115],v[56:59]
s_add_u32 s39, s45, 250880
buffer_load_dwordx4 v3, s[20:23], s39 offen  lds
tr a[96:97],v7,51200
mf v[132:135],a[112:115],v[60:63]
tr a[98:99],v7,59392
cv v80,v80,v81
v_add_f32 v25, v25, v29
mf v[136:139],a[112:115],v[64:67]
tr a[100:101],v8,51200
v_permlane16_swap_b32 v26, v30
mf v[140:143],a[116:119],v[56:59]
tr a[102:103],v8,59392
cv v81,v82,v83
v_add_f32 v26, v26, v30
mf v[144:147],a[116:119],v[60:63]
tr a[104:105],v9,51200
v_rcp_f32 v28, v24
mf v[148:151],a[116:119],v[64:67]
tr a[106:107],v9,59392
cv v82,v92,v93
v_mul_f32 v24, v24, v11
mf a[128:131],a[120:123],v[56:59]
tr a[108:109],v10,51200
v_rcp_f32 v29, v25
mf a[132:135],a[120:123],v[60:63]
tr a[110:111],v10,59392
cv v83,v94,v95
v_mul_f32 v25, v25, v12
mf a[136:139],a[120:123],v[64:67]
s_mov_b32 s41, 0
v_rcp_f32 v30, v26
v_mul_f32 v26, v26, v13
mf a[140:143],a[124:127],v[56:59]
s_add_u32 s38, s68, 24576
buffer_load_dword v20, v159, s[28:31], s38 offen
cv v84,v84,v85
mf a[144:147],a[124:127],v[60:63]
s_add_u32 s51, s45, 128
cv v85,v86,v87
cv v86,v96,v97
cv v87,v98,v99
mf a[148:151],a[124:127],v[64:67]
wl
cv v88,v88,v89
cv v89,v90,v91
cv v90,v100,v101
mf a[152:155],a[96:99],v[56:59]
tr a[112:113],v7,52224
cv v91,v102,v103
cv v104,v104,v105
mf a[156:159],a[96:99],v[60:63]
tr a[114:115],v7,60416
cv v105,v106,v107
cv v106,v116,v117
mf a[160:163],a[96:99],v[64:67]
tr a[116:117],v8,52224
cv v107,v118,v119
cv v108,v108,v109
mf a[164:167],a[100:103],v[56:59]
tr a[118:119],v8,60416
cv v109,v110,v111
cv v110,v120,v121
mf a[168:171],a[100:103],v[60:63]
tr a[120:121],v9,52224
cv v111,v122,v123
cv v112,v112,v113
mf a[172:175],a[100:103],v[64:67]
tr a[122:123],v9,60416
cv v113,v114,v115
cv v114,v124,v125
mf a[176:179],a[104:107],v[56:59]
tr a[124:125],v10,52224
cv v115,v126,v127
cv v128,v128,v129
mf a[180:183],a[104:107],v[60:63]
tr a[126:127],v10,60416
cv v129,v130,v131
cv v130,v140,v141
mf a[184:187],a[104:107],v[64:67]
s_add_u32 s52, s45, 256
cv v131,v142,v143
cv v132,v132,v133
cv v133,v134,v135
mf a[188:191],a[108:111],v[56:59]
s_add_u32 m0, s24, 49152
cv v134,v144,v145
cv v135,v146,v147
cv v136,v136,v137
mf a[192:195],a[108:111],v[60:63]
cv v137,v138,v139
cv v138,v148,v149
cv v139,v150,v151
mf a[196:199],a[108:111],v[64:67]
wl
ar v21,a128
ar v22,a129
cv v21,v21,v22
mf a[200:203],a[112:115],v[56:59]
s_waitcnt vmcnt(15)
aw a36,v21
ar v21,a130
s_barrier
mf a[204:207],a[112:115],v[60:63]
tr a[96:97],v15,0
ar v22,a131
cv v21,v21,v22
mf a[208:211],a[112:115],v[64:67]
tr a[98:99],v15,2048
aw a37,v21
ar v21,a140
mf a[212:215],a[116:119],v[56:59]
tr a[100:101],v15,4096
ar v22,a141
cv v21,v21,v22
mf a[216:219],a[116:119],v[60:63]
tr a[102:103],v15,6144
aw a38,v21
ar v21,a142
mf a[220:223],a[116:119],v[64:67]
tr a[104:105],v15,8192
ar v22,a143
cv v21,v21,v22
mf a[224:227],a[120:123],v[56:59]
tr a[106:107],v15,10240
aw a39,v21
ar v21,a132
mf a[228:231],a[120:123],v[60:63]
tr a[108:109],v15,12288
ar v22,a133
cv v21,v21,v22
mf a[232:235],a[120:123],v[64:67]
s_add_u32 s38, s68, 28672
buffer_load_dword v20, v159, s[28:31], s38 offen
tr a[110:111],v15,14336
mf a[236:239],a[124:127],v[56:59]
s_add_u32 s39, s45, 344064
buffer_load_dwordx4 v3, s[20:23], s39 offen  lds
aw a40,v21
mf a[240:243],a[124:127],v[60:63]
s_add_u32 m0, s24, 50176
ar v21,a134
ar v22,a135
cv v21,v21,v22
mf a[244:247],a[124:127],v[64:67]
s_add_u32 s39, s45, 351232
buffer_load_dwordx4 v3, s[20:23], s39 offen  lds
wl
mz v[32:35],a[96:99],v[160:163],0
tr a[112:113],v5,0
aw a41,v21
ar v21,a144
mf v[32:35],a[100:103],v[172:175]
tr a[114:115],v5,2048
ar v22,a145
cv v21,v21,v22
mf v[32:35],a[104:107],v[184:187]
tr a[116:117],v5,4096
aw a42,v21
ar v21,a146
mf v[32:35],a[108:111],v[196:199]
tr a[118:119],v5,6144
ar v22,a147
cv v21,v21,v22
mz v[36:39],a[108:111],v[200:203],0
tr a[120:121],v5,8192
aw a43,v21
ar v21,a136
mf v[36:39],a[104:107],v[188:191]
tr a[122:123],v5,10240
ar v22,a137
cv v21,v21,v22
mf v[36:39],a[100:103],v[176:179]
tr a[124:125],v5,12288
aw a44,v21
ar v21,a138
mf v[36:39],a[96:99],v[164:167]
tr a[126:127],v5,14336
ar v22,a139
cv v21,v21,v22
mz v[40:43],a[96:99],v[168:171],0
s_add_u32 m0, s24, 51200
aw a45,v21
ar v21,a148
ar v22,a149
mf v[40:43],a[100:103],v[180:183]
s_add_u32 s39, s45, 358400
buffer_load_dwordx4 v3, s[20:23], s39 offen  lds
cv v21,v21,v22
mf v[40:43],a[104:107],v[192:195]
s_add_u32 m0, s24, 52224
aw a46,v21
ar v21,a150
ar v22,a151
mf v[40:43],a[108:111],v[204:207]
s_add_u32 s39, s45, 365568
buffer_load_dwordx4 v3, s[20:23], s39 offen  lds
wl
mz v[52:55],a[124:127],v[204:207],0
tr a[96:97],v16,0
cv v21,v21,v22
aw a47,v21
mf v[52:55],a[120:123],v[192:195]
tr a[98:99],v16,2048
ar v21,a152
ar v22,a153
mf v[52:55],a[116:119],v[180:183]
tr a[100:101],v16,4096
cv v21,v21,v22
aw a48,v21
mf v[52:55],a[112:115],v[168:171]
tr a[102:103],v16,6144
ar v21,a154
ar v22,a155
mz v[48:51],a[112:115],v[164:167],0
s_add_u32 s38, s68, 262144
buffer_load_dword v20, v159, s[28:31], s38 offen
tr a[104:105],v16,8192
mf v[48:51],a[116:119],v[176:179]
tr a[106:107],v16,10240
cv v21,v21,v22
aw a49,v21
mf v[48:51],a[120:123],v[188:191]
tr a[108:109],v16,12288
ar v21,a164
ar v22,a165
mf v[48:51],a[124:127],v[200:203]
tr a[110:111],v16,14336
cv v21,v21,v22
aw a50,v21
mz v[44:47],a[124:127],v[196:199],0
ar v21,a166
ar v22,a167
cv v21,v21,v22
mf v[44:47],a[120:123],v[184:187]
aw a51,v21
ar v21,a176
ar v22,a177
mf v[44:47],a[116:119],v[172:175]
cv v21,v21,v22
aw a60,v21
ar v21,a178
mf v[44:47],a[112:115],v[160:163]
wl
ar v22,a179
cv v21,v21,v22
aw a61,v21
mz v[56:59],a[96:99],v[160:163],0
tr a[112:113],v6,0
ar v21,a188
ar v22,a189
mf v[56:59],a[100:103],v[172:175]
tr a[114:115],v6,2048
cv v21,v21,v22
aw a62,v21
mf v[56:59],a[104:107],v[184:187]
tr a[116:117],v6,4096
ar v21,a190
ar v22,a191
mf v[56:59],a[108:111],v[196:199]
tr a[118:119],v6,6144
cv v21,v21,v22
aw a63,v21
mz v[60:63],a[108:111],v[200:203],0
tr a[120:121],v6,8192
ar v21,a200
ar v22,a201
mf v[60:63],a[104:107],v[188:191]
tr a[122:123],v6,10240
cv v21,v21,v22
aw a72,v21
mf v[60:63],a[100:103],v[176:179]
tr a[124:125],v6,12288
ar v21,a202
ar v22,a203
mf v[60:63],a[96:99],v[164:167]
tr a[126:127],v6,14336
cv v21,v21,v22
aw a73,v21
mz v[64:67],a[96:99],v[168:171],0
s_add_u32 s38, s68, 266240
buffer_load_dword v20, v159, s[28:31], s38 offen
ar v21,a212
mf v[64:67],a[100:103],v[180:183]
s_add_u32 m0, s25, 0
ar v22,a213
cv v21,v21,v22
aw a74,v21
mf v[64:67],a[104:107],v[192:195]
ar v21,a214
ar v22,a215
cv v21,v21,v22
mf v[64:67],a[108:111],v[204:207]
wl
aw a75,v21
ar v21,a224
ar v22,a225
mz v[76:79],a[124:127],v[204:207],0
s_waitcnt vmcnt(8)
cv v21,v21,v22
aw a84,v21
s_barrier
mf v[76:79],a[120:123],v[192:195]
tr a[96:97],v15,16384
ar v21,a226
ar v22,a227
mf v[76:79],a[116:119],v[180:183]
tr a[98:99],v15,18432
cv v21,v21,v22
aw a85,v21
mf v[76:79],a[112:115],v[168:171]
tr a[100:101],v15,20480
ar v21,a236
ar v22,a237
mz v[72:75],a[112:115],v[164:167],0
tr a[102:103],v15,22528
cv v21,v21,v22
aw a86,v21
mf v[72:75],a[116:119],v[176:179]
tr a[104:105],v15,24576
ar v21,a238
ar v22,a239
mf v[72:75],a[120:123],v[188:191]
tr a[106:107],v15,26624
cv v21,v21,v22
aw a87,v21
mf v[72:75],a[124:127],v[200:203]
tr a[108:109],v15,28672
ar v21,a156
ar v22,a157
mz v[68:71],a[124:127],v[196:199],0
tr a[110:111],v15,30720
cv v21,v21,v22
aw a52,v21
mf v[68:71],a[120:123],v[184:187]
s_add_u32 s39, s51, 0
buffer_load_dwordx4 v3, s[20:23], s39 offen  lds
ar v21,a158
mf v[68:71],a[116:119],v[172:175]
s_add_u32 m0, s25, 1024
ar v22,a159
cv v21,v21,v22
aw a53,v21
mf v[68:71],a[112:115],v[160:163]
s_add_u32 s39, s51, 7168
buffer_load_dwordx4 v3, s[20:23], s39 offen  lds
wl
mf v[32:35],a[96:99],v[208:211]
tr a[112:113],v5,16384
ar v21,a168
ar v22,a169
mf v[32:35],a[100:103],v[220:223]
tr a[114:115],v5,18432
cv v21,v21,v22
aw a54,v21
mf v[32:35],a[104:107],v[232:235]
tr a[116:117],v5,20480
ar v21,a170
ar v22,a171
mf v[32:35],a[108:111],v[244:247]
tr a[118:119],v5,22528
cv v21,v21,v22
aw a55,v21
mf v[36:39],a[108:111],v[248:251]
tr a[120:121],v5,24576
ar v21,a180
ar v22,a181
mf v[36:39],a[104:107],v[236:239]
tr a[122:123],v5,26624
cv v21,v21,v22
aw a64,v21
mf v[36:39],a[100:103],v[224:227]
tr a[124:125],v5,28672
ar v21,a182
ar v22,a183
mf v[36:39],a[96:99],v[212:215]
s_add_u32 s38, s68, 270336
buffer_load_dword v20, v159, s[28:31], s38 offen
tr a[126:127],v5,30720
mf v[40:43],a[96:99],v[216:219]
s_add_u32 m0, s25, 2048
cv v21,v21,v22
aw a65,v21
ar v21,a192
mf v[40:43],a[100:103],v[228:231]
s_add_u32 s39, s51, 14336
buffer_load_dwordx4 v3, s[20:23], s39 offen  lds
v_mul_f32 v32, v32, v24
mf v[40:43],a[104:107],v[240:243]
s_add_u32 m0, s25, 3072
v_mul_f32 v33, v33, v24
v_mul_f32 v34, v34, v24
v_mul_f32 v35, v35, v24
mf v[40:43],a[108:111],v[252:255]
s_add_u32 s39, s51, 21504
buffer_load_dwordx4 v3, s[20:23], s39 offen  lds
wl
mf v[52:55],a[124:127],v[252:255]
tr a[96:97],v16,16384
ar v22,a193
cv v21,v21,v22
mf v[52:55],a[120:123],v[240:243]
tr a[98:99],v16,18432
v_mul_f32 v36, v36, v25
v_mul_f32 v37, v37, v25
mf v[52:55],a[116:119],v[228:231]
tr a[100:101],v16,20480
v_mul_f32 v38, v38, v25
v_mul_f32 v39, v39, v25
mf v[52:55],a[112:115],v[216:219]
tr a[102:103],v16,22528
aw a66,v21
ar v21,a194
mf v[48:51],a[112:115],v[212:215]
tr a[104:105],v16,24576
ar v22,a195
cv v21,v21,v22
mf v[48:51],a[116:119],v[224:227]
tr a[106:107],v16,26624
v_mul_f32 v40, v40, v26
v_mul_f32 v41, v41, v26
mf v[48:51],a[120:123],v[236:239]
tr a[108:109],v16,28672
v_mul_f32 v42, v42, v26
v_mul_f32 v43, v43, v26
mf v[48:51],a[124:127],v[248:251]
tr a[110:111],v16,30720
aw a67,v21
ar v21,a204
mf v[44:47],a[124:127],v[244:247]
s_add_u32 m0, s25, 16384
ar v22,a205
cv v21,v21,v22
aw a76,v21
mf v[44:47],a[120:123],v[232:235]
s_add_u32 s39, s51, 114688
buffer_load_dwordx4 v3, s[20:23], s39 offen  lds
v_mul_f32 v52, v52, v26
mf v[44:47],a[116:119],v[220:223]
s_add_u32 s38, s68, 274432
buffer_load_dword v20, v159, s[28:31], s38 offen
v_mul_f32 v53, v53, v26
mf v[44:47],a[112:115],v[208:211]
wl
ar v21,a206
v_mul_f32 v54, v54, v26
v_mul_f32 v55, v55, v26
mf v[56:59],a[96:99],v[208:211]
tr a[112:113],v6,16384
ar v22,a207
cv v21,v21,v22
mf v[56:59],a[100:103],v[220:223]
tr a[114:115],v6,18432
v_mul_f32 v48, v48, v25
v_mul_f32 v49, v49, v25
mf v[56:59],a[104:107],v[232:235]
tr a[116:117],v6,20480
v_mul_f32 v50, v50, v25
v_mul_f32 v51, v51, v25
mf v[56:59],a[108:111],v[244:247]
tr a[118:119],v6,22528
aw a77,v21
ar v21,a216
mf v[60:63],a[108:111],v[248:251]
tr a[120:121],v6,24576
ar v22,a217
cv v21,v21,v22
mf v[60:63],a[104:107],v[236:239]
tr a[122:123],v6,26624
v_mul_f32 v44, v44, v24
v_mul_f32 v45, v45, v24
mf v[60:63],a[100:103],v[224:227]
tr a[124:125],v6,28672
v_mul_f32 v46, v46, v24
v_mul_f32 v47, v47, v24
mf v[60:63],a[96:99],v[212:215]
tr a[126:127],v6,30720
aw a78,v21
ar v21,a218
mf v[64:67],a[96:99],v[216:219]
s_add_u32 m0, s25, 17408
ar v22,a219
cv v21,v21,v22
aw a79,v21
mf v[64:67],a[100:103],v[228:231]
s_add_u32 s39, s51, 121856
buffer_load_dwordx4 v3, s[20:23], s39 offen  lds
v_mul_f32 v56, v56, v24
mf v[64:67],a[104:107],v[240:243]
s_add_u32 m0, s25, 18432
v_mul_f32 v57, v57, v24
v_mul_f32 v58, v58, v24
v_mul_f32 v59, v59, v24
mf v[64:67],a[108:111],v[252:255]
s_add_u32 s39, s51, 129024
buffer_load_dwordx4 v3, s[20:23], s39 offen  lds
wl
mf v[76:79],a[124:127],v[252:255]
tr a[96:97],v15,32768
ar v21,a228
ar v22,a229
mf v[76:79],a[120:123],v[240:243]
tr a[98:99],v15,34816
v_mul_f32 v60, v60, v25
v_mul_f32 v61, v61, v25
mf v[76:79],a[116:119],v[228:231]
tr a[100:101],v15,36864
v_mul_f32 v62, v62, v25
v_mul_f32 v63, v63, v25
mf v[76:79],a[112:115],v[216:219]
tr a[102:103],v15,38912
cv v21,v21,v22
aw a88,v21
mf v[72:75],a[112:115],v[212:215]
s_add_u32 m0, s25, 19456
tr a[104:105],v15,40960
ar v21,a230
mf v[72:75],a[116:119],v[224:227]
s_add_u32 s39, s51, 136192
buffer_load_dwordx4 v3, s[20:23], s39 offen  lds
tr a[106:107],v15,43008
mf v[72:75],a[120:123],v[236:239]
tr a[108:109],v15,45056
v_mul_f32 v64, v64, v26
v_mul_f32 v65, v65, v26
mf v[72:75],a[124:127],v[248:251]
tr a[110:111],v15,47104
v_mul_f32 v66, v66, v26
v_mul_f32 v67, v67, v26
mf v[68:71],a[124:127],v[244:247]
s_add_u32 s38, s68, 278528
buffer_load_dword v20, v159, s[28:31], s38 offen
ar v22,a231
mf v[68:71],a[120:123],v[232:235]
s_add_u32 m0, s25, 32768
v_mul_f32 v76, v76, v26
v_mul_f32 v77, v77, v26
v_mul_f32 v78, v78, v26
mf v[68:71],a[116:119],v[220:223]
s_add_u32 s39, s51, 229376
buffer_load_dwordx4 v3, s[20:23], s39 offen  lds
v_mul_f32 v79, v79, v26
mf v[68:71],a[112:115],v[208:211]
wl
cv v21,v21,v22
aw a89,v21
ar v21,a240
mf v[32:35],a[96:99],v[80:83]
tr a[112:113],v5,32768
ar v22,a241
cv v21,v21,v22
mf v[32:35],a[100:103],v[104:107]
tr a[114:115],v5,34816
v_mul_f32 v72, v72, v25
v_mul_f32 v73, v73, v25
mf v[32:35],a[104:107],v[128:131]
tr a[116:117],v5,36864
v_mul_f32 v74, v74, v25
v_mul_f32 v75, v75, v25
mf v[32:35],a[108:111],a[36:39]
tr a[118:119],v5,38912
aw a90,v21
ar v21,a242
mf v[36:39],a[108:111],a[40:43]
tr a[120:121],v5,40960
ar v22,a243
cv v21,v21,v22
mf v[36:39],a[104:107],v[132:135]
tr a[122:123],v5,43008
v_mul_f32 v68, v68, v24
v_mul_f32 v69, v69, v24
mf v[36:39],a[100:103],v[108:111]
tr a[124:125],v5,45056
v_mul_f32 v70, v70, v24
v_mul_f32 v71, v71, v24
mf v[36:39],a[96:99],v[84:87]
tr a[126:127],v5,47104
aw a91,v21
ar v21,a160
mf v[40:43],a[96:99],v[88:91]
s_add_u32 m0, s25, 33792
ar v22,a161
cv v21,v21,v22
aw a56,v21
mf v[40:43],a[100:103],v[112:115]
s_add_u32 s39, s51, 236544
buffer_load_dwordx4 v3, s[20:23], s39 offen  lds
ar v21,a162
mf v[40:43],a[104:107],v[136:139]
s_add_u32 m0, s25, 34816
ar v22,a163
cv v21,v21,v22
aw a57,v21
mf v[40:43],a[108:111],a[44:47]
s_add_u32 s39, s51, 243712
buffer_load_dwordx4 v3, s[20:23], s39 offen  lds
wl
mf v[52:55],a[124:127],a[44:47]
tr a[96:97],v16,32768
ar v21,a172
ar v22,a173
mf v[52:55],a[120:123],v[136:139]
tr a[98:99],v16,34816
cv v21,v21,v22
aw a58,v21
mf v[52:55],a[116:119],v[112:115]
tr a[100:101],v16,36864
ar v21,a174
ar v22,a175
mf v[52:55],a[112:115],v[88:91]
tr a[102:103],v16,38912
cv v21,v21,v22
aw a59,v21
mf v[48:51],a[112:115],v[84:87]
tr a[104:105],v16,40960
ar v21,a184
ar v22,a185
mf v[48:51],a[116:119],v[108:111]
s_add_u32 s38, s68, 282624
buffer_load_dword v20, v159, s[28:31], s38 offen
tr a[106:107],v16,43008
mf v[48:51],a[120:123],v[132:135]
tr a[108:109],v16,45056
cv v21,v21,v22
aw a68,v21
mf v[48:51],a[124:127],a[40:43]
tr a[110:111],v16,47104
ar v21,a186
ar v22,a187
mf v[44:47],a[124:127],a[36:39]
s_add_u32 m0, s25, 35840
cv v21,v21,v22
aw a69,v21
ar v21,a196
mf v[44:47],a[120:123],v[128:131]
s_add_u32 s39, s51, 250880
buffer_load_dwordx4 v3, s[20:23], s39 offen  lds
ar v22,a197
mf v[44:47],a[116:119],v[104:107]
s_add_u32 m0, s25, 49152
cv v21,v21,v22
aw a70,v21
ar v21,a198
mf v[44:47],a[112:115],v[80:83]
s_add_u32 s39, s51, 344064
buffer_load_dwordx4 v3, s[20:23], s39 offen  lds
wl
mf v[56:59],a[96:99],v[80:83]
tr a[112:113],v6,32768
ar v22,a199
cv v21,v21,v22
mf v[56:59],a[100:103],v[104:107]
tr a[114:115],v6,34816
aw a71,v21
ar v21,a208
mf v[56:59],a[104:107],v[128:131]
tr a[116:117],v6,36864
ar v22,a209
cv v21,v21,v22
mf v[56:59],a[108:111],a[36:39]
tr a[118:119],v6,38912
aw a80,v21
ar v21,a210
mf v[60:63],a[108:111],a[40:43]
tr a[120:121],v6,40960
ar v22,a211
cv v21,v21,v22
mf v[60:63],a[104:107],v[132:135]
tr a[122:123],v6,43008
aw a81,v21
ar v21,a220
mf v[60:63],a[100:103],v[108:111]
tr a[124:125],v6,45056
ar v22,a221
cv v21,v21,v22
mf v[60:63],a[96:99],v[84:87]
tr a[126:127],v6,47104
aw a82,v21
ar v21,a222
mf v[64:67],a[96:99],v[88:91]
s_add_u32 m0, s25, 50176
ar v22,a223
cv v21,v21,v22
aw a83,v21
mf v[64:67],a[100:103],v[112:115]
s_add_u32 s39, s51, 351232
buffer_load_dwordx4 v3, s[20:23], s39 offen  lds
ar v21,a232
mf v[64:67],a[104:107],v[136:139]
s_add_u32 s38, s68, 286720
buffer_load_dword v20, v159, s[28:31], s38 offen
ar v22,a233
mf v[64:67],a[108:111],a[44:47]
wl
cv v21,v21,v22
aw a92,v21
ar v21,a234
mf v[76:79],a[124:127],a[44:47]
s_waitcnt vmcnt(21)
ar v22,a235
s_barrier
mf v[76:79],a[120:123],v[136:139]
tr a[96:97],v15,49152
cv v21,v21,v22
mf v[76:79],a[116:119],v[112:115]
tr a[98:99],v15,51200
aw a93,v21
mf v[76:79],a[112:115],v[88:91]
s_add_u32 m0, s25, 51200
tr a[100:101],v15,53248
mf v[72:75],a[112:115],v[84:87]
s_add_u32 s39, s51, 358400
buffer_load_dwordx4 v3, s[20:23], s39 offen  lds
s_add_u32 m0, s25, 52224
tr a[102:103],v15,55296
mf v[72:75],a[116:119],v[108:111]
s_add_u32 s39, s51, 365568
buffer_load_dwordx4 v3, s[20:23], s39 offen  lds
tr a[104:105],v15,57344
mf v[72:75],a[120:123],v[132:135]
tr a[106:107],v15,59392
ar v21,a244
mf v[72:75],a[124:127],a[40:43]
tr a[108:109],v15,61440
ar v22,a245
mf v[68:71],a[124:127],a[36:39]
tr a[110:111],v15,63488
cv v21,v21,v22
mf v[68:71],a[120:123],v[128:131]
s_add_u32 m0, s24, 0
aw a94,v21
ar v21,a246
mf v[68:71],a[116:119],v[104:107]
s_add_u32 s39, s52, 0
buffer_load_dwordx4 v3, s[20:23], s39 offen  lds
mf v[68:71],a[112:115],v[80:83]
wl
ar v22,a247
cv v21,v21,v22
mf v[32:35],a[96:99],a[48:51]
tr a[112:113],v5,49152
aw a95,v21
mf v[32:35],a[100:103],a[60:63]
tr a[114:115],v5,51200
v_add_u32 v4, 2359296, v0
mf v[32:35],a[104:107],a[72:75]
s_add_u32 m0, s24, 1024
tr a[116:117],v5,53248
mf v[32:35],a[108:111],a[84:87]
tr a[118:119],v5,55296
mf v[36:39],a[108:111],a[88:91]
tr a[120:121],v5,57344
mf v[36:39],a[104:107],a[76:79]
tr a[122:123],v5,59392
mf v[36:39],a[100:103],a[64:67]
tr a[124:125],v5,61440
mf v[36:39],a[96:99],a[52:55]
tr a[126:127],v5,63488
mf v[40:43],a[96:99],a[56:59]
s_add_u32 s38, s68, 290816
buffer_load_dword v20, v159, s[28:31], s38 offen
mf v[40:43],a[100:103],a[68:71]
s_add_u32 s39, s52, 7168
buffer_load_dwordx4 v3, s[20:23], s39 offen  lds
mf v[40:43],a[104:107],a[80:83]
s_add_u32 m0, s24, 2048
v_mul_f32 v32, v32, v28
v_mul_f32 v33, v33, v28
mf v[40:43],a[108:111],a[92:95]
wl
v_mul_f32 v34, v34, v28
v_mul_f32 v35, v35, v28
mf v[52:55],a[124:127],a[92:95]
tr a[96:97],v16,49152
cv v32,v32,v33
mf v[52:55],a[120:123],a[80:83]
tr a[98:99],v16,51200
cv v33,v34,v35
mf v[52:55],a[116:119],a[68:71]
tr a[100:101],v16,53248
v_mul_f32 v36, v36, v29
mf v[52:55],a[112:115],a[56:59]
tr a[102:103],v16,55296
v_mul_f32 v37, v37, v29
mf v[48:51],a[112:115],a[52:55]
tr a[104:105],v16,57344
v_mul_f32 v38, v38, v29
mf v[48:51],a[116:119],a[64:67]
tr a[106:107],v16,59392
v_mul_f32 v39, v39, v29
mf v[48:51],a[120:123],a[76:79]
tr a[108:109],v16,61440
cv v36,v36,v37
mf v[48:51],a[124:127],a[88:91]
tr a[110:111],v16,63488
cv v37,v38,v39
mf v[44:47],a[124:127],a[84:87]
s_add_u32 s39, s52, 14336
buffer_load_dwordx4 v3, s[20:23], s39 offen  lds
mf v[44:47],a[120:123],a[72:75]
s_add_u32 m0, s24, 3072
v_mul_f32 v40, v40, v30
v_mul_f32 v41, v41, v30
mf v[44:47],a[116:119],a[60:63]
s_add_u32 s39, s52, 21504
buffer_load_dwordx4 v3, s[20:23], s39 offen  lds
mf v[44:47],a[112:115],a[48:51]
wl
v_mul_f32 v42, v42, v30
v_mul_f32 v43, v43, v30
mf v[56:59],a[96:99],a[48:51]
tr a[112:113],v6,49152
cv v40,v40,v41
mf v[56:59],a[100:103],a[60:63]
tr a[114:115],v6,51200
cv v41,v42,v43
mf v[56:59],a[104:107],a[72:75]
tr a[116:117],v6,53248
v_mul_f32 v52, v52, v30
mf v[56:59],a[108:111],a[84:87]
tr a[118:119],v6,55296
v_mul_f32 v53, v53, v30
mf v[60:63],a[108:111],a[88:91]
tr a[120:121],v6,57344
v_mul_f32 v54, v54, v30
mf v[60:63],a[104:107],a[76:79]
tr a[122:123],v6,59392
v_mul_f32 v55, v55, v30
mf v[60:63],a[100:103],a[64:67]
tr a[124:125],v6,61440
cv v42,v52,v53
mf v[60:63],a[96:99],a[52:55]
tr a[126:127],v6,63488
cv v43,v54,v55
mf v[64:67],a[96:99],a[56:59]
s_add_u32 s38, s40, 32768
buffer_store_dwordx4 v[40:43], v1, s[28:31], s38 offen
mf v[64:67],a[100:103],a[68:71]
s_add_u32 m0, s24, 16384
v_mul_f32 v48, v48, v29
v_mul_f32 v49, v49, v29
mf v[64:67],a[104:107],a[80:83]
s_add_u32 s39, s52, 114688
buffer_load_dwordx4 v3, s[20:23], s39 offen  lds
mf v[64:67],a[108:111],a[92:95]
wl
v_mul_f32 v50, v50, v29
v_mul_f32 v51, v51, v29
mf v[76:79],a[124:127],a[92:95]
s_waitcnt vmcnt(18)
cv v38,v48,v49
s_barrier
mf v[76:79],a[120:123],a[80:83]
s_add_u32 m0, s24, 17408
cv v39,v50,v51
v_xor_b32 v15, 0x10000, v15
mf v[76:79],a[116:119],a[68:71]
tr a[96:97],v15,0
v_mul_f32 v44, v44, v28
mf v[76:79],a[112:115],a[56:59]
s_add_u32 s39, s52, 121856
buffer_load_dwordx4 v3, s[20:23], s39 offen  lds
s_add_u32 m0, s24, 18432
tr a[98:99],v15,2048
mf v[72:75],a[112:115],a[52:55]
s_add_u32 s39, s52, 129024
buffer_load_dwordx4 v3, s[20:23], s39 offen  lds
s_add_u32 m0, s24, 19456
tr a[100:101],v15,4096
mf v[72:75],a[116:119],a[64:67]
s_add_u32 s39, s52, 136192
buffer_load_dwordx4 v3, s[20:23], s39 offen  lds
tr a[102:103],v15,6144
mf v[72:75],a[120:123],a[76:79]
tr a[104:105],v15,8192
v_mul_f32 v45, v45, v28
mf v[72:75],a[124:127],a[88:91]
tr a[106:107],v15,10240
v_mul_f32 v46, v46, v28
mf v[68:71],a[124:127],a[84:87]
tr a[108:109],v15,12288
v_mul_f32 v47, v47, v28
mf v[68:71],a[120:123],a[72:75]
tr a[110:111],v15,14336
cv v34,v44,v45
mf v[68:71],a[116:119],a[60:63]
s_mov_b32 s45, s51
s_mov_b32 s51, s52
s_xor_b32 s24, s24, 0x10000
s_xor_b32 s25, s25, 0x10000
s_add_u32 s38, s40, 16384
buffer_store_dwordx4 v[36:39], v1, s[28:31], s38 offen
cv v35,v46,v47
v_mul_f32 v56, v56, v28
v_mul_f32 v57, v57, v28
v_mul_f32 v58, v58, v28
v_mul_f32 v59, v59, v28
cv v56,v56,v57
cv v57,v58,v59
v_mul_f32 v60, v60, v29
v_mul_f32 v61, v61, v29
v_mul_f32 v62, v62, v29
v_mul_f32 v63, v63, v29
cv v60,v60,v61
cv v61,v62,v63
v_mul_f32 v64, v64, v30
v_mul_f32 v65, v65, v30
v_mul_f32 v66, v66, v30
v_mul_f32 v67, v67, v30
cv v64,v64,v65
cv v65,v66,v67
s_add_u32 s38, s40, 0
buffer_store_dwordx4 v[32:35], v1, s[28:31], s38 offen
mf v[68:71],a[112:115],a[48:51]
s_add_u32 s41, s41, 1
wl
v_bfe_u32 v102, v1, 5, 3
v_bfe_u32 v103, v1, 8, 2
v_lshlrev_b32 v103, 1, v103
v_xor_b32 v102, v102, v103
v_and_b32 v103, 16, v1
v_mov_b32 v0, 0x3f80
v_lshlrev_b32 v103, v103, v0
v_cmp_eq_u32 vcc, 0, v102
v_cmp_eq_u32 s[72:73], 1, v102
v_nop
v_cndmask_b32 v100, 0, v103, vcc
v_cndmask_b32 v101, 0, v103, s[72:73]
v_mov_b32 v102, v100
v_mov_b32 v103, v101
v_xor_b32 v5, 0x10000, v5
v_xor_b32 v16, 0x10000, v16
v_xor_b32 v6, 0x10000, v6
.p2align 5
Loloopf_b:
mz v[32:35],a[96:99],v[160:163],0
tr a[112:113],v15,16384
v_mul_f32 v76, v76, v30
mf v[32:35],a[100:103],v[172:175]
tr a[114:115],v15,18432
v_mul_f32 v77, v77, v30
mf v[32:35],a[104:107],v[184:187]
tr a[116:117],v15,20480
v_mul_f32 v78, v78, v30
mf v[32:35],a[108:111],v[196:199]
tr a[118:119],v15,22528
v_mul_f32 v79, v79, v30
mz v[36:39],a[108:111],v[200:203],0
tr a[120:121],v15,24576
cv v66,v76,v77
mf v[36:39],a[104:107],v[188:191]
tr a[122:123],v15,26624
cv v67,v78,v79
mf v[36:39],a[100:103],v[176:179]
tr a[124:125],v15,28672
v_mul_f32 v72, v72, v29
mf v[36:39],a[96:99],v[164:167]
tr a[126:127],v15,30720
v_mul_f32 v73, v73, v29
mz v[40:43],a[96:99],v[168:171],0
s_add_u32 s38, s40, 40960
buffer_store_dwordx4 v[64:67], v1, s[28:31], s38 offen
mf v[40:43],a[100:103],v[180:183]
s_add_u32 s48, s51, 128
v_mul_f32 v74, v74, v29
v_mul_f32 v75, v75, v29
mf v[40:43],a[104:107],v[192:195]
s_cmp_lt_u32 s41, 5
s_cselect_b32 s52, s48, 0x40000000
cv v62,v72,v73
cv v63,v74,v75
mf v[40:43],a[108:111],v[204:207]
s_add_u32 m0, s25, 20480
v_mul_f32 v68, v68, v28
wl
mf v[40:43],a[124:127],v[252:255]
tr a[96:97],v5,16384
v_mul_f32 v69, v69, v28
mf v[40:43],a[120:123],v[240:243]
tr a[98:99],v5,18432
v_mul_f32 v70, v70, v28
mf v[40:43],a[116:119],v[228:231]
tr a[100:101],v5,20480
v_mul_f32 v71, v71, v28
mf v[40:43],a[112:115],v[216:219]
tr a[102:103],v5,22528
cv v58,v68,v69
mf v[36:39],a[112:115],v[212:215]
tr a[104:105],v5,24576
cv v59,v70,v71
mf v[36:39],a[116:119],v[224:227]
tr a[106:107],v5,26624
cv v118,v96,v97
mf v[36:39],a[120:123],v[236:239]
tr a[108:109],v5,28672
cv v119,v98,v99
mf v[36:39],a[124:127],v[248:251]
tr a[110:111],v5,30720
cv v116,v92,v93
mf v[32:35],a[124:127],v[244:247]
s_add_u32 s38, s40, 24576
buffer_store_dwordx4 v[60:63], v1, s[28:31], s38 offen
mf v[32:35],a[120:123],v[232:235]
s_add_u32 s38, s40, 8192
buffer_store_dwordx4 v[56:59], v1, s[28:31], s38 offen
mf v[32:35],a[116:119],v[220:223]
s_xor_b32 s40, s40, 262144
v_mul_f32 v40, v40, v26
v_mul_f32 v41, v41, v26
mf v[32:35],a[112:115],v[208:211]
wl
v_mul_f32 v42, v42, v26
v_mul_f32 v43, v43, v26
mz v[44:47],a[96:99],v[208:211],0
tr a[112:113],v5,0
cv v117,v94,v95
mf v[44:47],a[100:103],v[220:223]
tr a[114:115],v5,2048
v_mul_f32 v36, v36, v25
mf v[44:47],a[104:107],v[232:235]
tr a[116:117],v5,4096
v_mul_f32 v37, v37, v25
mf v[44:47],a[108:111],v[244:247]
tr a[118:119],v5,6144
v_mul_f32 v38, v38, v25
mz v[48:51],a[108:111],v[248:251],0
tr a[120:121],v5,8192
v_mul_f32 v39, v39, v25
mf v[48:51],a[104:107],v[236:239]
tr a[122:123],v5,10240
v_mul_f32 v32, v32, v24
mf v[48:51],a[100:103],v[224:227]
tr a[124:125],v5,12288
v_mul_f32 v33, v33, v24
mf v[48:51],a[96:99],v[212:215]
tr a[126:127],v5,14336
v_mul_f32 v34, v34, v24
mz v[52:55],a[96:99],v[216:219],0
v_mul_f32 v35, v35, v24
mf v[52:55],a[100:103],v[228:231]
mf v[52:55],a[104:107],v[240:243]
mf v[52:55],a[108:111],v[252:255]
wl
mf v[52:55],a[124:127],v[204:207]
tr a[96:97],v16,0
mf v[52:55],a[120:123],v[192:195]
tr a[98:99],v16,2048
mf v[52:55],a[116:119],v[180:183]
tr a[100:101],v16,4096
mf v[52:55],a[112:115],v[168:171]
tr a[102:103],v16,6144
mf v[48:51],a[112:115],v[164:167]
tr a[104:105],v16,8192
v_mov_b32 v0, s41
mf v[48:51],a[116:119],v[176:179]
tr a[106:107],v16,10240
mf v[48:51],a[120:123],v[188:191]
tr a[108:109],v16,12288
mf v[48:51],a[124:127],v[200:203]
tr a[110:111],v16,14336
mf v[44:47],a[124:127],v[196:199]
s_waitcnt vmcnt(0)
buffer_store_dword v0, v17, s[28:31], 0 offen
mf v[44:47],a[120:123],v[184:187]
v_mul_f32 v52, v52, v26
v_mul_f32 v53, v53, v26
mf v[44:47],a[116:119],v[172:175]
s_add_u32 s39, s51, 143360
buffer_load_dwordx4 v3, s[20:23], s39 offen offset:0 lds
mf v[44:47],a[112:115],v[160:163]
wl
buffer_load_dwordx4 v152, s[20:23], s39 offen offset:1024 lds
mz v[56:59],a[96:99],v[160:163],0
tr a[112:113],v16,16384
v_mul_f32 v54, v54, v26
mf v[56:59],a[100:103],v[172:175]
tr a[114:115],v16,18432
buffer_load_dwordx4 v153, s[20:23], s39 offen offset:2048 lds
mf v[56:59],a[104:107],v[184:187]
tr a[116:117],v16,20480
buffer_load_dwordx4 v154, s[20:23], s39 offen offset:3072 lds
mf v[56:59],a[108:111],v[196:199]
s_add_u32 m0, s25, 24576
s_add_u32 s39, s51, 172032
buffer_load_dwordx4 v3, s[20:23], s39 offen offset:0 lds
tr a[118:119],v16,22528
mz v[60:63],a[108:111],v[200:203],0
tr a[120:121],v16,24576
buffer_load_dwordx4 v152, s[20:23], s39 offen offset:1024 lds
mf v[60:63],a[104:107],v[188:191]
tr a[122:123],v16,26624
buffer_load_dwordx4 v153, s[20:23], s39 offen offset:2048 lds
mf v[60:63],a[100:103],v[176:179]
tr a[124:125],v16,28672
buffer_load_dwordx4 v154, s[20:23], s39 offen offset:3072 lds
mf v[60:63],a[96:99],v[164:167]
s_add_u32 m0, s25, 28672
tr a[126:127],v16,30720
mz v[64:67],a[96:99],v[168:171],0
s_add_u32 s39, s51, 200704
buffer_load_dwordx4 v3, s[20:23], s39 offen offset:0 lds
mf v[64:67],a[100:103],v[180:183]
buffer_load_dwordx4 v152, s[20:23], s39 offen offset:1024 lds
mf v[64:67],a[104:107],v[192:195]
buffer_load_dwordx4 v153, s[20:23], s39 offen offset:2048 lds
mf v[64:67],a[108:111],v[204:207]
wl
buffer_load_dwordx4 v154, s[20:23], s39 offen offset:3072 lds
mf v[64:67],a[124:127],v[252:255]
s_add_u32 m0, s25, 32768
s_add_u32 s39, s51, 229376
buffer_load_dwordx4 v3, s[20:23], s39 offen offset:0 lds
tr a[96:97],v6,16384
mf v[64:67],a[120:123],v[240:243]
tr a[98:99],v6,18432
buffer_load_dwordx4 v152, s[20:23], s39 offen offset:1024 lds
mf v[64:67],a[116:119],v[228:231]
tr a[100:101],v6,20480
v_mul_f32 v55, v55, v26
mf v[64:67],a[112:115],v[216:219]
tr a[102:103],v6,22528
buffer_load_dwordx4 v153, s[20:23], s39 offen offset:2048 lds
mf v[60:63],a[112:115],v[212:215]
tr a[104:105],v6,24576
buffer_load_dwordx4 v154, s[20:23], s39 offen offset:3072 lds
mf v[60:63],a[116:119],v[224:227]
s_add_u32 m0, s25, 36864
s_add_u32 s39, s51, 258048
buffer_load_dwordx4 v3, s[20:23], s39 offen offset:0 lds
tr a[106:107],v6,26624
mf v[60:63],a[120:123],v[236:239]
tr a[108:109],v6,28672
buffer_load_dwordx4 v152, s[20:23], s39 offen offset:1024 lds
mf v[60:63],a[124:127],v[248:251]
tr a[110:111],v6,30720
buffer_load_dwordx4 v153, s[20:23], s39 offen offset:2048 lds
mf v[56:59],a[124:127],v[244:247]
buffer_load_dwordx4 v154, s[20:23], s39 offen offset:3072 lds
mf v[56:59],a[120:123],v[232:235]
s_add_u32 m0, s25, 40960
v_mul_f32 v48, v48, v25
v_mul_f32 v49, v49, v25
mf v[56:59],a[116:119],v[220:223]
s_add_u32 s39, s51, 286720
buffer_load_dwordx4 v3, s[20:23], s39 offen offset:0 lds
mf v[56:59],a[112:115],v[208:211]
wl
buffer_load_dwordx4 v152, s[20:23], s39 offen offset:1024 lds
mz v[68:71],a[96:99],v[208:211],0
tr a[112:113],v6,0
buffer_load_dwordx4 v153, s[20:23], s39 offen offset:2048 lds
mf v[68:71],a[100:103],v[220:223]
tr a[114:115],v6,2048
buffer_load_dwordx4 v154, s[20:23], s39 offen offset:3072 lds
mf v[68:71],a[104:107],v[232:235]
s_add_u32 m0, s25, 45056
s_add_u32 s39, s51, 315392
buffer_load_dwordx4 v3, s[20:23], s39 offen offset:0 lds
tr a[116:117],v6,4096
mf v[68:71],a[108:111],v[244:247]
tr a[118:119],v6,6144
buffer_load_dwordx4 v152, s[20:23], s39 offen offset:1024 lds
mz v[72:75],a[108:111],v[248:251],0
tr a[120:121],v6,8192
v_mul_f32 v50, v50, v25
mf v[72:75],a[104:107],v[236:239]
tr a[122:123],v6,10240
buffer_load_dwordx4 v153, s[20:23], s39 offen offset:2048 lds
mf v[72:75],a[100:103],v[224:227]
tr a[124:125],v6,12288
buffer_load_dwordx4 v154, s[20:23], s39 offen offset:3072 lds
mf v[72:75],a[96:99],v[212:215]
s_add_u32 m0, s25, 49152
s_add_u32 s39, s51, 344064
buffer_load_dwordx4 v3, s[20:23], s39 offen offset:0 lds
tr a[126:127],v6,14336
mz v[76:79],a[96:99],v[216:219],0
buffer_load_dwordx4 v152, s[20:23], s39 offen offset:1024 lds
mf v[76:79],a[100:103],v[228:231]
buffer_load_dwordx4 v153, s[20:23], s39 offen offset:2048 lds
mf v[76:79],a[104:107],v[240:243]
buffer_load_dwordx4 v154, s[20:23], s39 offen offset:3072 lds
mf v[76:79],a[108:111],v[252:255]
wl
buffer_store_dwordx4 v[116:119], v2, s[92:95], s53 offen nt
mf v[76:79],a[124:127],v[204:207]
s_add_u32 m0, s24, -12288
s_waitcnt vmcnt(49)
s_barrier
mf v[76:79],a[120:123],v[192:195]
tr a[96:97],v15,32768
v_mul_f32 v51, v51, v25
mf v[76:79],a[116:119],v[180:183]
tr a[98:99],v15,34816
v_mul_f32 v44, v44, v24
mf v[76:79],a[112:115],v[168:171]
tr a[100:101],v15,36864
v_mul_f32 v45, v45, v24
mf v[72:75],a[112:115],v[164:167]
tr a[102:103],v15,38912
v_mul_f32 v46, v46, v24
mf v[72:75],a[116:119],v[176:179]
tr a[104:105],v15,40960
v_mul_f32 v47, v47, v24
mf v[72:75],a[120:123],v[188:191]
tr a[106:107],v15,43008
v_mul_f32 v64, v64, v26
mf v[72:75],a[124:127],v[200:203]
tr a[108:109],v15,45056
v_mul_f32 v65, v65, v26
mf v[68:71],a[124:127],v[196:199]
tr a[110:111],v15,47104
v_mul_f32 v66, v66, v26
mf v[68:71],a[120:123],v[184:187]
s_mov_b32 s53, s27
v_mul_f32 v67, v67, v26
v_mul_f32 v60, v60, v25
mf v[68:71],a[116:119],v[172:175]
s_add_u32 s27, s27, 128
v_mul_f32 v61, v61, v25
v_mul_f32 v62, v62, v25
mf v[68:71],a[112:115],v[160:163]
wl
v_mul_f32 v63, v63, v25
v_mul_f32 v56, v56, v24
mf v[32:35],a[96:99],v[80:83]
tr a[112:113],v15,49152
v_mul_f32 v57, v57, v24
mf v[32:35],a[100:103],v[104:107]
tr a[114:115],v15,51200
v_mul_f32 v58, v58, v24
mf v[32:35],a[104:107],v[128:131]
tr a[116:117],v15,53248
buffer_load_dword v23, v4, s[28:31], 0 offen sc1
s_add_u32 s39, s52, -86016
buffer_load_dwordx4 v3, s[20:23], s39 offen offset:0 lds
mf v[32:35],a[108:111],a[36:39]
tr a[118:119],v15,55296
v_mul_f32 v59, v59, v24
mf v[36:39],a[108:111],a[40:43]
tr a[120:121],v15,57344
v_mul_f32 v76, v76, v26
mf v[36:39],a[104:107],v[132:135]
tr a[122:123],v15,59392
buffer_load_dwordx4 v152, s[20:23], s39 offen offset:1024 lds
mf v[36:39],a[100:103],v[108:111]
tr a[124:125],v15,61440
v_mul_f32 v77, v77, v26
mf v[36:39],a[96:99],v[84:87]
tr a[126:127],v15,63488
buffer_load_dwordx4 v153, s[20:23], s39 offen offset:2048 lds
mf v[40:43],a[96:99],v[88:91]
v_mul_f32 v78, v78, v26
v_mul_f32 v79, v79, v26
mf v[40:43],a[100:103],v[112:115]
v_mul_f32 v72, v72, v25
v_mul_f32 v73, v73, v25
mf v[40:43],a[104:107],v[136:139]
buffer_load_dwordx4 v154, s[20:23], s39 offen offset:3072 lds
mf v[40:43],a[108:111],a[44:47]
s_add_u32 m0, s24, -8192
v_mul_f32 v74, v74, v25
wl
mf v[40:43],a[124:127],a[92:95]
tr a[96:97],v5,49152
v_mul_f32 v75, v75, v25
mf v[40:43],a[120:123],a[80:83]
s_add_u32 s39, s52, -57344
buffer_load_dwordx4 v3, s[20:23], s39 offen offset:0 lds
tr a[98:99],v5,51200
mf v[40:43],a[116:119],a[68:71]
tr a[100:101],v5,53248
v_mul_f32 v68, v68, v24
mf v[40:43],a[112:115],a[56:59]
tr a[102:103],v5,55296
v_mul_f32 v69, v69, v24
mf v[36:39],a[112:115],a[52:55]
tr a[104:105],v5,57344
buffer_load_dwordx4 v152, s[20:23], s39 offen offset:1024 lds
mf v[36:39],a[116:119],a[64:67]
tr a[106:107],v5,59392
v_mul_f32 v70, v70, v24
mf v[36:39],a[120:123],a[76:79]
tr a[108:109],v5,61440
buffer_load_dwordx4 v153, s[20:23], s39 offen offset:2048 lds
mf v[36:39],a[124:127],a[88:91]
tr a[110:111],v5,63488
v_mul_f32 v71, v71, v24
mf v[32:35],a[124:127],a[84:87]
s_waitcnt vmcnt(7)
v_cmp_gt_u32 vcc, s41, v23
mf v[32:35],a[120:123],a[72:75]
buffer_load_dwordx4 v154, s[20:23], s39 offen offset:3072 lds
mf v[32:35],a[116:119],a[60:63]
s_add_u32 m0, s24, -4096
v_mul_f32 v40, v40, v30
v_mul_f32 v41, v41, v30
mf v[32:35],a[112:115],a[48:51]
wl
v_mul_f32 v42, v42, v30
v_mul_f32 v43, v43, v30
mf v[44:47],a[96:99],a[48:51]
s_add_u32 s39, s52, -28672
buffer_load_dwordx4 v3, s[20:23], s39 offen offset:0 lds
tr a[112:113],v5,32768
mf v[44:47],a[100:103],a[60:63]
tr a[114:115],v5,34816
cv v40,v40,v41
mf v[44:47],a[104:107],a[72:75]
s_cbranch_vccnz Lspinf_b
Lspunf_b:
tr a[116:117],v5,36864
mf v[44:47],a[108:111],a[84:87]
tr a[118:119],v5,38912
buffer_load_dwordx4 v152, s[20:23], s39 offen offset:1024 lds
mf v[48:51],a[108:111],a[88:91]
s_add_u32 s72, s26, 4096
tr a[120:121],v5,40960
mf v[48:51],a[104:107],a[76:79]
tr a[122:123],v5,43008
buffer_load_dwordx4 v153, s[20:23], s39 offen offset:2048 lds
mf v[48:51],a[100:103],a[64:67]
tr a[124:125],v5,45056
cv v41,v42,v43
mf v[48:51],a[96:99],a[52:55]
tr a[126:127],v5,47104
v_mul_f32 v36, v36, v29
mf v[52:55],a[96:99],a[56:59]
buffer_load_dwordx4 v154, s[20:23], s39 offen offset:3072 lds
mf v[52:55],a[100:103],a[68:71]
s_add_u32 m0, s24, 0
buffer_load_dwordx2 a[162:163], v1, s[28:31], s26 offen offset:8 sc1
mf v[52:55],a[104:107],a[80:83]
v_mul_f32 v37, v37, v29
v_mul_f32 v38, v38, v29
mf v[52:55],a[108:111],a[92:95]
s_add_u32 s39, s52, 0
buffer_load_dwordx4 v3, s[20:23], s39 offen offset:0 lds
wl
mf v[52:55],a[124:127],a[44:47]
tr a[96:97],v16,32768
v_mul_f32 v39, v39, v29
mf v[52:55],a[120:123],v[136:139]
tr a[98:99],v16,34816
buffer_load_dwordx4 v152, s[20:23], s39 offen offset:1024 lds
mf v[52:55],a[116:119],v[112:115]
tr a[100:101],v16,36864
cv v36,v36,v37
mf v[52:55],a[112:115],v[88:91]
tr a[102:103],v16,38912
cv v37,v38,v39
mf v[48:51],a[112:115],v[84:87]
tr a[104:105],v16,40960
buffer_load_dwordx4 v153, s[20:23], s39 offen offset:2048 lds
mf v[48:51],a[116:119],v[108:111]
tr a[106:107],v16,43008
v_mul_f32 v32, v32, v28
mf v[48:51],a[120:123],v[132:135]
tr a[108:109],v16,45056
v_mul_f32 v33, v33, v28
mf v[48:51],a[124:127],a[40:43]
tr a[110:111],v16,47104
buffer_load_dwordx4 v154, s[20:23], s39 offen offset:3072 lds
mf v[44:47],a[124:127],a[36:39]
s_add_u32 m0, s24, 4096
buffer_load_dwordx4 a[164:167], v1, s[28:31], s26 offen offset:1024 sc1
mf v[44:47],a[120:123],v[128:131]
v_mul_f32 v34, v34, v28
v_mul_f32 v35, v35, v28
mf v[44:47],a[116:119],v[104:107]
s_add_u32 s39, s52, 28672
buffer_load_dwordx4 v3, s[20:23], s39 offen offset:0 lds
mf v[44:47],a[112:115],v[80:83]
wl
buffer_load_dwordx4 a[168:171], v1, s[28:31], s26 offen offset:2048 sc1
mf v[56:59],a[96:99],v[80:83]
tr a[112:113],v16,49152
buffer_load_dwordx4 v152, s[20:23], s39 offen offset:1024 lds
mf v[56:59],a[100:103],v[104:107]
tr a[114:115],v16,51200
cv v32,v32,v33
mf v[56:59],a[104:107],v[128:131]
tr a[116:117],v16,53248
cv v33,v34,v35
mf v[56:59],a[108:111],a[36:39]
tr a[118:119],v16,55296
buffer_load_dwordx4 v153, s[20:23], s39 offen offset:2048 lds
mf v[60:63],a[108:111],a[40:43]
tr a[120:121],v16,57344
v_mul_f32 v52, v52, v30
mf v[60:63],a[104:107],v[132:135]
tr a[122:123],v16,59392
v_mul_f32 v53, v53, v30
mf v[60:63],a[100:103],v[108:111]
s_cmp_eq_u32 s41, 4
s_cbranch_scc0 Lnotouchf_b
v_lshl_add_u32 v22, v1, 3, s3
v_min_u32 v22, L_end-L_main4, v22
global_load_dword v20, v22, s[58:59]
Lnotouchf_b:
tr a[124:125],v16,61440
buffer_load_dwordx4 v154, s[20:23], s39 offen offset:3072 lds
mf v[60:63],a[96:99],v[84:87]
s_add_u32 m0, s24, 8192
tr a[126:127],v16,63488
mf v[64:67],a[96:99],v[88:91]
buffer_load_dwordx4 a[172:175], v1, s[28:31], s26 offen offset:3072 sc1
mf v[64:67],a[100:103],v[112:115]
s_add_u32 s39, s52, 57344
buffer_load_dwordx4 v3, s[20:23], s39 offen offset:0 lds
mf v[64:67],a[104:107],v[136:139]
buffer_load_dwordx4 a[176:179], v1, s[28:31], s72 offen offset:0 sc1
mf v[64:67],a[108:111],a[44:47]
wl
buffer_load_dwordx4 v152, s[20:23], s39 offen offset:1024 lds
mf v[64:67],a[124:127],a[92:95]
tr a[96:97],v6,49152
v_mul_f32 v54, v54, v30
mf v[64:67],a[120:123],a[80:83]
tr a[98:99],v6,51200
v_mul_f32 v55, v55, v30
mf v[64:67],a[116:119],a[68:71]
tr a[100:101],v6,53248
buffer_load_dwordx4 v153, s[20:23], s39 offen offset:2048 lds
mf v[64:67],a[112:115],a[56:59]
tr a[102:103],v6,55296
cv v42,v52,v53
mf v[60:63],a[112:115],a[52:55]
tr a[104:105],v6,57344
cv v43,v54,v55
mf v[60:63],a[116:119],a[64:67]
tr a[106:107],v6,59392
buffer_load_dwordx4 v154, s[20:23], s39 offen offset:3072 lds
mf v[60:63],a[120:123],a[76:79]
tr a[108:109],v6,61440
buffer_load_dwordx4 a[180:183], v1, s[28:31], s72 offen offset:1024 sc1
mf v[60:63],a[124:127],a[88:91]
s_add_u32 m0, s24, 12288
tr a[110:111],v6,63488
mf v[56:59],a[124:127],a[84:87]
s_add_u32 s39, s52, 86016
buffer_load_dwordx4 v3, s[20:23], s39 offen offset:0 lds
buffer_load_dwordx4 a[184:187], v1, s[28:31], s72 offen offset:2048 sc1
mf v[56:59],a[120:123],a[72:75]
s_cmp_eq_u32 s41, 5
s_cbranch_scc1 Lofork_b
mf v[56:59],a[116:119],a[60:63]
buffer_load_dwordx4 a[188:191], v1, s[28:31], s72 offen offset:3072 sc1
buffer_load_dwordx4 v152, s[20:23], s39 offen offset:1024 lds
mf v[56:59],a[112:115],a[48:51]
wl
v_mul_f32 v48, v48, v29
v_mul_f32 v49, v49, v29
mf v[68:71],a[96:99],a[48:51]
tr a[112:113],v6,32768
buffer_load_dwordx2 a[192:193], v1, s[28:31], s26 offen offset:0 sc1
s_xor_b32 s26, s26, 262144
mf v[68:71],a[100:103],a[60:63]
tr a[114:115],v6,34816
buffer_load_dwordx4 v153, s[20:23], s39 offen offset:2048 lds
mf v[68:71],a[104:107],a[72:75]
tr a[116:117],v6,36864
v_mul_f32 v50, v50, v29
mf v[68:71],a[108:111],a[84:87]
tr a[118:119],v6,38912
v_mul_f32 v51, v51, v29
mf v[72:75],a[108:111],a[88:91]
tr a[120:121],v6,40960
buffer_load_dwordx4 v154, s[20:23], s39 offen offset:3072 lds
mf v[72:75],a[104:107],a[76:79]
s_add_u32 m0, s24, 16384
tr a[122:123],v6,43008
mf v[72:75],a[100:103],a[64:67]
tr a[124:125],v6,45056
cv v38,v48,v49
mf v[72:75],a[96:99],a[52:55]
s_add_u32 s39, s52, 114688
buffer_load_dwordx4 v3, s[20:23], s39 offen offset:0 lds
tr a[126:127],v6,47104
mf v[76:79],a[96:99],a[56:59]
s_add_u32 s38, s40, 32768
buffer_store_dwordx4 v[40:43], v1, s[28:31], s38 offen
mf v[76:79],a[100:103],a[68:71]
buffer_load_dwordx4 v152, s[20:23], s39 offen offset:1024 lds
mf v[76:79],a[104:107],a[80:83]
cv v39,v50,v51
v_mul_f32 v44, v44, v28
mf v[76:79],a[108:111],a[92:95]
wl
v_mul_f32 v45, v45, v28
v_mul_f32 v46, v46, v28
mf v[76:79],a[124:127],a[44:47]
s_waitcnt vmcnt(63)
buffer_load_dwordx4 v153, s[20:23], s39 offen offset:2048 lds
s_barrier
mf v[76:79],a[120:123],v[136:139]
v_mul_f32 v47, v47, v28
v_xor_b32 v15, 0x10000, v15
mf v[76:79],a[116:119],v[112:115]
tr a[96:97],v15,0
cv v34,v44,v45
mf v[76:79],a[112:115],v[88:91]
tr a[98:99],v15,2048
buffer_load_dwordx4 v154, s[20:23], s39 offen offset:3072 lds
mf v[72:75],a[112:115],v[84:87]
tr a[100:101],v15,4096
cv v35,v46,v47
mf v[72:75],a[116:119],v[108:111]
tr a[102:103],v15,6144
v_mul_f32 v64, v64, v30
mf v[72:75],a[120:123],v[132:135]
tr a[104:105],v15,8192
v_mul_f32 v65, v65, v30
mf v[72:75],a[124:127],a[40:43]
tr a[106:107],v15,10240
v_mul_f32 v66, v66, v30
mf v[68:71],a[124:127],a[36:39]
tr a[108:109],v15,12288
v_mul_f32 v67, v67, v30
mf v[68:71],a[120:123],v[128:131]
tr a[110:111],v15,14336
cv v64,v64,v65
mf v[68:71],a[116:119],v[104:107]
s_mov_b32 s45, s51
s_mov_b32 s51, s52
s_xor_b32 s24, s24, 0x10000
s_xor_b32 s25, s25, 0x10000
mf v[68:71],a[112:115],v[80:83]
s_add_u32 s41, s41, 1
s_waitcnt vmcnt(7)
v_xor_b32 v5, 0x10000, v5
v_xor_b32 v16, 0x10000, v16
v_xor_b32 v6, 0x10000, v6
wl
mz v[96:99],v[100:103],a[162:165],0
s_add_u32 s38, s40, 16384
buffer_store_dwordx4 v[36:39], v1, s[28:31], s38 offen
mf v[96:99],v[100:103],a[170:173]
s_add_u32 s38, s40, 0
buffer_store_dwordx4 v[32:35], v1, s[28:31], s38 offen
mf v[96:99],v[100:103],a[178:181]
cv v65,v66,v67
v_mul_f32 v60, v60, v29
mf v[96:99],v[100:103],a[186:189]
v_mul_f32 v61, v61, v29
v_mul_f32 v62, v62, v29
mz v[92:95],v[100:103],a[166:169],0
v_mul_f32 v63, v63, v29
cv v60,v60,v61
mf v[92:95],v[100:103],a[174:177]
cv v61,v62,v63
v_mul_f32 v56, v56, v28
mf v[92:95],v[100:103],a[182:185]
v_mul_f32 v57, v57, v28
v_mul_f32 v58, v58, v28
v_mul_f32 v59, v59, v28
cv v56,v56,v57
cv v57,v58,v59
mf v[92:95],v[100:103],a[190:193]
s_branch Loloopf_b
.p2align 5
Lofork_b:
mf v[56:59],a[116:119],a[60:63]
buffer_load_dwordx4 a[188:191], v1, s[28:31], s72 offen offset:3072 sc1
buffer_load_dwordx4 v152, s[20:23], s39 offen offset:1024 lds
mf v[56:59],a[112:115],a[48:51]
wl
v_mul_f32 v48, v48, v29
v_mul_f32 v49, v49, v29
mf v[68:71],a[96:99],a[48:51]
tr a[112:113],v6,32768
buffer_load_dwordx2 a[192:193], v1, s[28:31], s26 offen offset:0 sc1
s_xor_b32 s26, s26, 262144
mf v[68:71],a[100:103],a[60:63]
tr a[114:115],v6,34816
buffer_load_dwordx4 v153, s[20:23], s39 offen offset:2048 lds
mf v[68:71],a[104:107],a[72:75]
tr a[116:117],v6,36864
v_mul_f32 v50, v50, v29
mf v[68:71],a[108:111],a[84:87]
tr a[118:119],v6,38912
v_mul_f32 v51, v51, v29
mf v[72:75],a[108:111],a[88:91]
tr a[120:121],v6,40960
buffer_load_dwordx4 v154, s[20:23], s39 offen offset:3072 lds
mf v[72:75],a[104:107],a[76:79]
s_add_u32 m0, s24, 16384
tr a[122:123],v6,43008
mf v[72:75],a[100:103],a[64:67]
tr a[124:125],v6,45056
cv v38,v48,v49
mf v[72:75],a[96:99],a[52:55]
s_add_u32 s39, s52, 114688
buffer_load_dwordx4 v3, s[20:23], s39 offen offset:0 lds
tr a[126:127],v6,47104
mf v[76:79],a[96:99],a[56:59]
s_add_u32 s38, s40, 32768
buffer_store_dwordx4 v[40:43], v1, s[28:31], s38 offen  nt
mf v[76:79],a[100:103],a[68:71]
buffer_load_dwordx4 v152, s[20:23], s39 offen offset:1024 lds
mf v[76:79],a[104:107],a[80:83]
cv v39,v50,v51
v_mul_f32 v44, v44, v28
mf v[76:79],a[108:111],a[92:95]
wl
v_mul_f32 v45, v45, v28
v_mul_f32 v46, v46, v28
mf v[76:79],a[124:127],a[44:47]
s_waitcnt vmcnt(63)
buffer_load_dwordx4 v153, s[20:23], s39 offen offset:2048 lds
s_barrier
mf v[76:79],a[120:123],v[136:139]
v_mul_f32 v47, v47, v28
v_xor_b32 v15, 0x10000, v15
mf v[76:79],a[116:119],v[112:115]
tr a[96:97],v15,0
cv v34,v44,v45
mf v[76:79],a[112:115],v[88:91]
tr a[98:99],v15,2048
buffer_load_dwordx4 v154, s[20:23], s39 offen offset:3072 lds
mf v[72:75],a[112:115],v[84:87]
tr a[100:101],v15,4096
cv v35,v46,v47
mf v[72:75],a[116:119],v[108:111]
tr a[102:103],v15,6144
v_mul_f32 v64, v64, v30
mf v[72:75],a[120:123],v[132:135]
tr a[104:105],v15,8192
v_mul_f32 v65, v65, v30
mf v[72:75],a[124:127],a[40:43]
tr a[106:107],v15,10240
v_mul_f32 v66, v66, v30
mf v[68:71],a[124:127],a[36:39]
tr a[108:109],v15,12288
v_mul_f32 v67, v67, v30
mf v[68:71],a[120:123],v[128:131]
tr a[110:111],v15,14336
cv v64,v64,v65
mf v[68:71],a[116:119],v[104:107]
s_mov_b32 s45, s51
s_mov_b32 s51, s52
s_xor_b32 s24, s24, 0x10000
s_xor_b32 s25, s25, 0x10000
mf v[68:71],a[112:115],v[80:83]
s_add_u32 s41, s41, 1
s_waitcnt vmcnt(7)
v_xor_b32 v5, 0x10000, v5
v_xor_b32 v16, 0x10000, v16
v_xor_b32 v6, 0x10000, v6
wl
mz v[96:99],v[100:103],a[162:165],0
s_add_u32 s38, s40, 16384
buffer_store_dwordx4 v[36:39], v1, s[28:31], s38 offen  nt
mf v[96:99],v[100:103],a[170:173]
s_add_u32 s38, s40, 0
buffer_store_dwordx4 v[32:35], v1, s[28:31], s38 offen  nt
mf v[96:99],v[100:103],a[178:181]
cv v65,v66,v67
v_mul_f32 v60, v60, v29
mf v[96:99],v[100:103],a[186:189]
v_mul_f32 v61, v61, v29
v_mul_f32 v62, v62, v29
mz v[92:95],v[100:103],a[166:169],0
v_mul_f32 v63, v63, v29
cv v60,v60,v61
mf v[92:95],v[100:103],a[174:177]
cv v61,v62,v63
v_mul_f32 v56, v56, v28
mf v[92:95],v[100:103],a[182:185]
v_mul_f32 v57, v57, v28
v_mul_f32 v58, v58, v28
v_mul_f32 v59, v59, v28
cv v56,v56,v57
cv v57,v58,v59
mf v[92:95],v[100:103],a[190:193]
s_nop 0
mz v[32:35],a[96:99],v[160:163],0
tr a[112:113],v15,16384
v_mul_f32 v76, v76, v30
mf v[32:35],a[100:103],v[172:175]
tr a[114:115],v15,18432
v_mul_f32 v77, v77, v30
mf v[32:35],a[104:107],v[184:187]
tr a[116:117],v15,20480
v_mul_f32 v78, v78, v30
mf v[32:35],a[108:111],v[196:199]
tr a[118:119],v15,22528
v_mul_f32 v79, v79, v30
mz v[36:39],a[108:111],v[200:203],0
tr a[120:121],v15,24576
cv v66,v76,v77
mf v[36:39],a[104:107],v[188:191]
tr a[122:123],v15,26624
cv v67,v78,v79
mf v[36:39],a[100:103],v[176:179]
tr a[124:125],v15,28672
v_mul_f32 v72, v72, v29
mf v[36:39],a[96:99],v[164:167]
tr a[126:127],v15,30720
v_mul_f32 v73, v73, v29
mz v[40:43],a[96:99],v[168:171],0
s_add_u32 s38, s40, 40960
buffer_store_dwordx4 v[64:67], v1, s[28:31], s38 offen nt
mf v[40:43],a[100:103],v[180:183]
v_mul_f32 v74, v74, v29
v_mul_f32 v75, v75, v29
mf v[40:43],a[104:107],v[192:195]
cv v62,v72,v73
cv v63,v74,v75
mf v[40:43],a[108:111],v[204:207]
wl
v_mul_f32 v68, v68, v28
v_mul_f32 v69, v69, v28
mf v[40:43],a[124:127],v[252:255]
tr a[96:97],v5,16384
v_mul_f32 v70, v70, v28
mf v[40:43],a[120:123],v[240:243]
tr a[98:99],v5,18432
v_mul_f32 v71, v71, v28
mf v[40:43],a[116:119],v[228:231]
tr a[100:101],v5,20480
cv v58,v68,v69
mf v[40:43],a[112:115],v[216:219]
tr a[102:103],v5,22528
cv v59,v70,v71
mf v[36:39],a[112:115],v[212:215]
tr a[104:105],v5,24576
cv v118,v96,v97
mf v[36:39],a[116:119],v[224:227]
tr a[106:107],v5,26624
cv v119,v98,v99
mf v[36:39],a[120:123],v[236:239]
tr a[108:109],v5,28672
cv v116,v92,v93
mf v[36:39],a[124:127],v[248:251]
tr a[110:111],v5,30720
cv v117,v94,v95
mf v[32:35],a[124:127],v[244:247]
s_add_u32 s38, s40, 24576
buffer_store_dwordx4 v[60:63], v1, s[28:31], s38 offen nt
mf v[32:35],a[120:123],v[232:235]
s_add_u32 s38, s40, 8192
buffer_store_dwordx4 v[56:59], v1, s[28:31], s38 offen nt
mf v[32:35],a[116:119],v[220:223]
s_xor_b32 s40, s40, 262144
v_mul_f32 v40, v40, v26
v_mul_f32 v41, v41, v26
mf v[32:35],a[112:115],v[208:211]
wl
v_mul_f32 v42, v42, v26
v_mul_f32 v43, v43, v26
mz v[44:47],a[96:99],v[208:211],0
tr a[112:113],v5,0
mf v[44:47],a[100:103],v[220:223]
tr a[114:115],v5,2048
v_mul_f32 v36, v36, v25
mf v[44:47],a[104:107],v[232:235]
tr a[116:117],v5,4096
v_mul_f32 v37, v37, v25
mf v[44:47],a[108:111],v[244:247]
tr a[118:119],v5,6144
v_mul_f32 v38, v38, v25
mz v[48:51],a[108:111],v[248:251],0
tr a[120:121],v5,8192
v_mul_f32 v39, v39, v25
mf v[48:51],a[104:107],v[236:239]
tr a[122:123],v5,10240
v_mul_f32 v32, v32, v24
mf v[48:51],a[100:103],v[224:227]
tr a[124:125],v5,12288
v_mul_f32 v33, v33, v24
mf v[48:51],a[96:99],v[212:215]
tr a[126:127],v5,14336
v_mul_f32 v34, v34, v24
mz v[52:55],a[96:99],v[216:219],0
v_mul_f32 v35, v35, v24
mf v[52:55],a[100:103],v[228:231]
mf v[52:55],a[104:107],v[240:243]
mf v[52:55],a[108:111],v[252:255]
wl
mf v[52:55],a[124:127],v[204:207]
tr a[96:97],v16,0
mf v[52:55],a[120:123],v[192:195]
tr a[98:99],v16,2048
mf v[52:55],a[116:119],v[180:183]
tr a[100:101],v16,4096
mf v[52:55],a[112:115],v[168:171]
tr a[102:103],v16,6144
mf v[48:51],a[112:115],v[164:167]
tr a[104:105],v16,8192
v_mov_b32 v0, s41
mf v[48:51],a[116:119],v[176:179]
tr a[106:107],v16,10240
mf v[48:51],a[120:123],v[188:191]
tr a[108:109],v16,12288
mf v[48:51],a[124:127],v[200:203]
tr a[110:111],v16,14336
mf v[44:47],a[124:127],v[196:199]
s_waitcnt vmcnt(0)
buffer_store_dword v0, v17, s[28:31], 0 offen
mf v[44:47],a[120:123],v[184:187]
v_mul_f32 v52, v52, v26
v_mul_f32 v53, v53, v26
mf v[44:47],a[116:119],v[172:175]
v_mul_f32 v54, v54, v26
v_mul_f32 v55, v55, v26
mf v[44:47],a[112:115],v[160:163]
wl
mz v[56:59],a[96:99],v[160:163],0
tr a[112:113],v16,16384
mf v[56:59],a[100:103],v[172:175]
tr a[114:115],v16,18432
v_mul_f32 v48, v48, v25
mf v[56:59],a[104:107],v[184:187]
tr a[116:117],v16,20480
v_mul_f32 v49, v49, v25
mf v[56:59],a[108:111],v[196:199]
tr a[118:119],v16,22528
v_mul_f32 v50, v50, v25
mz v[60:63],a[108:111],v[200:203],0
tr a[120:121],v16,24576
v_mul_f32 v51, v51, v25
mf v[60:63],a[104:107],v[188:191]
tr a[122:123],v16,26624
v_mul_f32 v44, v44, v24
mf v[60:63],a[100:103],v[176:179]
tr a[124:125],v16,28672
v_mul_f32 v45, v45, v24
mf v[60:63],a[96:99],v[164:167]
tr a[126:127],v16,30720
v_mul_f32 v46, v46, v24
mz v[64:67],a[96:99],v[168:171],0
v_mul_f32 v47, v47, v24
mf v[64:67],a[100:103],v[180:183]
mf v[64:67],a[104:107],v[192:195]
mf v[64:67],a[108:111],v[204:207]
wl
mf v[64:67],a[124:127],v[252:255]
tr a[96:97],v6,16384
mf v[64:67],a[120:123],v[240:243]
tr a[98:99],v6,18432
mf v[64:67],a[116:119],v[228:231]
tr a[100:101],v6,20480
mf v[64:67],a[112:115],v[216:219]
tr a[102:103],v6,22528
mf v[60:63],a[112:115],v[212:215]
tr a[104:105],v6,24576
mf v[60:63],a[116:119],v[224:227]
tr a[106:107],v6,26624
mf v[60:63],a[120:123],v[236:239]
tr a[108:109],v6,28672
mf v[60:63],a[124:127],v[248:251]
tr a[110:111],v6,30720
mf v[56:59],a[124:127],v[244:247]
mf v[56:59],a[120:123],v[232:235]
v_mul_f32 v64, v64, v26
v_mul_f32 v65, v65, v26
mf v[56:59],a[116:119],v[220:223]
v_mul_f32 v66, v66, v26
v_mul_f32 v67, v67, v26
mf v[56:59],a[112:115],v[208:211]
wl
mz v[68:71],a[96:99],v[208:211],0
tr a[112:113],v6,0
mf v[68:71],a[100:103],v[220:223]
tr a[114:115],v6,2048
v_mul_f32 v60, v60, v25
mf v[68:71],a[104:107],v[232:235]
tr a[116:117],v6,4096
v_mul_f32 v61, v61, v25
mf v[68:71],a[108:111],v[244:247]
tr a[118:119],v6,6144
v_mul_f32 v62, v62, v25
mz v[72:75],a[108:111],v[248:251],0
tr a[120:121],v6,8192
v_mul_f32 v63, v63, v25
mf v[72:75],a[104:107],v[236:239]
tr a[122:123],v6,10240
v_mul_f32 v56, v56, v24
mf v[72:75],a[100:103],v[224:227]
tr a[124:125],v6,12288
v_mul_f32 v57, v57, v24
mf v[72:75],a[96:99],v[212:215]
tr a[126:127],v6,14336
v_mul_f32 v58, v58, v24
mz v[76:79],a[96:99],v[216:219],0
v_mul_f32 v59, v59, v24
mf v[76:79],a[100:103],v[228:231]
buffer_store_dwordx4 v[116:119], v2, s[92:95], s53 offen nt
mf v[76:79],a[104:107],v[240:243]
s_mov_b32 s53, s27
s_add_u32 s27, s27, 128
mf v[76:79],a[108:111],v[252:255]
wl
mf v[76:79],a[124:127],v[204:207]
s_waitcnt vmcnt(51)
s_barrier
mf v[76:79],a[120:123],v[192:195]
tr a[96:97],v15,32768
mf v[76:79],a[116:119],v[180:183]
tr a[98:99],v15,34816
mf v[76:79],a[112:115],v[168:171]
tr a[100:101],v15,36864
mf v[72:75],a[112:115],v[164:167]
tr a[102:103],v15,38912
mf v[72:75],a[116:119],v[176:179]
tr a[104:105],v15,40960
mf v[72:75],a[120:123],v[188:191]
tr a[106:107],v15,43008
mf v[72:75],a[124:127],v[200:203]
tr a[108:109],v15,45056
mf v[68:71],a[124:127],v[196:199]
tr a[110:111],v15,47104
mf v[68:71],a[120:123],v[184:187]
v_mul_f32 v76, v76, v26
v_mul_f32 v77, v77, v26
mf v[68:71],a[116:119],v[172:175]
v_mul_f32 v78, v78, v26
v_mul_f32 v79, v79, v26
mf v[68:71],a[112:115],v[160:163]
wl
mf v[32:35],a[96:99],v[80:83]
tr a[112:113],v15,49152
mf v[32:35],a[100:103],v[104:107]
tr a[114:115],v15,51200
v_mul_f32 v72, v72, v25
mf v[32:35],a[104:107],v[128:131]
tr a[116:117],v15,53248
v_mul_f32 v73, v73, v25
mf v[32:35],a[108:111],a[36:39]
tr a[118:119],v15,55296
v_mul_f32 v74, v74, v25
mf v[36:39],a[108:111],a[40:43]
tr a[120:121],v15,57344
v_mul_f32 v75, v75, v25
mf v[36:39],a[104:107],v[132:135]
tr a[122:123],v15,59392
v_mul_f32 v68, v68, v24
mf v[36:39],a[100:103],v[108:111]
tr a[124:125],v15,61440
buffer_load_dword v23, v4, s[28:31], 0 offen sc1
mf v[36:39],a[96:99],v[84:87]
tr a[126:127],v15,63488
v_mul_f32 v69, v69, v24
mf v[40:43],a[96:99],v[88:91]
v_mul_f32 v70, v70, v24
v_mul_f32 v71, v71, v24
mf v[40:43],a[100:103],v[112:115]
mf v[40:43],a[104:107],v[136:139]
mf v[40:43],a[108:111],a[44:47]
wl
mf v[40:43],a[124:127],a[92:95]
tr a[96:97],v5,49152
mf v[40:43],a[120:123],a[80:83]
tr a[98:99],v5,51200
mf v[40:43],a[116:119],a[68:71]
tr a[100:101],v5,53248
mf v[40:43],a[112:115],a[56:59]
tr a[102:103],v5,55296
mf v[36:39],a[112:115],a[52:55]
tr a[104:105],v5,57344
mf v[36:39],a[116:119],a[64:67]
tr a[106:107],v5,59392
mf v[36:39],a[120:123],a[76:79]
tr a[108:109],v5,61440
mf v[36:39],a[124:127],a[88:91]
tr a[110:111],v5,63488
mf v[32:35],a[124:127],a[84:87]
s_waitcnt vmcnt(0)
v_cmp_gt_u32 vcc, s41, v23
mf v[32:35],a[120:123],a[72:75]
v_mul_f32 v40, v40, v30
v_mul_f32 v41, v41, v30
mf v[32:35],a[116:119],a[60:63]
s_cbranch_vccnz Lspinfb_b
Lspunfb_b:
mf v[32:35],a[112:115],a[48:51]
s_add_u32 s72, s26, 4096
v_mul_f32 v42, v42, v30
wl
mf v[44:47],a[96:99],a[48:51]
tr a[112:113],v5,32768
v_mul_f32 v43, v43, v30
mf v[44:47],a[100:103],a[60:63]
tr a[114:115],v5,34816
cv v40,v40,v41
mf v[44:47],a[104:107],a[72:75]
tr a[116:117],v5,36864
cv v41,v42,v43
mf v[44:47],a[108:111],a[84:87]
tr a[118:119],v5,38912
v_mul_f32 v36, v36, v29
mf v[48:51],a[108:111],a[88:91]
tr a[120:121],v5,40960
v_mul_f32 v37, v37, v29
mf v[48:51],a[104:107],a[76:79]
tr a[122:123],v5,43008
v_mul_f32 v38, v38, v29
mf v[48:51],a[100:103],a[64:67]
tr a[124:125],v5,45056
v_mul_f32 v39, v39, v29
mf v[48:51],a[96:99],a[52:55]
tr a[126:127],v5,47104
cv v36,v36,v37
mf v[52:55],a[96:99],a[56:59]
buffer_load_dwordx2 a[162:163], v1, s[28:31], s26 offen offset:8 sc1
mf v[52:55],a[100:103],a[68:71]
cv v37,v38,v39
v_mul_f32 v32, v32, v28
mf v[52:55],a[104:107],a[80:83]
buffer_load_dwordx4 a[164:167], v1, s[28:31], s26 offen offset:1024 sc1
mf v[52:55],a[108:111],a[92:95]
wl
v_mul_f32 v33, v33, v28
v_mul_f32 v34, v34, v28
mf v[52:55],a[124:127],a[44:47]
tr a[96:97],v16,32768
v_mul_f32 v35, v35, v28
mf v[52:55],a[120:123],v[136:139]
tr a[98:99],v16,34816
cv v32,v32,v33
mf v[52:55],a[116:119],v[112:115]
tr a[100:101],v16,36864
cv v33,v34,v35
mf v[52:55],a[112:115],v[88:91]
tr a[102:103],v16,38912
mf v[48:51],a[112:115],v[84:87]
tr a[104:105],v16,40960
mf v[48:51],a[116:119],v[108:111]
tr a[106:107],v16,43008
mf v[48:51],a[120:123],v[132:135]
tr a[108:109],v16,45056
mf v[48:51],a[124:127],a[40:43]
tr a[110:111],v16,47104
mf v[44:47],a[124:127],a[36:39]
buffer_load_dwordx4 a[168:171], v1, s[28:31], s26 offen offset:2048 sc1
mf v[44:47],a[120:123],v[128:131]
v_mul_f32 v52, v52, v30
v_mul_f32 v53, v53, v30
mf v[44:47],a[116:119],v[104:107]
buffer_load_dwordx4 a[172:175], v1, s[28:31], s26 offen offset:3072 sc1
mf v[44:47],a[112:115],v[80:83]
wl
v_mul_f32 v54, v54, v30
v_mul_f32 v55, v55, v30
mf v[56:59],a[96:99],v[80:83]
tr a[112:113],v16,49152
cv v42,v52,v53
mf v[56:59],a[100:103],v[104:107]
tr a[114:115],v16,51200
cv v43,v54,v55
mf v[56:59],a[104:107],v[128:131]
tr a[116:117],v16,53248
v_mul_f32 v48, v48, v29
mf v[56:59],a[108:111],a[36:39]
tr a[118:119],v16,55296
v_mul_f32 v49, v49, v29
mf v[60:63],a[108:111],a[40:43]
tr a[120:121],v16,57344
v_mul_f32 v50, v50, v29
mf v[60:63],a[104:107],v[132:135]
tr a[122:123],v16,59392
v_mul_f32 v51, v51, v29
mf v[60:63],a[100:103],v[108:111]
tr a[124:125],v16,61440
cv v38,v48,v49
mf v[60:63],a[96:99],v[84:87]
tr a[126:127],v16,63488
cv v39,v50,v51
mf v[64:67],a[96:99],v[88:91]
buffer_load_dwordx4 a[176:179], v1, s[28:31], s72 offen offset:0 sc1
mf v[64:67],a[100:103],v[112:115]
s_add_u32 s38, s40, 32768
buffer_store_dwordx4 v[40:43], v1, s[28:31], s38 offen nt
mf v[64:67],a[104:107],v[136:139]
buffer_load_dwordx4 a[180:183], v1, s[28:31], s72 offen offset:1024 sc1
mf v[64:67],a[108:111],a[44:47]
wl
v_mul_f32 v44, v44, v28
v_mul_f32 v45, v45, v28
mf v[64:67],a[124:127],a[92:95]
tr a[96:97],v6,49152
v_mul_f32 v46, v46, v28
mf v[64:67],a[120:123],a[80:83]
tr a[98:99],v6,51200
v_mul_f32 v47, v47, v28
mf v[64:67],a[116:119],a[68:71]
tr a[100:101],v6,53248
cv v34,v44,v45
mf v[64:67],a[112:115],a[56:59]
tr a[102:103],v6,55296
cv v35,v46,v47
mf v[60:63],a[112:115],a[52:55]
tr a[104:105],v6,57344
mf v[60:63],a[116:119],a[64:67]
tr a[106:107],v6,59392
mf v[60:63],a[120:123],a[76:79]
tr a[108:109],v6,61440
mf v[60:63],a[124:127],a[88:91]
tr a[110:111],v6,63488
mf v[56:59],a[124:127],a[84:87]
buffer_load_dwordx4 a[184:187], v1, s[28:31], s72 offen offset:2048 sc1
mf v[56:59],a[120:123],a[72:75]
s_add_u32 s38, s40, 16384
buffer_store_dwordx4 v[36:39], v1, s[28:31], s38 offen nt
mf v[56:59],a[116:119],a[60:63]
buffer_load_dwordx4 a[188:191], v1, s[28:31], s72 offen offset:3072 sc1
mf v[56:59],a[112:115],a[48:51]
wl
v_mul_f32 v64, v64, v30
v_mul_f32 v65, v65, v30
mf v[68:71],a[96:99],a[48:51]
tr a[112:113],v6,32768
buffer_load_dwordx2 a[192:193], v1, s[28:31], s26 offen offset:0 sc1
s_xor_b32 s26, s26, 262144
mf v[68:71],a[100:103],a[60:63]
tr a[114:115],v6,34816
v_mul_f32 v66, v66, v30
mf v[68:71],a[104:107],a[72:75]
tr a[116:117],v6,36864
v_mul_f32 v67, v67, v30
mf v[68:71],a[108:111],a[84:87]
tr a[118:119],v6,38912
cv v64,v64,v65
mf v[72:75],a[108:111],a[88:91]
tr a[120:121],v6,40960
cv v65,v66,v67
mf v[72:75],a[104:107],a[76:79]
tr a[122:123],v6,43008
v_mul_f32 v60, v60, v29
mf v[72:75],a[100:103],a[64:67]
tr a[124:125],v6,45056
v_mul_f32 v61, v61, v29
mf v[72:75],a[96:99],a[52:55]
tr a[126:127],v6,47104
v_mul_f32 v62, v62, v29
mf v[76:79],a[96:99],a[56:59]
s_add_u32 s38, s40, 0
buffer_store_dwordx4 v[32:35], v1, s[28:31], s38 offen nt
mf v[76:79],a[100:103],a[68:71]
v_mul_f32 v63, v63, v29
cv v60,v60,v61
mf v[76:79],a[104:107],a[80:83]
cv v61,v62,v63
v_mul_f32 v56, v56, v28
mf v[76:79],a[108:111],a[92:95]
wl
v_mul_f32 v57, v57, v28
v_mul_f32 v58, v58, v28
mf v[76:79],a[124:127],a[44:47]
v_mul_f32 v59, v59, v28
cv v56,v56,v57
mf v[76:79],a[120:123],v[136:139]
cv v57,v58,v59
mf v[76:79],a[116:119],v[112:115]
mf v[76:79],a[112:115],v[88:91]
mf v[72:75],a[112:115],v[84:87]
mf v[72:75],a[116:119],v[108:111]
mf v[72:75],a[120:123],v[132:135]
mf v[72:75],a[124:127],a[40:43]
mf v[68:71],a[124:127],a[36:39]
mf v[68:71],a[120:123],v[128:131]
s_add_u32 s41, s41, 1
s_nop 0
v_mul_f32 v76, v76, v30
v_mul_f32 v77, v77, v30
mf v[68:71],a[116:119],v[104:107]
s_waitcnt vmcnt(1)
v_mul_f32 v78, v78, v30
v_mul_f32 v79, v79, v30
mf v[68:71],a[112:115],v[80:83]
cv v66,v76,v77
cv v67,v78,v79
mz v[96:99],v[100:103],a[162:165],0
s_add_u32 s38, s40, 40960
buffer_store_dwordx4 v[64:67], v1, s[28:31], s38 offen nt
mf v[96:99],v[100:103],a[170:173]
v_mul_f32 v72, v72, v29
v_mul_f32 v73, v73, v29
mf v[96:99],v[100:103],a[178:181]
v_mul_f32 v74, v74, v29
v_mul_f32 v75, v75, v29
mf v[96:99],v[100:103],a[186:189]
cv v62,v72,v73
cv v63,v74,v75
mz v[92:95],v[100:103],a[166:169],0
s_add_u32 s38, s40, 24576
buffer_store_dwordx4 v[60:63], v1, s[28:31], s38 offen nt
mf v[92:95],v[100:103],a[174:177]
v_mul_f32 v68, v68, v28
v_mul_f32 v69, v69, v28
mf v[92:95],v[100:103],a[182:185]
v_mul_f32 v70, v70, v28
v_mul_f32 v71, v71, v28
mf v[92:95],v[100:103],a[190:193]
cv v58,v68,v69
cv v59,v70,v71
s_add_u32 s38, s40, 8192
buffer_store_dwordx4 v[56:59], v1, s[28:31], s38 offen nt
s_bfe_u32 s73, s26, 0x20010
s_lshl_b32 s73, s73, 2
s_add_u32 s73, s73, 2359296
v_and_b32 v4, 0x70, v1
v_add_u32 v4, s73, v4
cv v118,v96,v97
cv v119,v98,v99
cv v116,v92,v93
cv v117,v94,v95
v_mov_b32 v0, s41
s_waitcnt vmcnt(0)
buffer_store_dword v0, v17, s[28:31], 0 offen
buffer_load_dword v23, v4, s[28:31], 0 offen sc1
s_waitcnt vmcnt(0)
v_cmp_gt_u32 vcc, s41, v23
s_cbranch_vccnz Lspintf_b
Lspuntf_b:
s_add_u32 s72, s26, 4096
buffer_load_dwordx2 a[162:163], v1, s[28:31], s26 offen offset:8 sc1
buffer_load_dwordx4 a[164:167], v1, s[28:31], s26 offen offset:1024 sc1
buffer_load_dwordx4 a[168:171], v1, s[28:31], s26 offen offset:2048 sc1
buffer_load_dwordx4 a[172:175], v1, s[28:31], s26 offen offset:3072 sc1
buffer_load_dwordx4 a[176:179], v1, s[28:31], s72 offen offset:0 sc1
buffer_load_dwordx4 a[180:183], v1, s[28:31], s72 offen offset:1024 sc1
buffer_load_dwordx4 a[184:187], v1, s[28:31], s72 offen offset:2048 sc1
buffer_load_dwordx4 a[188:191], v1, s[28:31], s72 offen offset:3072 sc1
buffer_load_dwordx2 a[192:193], v1, s[28:31], s26 offen offset:0 sc1
s_xor_b32 s26, s26, 262144
buffer_store_dwordx4 v[116:119], v2, s[92:95], s53 offen nt
s_mov_b32 s53, s27
s_add_u32 s27, s27, 128
s_waitcnt vmcnt(1)
mz v[96:99],v[100:103],a[162:165],0
mf v[96:99],v[100:103],a[170:173]
mf v[96:99],v[100:103],a[178:181]
mf v[96:99],v[100:103],a[186:189]
mz v[92:95],v[100:103],a[166:169],0
mf v[92:95],v[100:103],a[174:177]
mf v[92:95],v[100:103],a[182:185]
mf v[92:95],v[100:103],a[190:193]
s_nop 3
cv v118,v96,v97
cv v119,v98,v99
s_nop 1
cv v116,v92,v93
cv v117,v94,v95
buffer_store_dwordx4 v[116:119], v2, s[92:95], s53 offen nt
s_endpgm
Loslow_b:
s_add_u32 s40, s40, 524288
s_add_u32 s26, s26, 524288
mz v[56:59],a[96:99],a[0:3],v[32:35]
ds_read_b128 a[112:115], v5 offset:18432
v_mov_b32 v21, v11
mf v[56:59],a[100:103],a[12:15]
ds_read_b128 a[116:119], v6 offset:18432
v_add_u32 v152, 6144, v3
mf v[56:59],a[104:107],a[24:27]
ds_read_b128 a[120:123], v5 offset:19456
v_add_u32 v153, 12288, v3
mf v[56:59],a[108:111],a[36:39]
ds_read_b128 a[124:127], v6 offset:19456
v_add_u32 v154, 18432, v3
mz v[60:63],a[108:111],a[40:43],v[36:39]
s_add_u32 s38, s68, 0
buffer_load_dword v20, v159, s[28:31], s38 offen
mf v[60:63],a[104:107],a[28:31]
s_add_u32 m0, s24, 0
v_permlane32_swap_b32 v11, v21
mf v[60:63],a[100:103],a[16:19]
s_add_u32 s39, s45, 0
buffer_load_dwordx4 v3, s[20:23], s39 offen  lds
mf v[60:63],a[96:99],a[4:7]
s_add_u32 m0, s24, 1024
v_add_f32 v11, v11, v21
v_mov_b32 v21, v11
mz v[64:67],a[96:99],a[8:11],v[40:43]
s_add_u32 s39, s45, 7168
buffer_load_dwordx4 v3, s[20:23], s39 offen  lds
mf v[64:67],a[100:103],a[20:23]
s_add_u32 m0, s24, 2048
v_permlane16_swap_b32 v11, v21
mf v[64:67],a[104:107],a[32:35]
s_add_u32 s39, s45, 14336
buffer_load_dwordx4 v3, s[20:23], s39 offen  lds
mf v[64:67],a[108:111],a[44:47]
wl
v_lshl_add_u32 v22, v1, 3, s3
v_add_f32 v11, v11, v21
mf v[64:67],a[124:127],a[92:95]
ds_read_b128 a[96:99], v5 offset:26624
v_min_u32 v22, L_end-L_main4, v22
mf v[64:67],a[120:123],a[80:83]
s_add_u32 m0, s24, 3072
ds_read_b128 a[100:103], v6 offset:26624
mf v[64:67],a[116:119],a[68:71]
ds_read_b128 a[104:107], v5 offset:27648
mf v[64:67],a[112:115],a[56:59]
ds_read_b128 a[108:111], v6 offset:27648
mf v[60:63],a[112:115],a[52:55]
s_add_u32 s39, s45, 21504
buffer_load_dwordx4 v3, s[20:23], s39 offen  lds
mf v[60:63],a[116:119],a[64:67]
v_rcp_f32 v11, v11
mf v[60:63],a[120:123],a[76:79]
v_mov_b32 v21, v12
mf v[60:63],a[124:127],a[88:91]
s_add_u32 s38, s68, 4096
buffer_load_dword v20, v159, s[28:31], s38 offen
mf v[56:59],a[124:127],a[84:87]
v_permlane32_swap_b32 v12, v21
mf v[56:59],a[120:123],a[72:75]
v_add_f32 v12, v12, v21
v_mov_b32 v21, v12
mf v[56:59],a[116:119],a[60:63]
v_exp_f32 v64, v64
mf v[56:59],a[112:115],a[48:51]
wl
v_exp_f32 v65, v65
mz v[68:71],a[96:99],a[48:51],v[32:35]
ds_read_b128 a[112:115], v5 offset:24576
global_load_dword v20, v22, s[58:59]
mf v[68:71],a[100:103],a[60:63]
ds_read_b128 a[116:119], v6 offset:24576
v_add_f32 v30, v64, v65
mf v[68:71],a[104:107],a[72:75]
ds_read_b128 a[120:123], v5 offset:25600
cv v64,v64,v65
mf v[68:71],a[108:111],a[84:87]
ds_read_b128 a[124:127], v6 offset:25600
mz v[72:75],a[108:111],a[88:91],v[36:39]
v_exp_f32 v66, v66
mf v[72:75],a[104:107],a[76:79]
v_exp_f32 v67, v67
mf v[72:75],a[100:103],a[64:67]
v_exp_f32 v60, v60
mf v[72:75],a[96:99],a[52:55]
s_add_u32 m0, s24, 16384
v_exp_f32 v61, v61
mz v[76:79],a[96:99],a[56:59],v[40:43]
v_exp_f32 v62, v62
mf v[76:79],a[100:103],a[68:71]
v_exp_f32 v63, v63
mf v[76:79],a[104:107],a[80:83]
v_exp_f32 v56, v56
mf v[76:79],a[108:111],a[92:95]
wl
v_exp_f32 v57, v57
mf v[76:79],a[124:127],a[44:47]
s_waitcnt vmcnt(30)
v_add_f32 v30, v66, v30
s_barrier
mf v[76:79],a[120:123],a[32:35]
tr a[96:97],v7,32768
v_add_f32 v30, v67, v30
mf v[76:79],a[116:119],a[20:23]
tr a[98:99],v7,40960
cv v65,v66,v67
mf v[76:79],a[112:115],a[8:11]
tr a[100:101],v8,32768
v_add_f32 v29, v60, v61
mf v[72:75],a[112:115],a[4:7]
tr a[102:103],v8,40960
cv v60,v60,v61
mf v[72:75],a[116:119],a[16:19]
tr a[104:105],v9,32768
v_add_f32 v29, v62, v29
mf v[72:75],a[120:123],a[28:31]
tr a[106:107],v9,40960
v_add_f32 v29, v63, v29
mf v[72:75],a[124:127],a[40:43]
s_add_u32 s38, s68, 8192
buffer_load_dword v20, v159, s[28:31], s38 offen
tr a[108:109],v10,32768
mf v[68:71],a[124:127],a[36:39]
tr a[110:111],v10,40960
cv v61,v62,v63
mf v[68:71],a[120:123],a[24:27]
s_add_u32 s39, s45, 114688
buffer_load_dwordx4 v3, s[20:23], s39 offen  lds
mf v[68:71],a[116:119],a[12:15]
s_add_u32 m0, s24, 17408
v_exp_f32 v58, v58
mf v[68:71],a[112:115],a[0:3]
wl
v_exp_f32 v59, v59
mf v[80:83],a[96:99],v[44:47]
tr a[112:113],v7,33792
v_add_f32 v28, v56, v57
mf v[84:87],a[96:99],v[48:51]
tr a[114:115],v7,41984
cv v56,v56,v57
mf v[88:91],a[96:99],v[52:55]
tr a[116:117],v8,33792
v_add_f32 v28, v58, v28
mf v[100:103],a[100:103],v[52:55]
tr a[118:119],v8,41984
v_add_f32 v28, v59, v28
mf v[96:99],a[100:103],v[48:51]
tr a[120:121],v9,33792
cv v57,v58,v59
mf v[92:95],a[100:103],v[44:47]
tr a[122:123],v9,41984
v_xor_b32 v5, 8, v15
mf v[104:107],a[104:107],v[44:47]
tr a[124:125],v10,33792
v_xor_b32 v6, 8, v16
mf v[108:111],a[104:107],v[48:51]
tr a[126:127],v10,41984
mf v[112:115],a[104:107],v[52:55]
s_add_u32 s39, s45, 121856
buffer_load_dwordx4 v3, s[20:23], s39 offen  lds
mf v[124:127],a[108:111],v[52:55]
s_add_u32 m0, s24, 18432
v_exp_f32 v76, v76
mf v[120:123],a[108:111],v[48:51]
s_add_u32 s39, s45, 129024
buffer_load_dwordx4 v3, s[20:23], s39 offen  lds
mf v[116:119],a[108:111],v[44:47]
wl
v_exp_f32 v77, v77
mf v[128:131],a[112:115],v[44:47]
tr a[96:97],v7,34816
v_add_f32 v30, v76, v30
mf v[132:135],a[112:115],v[48:51]
tr a[98:99],v7,43008
v_add_f32 v30, v77, v30
mf v[136:139],a[112:115],v[52:55]
s_add_u32 s38, s68, 12288
buffer_load_dword v20, v159, s[28:31], s38 offen
tr a[100:101],v8,34816
mf v[148:151],a[116:119],v[52:55]
tr a[102:103],v8,43008
cv v66,v76,v77
mf v[144:147],a[116:119],v[48:51]
s_add_u32 m0, s24, 19456
tr a[104:105],v9,34816
mf v[140:143],a[116:119],v[44:47]
tr a[106:107],v9,43008
mf a[128:131],a[120:123],v[44:47]
tr a[108:109],v10,34816
mf a[132:135],a[120:123],v[48:51]
tr a[110:111],v10,43008
mf a[136:139],a[120:123],v[52:55]
s_add_u32 s39, s45, 136192
buffer_load_dwordx4 v3, s[20:23], s39 offen  lds
mf a[148:151],a[124:127],v[52:55]
v_exp_f32 v78, v78
mf a[144:147],a[124:127],v[48:51]
v_exp_f32 v79, v79
mf a[140:143],a[124:127],v[44:47]
wl
v_exp_f32 v72, v72
mf a[152:155],a[96:99],v[44:47]
tr a[112:113],v7,35840
v_add_f32 v30, v78, v30
mf a[156:159],a[96:99],v[48:51]
tr a[114:115],v7,44032
v_add_f32 v30, v79, v30
mf a[160:163],a[96:99],v[52:55]
tr a[116:117],v8,35840
cv v67,v78,v79
mf a[172:175],a[100:103],v[52:55]
tr a[118:119],v8,44032
v_add_f32 v29, v72, v29
mf a[168:171],a[100:103],v[48:51]
tr a[120:121],v9,35840
mf a[164:167],a[100:103],v[44:47]
tr a[122:123],v9,44032
mf a[176:179],a[104:107],v[44:47]
tr a[124:125],v10,35840
v_exp_f32 v73, v73
v_exp_f32 v74, v74
v_exp_f32 v75, v75
v_exp_f32 v68, v68
v_exp_f32 v69, v69
v_exp_f32 v70, v70
v_exp_f32 v71, v71
mf a[180:183],a[104:107],v[48:51]
tr a[126:127],v10,44032
v_permlane16_swap_b32 v12, v21
v_add_f32 v12, v12, v21
v_rcp_f32 v12, v12
v_mov_b32 v21, v13
v_add_f32 v28, v68, v28
v_add_f32 v28, v69, v28
cv v58,v68,v69
v_add_f32 v28, v70, v28
v_add_f32 v28, v71, v28
cv v59,v70,v71
v_add_f32 v29, v73, v29
cv v62,v72,v73
v_add_f32 v29, v74, v29
v_add_f32 v29, v75, v29
cv v63,v74,v75
mf a[184:187],a[104:107],v[52:55]
s_add_u32 s38, s68, 16384
buffer_load_dword v20, v159, s[28:31], s38 offen
mf a[196:199],a[108:111],v[52:55]
v_permlane32_swap_b32 v13, v21
v_add_f32 v13, v13, v21
v_mov_b32 v21, v13
v_max3_f32 v0, v28, v29, v30
mf a[192:195],a[108:111],v[48:51]
s_add_u32 m0, s24, 32768
v_cmp_lt_f32 vcc, s36, v0
mf a[188:191],a[108:111],v[44:47]
wl
v_permlane16_swap_b32 v13, v21
v_add_f32 v13, v13, v21
v_rcp_f32 v13, v13
mf a[200:203],a[112:115],v[44:47]
s_cbranch_vccnz Lslow_ends15_b
Lret_ends15_b:
mf a[204:207],a[112:115],v[48:51]
s_waitcnt vmcnt(15)
v_add_f32 v24, v24, v28
s_barrier
mf a[208:211],a[112:115],v[52:55]
tr a[96:97],v7,49152
v_add_f32 v25, v25, v29
mf a[220:223],a[116:119],v[52:55]
tr a[98:99],v7,57344
v_add_f32 v26, v26, v30
mf a[216:219],a[116:119],v[48:51]
tr a[100:101],v8,49152
v_bfe_u32 v0, v1, 4, 4
mf a[212:215],a[116:119],v[44:47]
tr a[102:103],v8,57344
v_lshrrev_b32 v2, 8, v1
mf a[224:227],a[120:123],v[44:47]
tr a[104:105],v9,49152
v_mul_u32_u24 v0, 1792, v0
mf a[228:231],a[120:123],v[48:51]
tr a[106:107],v9,57344
v_lshl_add_u32 v2, v2, 4, v0
mf a[232:235],a[120:123],v[52:55]
tr a[108:109],v10,49152
v_bfe_u32 v0, v1, 4, 5
mf a[244:247],a[124:127],v[52:55]
tr a[110:111],v10,57344
s_add_u32 s43, s43, 16384
mf a[240:243],a[124:127],v[48:51]
s_add_u32 s39, s45, 229376
buffer_load_dwordx4 v3, s[20:23], s39 offen  lds
mf a[236:239],a[124:127],v[44:47]
s_add_u32 m0, s24, 33792
wl
v_lshlrev_b32 v0, 2, v0
mf v[80:83],a[96:99],v[56:59]
tr a[112:113],v7,50176
v_mov_b32 v29, v25
v_mov_b32 v28, v24
mf v[84:87],a[96:99],v[60:63]
tr a[114:115],v7,58368
v_mov_b32 v30, v26
mf v[88:91],a[96:99],v[64:67]
tr a[116:117],v8,50176
v_permlane32_swap_b32 v24, v28
mf v[92:95],a[100:103],v[56:59]
tr a[118:119],v8,58368
v_add_f32 v24, v24, v28
v_mov_b32 v28, v24
mf v[96:99],a[100:103],v[60:63]
tr a[120:121],v9,50176
v_permlane32_swap_b32 v25, v29
mf v[100:103],a[100:103],v[64:67]
s_add_u32 s38, s68, 20480
buffer_load_dword v20, v159, s[28:31], s38 offen
tr a[122:123],v9,58368
mf v[104:107],a[104:107],v[56:59]
tr a[124:125],v10,50176
v_add_f32 v25, v25, v29
v_mov_b32 v29, v25
mf v[108:111],a[104:107],v[60:63]
tr a[126:127],v10,58368
v_permlane32_swap_b32 v26, v30
mf v[112:115],a[104:107],v[64:67]
s_add_u32 s39, s45, 236544
buffer_load_dwordx4 v3, s[20:23], s39 offen  lds
v_add_f32 v26, v26, v30
mf v[116:119],a[108:111],v[56:59]
s_add_u32 m0, s24, 34816
v_permlane16_swap_b32 v24, v28
v_mov_b32 v30, v26
mf v[120:123],a[108:111],v[60:63]
s_add_u32 s39, s45, 243712
buffer_load_dwordx4 v3, s[20:23], s39 offen  lds
v_add_f32 v24, v24, v28
mf v[124:127],a[108:111],v[64:67]
s_add_u32 m0, s24, 35840
v_permlane16_swap_b32 v25, v29
wl
mf v[128:131],a[112:115],v[56:59]
s_add_u32 s39, s45, 250880
buffer_load_dwordx4 v3, s[20:23], s39 offen  lds
tr a[96:97],v7,51200
mf v[132:135],a[112:115],v[60:63]
tr a[98:99],v7,59392
cv v80,v80,v81
v_add_f32 v25, v25, v29
mf v[136:139],a[112:115],v[64:67]
tr a[100:101],v8,51200
v_permlane16_swap_b32 v26, v30
mf v[140:143],a[116:119],v[56:59]
tr a[102:103],v8,59392
cv v81,v82,v83
v_add_f32 v26, v26, v30
mf v[144:147],a[116:119],v[60:63]
tr a[104:105],v9,51200
v_rcp_f32 v28, v24
mf v[148:151],a[116:119],v[64:67]
tr a[106:107],v9,59392
cv v82,v92,v93
v_mul_f32 v24, v24, v11
mf a[128:131],a[120:123],v[56:59]
tr a[108:109],v10,51200
v_rcp_f32 v29, v25
mf a[132:135],a[120:123],v[60:63]
tr a[110:111],v10,59392
cv v83,v94,v95
v_mul_f32 v25, v25, v12
mf a[136:139],a[120:123],v[64:67]
s_mov_b32 s41, 0
v_rcp_f32 v30, v26
v_mul_f32 v26, v26, v13
mf a[140:143],a[124:127],v[56:59]
s_add_u32 s38, s68, 24576
buffer_load_dword v20, v159, s[28:31], s38 offen
cv v84,v84,v85
mf a[144:147],a[124:127],v[60:63]
s_add_u32 s51, s45, 128
cv v85,v86,v87
cv v86,v96,v97
cv v87,v98,v99
mf a[148:151],a[124:127],v[64:67]
wl
cv v88,v88,v89
cv v89,v90,v91
cv v90,v100,v101
mf a[152:155],a[96:99],v[56:59]
tr a[112:113],v7,52224
cv v91,v102,v103
cv v104,v104,v105
mf a[156:159],a[96:99],v[60:63]
tr a[114:115],v7,60416
cv v105,v106,v107
cv v106,v116,v117
mf a[160:163],a[96:99],v[64:67]
tr a[116:117],v8,52224
cv v107,v118,v119
cv v108,v108,v109
mf a[164:167],a[100:103],v[56:59]
tr a[118:119],v8,60416
cv v109,v110,v111
cv v110,v120,v121
mf a[168:171],a[100:103],v[60:63]
tr a[120:121],v9,52224
cv v111,v122,v123
cv v112,v112,v113
mf a[172:175],a[100:103],v[64:67]
tr a[122:123],v9,60416
cv v113,v114,v115
cv v114,v124,v125
mf a[176:179],a[104:107],v[56:59]
tr a[124:125],v10,52224
cv v115,v126,v127
cv v128,v128,v129
mf a[180:183],a[104:107],v[60:63]
tr a[126:127],v10,60416
cv v129,v130,v131
cv v130,v140,v141
mf a[184:187],a[104:107],v[64:67]
s_add_u32 s52, s45, 256
cv v131,v142,v143
cv v132,v132,v133
cv v133,v134,v135
mf a[188:191],a[108:111],v[56:59]
s_add_u32 m0, s24, 49152
cv v134,v144,v145
cv v135,v146,v147
cv v136,v136,v137
mf a[192:195],a[108:111],v[60:63]
cv v137,v138,v139
cv v138,v148,v149
cv v139,v150,v151
mf a[196:199],a[108:111],v[64:67]
wl
ar v21,a128
ar v22,a129
cv v21,v21,v22
mf a[200:203],a[112:115],v[56:59]
s_waitcnt vmcnt(15)
aw a36,v21
ar v21,a130
s_barrier
mf a[204:207],a[112:115],v[60:63]
tr a[96:97],v15,0
ar v22,a131
cv v21,v21,v22
mf a[208:211],a[112:115],v[64:67]
tr a[98:99],v15,2048
aw a37,v21
ar v21,a140
mf a[212:215],a[116:119],v[56:59]
tr a[100:101],v15,4096
ar v22,a141
cv v21,v21,v22
mf a[216:219],a[116:119],v[60:63]
tr a[102:103],v15,6144
aw a38,v21
ar v21,a142
mf a[220:223],a[116:119],v[64:67]
tr a[104:105],v15,8192
ar v22,a143
cv v21,v21,v22
mf a[224:227],a[120:123],v[56:59]
tr a[106:107],v15,10240
aw a39,v21
ar v21,a132
mf a[228:231],a[120:123],v[60:63]
tr a[108:109],v15,12288
ar v22,a133
cv v21,v21,v22
mf a[232:235],a[120:123],v[64:67]
s_add_u32 s38, s68, 28672
buffer_load_dword v20, v159, s[28:31], s38 offen
tr a[110:111],v15,14336
mf a[236:239],a[124:127],v[56:59]
s_add_u32 s39, s45, 344064
buffer_load_dwordx4 v3, s[20:23], s39 offen  lds
aw a40,v21
mf a[240:243],a[124:127],v[60:63]
s_add_u32 m0, s24, 50176
ar v21,a134
ar v22,a135
cv v21,v21,v22
mf a[244:247],a[124:127],v[64:67]
s_add_u32 s39, s45, 351232
buffer_load_dwordx4 v3, s[20:23], s39 offen  lds
wl
mz v[32:35],a[96:99],v[160:163],0
tr a[112:113],v5,0
aw a41,v21
ar v21,a144
mf v[32:35],a[100:103],v[172:175]
tr a[114:115],v5,2048
ar v22,a145
cv v21,v21,v22
mf v[32:35],a[104:107],v[184:187]
tr a[116:117],v5,4096
aw a42,v21
ar v21,a146
mf v[32:35],a[108:111],v[196:199]
tr a[118:119],v5,6144
ar v22,a147
cv v21,v21,v22
mz v[36:39],a[108:111],v[200:203],0
tr a[120:121],v5,8192
aw a43,v21
ar v21,a136
mf v[36:39],a[104:107],v[188:191]
tr a[122:123],v5,10240
ar v22,a137
cv v21,v21,v22
mf v[36:39],a[100:103],v[176:179]
tr a[124:125],v5,12288
aw a44,v21
ar v21,a138
mf v[36:39],a[96:99],v[164:167]
tr a[126:127],v5,14336
ar v22,a139
cv v21,v21,v22
mz v[40:43],a[96:99],v[168:171],0
s_add_u32 m0, s24, 51200
aw a45,v21
ar v21,a148
ar v22,a149
mf v[40:43],a[100:103],v[180:183]
s_add_u32 s39, s45, 358400
buffer_load_dwordx4 v3, s[20:23], s39 offen  lds
cv v21,v21,v22
mf v[40:43],a[104:107],v[192:195]
s_add_u32 m0, s24, 52224
aw a46,v21
ar v21,a150
ar v22,a151
mf v[40:43],a[108:111],v[204:207]
s_add_u32 s39, s45, 365568
buffer_load_dwordx4 v3, s[20:23], s39 offen  lds
wl
mz v[52:55],a[124:127],v[204:207],0
tr a[96:97],v16,0
cv v21,v21,v22
aw a47,v21
mf v[52:55],a[120:123],v[192:195]
tr a[98:99],v16,2048
ar v21,a152
ar v22,a153
mf v[52:55],a[116:119],v[180:183]
tr a[100:101],v16,4096
cv v21,v21,v22
aw a48,v21
mf v[52:55],a[112:115],v[168:171]
tr a[102:103],v16,6144
ar v21,a154
ar v22,a155
mz v[48:51],a[112:115],v[164:167],0
s_add_u32 s38, s68, 262144
buffer_load_dword v20, v159, s[28:31], s38 offen
tr a[104:105],v16,8192
mf v[48:51],a[116:119],v[176:179]
tr a[106:107],v16,10240
cv v21,v21,v22
aw a49,v21
mf v[48:51],a[120:123],v[188:191]
tr a[108:109],v16,12288
ar v21,a164
ar v22,a165
mf v[48:51],a[124:127],v[200:203]
tr a[110:111],v16,14336
cv v21,v21,v22
aw a50,v21
mz v[44:47],a[124:127],v[196:199],0
ar v21,a166
ar v22,a167
cv v21,v21,v22
mf v[44:47],a[120:123],v[184:187]
aw a51,v21
ar v21,a176
ar v22,a177
mf v[44:47],a[116:119],v[172:175]
cv v21,v21,v22
aw a60,v21
ar v21,a178
mf v[44:47],a[112:115],v[160:163]
wl
ar v22,a179
cv v21,v21,v22
aw a61,v21
mz v[56:59],a[96:99],v[160:163],0
tr a[112:113],v6,0
ar v21,a188
ar v22,a189
mf v[56:59],a[100:103],v[172:175]
tr a[114:115],v6,2048
cv v21,v21,v22
aw a62,v21
mf v[56:59],a[104:107],v[184:187]
tr a[116:117],v6,4096
ar v21,a190
ar v22,a191
mf v[56:59],a[108:111],v[196:199]
tr a[118:119],v6,6144
cv v21,v21,v22
aw a63,v21
mz v[60:63],a[108:111],v[200:203],0
tr a[120:121],v6,8192
ar v21,a200
ar v22,a201
mf v[60:63],a[104:107],v[188:191]
tr a[122:123],v6,10240
cv v21,v21,v22
aw a72,v21
mf v[60:63],a[100:103],v[176:179]
tr a[124:125],v6,12288
ar v21,a202
ar v22,a203
mf v[60:63],a[96:99],v[164:167]
tr a[126:127],v6,14336
cv v21,v21,v22
aw a73,v21
mz v[64:67],a[96:99],v[168:171],0
s_add_u32 s38, s68, 266240
buffer_load_dword v20, v159, s[28:31], s38 offen
ar v21,a212
mf v[64:67],a[100:103],v[180:183]
s_add_u32 m0, s25, 0
ar v22,a213
cv v21,v21,v22
aw a74,v21
mf v[64:67],a[104:107],v[192:195]
ar v21,a214
ar v22,a215
cv v21,v21,v22
mf v[64:67],a[108:111],v[204:207]
wl
aw a75,v21
ar v21,a224
ar v22,a225
mz v[76:79],a[124:127],v[204:207],0
s_waitcnt vmcnt(8)
cv v21,v21,v22
aw a84,v21
s_barrier
mf v[76:79],a[120:123],v[192:195]
tr a[96:97],v15,16384
ar v21,a226
ar v22,a227
mf v[76:79],a[116:119],v[180:183]
tr a[98:99],v15,18432
cv v21,v21,v22
aw a85,v21
mf v[76:79],a[112:115],v[168:171]
tr a[100:101],v15,20480
ar v21,a236
ar v22,a237
mz v[72:75],a[112:115],v[164:167],0
tr a[102:103],v15,22528
cv v21,v21,v22
aw a86,v21
mf v[72:75],a[116:119],v[176:179]
tr a[104:105],v15,24576
ar v21,a238
ar v22,a239
mf v[72:75],a[120:123],v[188:191]
tr a[106:107],v15,26624
cv v21,v21,v22
aw a87,v21
mf v[72:75],a[124:127],v[200:203]
tr a[108:109],v15,28672
ar v21,a156
ar v22,a157
mz v[68:71],a[124:127],v[196:199],0
tr a[110:111],v15,30720
cv v21,v21,v22
aw a52,v21
mf v[68:71],a[120:123],v[184:187]
s_add_u32 s39, s51, 0
buffer_load_dwordx4 v3, s[20:23], s39 offen  lds
ar v21,a158
mf v[68:71],a[116:119],v[172:175]
s_add_u32 m0, s25, 1024
ar v22,a159
cv v21,v21,v22
aw a53,v21
mf v[68:71],a[112:115],v[160:163]
s_add_u32 s39, s51, 7168
buffer_load_dwordx4 v3, s[20:23], s39 offen  lds
wl
mf v[32:35],a[96:99],v[208:211]
tr a[112:113],v5,16384
ar v21,a168
ar v22,a169
mf v[32:35],a[100:103],v[220:223]
tr a[114:115],v5,18432
cv v21,v21,v22
aw a54,v21
mf v[32:35],a[104:107],v[232:235]
tr a[116:117],v5,20480
ar v21,a170
ar v22,a171
mf v[32:35],a[108:111],v[244:247]
tr a[118:119],v5,22528
cv v21,v21,v22
aw a55,v21
mf v[36:39],a[108:111],v[248:251]
tr a[120:121],v5,24576
ar v21,a180
ar v22,a181
mf v[36:39],a[104:107],v[236:239]
tr a[122:123],v5,26624
cv v21,v21,v22
aw a64,v21
mf v[36:39],a[100:103],v[224:227]
tr a[124:125],v5,28672
ar v21,a182
ar v22,a183
mf v[36:39],a[96:99],v[212:215]
s_add_u32 s38, s68, 270336
buffer_load_dword v20, v159, s[28:31], s38 offen
tr a[126:127],v5,30720
mf v[40:43],a[96:99],v[216:219]
s_add_u32 m0, s25, 2048
cv v21,v21,v22
aw a65,v21
ar v21,a192
mf v[40:43],a[100:103],v[228:231]
s_add_u32 s39, s51, 14336
buffer_load_dwordx4 v3, s[20:23], s39 offen  lds
v_mul_f32 v32, v32, v24
mf v[40:43],a[104:107],v[240:243]
s_add_u32 m0, s25, 3072
v_mul_f32 v33, v33, v24
v_mul_f32 v34, v34, v24
v_mul_f32 v35, v35, v24
mf v[40:43],a[108:111],v[252:255]
s_add_u32 s39, s51, 21504
buffer_load_dwordx4 v3, s[20:23], s39 offen  lds
wl
mf v[52:55],a[124:127],v[252:255]
tr a[96:97],v16,16384
ar v22,a193
cv v21,v21,v22
mf v[52:55],a[120:123],v[240:243]
tr a[98:99],v16,18432
v_mul_f32 v36, v36, v25
v_mul_f32 v37, v37, v25
mf v[52:55],a[116:119],v[228:231]
tr a[100:101],v16,20480
v_mul_f32 v38, v38, v25
v_mul_f32 v39, v39, v25
mf v[52:55],a[112:115],v[216:219]
tr a[102:103],v16,22528
aw a66,v21
ar v21,a194
mf v[48:51],a[112:115],v[212:215]
tr a[104:105],v16,24576
ar v22,a195
cv v21,v21,v22
mf v[48:51],a[116:119],v[224:227]
tr a[106:107],v16,26624
v_mul_f32 v40, v40, v26
v_mul_f32 v41, v41, v26
mf v[48:51],a[120:123],v[236:239]
tr a[108:109],v16,28672
v_mul_f32 v42, v42, v26
v_mul_f32 v43, v43, v26
mf v[48:51],a[124:127],v[248:251]
tr a[110:111],v16,30720
aw a67,v21
ar v21,a204
mf v[44:47],a[124:127],v[244:247]
s_add_u32 m0, s25, 16384
ar v22,a205
cv v21,v21,v22
aw a76,v21
mf v[44:47],a[120:123],v[232:235]
s_add_u32 s39, s51, 114688
buffer_load_dwordx4 v3, s[20:23], s39 offen  lds
v_mul_f32 v52, v52, v26
mf v[44:47],a[116:119],v[220:223]
s_add_u32 s38, s68, 274432
buffer_load_dword v20, v159, s[28:31], s38 offen
v_mul_f32 v53, v53, v26
mf v[44:47],a[112:115],v[208:211]
wl
ar v21,a206
v_mul_f32 v54, v54, v26
v_mul_f32 v55, v55, v26
mf v[56:59],a[96:99],v[208:211]
tr a[112:113],v6,16384
ar v22,a207
cv v21,v21,v22
mf v[56:59],a[100:103],v[220:223]
tr a[114:115],v6,18432
v_mul_f32 v48, v48, v25
v_mul_f32 v49, v49, v25
mf v[56:59],a[104:107],v[232:235]
tr a[116:117],v6,20480
v_mul_f32 v50, v50, v25
v_mul_f32 v51, v51, v25
mf v[56:59],a[108:111],v[244:247]
tr a[118:119],v6,22528
aw a77,v21
ar v21,a216
mf v[60:63],a[108:111],v[248:251]
tr a[120:121],v6,24576
ar v22,a217
cv v21,v21,v22
mf v[60:63],a[104:107],v[236:239]
tr a[122:123],v6,26624
v_mul_f32 v44, v44, v24
v_mul_f32 v45, v45, v24
mf v[60:63],a[100:103],v[224:227]
tr a[124:125],v6,28672
v_mul_f32 v46, v46, v24
v_mul_f32 v47, v47, v24
mf v[60:63],a[96:99],v[212:215]
tr a[126:127],v6,30720
aw a78,v21
ar v21,a218
mf v[64:67],a[96:99],v[216:219]
s_add_u32 m0, s25, 17408
ar v22,a219
cv v21,v21,v22
aw a79,v21
mf v[64:67],a[100:103],v[228:231]
s_add_u32 s39, s51, 121856
buffer_load_dwordx4 v3, s[20:23], s39 offen  lds
v_mul_f32 v56, v56, v24
mf v[64:67],a[104:107],v[240:243]
s_add_u32 m0, s25, 18432
v_mul_f32 v57, v57, v24
v_mul_f32 v58, v58, v24
v_mul_f32 v59, v59, v24
mf v[64:67],a[108:111],v[252:255]
s_add_u32 s39, s51, 129024
buffer_load_dwordx4 v3, s[20:23], s39 offen  lds
wl
mf v[76:79],a[124:127],v[252:255]
tr a[96:97],v15,32768
ar v21,a228
ar v22,a229
mf v[76:79],a[120:123],v[240:243]
tr a[98:99],v15,34816
v_mul_f32 v60, v60, v25
v_mul_f32 v61, v61, v25
mf v[76:79],a[116:119],v[228:231]
tr a[100:101],v15,36864
v_mul_f32 v62, v62, v25
v_mul_f32 v63, v63, v25
mf v[76:79],a[112:115],v[216:219]
tr a[102:103],v15,38912
cv v21,v21,v22
aw a88,v21
mf v[72:75],a[112:115],v[212:215]
s_add_u32 m0, s25, 19456
tr a[104:105],v15,40960
ar v21,a230
mf v[72:75],a[116:119],v[224:227]
s_add_u32 s39, s51, 136192
buffer_load_dwordx4 v3, s[20:23], s39 offen  lds
tr a[106:107],v15,43008
mf v[72:75],a[120:123],v[236:239]
tr a[108:109],v15,45056
v_mul_f32 v64, v64, v26
v_mul_f32 v65, v65, v26
mf v[72:75],a[124:127],v[248:251]
tr a[110:111],v15,47104
v_mul_f32 v66, v66, v26
v_mul_f32 v67, v67, v26
mf v[68:71],a[124:127],v[244:247]
s_add_u32 s38, s68, 278528
buffer_load_dword v20, v159, s[28:31], s38 offen
ar v22,a231
mf v[68:71],a[120:123],v[232:235]
s_add_u32 m0, s25, 32768
v_mul_f32 v76, v76, v26
v_mul_f32 v77, v77, v26
v_mul_f32 v78, v78, v26
mf v[68:71],a[116:119],v[220:223]
s_add_u32 s39, s51, 229376
buffer_load_dwordx4 v3, s[20:23], s39 offen  lds
v_mul_f32 v79, v79, v26
mf v[68:71],a[112:115],v[208:211]
wl
cv v21,v21,v22
aw a89,v21
ar v21,a240
mf v[32:35],a[96:99],v[80:83]
tr a[112:113],v5,32768
ar v22,a241
cv v21,v21,v22
mf v[32:35],a[100:103],v[104:107]
tr a[114:115],v5,34816
v_mul_f32 v72, v72, v25
v_mul_f32 v73, v73, v25
mf v[32:35],a[104:107],v[128:131]
tr a[116:117],v5,36864
v_mul_f32 v74, v74, v25
v_mul_f32 v75, v75, v25
mf v[32:35],a[108:111],a[36:39]
tr a[118:119],v5,38912
aw a90,v21
ar v21,a242
mf v[36:39],a[108:111],a[40:43]
tr a[120:121],v5,40960
ar v22,a243
cv v21,v21,v22
mf v[36:39],a[104:107],v[132:135]
tr a[122:123],v5,43008
v_mul_f32 v68, v68, v24
v_mul_f32 v69, v69, v24
mf v[36:39],a[100:103],v[108:111]
tr a[124:125],v5,45056
v_mul_f32 v70, v70, v24
v_mul_f32 v71, v71, v24
mf v[36:39],a[96:99],v[84:87]
tr a[126:127],v5,47104
aw a91,v21
ar v21,a160
mf v[40:43],a[96:99],v[88:91]
s_add_u32 m0, s25, 33792
ar v22,a161
cv v21,v21,v22
aw a56,v21
mf v[40:43],a[100:103],v[112:115]
s_add_u32 s39, s51, 236544
buffer_load_dwordx4 v3, s[20:23], s39 offen  lds
ar v21,a162
mf v[40:43],a[104:107],v[136:139]
s_add_u32 m0, s25, 34816
ar v22,a163
cv v21,v21,v22
aw a57,v21
mf v[40:43],a[108:111],a[44:47]
s_add_u32 s39, s51, 243712
buffer_load_dwordx4 v3, s[20:23], s39 offen  lds
wl
mf v[52:55],a[124:127],a[44:47]
tr a[96:97],v16,32768
ar v21,a172
ar v22,a173
mf v[52:55],a[120:123],v[136:139]
tr a[98:99],v16,34816
cv v21,v21,v22
aw a58,v21
mf v[52:55],a[116:119],v[112:115]
tr a[100:101],v16,36864
ar v21,a174
ar v22,a175
mf v[52:55],a[112:115],v[88:91]
tr a[102:103],v16,38912
cv v21,v21,v22
aw a59,v21
mf v[48:51],a[112:115],v[84:87]
tr a[104:105],v16,40960
ar v21,a184
ar v22,a185
mf v[48:51],a[116:119],v[108:111]
s_add_u32 s38, s68, 282624
buffer_load_dword v20, v159, s[28:31], s38 offen
tr a[106:107],v16,43008
mf v[48:51],a[120:123],v[132:135]
tr a[108:109],v16,45056
cv v21,v21,v22
aw a68,v21
mf v[48:51],a[124:127],a[40:43]
tr a[110:111],v16,47104
ar v21,a186
ar v22,a187
mf v[44:47],a[124:127],a[36:39]
s_add_u32 m0, s25, 35840
cv v21,v21,v22
aw a69,v21
ar v21,a196
mf v[44:47],a[120:123],v[128:131]
s_add_u32 s39, s51, 250880
buffer_load_dwordx4 v3, s[20:23], s39 offen  lds
ar v22,a197
mf v[44:47],a[116:119],v[104:107]
s_add_u32 m0, s25, 49152
cv v21,v21,v22
aw a70,v21
ar v21,a198
mf v[44:47],a[112:115],v[80:83]
s_add_u32 s39, s51, 344064
buffer_load_dwordx4 v3, s[20:23], s39 offen  lds
wl
mf v[56:59],a[96:99],v[80:83]
tr a[112:113],v6,32768
ar v22,a199
cv v21,v21,v22
mf v[56:59],a[100:103],v[104:107]
tr a[114:115],v6,34816
aw a71,v21
ar v21,a208
mf v[56:59],a[104:107],v[128:131]
tr a[116:117],v6,36864
ar v22,a209
cv v21,v21,v22
mf v[56:59],a[108:111],a[36:39]
tr a[118:119],v6,38912
aw a80,v21
ar v21,a210
mf v[60:63],a[108:111],a[40:43]
tr a[120:121],v6,40960
ar v22,a211
cv v21,v21,v22
mf v[60:63],a[104:107],v[132:135]
tr a[122:123],v6,43008
aw a81,v21
ar v21,a220
mf v[60:63],a[100:103],v[108:111]
tr a[124:125],v6,45056
ar v22,a221
cv v21,v21,v22
mf v[60:63],a[96:99],v[84:87]
tr a[126:127],v6,47104
aw a82,v21
ar v21,a222
mf v[64:67],a[96:99],v[88:91]
s_add_u32 m0, s25, 50176
ar v22,a223
cv v21,v21,v22
aw a83,v21
mf v[64:67],a[100:103],v[112:115]
s_add_u32 s39, s51, 351232
buffer_load_dwordx4 v3, s[20:23], s39 offen  lds
ar v21,a232
mf v[64:67],a[104:107],v[136:139]
s_add_u32 s38, s68, 286720
buffer_load_dword v20, v159, s[28:31], s38 offen
ar v22,a233
mf v[64:67],a[108:111],a[44:47]
wl
cv v21,v21,v22
aw a92,v21
ar v21,a234
mf v[76:79],a[124:127],a[44:47]
s_waitcnt vmcnt(21)
ar v22,a235
s_barrier
mf v[76:79],a[120:123],v[136:139]
tr a[96:97],v15,49152
cv v21,v21,v22
mf v[76:79],a[116:119],v[112:115]
tr a[98:99],v15,51200
aw a93,v21
mf v[76:79],a[112:115],v[88:91]
s_add_u32 m0, s25, 51200
tr a[100:101],v15,53248
mf v[72:75],a[112:115],v[84:87]
s_add_u32 s39, s51, 358400
buffer_load_dwordx4 v3, s[20:23], s39 offen  lds
s_add_u32 m0, s25, 52224
tr a[102:103],v15,55296
mf v[72:75],a[116:119],v[108:111]
s_add_u32 s39, s51, 365568
buffer_load_dwordx4 v3, s[20:23], s39 offen  lds
tr a[104:105],v15,57344
mf v[72:75],a[120:123],v[132:135]
tr a[106:107],v15,59392
ar v21,a244
mf v[72:75],a[124:127],a[40:43]
tr a[108:109],v15,61440
ar v22,a245
mf v[68:71],a[124:127],a[36:39]
tr a[110:111],v15,63488
cv v21,v21,v22
mf v[68:71],a[120:123],v[128:131]
s_add_u32 m0, s24, 0
aw a94,v21
ar v21,a246
mf v[68:71],a[116:119],v[104:107]
s_add_u32 s39, s52, 0
buffer_load_dwordx4 v3, s[20:23], s39 offen  lds
mf v[68:71],a[112:115],v[80:83]
wl
ar v22,a247
cv v21,v21,v22
mf v[32:35],a[96:99],a[48:51]
tr a[112:113],v5,49152
aw a95,v21
mf v[32:35],a[100:103],a[60:63]
tr a[114:115],v5,51200
v_add_u32 v4, 2359296, v0
mf v[32:35],a[104:107],a[72:75]
s_add_u32 m0, s24, 1024
tr a[116:117],v5,53248
mf v[32:35],a[108:111],a[84:87]
tr a[118:119],v5,55296
mf v[36:39],a[108:111],a[88:91]
tr a[120:121],v5,57344
mf v[36:39],a[104:107],a[76:79]
tr a[122:123],v5,59392
mf v[36:39],a[100:103],a[64:67]
tr a[124:125],v5,61440
mf v[36:39],a[96:99],a[52:55]
tr a[126:127],v5,63488
mf v[40:43],a[96:99],a[56:59]
s_add_u32 s38, s68, 290816
buffer_load_dword v20, v159, s[28:31], s38 offen
mf v[40:43],a[100:103],a[68:71]
s_add_u32 s39, s52, 7168
buffer_load_dwordx4 v3, s[20:23], s39 offen  lds
mf v[40:43],a[104:107],a[80:83]
s_add_u32 m0, s24, 2048
v_mul_f32 v32, v32, v28
v_mul_f32 v33, v33, v28
mf v[40:43],a[108:111],a[92:95]
wl
v_mul_f32 v34, v34, v28
v_mul_f32 v35, v35, v28
mf v[52:55],a[124:127],a[92:95]
tr a[96:97],v16,49152
cv v32,v32,v33
mf v[52:55],a[120:123],a[80:83]
tr a[98:99],v16,51200
cv v33,v34,v35
mf v[52:55],a[116:119],a[68:71]
tr a[100:101],v16,53248
v_mul_f32 v36, v36, v29
mf v[52:55],a[112:115],a[56:59]
tr a[102:103],v16,55296
v_mul_f32 v37, v37, v29
mf v[48:51],a[112:115],a[52:55]
tr a[104:105],v16,57344
v_mul_f32 v38, v38, v29
mf v[48:51],a[116:119],a[64:67]
tr a[106:107],v16,59392
v_mul_f32 v39, v39, v29
mf v[48:51],a[120:123],a[76:79]
tr a[108:109],v16,61440
cv v36,v36,v37
mf v[48:51],a[124:127],a[88:91]
tr a[110:111],v16,63488
cv v37,v38,v39
mf v[44:47],a[124:127],a[84:87]
s_add_u32 s39, s52, 14336
buffer_load_dwordx4 v3, s[20:23], s39 offen  lds
mf v[44:47],a[120:123],a[72:75]
s_add_u32 m0, s24, 3072
v_mul_f32 v40, v40, v30
v_mul_f32 v41, v41, v30
mf v[44:47],a[116:119],a[60:63]
s_add_u32 s39, s52, 21504
buffer_load_dwordx4 v3, s[20:23], s39 offen  lds
mf v[44:47],a[112:115],a[48:51]
wl
v_mul_f32 v42, v42, v30
v_mul_f32 v43, v43, v30
mf v[56:59],a[96:99],a[48:51]
tr a[112:113],v6,49152
cv v40,v40,v41
mf v[56:59],a[100:103],a[60:63]
tr a[114:115],v6,51200
cv v41,v42,v43
mf v[56:59],a[104:107],a[72:75]
tr a[116:117],v6,53248
v_mul_f32 v52, v52, v30
mf v[56:59],a[108:111],a[84:87]
tr a[118:119],v6,55296
v_mul_f32 v53, v53, v30
mf v[60:63],a[108:111],a[88:91]
tr a[120:121],v6,57344
v_mul_f32 v54, v54, v30
mf v[60:63],a[104:107],a[76:79]
tr a[122:123],v6,59392
v_mul_f32 v55, v55, v30
mf v[60:63],a[100:103],a[64:67]
tr a[124:125],v6,61440
cv v42,v52,v53
mf v[60:63],a[96:99],a[52:55]
tr a[126:127],v6,63488
cv v43,v54,v55
mf v[64:67],a[96:99],a[56:59]
s_add_u32 s38, s40, 32768
buffer_store_dwordx4 v[40:43], v1, s[28:31], s38 offen sc1
mf v[64:67],a[100:103],a[68:71]
s_add_u32 m0, s24, 16384
v_mul_f32 v48, v48, v29
v_mul_f32 v49, v49, v29
mf v[64:67],a[104:107],a[80:83]
s_add_u32 s39, s52, 114688
buffer_load_dwordx4 v3, s[20:23], s39 offen  lds
mf v[64:67],a[108:111],a[92:95]
wl
v_mul_f32 v50, v50, v29
v_mul_f32 v51, v51, v29
mf v[76:79],a[124:127],a[92:95]
s_waitcnt vmcnt(18)
cv v38,v48,v49
s_barrier
mf v[76:79],a[120:123],a[80:83]
s_add_u32 m0, s24, 17408
cv v39,v50,v51
v_xor_b32 v15, 0x10000, v15
mf v[76:79],a[116:119],a[68:71]
tr a[96:97],v15,0
v_mul_f32 v44, v44, v28
mf v[76:79],a[112:115],a[56:59]
s_add_u32 s39, s52, 121856
buffer_load_dwordx4 v3, s[20:23], s39 offen  lds
s_add_u32 m0, s24, 18432
tr a[98:99],v15,2048
mf v[72:75],a[112:115],a[52:55]
s_add_u32 s39, s52, 129024
buffer_load_dwordx4 v3, s[20:23], s39 offen  lds
s_add_u32 m0, s24, 19456
tr a[100:101],v15,4096
mf v[72:75],a[116:119],a[64:67]
s_add_u32 s39, s52, 136192
buffer_load_dwordx4 v3, s[20:23], s39 offen  lds
tr a[102:103],v15,6144
mf v[72:75],a[120:123],a[76:79]
tr a[104:105],v15,8192
v_mul_f32 v45, v45, v28
mf v[72:75],a[124:127],a[88:91]
tr a[106:107],v15,10240
v_mul_f32 v46, v46, v28
mf v[68:71],a[124:127],a[84:87]
tr a[108:109],v15,12288
v_mul_f32 v47, v47, v28
mf v[68:71],a[120:123],a[72:75]
tr a[110:111],v15,14336
cv v34,v44,v45
mf v[68:71],a[116:119],a[60:63]
s_mov_b32 s45, s51
s_mov_b32 s51, s52
s_xor_b32 s24, s24, 0x10000
s_xor_b32 s25, s25, 0x10000
s_add_u32 s38, s40, 16384
buffer_store_dwordx4 v[36:39], v1, s[28:31], s38 offen sc1
cv v35,v46,v47
v_mul_f32 v56, v56, v28
v_mul_f32 v57, v57, v28
v_mul_f32 v58, v58, v28
v_mul_f32 v59, v59, v28
cv v56,v56,v57
cv v57,v58,v59
v_mul_f32 v60, v60, v29
v_mul_f32 v61, v61, v29
v_mul_f32 v62, v62, v29
v_mul_f32 v63, v63, v29
cv v60,v60,v61
cv v61,v62,v63
v_mul_f32 v64, v64, v30
v_mul_f32 v65, v65, v30
v_mul_f32 v66, v66, v30
v_mul_f32 v67, v67, v30
cv v64,v64,v65
cv v65,v66,v67
s_add_u32 s38, s40, 0
buffer_store_dwordx4 v[32:35], v1, s[28:31], s38 offen sc1
mf v[68:71],a[112:115],a[48:51]
s_add_u32 s41, s41, 1
wl
v_bfe_u32 v102, v1, 5, 3
v_bfe_u32 v103, v1, 8, 2
v_lshlrev_b32 v103, 1, v103
v_xor_b32 v102, v102, v103
v_and_b32 v103, 16, v1
v_mov_b32 v0, 0x3f80
v_lshlrev_b32 v103, v103, v0
v_cmp_eq_u32 vcc, 0, v102
v_cmp_eq_u32 s[72:73], 1, v102
v_nop
v_cndmask_b32 v100, 0, v103, vcc
v_cndmask_b32 v101, 0, v103, s[72:73]
v_mov_b32 v102, v100
v_mov_b32 v103, v101
v_xor_b32 v5, 0x10000, v5
v_xor_b32 v16, 0x10000, v16
v_xor_b32 v6, 0x10000, v6
.p2align 5
Loloops_b:
mz v[32:35],a[96:99],v[160:163],0
tr a[112:113],v15,16384
v_mul_f32 v76, v76, v30
mf v[32:35],a[100:103],v[172:175]
tr a[114:115],v15,18432
v_mul_f32 v77, v77, v30
mf v[32:35],a[104:107],v[184:187]
tr a[116:117],v15,20480
v_mul_f32 v78, v78, v30
mf v[32:35],a[108:111],v[196:199]
tr a[118:119],v15,22528
v_mul_f32 v79, v79, v30
mz v[36:39],a[108:111],v[200:203],0
tr a[120:121],v15,24576
cv v66,v76,v77
mf v[36:39],a[104:107],v[188:191]
tr a[122:123],v15,26624
cv v67,v78,v79
mf v[36:39],a[100:103],v[176:179]
tr a[124:125],v15,28672
v_mul_f32 v72, v72, v29
mf v[36:39],a[96:99],v[164:167]
tr a[126:127],v15,30720
v_mul_f32 v73, v73, v29
mz v[40:43],a[96:99],v[168:171],0
s_add_u32 s38, s40, 40960
buffer_store_dwordx4 v[64:67], v1, s[28:31], s38 offen sc1
mf v[40:43],a[100:103],v[180:183]
s_add_u32 s48, s51, 128
v_mul_f32 v74, v74, v29
v_mul_f32 v75, v75, v29
mf v[40:43],a[104:107],v[192:195]
s_cmp_lt_u32 s41, 5
s_cselect_b32 s52, s48, 0x40000000
cv v62,v72,v73
cv v63,v74,v75
mf v[40:43],a[108:111],v[204:207]
s_add_u32 m0, s25, 20480
v_mul_f32 v68, v68, v28
wl
mf v[40:43],a[124:127],v[252:255]
tr a[96:97],v5,16384
v_mul_f32 v69, v69, v28
mf v[40:43],a[120:123],v[240:243]
tr a[98:99],v5,18432
v_mul_f32 v70, v70, v28
mf v[40:43],a[116:119],v[228:231]
tr a[100:101],v5,20480
v_mul_f32 v71, v71, v28
mf v[40:43],a[112:115],v[216:219]
tr a[102:103],v5,22528
cv v58,v68,v69
mf v[36:39],a[112:115],v[212:215]
tr a[104:105],v5,24576
cv v59,v70,v71
mf v[36:39],a[116:119],v[224:227]
tr a[106:107],v5,26624
cv v118,v96,v97
mf v[36:39],a[120:123],v[236:239]
tr a[108:109],v5,28672
cv v119,v98,v99
mf v[36:39],a[124:127],v[248:251]
tr a[110:111],v5,30720
cv v116,v92,v93
mf v[32:35],a[124:127],v[244:247]
s_add_u32 s38, s40, 24576
buffer_store_dwordx4 v[60:63], v1, s[28:31], s38 offen sc1
mf v[32:35],a[120:123],v[232:235]
s_add_u32 s38, s40, 8192
buffer_store_dwordx4 v[56:59], v1, s[28:31], s38 offen sc1
mf v[32:35],a[116:119],v[220:223]
s_add_u32 s40, s40, 262144
v_mul_f32 v40, v40, v26
v_mul_f32 v41, v41, v26
mf v[32:35],a[112:115],v[208:211]
wl
v_mul_f32 v42, v42, v26
v_mul_f32 v43, v43, v26
mz v[44:47],a[96:99],v[208:211],0
tr a[112:113],v5,0
cv v117,v94,v95
mf v[44:47],a[100:103],v[220:223]
tr a[114:115],v5,2048
v_mul_f32 v36, v36, v25
mf v[44:47],a[104:107],v[232:235]
tr a[116:117],v5,4096
v_mul_f32 v37, v37, v25
mf v[44:47],a[108:111],v[244:247]
tr a[118:119],v5,6144
v_mul_f32 v38, v38, v25
mz v[48:51],a[108:111],v[248:251],0
tr a[120:121],v5,8192
v_mul_f32 v39, v39, v25
mf v[48:51],a[104:107],v[236:239]
tr a[122:123],v5,10240
v_mul_f32 v32, v32, v24
mf v[48:51],a[100:103],v[224:227]
tr a[124:125],v5,12288
v_mul_f32 v33, v33, v24
mf v[48:51],a[96:99],v[212:215]
tr a[126:127],v5,14336
v_mul_f32 v34, v34, v24
mz v[52:55],a[96:99],v[216:219],0
v_mul_f32 v35, v35, v24
mf v[52:55],a[100:103],v[228:231]
mf v[52:55],a[104:107],v[240:243]
mf v[52:55],a[108:111],v[252:255]
wl
mf v[52:55],a[124:127],v[204:207]
tr a[96:97],v16,0
mf v[52:55],a[120:123],v[192:195]
tr a[98:99],v16,2048
mf v[52:55],a[116:119],v[180:183]
tr a[100:101],v16,4096
mf v[52:55],a[112:115],v[168:171]
tr a[102:103],v16,6144
mf v[48:51],a[112:115],v[164:167]
tr a[104:105],v16,8192
v_mov_b32 v0, s41
mf v[48:51],a[116:119],v[176:179]
tr a[106:107],v16,10240
mf v[48:51],a[120:123],v[188:191]
tr a[108:109],v16,12288
mf v[48:51],a[124:127],v[200:203]
tr a[110:111],v16,14336
mf v[44:47],a[124:127],v[196:199]
s_waitcnt vmcnt(0)
buffer_store_dword v0, v17, s[28:31], 0 offen sc1
mf v[44:47],a[120:123],v[184:187]
v_mul_f32 v52, v52, v26
v_mul_f32 v53, v53, v26
mf v[44:47],a[116:119],v[172:175]
s_add_u32 s39, s51, 143360
buffer_load_dwordx4 v3, s[20:23], s39 offen offset:0 lds
mf v[44:47],a[112:115],v[160:163]
wl
buffer_load_dwordx4 v152, s[20:23], s39 offen offset:1024 lds
mz v[56:59],a[96:99],v[160:163],0
tr a[112:113],v16,16384
v_mul_f32 v54, v54, v26
mf v[56:59],a[100:103],v[172:175]
tr a[114:115],v16,18432
buffer_load_dwordx4 v153, s[20:23], s39 offen offset:2048 lds
mf v[56:59],a[104:107],v[184:187]
tr a[116:117],v16,20480
buffer_load_dwordx4 v154, s[20:23], s39 offen offset:3072 lds
mf v[56:59],a[108:111],v[196:199]
s_add_u32 m0, s25, 24576
s_add_u32 s39, s51, 172032
buffer_load_dwordx4 v3, s[20:23], s39 offen offset:0 lds
tr a[118:119],v16,22528
mz v[60:63],a[108:111],v[200:203],0
tr a[120:121],v16,24576
buffer_load_dwordx4 v152, s[20:23], s39 offen offset:1024 lds
mf v[60:63],a[104:107],v[188:191]
tr a[122:123],v16,26624
buffer_load_dwordx4 v153, s[20:23], s39 offen offset:2048 lds
mf v[60:63],a[100:103],v[176:179]
tr a[124:125],v16,28672
buffer_load_dwordx4 v154, s[20:23], s39 offen offset:3072 lds
mf v[60:63],a[96:99],v[164:167]
s_add_u32 m0, s25, 28672
tr a[126:127],v16,30720
mz v[64:67],a[96:99],v[168:171],0
s_add_u32 s39, s51, 200704
buffer_load_dwordx4 v3, s[20:23], s39 offen offset:0 lds
mf v[64:67],a[100:103],v[180:183]
buffer_load_dwordx4 v152, s[20:23], s39 offen offset:1024 lds
mf v[64:67],a[104:107],v[192:195]
buffer_load_dwordx4 v153, s[20:23], s39 offen offset:2048 lds
mf v[64:67],a[108:111],v[204:207]
wl
buffer_load_dwordx4 v154, s[20:23], s39 offen offset:3072 lds
mf v[64:67],a[124:127],v[252:255]
s_add_u32 m0, s25, 32768
s_add_u32 s39, s51, 229376
buffer_load_dwordx4 v3, s[20:23], s39 offen offset:0 lds
tr a[96:97],v6,16384
mf v[64:67],a[120:123],v[240:243]
tr a[98:99],v6,18432
buffer_load_dwordx4 v152, s[20:23], s39 offen offset:1024 lds
mf v[64:67],a[116:119],v[228:231]
tr a[100:101],v6,20480
v_mul_f32 v55, v55, v26
mf v[64:67],a[112:115],v[216:219]
tr a[102:103],v6,22528
buffer_load_dwordx4 v153, s[20:23], s39 offen offset:2048 lds
mf v[60:63],a[112:115],v[212:215]
tr a[104:105],v6,24576
buffer_load_dwordx4 v154, s[20:23], s39 offen offset:3072 lds
mf v[60:63],a[116:119],v[224:227]
s_add_u32 m0, s25, 36864
s_add_u32 s39, s51, 258048
buffer_load_dwordx4 v3, s[20:23], s39 offen offset:0 lds
tr a[106:107],v6,26624
mf v[60:63],a[120:123],v[236:239]
tr a[108:109],v6,28672
buffer_load_dwordx4 v152, s[20:23], s39 offen offset:1024 lds
mf v[60:63],a[124:127],v[248:251]
tr a[110:111],v6,30720
buffer_load_dwordx4 v153, s[20:23], s39 offen offset:2048 lds
mf v[56:59],a[124:127],v[244:247]
buffer_load_dwordx4 v154, s[20:23], s39 offen offset:3072 lds
mf v[56:59],a[120:123],v[232:235]
s_add_u32 m0, s25, 40960
v_mul_f32 v48, v48, v25
v_mul_f32 v49, v49, v25
mf v[56:59],a[116:119],v[220:223]
s_add_u32 s39, s51, 286720
buffer_load_dwordx4 v3, s[20:23], s39 offen offset:0 lds
mf v[56:59],a[112:115],v[208:211]
wl
buffer_load_dwordx4 v152, s[20:23], s39 offen offset:1024 lds
mz v[68:71],a[96:99],v[208:211],0
tr a[112:113],v6,0
buffer_load_dwordx4 v153, s[20:23], s39 offen offset:2048 lds
mf v[68:71],a[100:103],v[220:223]
tr a[114:115],v6,2048
buffer_load_dwordx4 v154, s[20:23], s39 offen offset:3072 lds
mf v[68:71],a[104:107],v[232:235]
s_add_u32 m0, s25, 45056
s_add_u32 s39, s51, 315392
buffer_load_dwordx4 v3, s[20:23], s39 offen offset:0 lds
tr a[116:117],v6,4096
mf v[68:71],a[108:111],v[244:247]
tr a[118:119],v6,6144
buffer_load_dwordx4 v152, s[20:23], s39 offen offset:1024 lds
mz v[72:75],a[108:111],v[248:251],0
tr a[120:121],v6,8192
v_mul_f32 v50, v50, v25
mf v[72:75],a[104:107],v[236:239]
tr a[122:123],v6,10240
buffer_load_dwordx4 v153, s[20:23], s39 offen offset:2048 lds
mf v[72:75],a[100:103],v[224:227]
tr a[124:125],v6,12288
buffer_load_dwordx4 v154, s[20:23], s39 offen offset:3072 lds
mf v[72:75],a[96:99],v[212:215]
s_add_u32 m0, s25, 49152
s_add_u32 s39, s51, 344064
buffer_load_dwordx4 v3, s[20:23], s39 offen offset:0 lds
tr a[126:127],v6,14336
mz v[76:79],a[96:99],v[216:219],0
buffer_load_dwordx4 v152, s[20:23], s39 offen offset:1024 lds
mf v[76:79],a[100:103],v[228:231]
buffer_load_dwordx4 v153, s[20:23], s39 offen offset:2048 lds
mf v[76:79],a[104:107],v[240:243]
buffer_load_dwordx4 v154, s[20:23], s39 offen offset:3072 lds
mf v[76:79],a[108:111],v[252:255]
wl
buffer_store_dwordx4 v[116:119], v2, s[92:95], s53 offen nt
mf v[76:79],a[124:127],v[204:207]
s_add_u32 m0, s24, -12288
s_waitcnt vmcnt(49)
s_barrier
mf v[76:79],a[120:123],v[192:195]
tr a[96:97],v15,32768
v_mul_f32 v51, v51, v25
mf v[76:79],a[116:119],v[180:183]
tr a[98:99],v15,34816
v_mul_f32 v44, v44, v24
mf v[76:79],a[112:115],v[168:171]
tr a[100:101],v15,36864
v_mul_f32 v45, v45, v24
mf v[72:75],a[112:115],v[164:167]
tr a[102:103],v15,38912
v_mul_f32 v46, v46, v24
mf v[72:75],a[116:119],v[176:179]
tr a[104:105],v15,40960
v_mul_f32 v47, v47, v24
mf v[72:75],a[120:123],v[188:191]
tr a[106:107],v15,43008
v_mul_f32 v64, v64, v26
mf v[72:75],a[124:127],v[200:203]
tr a[108:109],v15,45056
v_mul_f32 v65, v65, v26
mf v[68:71],a[124:127],v[196:199]
tr a[110:111],v15,47104
v_mul_f32 v66, v66, v26
mf v[68:71],a[120:123],v[184:187]
s_mov_b32 s53, s27
v_mul_f32 v67, v67, v26
v_mul_f32 v60, v60, v25
mf v[68:71],a[116:119],v[172:175]
s_add_u32 s27, s27, 128
v_mul_f32 v61, v61, v25
v_mul_f32 v62, v62, v25
mf v[68:71],a[112:115],v[160:163]
wl
v_mul_f32 v63, v63, v25
v_mul_f32 v56, v56, v24
mf v[32:35],a[96:99],v[80:83]
tr a[112:113],v15,49152
v_mul_f32 v57, v57, v24
mf v[32:35],a[100:103],v[104:107]
tr a[114:115],v15,51200
v_mul_f32 v58, v58, v24
mf v[32:35],a[104:107],v[128:131]
tr a[116:117],v15,53248
buffer_load_dword v23, v4, s[28:31], 0 offen sc1
s_add_u32 s39, s52, -86016
buffer_load_dwordx4 v3, s[20:23], s39 offen offset:0 lds
mf v[32:35],a[108:111],a[36:39]
tr a[118:119],v15,55296
v_mul_f32 v59, v59, v24
mf v[36:39],a[108:111],a[40:43]
tr a[120:121],v15,57344
v_mul_f32 v76, v76, v26
mf v[36:39],a[104:107],v[132:135]
tr a[122:123],v15,59392
buffer_load_dwordx4 v152, s[20:23], s39 offen offset:1024 lds
mf v[36:39],a[100:103],v[108:111]
tr a[124:125],v15,61440
v_mul_f32 v77, v77, v26
mf v[36:39],a[96:99],v[84:87]
tr a[126:127],v15,63488
buffer_load_dwordx4 v153, s[20:23], s39 offen offset:2048 lds
mf v[40:43],a[96:99],v[88:91]
v_mul_f32 v78, v78, v26
v_mul_f32 v79, v79, v26
mf v[40:43],a[100:103],v[112:115]
v_mul_f32 v72, v72, v25
v_mul_f32 v73, v73, v25
mf v[40:43],a[104:107],v[136:139]
buffer_load_dwordx4 v154, s[20:23], s39 offen offset:3072 lds
mf v[40:43],a[108:111],a[44:47]
s_add_u32 m0, s24, -8192
v_mul_f32 v74, v74, v25
wl
mf v[40:43],a[124:127],a[92:95]
tr a[96:97],v5,49152
v_mul_f32 v75, v75, v25
mf v[40:43],a[120:123],a[80:83]
s_add_u32 s39, s52, -57344
buffer_load_dwordx4 v3, s[20:23], s39 offen offset:0 lds
tr a[98:99],v5,51200
mf v[40:43],a[116:119],a[68:71]
tr a[100:101],v5,53248
v_mul_f32 v68, v68, v24
mf v[40:43],a[112:115],a[56:59]
tr a[102:103],v5,55296
v_mul_f32 v69, v69, v24
mf v[36:39],a[112:115],a[52:55]
tr a[104:105],v5,57344
buffer_load_dwordx4 v152, s[20:23], s39 offen offset:1024 lds
mf v[36:39],a[116:119],a[64:67]
tr a[106:107],v5,59392
v_mul_f32 v70, v70, v24
mf v[36:39],a[120:123],a[76:79]
tr a[108:109],v5,61440
buffer_load_dwordx4 v153, s[20:23], s39 offen offset:2048 lds
mf v[36:39],a[124:127],a[88:91]
tr a[110:111],v5,63488
v_mul_f32 v71, v71, v24
mf v[32:35],a[124:127],a[84:87]
s_waitcnt vmcnt(7)
v_cmp_gt_u32 vcc, s41, v23
mf v[32:35],a[120:123],a[72:75]
buffer_load_dwordx4 v154, s[20:23], s39 offen offset:3072 lds
mf v[32:35],a[116:119],a[60:63]
s_add_u32 m0, s24, -4096
v_mul_f32 v40, v40, v30
v_mul_f32 v41, v41, v30
mf v[32:35],a[112:115],a[48:51]
wl
v_mul_f32 v42, v42, v30
v_mul_f32 v43, v43, v30
mf v[44:47],a[96:99],a[48:51]
s_add_u32 s39, s52, -28672
buffer_load_dwordx4 v3, s[20:23], s39 offen offset:0 lds
tr a[112:113],v5,32768
mf v[44:47],a[100:103],a[60:63]
tr a[114:115],v5,34816
cv v40,v40,v41
mf v[44:47],a[104:107],a[72:75]
s_cbranch_vccnz Lspins_b
Lspuns_b:
tr a[116:117],v5,36864
mf v[44:47],a[108:111],a[84:87]
tr a[118:119],v5,38912
buffer_load_dwordx4 v152, s[20:23], s39 offen offset:1024 lds
mf v[48:51],a[108:111],a[88:91]
s_add_u32 s72, s26, 4096
tr a[120:121],v5,40960
mf v[48:51],a[104:107],a[76:79]
tr a[122:123],v5,43008
buffer_load_dwordx4 v153, s[20:23], s39 offen offset:2048 lds
mf v[48:51],a[100:103],a[64:67]
tr a[124:125],v5,45056
cv v41,v42,v43
mf v[48:51],a[96:99],a[52:55]
tr a[126:127],v5,47104
v_mul_f32 v36, v36, v29
mf v[52:55],a[96:99],a[56:59]
buffer_load_dwordx4 v154, s[20:23], s39 offen offset:3072 lds
mf v[52:55],a[100:103],a[68:71]
s_add_u32 m0, s24, 0
buffer_load_dwordx2 a[162:163], v1, s[28:31], s26 offen offset:8 sc1
mf v[52:55],a[104:107],a[80:83]
v_mul_f32 v37, v37, v29
v_mul_f32 v38, v38, v29
mf v[52:55],a[108:111],a[92:95]
s_add_u32 s39, s52, 0
buffer_load_dwordx4 v3, s[20:23], s39 offen offset:0 lds
wl
mf v[52:55],a[124:127],a[44:47]
tr a[96:97],v16,32768
v_mul_f32 v39, v39, v29
mf v[52:55],a[120:123],v[136:139]
tr a[98:99],v16,34816
buffer_load_dwordx4 v152, s[20:23], s39 offen offset:1024 lds
mf v[52:55],a[116:119],v[112:115]
tr a[100:101],v16,36864
cv v36,v36,v37
mf v[52:55],a[112:115],v[88:91]
tr a[102:103],v16,38912
cv v37,v38,v39
mf v[48:51],a[112:115],v[84:87]
tr a[104:105],v16,40960
buffer_load_dwordx4 v153, s[20:23], s39 offen offset:2048 lds
mf v[48:51],a[116:119],v[108:111]
tr a[106:107],v16,43008
v_mul_f32 v32, v32, v28
mf v[48:51],a[120:123],v[132:135]
tr a[108:109],v16,45056
v_mul_f32 v33, v33, v28
mf v[48:51],a[124:127],a[40:43]
tr a[110:111],v16,47104
buffer_load_dwordx4 v154, s[20:23], s39 offen offset:3072 lds
mf v[44:47],a[124:127],a[36:39]
s_add_u32 m0, s24, 4096
buffer_load_dwordx4 a[164:167], v1, s[28:31], s26 offen offset:1024 sc1
mf v[44:47],a[120:123],v[128:131]
v_mul_f32 v34, v34, v28
v_mul_f32 v35, v35, v28
mf v[44:47],a[116:119],v[104:107]
s_add_u32 s39, s52, 28672
buffer_load_dwordx4 v3, s[20:23], s39 offen offset:0 lds
mf v[44:47],a[112:115],v[80:83]
wl
buffer_load_dwordx4 a[168:171], v1, s[28:31], s26 offen offset:2048 sc1
mf v[56:59],a[96:99],v[80:83]
tr a[112:113],v16,49152
buffer_load_dwordx4 v152, s[20:23], s39 offen offset:1024 lds
mf v[56:59],a[100:103],v[104:107]
tr a[114:115],v16,51200
cv v32,v32,v33
mf v[56:59],a[104:107],v[128:131]
tr a[116:117],v16,53248
cv v33,v34,v35
mf v[56:59],a[108:111],a[36:39]
tr a[118:119],v16,55296
buffer_load_dwordx4 v153, s[20:23], s39 offen offset:2048 lds
mf v[60:63],a[108:111],a[40:43]
tr a[120:121],v16,57344
v_mul_f32 v52, v52, v30
mf v[60:63],a[104:107],v[132:135]
tr a[122:123],v16,59392
v_mul_f32 v53, v53, v30
mf v[60:63],a[100:103],v[108:111]
s_cmp_eq_u32 s41, 4
s_cbranch_scc0 Lnotouchs_b
v_lshl_add_u32 v22, v1, 3, s3
v_min_u32 v22, L_end-L_main4, v22
global_load_dword v20, v22, s[58:59]
Lnotouchs_b:
tr a[124:125],v16,61440
buffer_load_dwordx4 v154, s[20:23], s39 offen offset:3072 lds
mf v[60:63],a[96:99],v[84:87]
s_add_u32 m0, s24, 8192
tr a[126:127],v16,63488
mf v[64:67],a[96:99],v[88:91]
buffer_load_dwordx4 a[172:175], v1, s[28:31], s26 offen offset:3072 sc1
mf v[64:67],a[100:103],v[112:115]
s_add_u32 s39, s52, 57344
buffer_load_dwordx4 v3, s[20:23], s39 offen offset:0 lds
mf v[64:67],a[104:107],v[136:139]
buffer_load_dwordx4 a[176:179], v1, s[28:31], s72 offen offset:0 sc1
mf v[64:67],a[108:111],a[44:47]
wl
buffer_load_dwordx4 v152, s[20:23], s39 offen offset:1024 lds
mf v[64:67],a[124:127],a[92:95]
tr a[96:97],v6,49152
v_mul_f32 v54, v54, v30
mf v[64:67],a[120:123],a[80:83]
tr a[98:99],v6,51200
v_mul_f32 v55, v55, v30
mf v[64:67],a[116:119],a[68:71]
tr a[100:101],v6,53248
buffer_load_dwordx4 v153, s[20:23], s39 offen offset:2048 lds
mf v[64:67],a[112:115],a[56:59]
tr a[102:103],v6,55296
cv v42,v52,v53
mf v[60:63],a[112:115],a[52:55]
tr a[104:105],v6,57344
cv v43,v54,v55
mf v[60:63],a[116:119],a[64:67]
tr a[106:107],v6,59392
buffer_load_dwordx4 v154, s[20:23], s39 offen offset:3072 lds
mf v[60:63],a[120:123],a[76:79]
tr a[108:109],v6,61440
buffer_load_dwordx4 a[180:183], v1, s[28:31], s72 offen offset:1024 sc1
mf v[60:63],a[124:127],a[88:91]
s_add_u32 m0, s24, 12288
tr a[110:111],v6,63488
mf v[56:59],a[124:127],a[84:87]
s_add_u32 s39, s52, 86016
buffer_load_dwordx4 v3, s[20:23], s39 offen offset:0 lds
buffer_load_dwordx4 a[184:187], v1, s[28:31], s72 offen offset:2048 sc1
mf v[56:59],a[120:123],a[72:75]
s_add_u32 s38, s40, 32768
buffer_store_dwordx4 v[40:43], v1, s[28:31], s38 offen sc1
mf v[56:59],a[116:119],a[60:63]
buffer_load_dwordx4 a[188:191], v1, s[28:31], s72 offen offset:3072 sc1
buffer_load_dwordx4 v152, s[20:23], s39 offen offset:1024 lds
mf v[56:59],a[112:115],a[48:51]
wl
v_mul_f32 v48, v48, v29
v_mul_f32 v49, v49, v29
mf v[68:71],a[96:99],a[48:51]
tr a[112:113],v6,32768
buffer_load_dwordx2 a[192:193], v1, s[28:31], s26 offen offset:0 sc1
s_add_u32 s26, s26, 262144
mf v[68:71],a[100:103],a[60:63]
tr a[114:115],v6,34816
buffer_load_dwordx4 v153, s[20:23], s39 offen offset:2048 lds
mf v[68:71],a[104:107],a[72:75]
tr a[116:117],v6,36864
v_mul_f32 v50, v50, v29
mf v[68:71],a[108:111],a[84:87]
tr a[118:119],v6,38912
v_mul_f32 v51, v51, v29
mf v[72:75],a[108:111],a[88:91]
tr a[120:121],v6,40960
buffer_load_dwordx4 v154, s[20:23], s39 offen offset:3072 lds
mf v[72:75],a[104:107],a[76:79]
s_add_u32 m0, s24, 16384
tr a[122:123],v6,43008
mf v[72:75],a[100:103],a[64:67]
tr a[124:125],v6,45056
cv v38,v48,v49
mf v[72:75],a[96:99],a[52:55]
s_add_u32 s39, s52, 114688
buffer_load_dwordx4 v3, s[20:23], s39 offen offset:0 lds
tr a[126:127],v6,47104
mf v[76:79],a[96:99],a[56:59]
cv v39,v50,v51
v_mul_f32 v44, v44, v28
mf v[76:79],a[100:103],a[68:71]
buffer_load_dwordx4 v152, s[20:23], s39 offen offset:1024 lds
mf v[76:79],a[104:107],a[80:83]
s_add_u32 s38, s40, 16384
buffer_store_dwordx4 v[36:39], v1, s[28:31], s38 offen sc1
mf v[76:79],a[108:111],a[92:95]
wl
v_mul_f32 v45, v45, v28
v_mul_f32 v46, v46, v28
mf v[76:79],a[124:127],a[44:47]
s_waitcnt vmcnt(63)
buffer_load_dwordx4 v153, s[20:23], s39 offen offset:2048 lds
s_barrier
mf v[76:79],a[120:123],v[136:139]
v_mul_f32 v47, v47, v28
v_xor_b32 v15, 0x10000, v15
mf v[76:79],a[116:119],v[112:115]
tr a[96:97],v15,0
cv v34,v44,v45
mf v[76:79],a[112:115],v[88:91]
tr a[98:99],v15,2048
buffer_load_dwordx4 v154, s[20:23], s39 offen offset:3072 lds
mf v[72:75],a[112:115],v[84:87]
tr a[100:101],v15,4096
cv v35,v46,v47
mf v[72:75],a[116:119],v[108:111]
tr a[102:103],v15,6144
v_mul_f32 v64, v64, v30
mf v[72:75],a[120:123],v[132:135]
tr a[104:105],v15,8192
v_mul_f32 v65, v65, v30
mf v[72:75],a[124:127],a[40:43]
tr a[106:107],v15,10240
v_mul_f32 v66, v66, v30
mf v[68:71],a[124:127],a[36:39]
tr a[108:109],v15,12288
v_mul_f32 v67, v67, v30
mf v[68:71],a[120:123],v[128:131]
tr a[110:111],v15,14336
cv v64,v64,v65
mf v[68:71],a[116:119],v[104:107]
s_mov_b32 s45, s51
s_mov_b32 s51, s52
s_xor_b32 s24, s24, 0x10000
s_xor_b32 s25, s25, 0x10000
mf v[68:71],a[112:115],v[80:83]
s_add_u32 s41, s41, 1
s_waitcnt vmcnt(7)
v_xor_b32 v5, 0x10000, v5
v_xor_b32 v16, 0x10000, v16
v_xor_b32 v6, 0x10000, v6
wl
mz v[96:99],v[100:103],a[162:165],0
s_add_u32 s38, s40, 0
buffer_store_dwordx4 v[32:35], v1, s[28:31], s38 offen sc1
mf v[96:99],v[100:103],a[170:173]
cv v65,v66,v67
v_mul_f32 v60, v60, v29
mf v[96:99],v[100:103],a[178:181]
v_mul_f32 v61, v61, v29
v_mul_f32 v62, v62, v29
mf v[96:99],v[100:103],a[186:189]
v_mul_f32 v63, v63, v29
cv v60,v60,v61
mz v[92:95],v[100:103],a[166:169],0
cv v61,v62,v63
v_mul_f32 v56, v56, v28
mf v[92:95],v[100:103],a[174:177]
v_mul_f32 v57, v57, v28
v_mul_f32 v58, v58, v28
mf v[92:95],v[100:103],a[182:185]
v_mul_f32 v59, v59, v28
cv v56,v56,v57
cv v57,v58,v59
mf v[92:95],v[100:103],a[190:193]
s_cmp_lt_u32 s41, 6
s_cbranch_scc1 Loloops_b
mz v[32:35],a[96:99],v[160:163],0
tr a[112:113],v15,16384
v_mul_f32 v76, v76, v30
mf v[32:35],a[100:103],v[172:175]
tr a[114:115],v15,18432
v_mul_f32 v77, v77, v30
mf v[32:35],a[104:107],v[184:187]
tr a[116:117],v15,20480
v_mul_f32 v78, v78, v30
mf v[32:35],a[108:111],v[196:199]
tr a[118:119],v15,22528
v_mul_f32 v79, v79, v30
mz v[36:39],a[108:111],v[200:203],0
tr a[120:121],v15,24576
cv v66,v76,v77
mf v[36:39],a[104:107],v[188:191]
tr a[122:123],v15,26624
cv v67,v78,v79
mf v[36:39],a[100:103],v[176:179]
tr a[124:125],v15,28672
v_mul_f32 v72, v72, v29
mf v[36:39],a[96:99],v[164:167]
tr a[126:127],v15,30720
v_mul_f32 v73, v73, v29
mz v[40:43],a[96:99],v[168:171],0
s_add_u32 s38, s40, 40960
buffer_store_dwordx4 v[64:67], v1, s[28:31], s38 offen sc1
mf v[40:43],a[100:103],v[180:183]
v_mul_f32 v74, v74, v29
v_mul_f32 v75, v75, v29
mf v[40:43],a[104:107],v[192:195]
cv v62,v72,v73
cv v63,v74,v75
mf v[40:43],a[108:111],v[204:207]
wl
v_mul_f32 v68, v68, v28
v_mul_f32 v69, v69, v28
mf v[40:43],a[124:127],v[252:255]
tr a[96:97],v5,16384
v_mul_f32 v70, v70, v28
mf v[40:43],a[120:123],v[240:243]
tr a[98:99],v5,18432
v_mul_f32 v71, v71, v28
mf v[40:43],a[116:119],v[228:231]
tr a[100:101],v5,20480
cv v58,v68,v69
mf v[40:43],a[112:115],v[216:219]
tr a[102:103],v5,22528
cv v59,v70,v71
mf v[36:39],a[112:115],v[212:215]
tr a[104:105],v5,24576
cv v118,v96,v97
mf v[36:39],a[116:119],v[224:227]
tr a[106:107],v5,26624
cv v119,v98,v99
mf v[36:39],a[120:123],v[236:239]
tr a[108:109],v5,28672
cv v116,v92,v93
mf v[36:39],a[124:127],v[248:251]
tr a[110:111],v5,30720
cv v117,v94,v95
mf v[32:35],a[124:127],v[244:247]
s_add_u32 s38, s40, 24576
buffer_store_dwordx4 v[60:63], v1, s[28:31], s38 offen sc1
mf v[32:35],a[120:123],v[232:235]
s_add_u32 s38, s40, 8192
buffer_store_dwordx4 v[56:59], v1, s[28:31], s38 offen sc1
mf v[32:35],a[116:119],v[220:223]
s_add_u32 s40, s40, 262144
v_mul_f32 v40, v40, v26
v_mul_f32 v41, v41, v26
mf v[32:35],a[112:115],v[208:211]
wl
v_mul_f32 v42, v42, v26
v_mul_f32 v43, v43, v26
mz v[44:47],a[96:99],v[208:211],0
tr a[112:113],v5,0
mf v[44:47],a[100:103],v[220:223]
tr a[114:115],v5,2048
v_mul_f32 v36, v36, v25
mf v[44:47],a[104:107],v[232:235]
tr a[116:117],v5,4096
v_mul_f32 v37, v37, v25
mf v[44:47],a[108:111],v[244:247]
tr a[118:119],v5,6144
v_mul_f32 v38, v38, v25
mz v[48:51],a[108:111],v[248:251],0
tr a[120:121],v5,8192
v_mul_f32 v39, v39, v25
mf v[48:51],a[104:107],v[236:239]
tr a[122:123],v5,10240
v_mul_f32 v32, v32, v24
mf v[48:51],a[100:103],v[224:227]
tr a[124:125],v5,12288
v_mul_f32 v33, v33, v24
mf v[48:51],a[96:99],v[212:215]
tr a[126:127],v5,14336
v_mul_f32 v34, v34, v24
mz v[52:55],a[96:99],v[216:219],0
v_mul_f32 v35, v35, v24
mf v[52:55],a[100:103],v[228:231]
mf v[52:55],a[104:107],v[240:243]
mf v[52:55],a[108:111],v[252:255]
wl
mf v[52:55],a[124:127],v[204:207]
tr a[96:97],v16,0
mf v[52:55],a[120:123],v[192:195]
tr a[98:99],v16,2048
mf v[52:55],a[116:119],v[180:183]
tr a[100:101],v16,4096
mf v[52:55],a[112:115],v[168:171]
tr a[102:103],v16,6144
mf v[48:51],a[112:115],v[164:167]
tr a[104:105],v16,8192
v_mov_b32 v0, s41
mf v[48:51],a[116:119],v[176:179]
tr a[106:107],v16,10240
mf v[48:51],a[120:123],v[188:191]
tr a[108:109],v16,12288
mf v[48:51],a[124:127],v[200:203]
tr a[110:111],v16,14336
mf v[44:47],a[124:127],v[196:199]
s_waitcnt vmcnt(0)
buffer_store_dword v0, v17, s[28:31], 0 offen sc1
mf v[44:47],a[120:123],v[184:187]
v_mul_f32 v52, v52, v26
v_mul_f32 v53, v53, v26
mf v[44:47],a[116:119],v[172:175]
v_mul_f32 v54, v54, v26
v_mul_f32 v55, v55, v26
mf v[44:47],a[112:115],v[160:163]
wl
mz v[56:59],a[96:99],v[160:163],0
tr a[112:113],v16,16384
mf v[56:59],a[100:103],v[172:175]
tr a[114:115],v16,18432
v_mul_f32 v48, v48, v25
mf v[56:59],a[104:107],v[184:187]
tr a[116:117],v16,20480
v_mul_f32 v49, v49, v25
mf v[56:59],a[108:111],v[196:199]
tr a[118:119],v16,22528
v_mul_f32 v50, v50, v25
mz v[60:63],a[108:111],v[200:203],0
tr a[120:121],v16,24576
v_mul_f32 v51, v51, v25
mf v[60:63],a[104:107],v[188:191]
tr a[122:123],v16,26624
v_mul_f32 v44, v44, v24
mf v[60:63],a[100:103],v[176:179]
tr a[124:125],v16,28672
v_mul_f32 v45, v45, v24
mf v[60:63],a[96:99],v[164:167]
tr a[126:127],v16,30720
v_mul_f32 v46, v46, v24
mz v[64:67],a[96:99],v[168:171],0
v_mul_f32 v47, v47, v24
mf v[64:67],a[100:103],v[180:183]
mf v[64:67],a[104:107],v[192:195]
mf v[64:67],a[108:111],v[204:207]
wl
mf v[64:67],a[124:127],v[252:255]
tr a[96:97],v6,16384
mf v[64:67],a[120:123],v[240:243]
tr a[98:99],v6,18432
mf v[64:67],a[116:119],v[228:231]
tr a[100:101],v6,20480
mf v[64:67],a[112:115],v[216:219]
tr a[102:103],v6,22528
mf v[60:63],a[112:115],v[212:215]
tr a[104:105],v6,24576
mf v[60:63],a[116:119],v[224:227]
tr a[106:107],v6,26624
mf v[60:63],a[120:123],v[236:239]
tr a[108:109],v6,28672
mf v[60:63],a[124:127],v[248:251]
tr a[110:111],v6,30720
mf v[56:59],a[124:127],v[244:247]
mf v[56:59],a[120:123],v[232:235]
v_mul_f32 v64, v64, v26
v_mul_f32 v65, v65, v26
mf v[56:59],a[116:119],v[220:223]
v_mul_f32 v66, v66, v26
v_mul_f32 v67, v67, v26
mf v[56:59],a[112:115],v[208:211]
wl
mz v[68:71],a[96:99],v[208:211],0
tr a[112:113],v6,0
mf v[68:71],a[100:103],v[220:223]
tr a[114:115],v6,2048
v_mul_f32 v60, v60, v25
mf v[68:71],a[104:107],v[232:235]
tr a[116:117],v6,4096
v_mul_f32 v61, v61, v25
mf v[68:71],a[108:111],v[244:247]
tr a[118:119],v6,6144
v_mul_f32 v62, v62, v25
mz v[72:75],a[108:111],v[248:251],0
tr a[120:121],v6,8192
v_mul_f32 v63, v63, v25
mf v[72:75],a[104:107],v[236:239]
tr a[122:123],v6,10240
v_mul_f32 v56, v56, v24
mf v[72:75],a[100:103],v[224:227]
tr a[124:125],v6,12288
v_mul_f32 v57, v57, v24
mf v[72:75],a[96:99],v[212:215]
tr a[126:127],v6,14336
v_mul_f32 v58, v58, v24
mz v[76:79],a[96:99],v[216:219],0
v_mul_f32 v59, v59, v24
mf v[76:79],a[100:103],v[228:231]
buffer_store_dwordx4 v[116:119], v2, s[92:95], s53 offen nt
mf v[76:79],a[104:107],v[240:243]
s_mov_b32 s53, s27
s_add_u32 s27, s27, 128
mf v[76:79],a[108:111],v[252:255]
wl
mf v[76:79],a[124:127],v[204:207]
s_waitcnt vmcnt(51)
s_barrier
mf v[76:79],a[120:123],v[192:195]
tr a[96:97],v15,32768
mf v[76:79],a[116:119],v[180:183]
tr a[98:99],v15,34816
mf v[76:79],a[112:115],v[168:171]
tr a[100:101],v15,36864
mf v[72:75],a[112:115],v[164:167]
tr a[102:103],v15,38912
mf v[72:75],a[116:119],v[176:179]
tr a[104:105],v15,40960
mf v[72:75],a[120:123],v[188:191]
tr a[106:107],v15,43008
mf v[72:75],a[124:127],v[200:203]
tr a[108:109],v15,45056
mf v[68:71],a[124:127],v[196:199]
tr a[110:111],v15,47104
mf v[68:71],a[120:123],v[184:187]
v_mul_f32 v76, v76, v26
v_mul_f32 v77, v77, v26
mf v[68:71],a[116:119],v[172:175]
v_mul_f32 v78, v78, v26
v_mul_f32 v79, v79, v26
mf v[68:71],a[112:115],v[160:163]
wl
mf v[32:35],a[96:99],v[80:83]
tr a[112:113],v15,49152
mf v[32:35],a[100:103],v[104:107]
tr a[114:115],v15,51200
v_mul_f32 v72, v72, v25
mf v[32:35],a[104:107],v[128:131]
tr a[116:117],v15,53248
v_mul_f32 v73, v73, v25
mf v[32:35],a[108:111],a[36:39]
tr a[118:119],v15,55296
v_mul_f32 v74, v74, v25
mf v[36:39],a[108:111],a[40:43]
tr a[120:121],v15,57344
v_mul_f32 v75, v75, v25
mf v[36:39],a[104:107],v[132:135]
tr a[122:123],v15,59392
v_mul_f32 v68, v68, v24
mf v[36:39],a[100:103],v[108:111]
tr a[124:125],v15,61440
buffer_load_dword v23, v4, s[28:31], 0 offen sc1
mf v[36:39],a[96:99],v[84:87]
tr a[126:127],v15,63488
v_mul_f32 v69, v69, v24
mf v[40:43],a[96:99],v[88:91]
v_mul_f32 v70, v70, v24
v_mul_f32 v71, v71, v24
mf v[40:43],a[100:103],v[112:115]
mf v[40:43],a[104:107],v[136:139]
mf v[40:43],a[108:111],a[44:47]
wl
mf v[40:43],a[124:127],a[92:95]
tr a[96:97],v5,49152
mf v[40:43],a[120:123],a[80:83]
tr a[98:99],v5,51200
mf v[40:43],a[116:119],a[68:71]
tr a[100:101],v5,53248
mf v[40:43],a[112:115],a[56:59]
tr a[102:103],v5,55296
mf v[36:39],a[112:115],a[52:55]
tr a[104:105],v5,57344
mf v[36:39],a[116:119],a[64:67]
tr a[106:107],v5,59392
mf v[36:39],a[120:123],a[76:79]
tr a[108:109],v5,61440
mf v[36:39],a[124:127],a[88:91]
tr a[110:111],v5,63488
mf v[32:35],a[124:127],a[84:87]
s_waitcnt vmcnt(0)
v_cmp_gt_u32 vcc, s41, v23
mf v[32:35],a[120:123],a[72:75]
v_mul_f32 v40, v40, v30
v_mul_f32 v41, v41, v30
mf v[32:35],a[116:119],a[60:63]
s_cbranch_vccnz Lspinsb_b
Lspunsb_b:
mf v[32:35],a[112:115],a[48:51]
s_add_u32 s72, s26, 4096
v_mul_f32 v42, v42, v30
wl
mf v[44:47],a[96:99],a[48:51]
tr a[112:113],v5,32768
v_mul_f32 v43, v43, v30
mf v[44:47],a[100:103],a[60:63]
tr a[114:115],v5,34816
cv v40,v40,v41
mf v[44:47],a[104:107],a[72:75]
tr a[116:117],v5,36864
cv v41,v42,v43
mf v[44:47],a[108:111],a[84:87]
tr a[118:119],v5,38912
v_mul_f32 v36, v36, v29
mf v[48:51],a[108:111],a[88:91]
tr a[120:121],v5,40960
v_mul_f32 v37, v37, v29
mf v[48:51],a[104:107],a[76:79]
tr a[122:123],v5,43008
v_mul_f32 v38, v38, v29
mf v[48:51],a[100:103],a[64:67]
tr a[124:125],v5,45056
v_mul_f32 v39, v39, v29
mf v[48:51],a[96:99],a[52:55]
tr a[126:127],v5,47104
cv v36,v36,v37
mf v[52:55],a[96:99],a[56:59]
buffer_load_dwordx2 a[162:163], v1, s[28:31], s26 offen offset:8 sc1
mf v[52:55],a[100:103],a[68:71]
cv v37,v38,v39
v_mul_f32 v32, v32, v28
mf v[52:55],a[104:107],a[80:83]
buffer_load_dwordx4 a[164:167], v1, s[28:31], s26 offen offset:1024 sc1
mf v[52:55],a[108:111],a[92:95]
wl
v_mul_f32 v33, v33, v28
v_mul_f32 v34, v34, v28
mf v[52:55],a[124:127],a[44:47]
tr a[96:97],v16,32768
v_mul_f32 v35, v35, v28
mf v[52:55],a[120:123],v[136:139]
tr a[98:99],v16,34816
cv v32,v32,v33
mf v[52:55],a[116:119],v[112:115]
tr a[100:101],v16,36864
cv v33,v34,v35
mf v[52:55],a[112:115],v[88:91]
tr a[102:103],v16,38912
mf v[48:51],a[112:115],v[84:87]
tr a[104:105],v16,40960
mf v[48:51],a[116:119],v[108:111]
tr a[106:107],v16,43008
mf v[48:51],a[120:123],v[132:135]
tr a[108:109],v16,45056
mf v[48:51],a[124:127],a[40:43]
tr a[110:111],v16,47104
mf v[44:47],a[124:127],a[36:39]
buffer_load_dwordx4 a[168:171], v1, s[28:31], s26 offen offset:2048 sc1
mf v[44:47],a[120:123],v[128:131]
v_mul_f32 v52, v52, v30
v_mul_f32 v53, v53, v30
mf v[44:47],a[116:119],v[104:107]
buffer_load_dwordx4 a[172:175], v1, s[28:31], s26 offen offset:3072 sc1
mf v[44:47],a[112:115],v[80:83]
wl
v_mul_f32 v54, v54, v30
v_mul_f32 v55, v55, v30
mf v[56:59],a[96:99],v[80:83]
tr a[112:113],v16,49152
cv v42,v52,v53
mf v[56:59],a[100:103],v[104:107]
tr a[114:115],v16,51200
cv v43,v54,v55
mf v[56:59],a[104:107],v[128:131]
tr a[116:117],v16,53248
v_mul_f32 v48, v48, v29
mf v[56:59],a[108:111],a[36:39]
tr a[118:119],v16,55296
v_mul_f32 v49, v49, v29
mf v[60:63],a[108:111],a[40:43]
tr a[120:121],v16,57344
v_mul_f32 v50, v50, v29
mf v[60:63],a[104:107],v[132:135]
tr a[122:123],v16,59392
v_mul_f32 v51, v51, v29
mf v[60:63],a[100:103],v[108:111]
tr a[124:125],v16,61440
cv v38,v48,v49
mf v[60:63],a[96:99],v[84:87]
tr a[126:127],v16,63488
cv v39,v50,v51
mf v[64:67],a[96:99],v[88:91]
buffer_load_dwordx4 a[176:179], v1, s[28:31], s72 offen offset:0 sc1
mf v[64:67],a[100:103],v[112:115]
s_add_u32 s38, s40, 32768
buffer_store_dwordx4 v[40:43], v1, s[28:31], s38 offen sc1
mf v[64:67],a[104:107],v[136:139]
buffer_load_dwordx4 a[180:183], v1, s[28:31], s72 offen offset:1024 sc1
mf v[64:67],a[108:111],a[44:47]
wl
v_mul_f32 v44, v44, v28
v_mul_f32 v45, v45, v28
mf v[64:67],a[124:127],a[92:95]
tr a[96:97],v6,49152
v_mul_f32 v46, v46, v28
mf v[64:67],a[120:123],a[80:83]
tr a[98:99],v6,51200
v_mul_f32 v47, v47, v28
mf v[64:67],a[116:119],a[68:71]
tr a[100:101],v6,53248
cv v34,v44,v45
mf v[64:67],a[112:115],a[56:59]
tr a[102:103],v6,55296
cv v35,v46,v47
mf v[60:63],a[112:115],a[52:55]
tr a[104:105],v6,57344
mf v[60:63],a[116:119],a[64:67]
tr a[106:107],v6,59392
mf v[60:63],a[120:123],a[76:79]
tr a[108:109],v6,61440
mf v[60:63],a[124:127],a[88:91]
tr a[110:111],v6,63488
mf v[56:59],a[124:127],a[84:87]
buffer_load_dwordx4 a[184:187], v1, s[28:31], s72 offen offset:2048 sc1
mf v[56:59],a[120:123],a[72:75]
s_add_u32 s38, s40, 16384
buffer_store_dwordx4 v[36:39], v1, s[28:31], s38 offen sc1
mf v[56:59],a[116:119],a[60:63]
buffer_load_dwordx4 a[188:191], v1, s[28:31], s72 offen offset:3072 sc1
mf v[56:59],a[112:115],a[48:51]
wl
v_mul_f32 v64, v64, v30
v_mul_f32 v65, v65, v30
mf v[68:71],a[96:99],a[48:51]
tr a[112:113],v6,32768
buffer_load_dwordx2 a[192:193], v1, s[28:31], s26 offen offset:0 sc1
s_add_u32 s26, s26, 262144
mf v[68:71],a[100:103],a[60:63]
tr a[114:115],v6,34816
v_mul_f32 v66, v66, v30
mf v[68:71],a[104:107],a[72:75]
tr a[116:117],v6,36864
v_mul_f32 v67, v67, v30
mf v[68:71],a[108:111],a[84:87]
tr a[118:119],v6,38912
cv v64,v64,v65
mf v[72:75],a[108:111],a[88:91]
tr a[120:121],v6,40960
cv v65,v66,v67
mf v[72:75],a[104:107],a[76:79]
tr a[122:123],v6,43008
v_mul_f32 v60, v60, v29
mf v[72:75],a[100:103],a[64:67]
tr a[124:125],v6,45056
v_mul_f32 v61, v61, v29
mf v[72:75],a[96:99],a[52:55]
tr a[126:127],v6,47104
v_mul_f32 v62, v62, v29
mf v[76:79],a[96:99],a[56:59]
s_add_u32 s38, s40, 0
buffer_store_dwordx4 v[32:35], v1, s[28:31], s38 offen sc1
mf v[76:79],a[100:103],a[68:71]
v_mul_f32 v63, v63, v29
cv v60,v60,v61
mf v[76:79],a[104:107],a[80:83]
cv v61,v62,v63
v_mul_f32 v56, v56, v28
mf v[76:79],a[108:111],a[92:95]
wl
v_mul_f32 v57, v57, v28
v_mul_f32 v58, v58, v28
mf v[76:79],a[124:127],a[44:47]
v_mul_f32 v59, v59, v28
cv v56,v56,v57
mf v[76:79],a[120:123],v[136:139]
cv v57,v58,v59
mf v[76:79],a[116:119],v[112:115]
mf v[76:79],a[112:115],v[88:91]
mf v[72:75],a[112:115],v[84:87]
mf v[72:75],a[116:119],v[108:111]
mf v[72:75],a[120:123],v[132:135]
mf v[72:75],a[124:127],a[40:43]
mf v[68:71],a[124:127],a[36:39]
mf v[68:71],a[120:123],v[128:131]
s_add_u32 s41, s41, 1
s_nop 0
v_mul_f32 v76, v76, v30
v_mul_f32 v77, v77, v30
mf v[68:71],a[116:119],v[104:107]
s_waitcnt vmcnt(1)
v_mul_f32 v78, v78, v30
v_mul_f32 v79, v79, v30
mf v[68:71],a[112:115],v[80:83]
cv v66,v76,v77
cv v67,v78,v79
mz v[96:99],v[100:103],a[162:165],0
s_add_u32 s38, s40, 40960
buffer_store_dwordx4 v[64:67], v1, s[28:31], s38 offen sc1
mf v[96:99],v[100:103],a[170:173]
v_mul_f32 v72, v72, v29
v_mul_f32 v73, v73, v29
mf v[96:99],v[100:103],a[178:181]
v_mul_f32 v74, v74, v29
v_mul_f32 v75, v75, v29
mf v[96:99],v[100:103],a[186:189]
cv v62,v72,v73
cv v63,v74,v75
mz v[92:95],v[100:103],a[166:169],0
s_add_u32 s38, s40, 24576
buffer_store_dwordx4 v[60:63], v1, s[28:31], s38 offen sc1
mf v[92:95],v[100:103],a[174:177]
v_mul_f32 v68, v68, v28
v_mul_f32 v69, v69, v28
mf v[92:95],v[100:103],a[182:185]
v_mul_f32 v70, v70, v28
v_mul_f32 v71, v71, v28
mf v[92:95],v[100:103],a[190:193]
cv v58,v68,v69
cv v59,v70,v71
s_add_u32 s38, s40, 8192
buffer_store_dwordx4 v[56:59], v1, s[28:31], s38 offen sc1
s_bfe_u32 s73, s26, 0x20010
s_lshl_b32 s73, s73, 2
s_add_u32 s73, s73, 2359296
v_and_b32 v4, 0x70, v1
v_add_u32 v4, s73, v4
cv v118,v96,v97
cv v119,v98,v99
cv v116,v92,v93
cv v117,v94,v95
v_mov_b32 v0, s41
s_waitcnt vmcnt(0)
buffer_store_dword v0, v17, s[28:31], 0 offen sc1
buffer_load_dword v23, v4, s[28:31], 0 offen sc1
s_waitcnt vmcnt(0)
v_cmp_gt_u32 vcc, s41, v23
s_cbranch_vccnz Lspints_b
Lspunts_b:
s_add_u32 s72, s26, 4096
buffer_load_dwordx2 a[162:163], v1, s[28:31], s26 offen offset:8 sc1
buffer_load_dwordx4 a[164:167], v1, s[28:31], s26 offen offset:1024 sc1
buffer_load_dwordx4 a[168:171], v1, s[28:31], s26 offen offset:2048 sc1
buffer_load_dwordx4 a[172:175], v1, s[28:31], s26 offen offset:3072 sc1
buffer_load_dwordx4 a[176:179], v1, s[28:31], s72 offen offset:0 sc1
buffer_load_dwordx4 a[180:183], v1, s[28:31], s72 offen offset:1024 sc1
buffer_load_dwordx4 a[184:187], v1, s[28:31], s72 offen offset:2048 sc1
buffer_load_dwordx4 a[188:191], v1, s[28:31], s72 offen offset:3072 sc1
buffer_load_dwordx2 a[192:193], v1, s[28:31], s26 offen offset:0 sc1
s_add_u32 s26, s26, 262144
buffer_store_dwordx4 v[116:119], v2, s[92:95], s53 offen nt
s_mov_b32 s53, s27
s_add_u32 s27, s27, 128
s_waitcnt vmcnt(1)
mz v[96:99],v[100:103],a[162:165],0
mf v[96:99],v[100:103],a[170:173]
mf v[96:99],v[100:103],a[178:181]
mf v[96:99],v[100:103],a[186:189]
mz v[92:95],v[100:103],a[166:169],0
mf v[92:95],v[100:103],a[174:177]
mf v[92:95],v[100:103],a[182:185]
mf v[92:95],v[100:103],a[190:193]
s_nop 3
cv v118,v96,v97
cv v119,v98,v99
s_nop 1
cv v116,v92,v93
cv v117,v94,v95
buffer_store_dwordx4 v[116:119], v2, s[92:95], s53 offen nt
s_endpgm
Lslow_fronth_b:
s_call_b64 s[84:85], Lslowh_b
s_branch Lret_fronth_b
Lslow_front_b:
s_call_b64 s[84:85], Lslow1_b
s_branch Lret_front_b
Lslow_lp0_b:
s_call_b64 s[84:85], Lslow0_b
s_branch Lret_lp0_b
Lslow_lp1_b:
s_call_b64 s[84:85], Lslow1_b
s_branch Lret_lp1_b
Lslow_it14_b:
s_call_b64 s[84:85], Lslow0_b
s_branch Lret_it14_b
Lslow_mid15_b:
s_call_b64 s[84:85], Lslow1_b
s_branch Lret_mid15_b
Lmodewait_b:
s_cmp_eq_u32 s49, 0
s_cbranch_scc1 Lmodeok_b
s_sub_u32 s49, s49, 1
buffer_load_dword v23, v21, s[96:99], s90 offen sc1
s_waitcnt vmcnt(0)
v_readfirstlane_b32 s54, v23
s_nop 1
s_and_b32 s73, s54, 0x0f0f0f0f
s_lshr_b32 s72, s54, 4
s_and_b32 s72, s72, 0x0f0f0f0f
s_add_u32 s73, s73, s72
s_mul_i32 s73, s73, 0x01010101
s_lshr_b32 s73, s73, 24
s_cmp_lt_u32 s73, 8
s_cbranch_scc1 Lmodewait_b
s_branch Lmodeok_b
Lslow_midh_b:
s_call_b64 s[84:85], Lslowh_b
s_branch Lret_midh_b
Lslow_mid_b:
s_call_b64 s[84:85], Lslow1_b
s_branch Lret_mid_b
Lslow_endf15_b:
s_call_b64 s[84:85], Lslow1_b
s_branch Lret_endf15_b
Lspinf_b:
s_cmp_eq_u32 s49, 0
s_cbranch_scc1 Lspunf_b
s_sub_u32 s49, s49, 1
buffer_load_dword v23, v4, s[28:31], 0 offen sc1
s_waitcnt vmcnt(0)
v_cmp_gt_u32 vcc, s41, v23
s_cbranch_vccnz Lspinf_b
s_branch Lspunf_b
Lspinfb_b:
s_cmp_eq_u32 s49, 0
s_cbranch_scc1 Lspunfb_b
s_sub_u32 s49, s49, 1
buffer_load_dword v23, v4, s[28:31], 0 offen sc1
s_waitcnt vmcnt(0)
v_cmp_gt_u32 vcc, s41, v23
s_cbranch_vccnz Lspinfb_b
s_branch Lspunfb_b
Lspintf_b:
s_cmp_eq_u32 s49, 0
s_cbranch_scc1 Lspuntf_b
s_sub_u32 s49, s49, 1
buffer_load_dword v23, v4, s[28:31], 0 offen sc1
s_waitcnt vmcnt(0)
v_cmp_gt_u32 vcc, s41, v23
s_cbranch_vccnz Lspintf_b
s_branch Lspuntf_b
Lslow_ends15_b:
s_call_b64 s[84:85], Lslow1_b
s_branch Lret_ends15_b
Lspins_b:
s_cmp_eq_u32 s49, 0
s_cbranch_scc1 Lspuns_b
s_sub_u32 s49, s49, 1
buffer_load_dword v23, v4, s[28:31], 0 offen sc1
s_waitcnt vmcnt(0)
v_cmp_gt_u32 vcc, s41, v23
s_cbranch_vccnz Lspins_b
s_branch Lspuns_b
Lspinsb_b:
s_cmp_eq_u32 s49, 0
s_cbranch_scc1 Lspunsb_b
s_sub_u32 s49, s49, 1
buffer_load_dword v23, v4, s[28:31], 0 offen sc1
s_waitcnt vmcnt(0)
v_cmp_gt_u32 vcc, s41, v23
s_cbranch_vccnz Lspinsb_b
s_branch Lspunsb_b
Lspints_b:
s_cmp_eq_u32 s49, 0
s_cbranch_scc1 Lspunts_b
s_sub_u32 s49, s49, 1
buffer_load_dword v23, v4, s[28:31], 0 offen sc1
s_waitcnt vmcnt(0)
v_cmp_gt_u32 vcc, s41, v23
s_cbranch_vccnz Lspints_b
s_branch Lspunts_b
Lslow0_b:
s_nop 15
v_bfe_u32 v0, v1, 4, 4
v_lshrrev_b32 v23, 8, v1
v_lshlrev_b32 v23, 4, v23
v_lshl_add_u32 v0, v0, 9, v23
s_add_u32 s72, s43, 0
buffer_load_dwordx4 a[96:99], v0, s[12:15], s72 offen offset:0
buffer_load_dwordx4 a[100:103], v0, s[12:15], s72 offen offset:64
buffer_load_dwordx4 a[104:107], v0, s[12:15], s72 offen offset:128
buffer_load_dwordx4 a[108:111], v0, s[12:15], s72 offen offset:192
s_waitcnt vmcnt(0)
mz v[44:47],a[96:99],a[0:3],v[32:35]
mf v[44:47],a[100:103],a[12:15]
mf v[44:47],a[104:107],a[24:27]
mf v[44:47],a[108:111],a[36:39]
mz v[48:51],a[96:99],a[4:7],v[36:39]
mf v[48:51],a[100:103],a[16:19]
mf v[48:51],a[104:107],a[28:31]
mf v[48:51],a[108:111],a[40:43]
mz v[52:55],a[96:99],a[8:11],v[40:43]
mf v[52:55],a[100:103],a[20:23]
mf v[52:55],a[104:107],a[32:35]
mf v[52:55],a[108:111],a[44:47]
s_nop 7
buffer_load_dwordx4 a[96:99], v0, s[12:15], s72 offen offset:256
buffer_load_dwordx4 a[100:103], v0, s[12:15], s72 offen offset:320
buffer_load_dwordx4 a[104:107], v0, s[12:15], s72 offen offset:384
buffer_load_dwordx4 a[108:111], v0, s[12:15], s72 offen offset:448
s_waitcnt vmcnt(0)
mf v[44:47],a[96:99],a[48:51]
mf v[44:47],a[100:103],a[60:63]
mf v[44:47],a[104:107],a[72:75]
mf v[44:47],a[108:111],a[84:87]
mf v[48:51],a[96:99],a[52:55]
mf v[48:51],a[100:103],a[64:67]
mf v[48:51],a[104:107],a[76:79]
mf v[48:51],a[108:111],a[88:91]
mf v[52:55],a[96:99],a[56:59]
mf v[52:55],a[100:103],a[68:71]
mf v[52:55],a[104:107],a[80:83]
mf v[52:55],a[108:111],a[92:95]
s_nop 7
s_add_u32 s72, s43, 8192
buffer_load_dwordx4 a[96:99], v0, s[12:15], s72 offen offset:0
buffer_load_dwordx4 a[100:103], v0, s[12:15], s72 offen offset:64
buffer_load_dwordx4 a[104:107], v0, s[12:15], s72 offen offset:128
buffer_load_dwordx4 a[108:111], v0, s[12:15], s72 offen offset:192
s_waitcnt vmcnt(0)
mz v[68:71],a[96:99],a[0:3],v[32:35]
mf v[68:71],a[100:103],a[12:15]
mf v[68:71],a[104:107],a[24:27]
mf v[68:71],a[108:111],a[36:39]
mz v[72:75],a[96:99],a[4:7],v[36:39]
mf v[72:75],a[100:103],a[16:19]
mf v[72:75],a[104:107],a[28:31]
mf v[72:75],a[108:111],a[40:43]
mz v[76:79],a[96:99],a[8:11],v[40:43]
mf v[76:79],a[100:103],a[20:23]
mf v[76:79],a[104:107],a[32:35]
mf v[76:79],a[108:111],a[44:47]
s_nop 7
buffer_load_dwordx4 a[96:99], v0, s[12:15], s72 offen offset:256
buffer_load_dwordx4 a[100:103], v0, s[12:15], s72 offen offset:320
buffer_load_dwordx4 a[104:107], v0, s[12:15], s72 offen offset:384
buffer_load_dwordx4 a[108:111], v0, s[12:15], s72 offen offset:448
s_waitcnt vmcnt(0)
mf v[68:71],a[96:99],a[48:51]
mf v[68:71],a[100:103],a[60:63]
mf v[68:71],a[104:107],a[72:75]
mf v[68:71],a[108:111],a[84:87]
mf v[72:75],a[96:99],a[52:55]
mf v[72:75],a[100:103],a[64:67]
mf v[72:75],a[104:107],a[76:79]
mf v[72:75],a[108:111],a[88:91]
mf v[76:79],a[96:99],a[56:59]
mf v[76:79],a[100:103],a[68:71]
mf v[76:79],a[104:107],a[80:83]
mf v[76:79],a[108:111],a[92:95]
s_nop 7
s_nop 15
aw a96,v21
v_max3_f32 v0, v44, v45, v46
v_max3_f32 v0, v0, v47, v68
v_max3_f32 v0, v0, v69, v70
v_max_f32 v0, v0, v71
v_mov_b32 v23, v0
s_nop 1
v_permlane32_swap_b32 v0, v23
v_max_f32 v0, v0, v23
v_mov_b32 v23, v0
s_nop 1
v_permlane16_swap_b32 v0, v23
v_max_f32 v0, v0, v23
v_ceil_f32 v0, v0
v_max_f32 v0, 0, v0
v_exp_f32 v21, -v0
v_sub_f32 v32, v32, v0
v_sub_f32 v33, v33, v0
v_sub_f32 v34, v34, v0
v_sub_f32 v35, v35, v0
v_sub_f32 v44, v44, v0
v_sub_f32 v45, v45, v0
v_sub_f32 v46, v46, v0
v_sub_f32 v47, v47, v0
v_sub_f32 v68, v68, v0
v_sub_f32 v69, v69, v0
v_sub_f32 v70, v70, v0
v_sub_f32 v71, v71, v0
v_exp_f32 v44, v44
v_exp_f32 v45, v45
s_nop 0
v_add_f32 v28, v44, v45
cv v44,v44,v45
v_exp_f32 v46, v46
v_exp_f32 v47, v47
v_add_f32 v28, v46, v28
v_add_f32 v28, v47, v28
cv v45,v46,v47
v_exp_f32 v68, v68
v_exp_f32 v69, v69
v_add_f32 v28, v68, v28
v_add_f32 v28, v69, v28
cv v46,v68,v69
v_exp_f32 v70, v70
v_exp_f32 v71, v71
v_add_f32 v28, v70, v28
v_add_f32 v28, v71, v28
cv v47,v70,v71
v_mul_f32 v24, v24, v21
v_lshlrev_b32 v0, 16, v56
v_and_b32 v23, 0xffff0000, v56
v_mul_f32 v0, v0, v21
v_mul_f32 v23, v23, v21
cv v56,v0,v23
v_lshlrev_b32 v0, 16, v57
v_and_b32 v23, 0xffff0000, v57
v_mul_f32 v0, v0, v21
v_mul_f32 v23, v23, v21
cv v57,v0,v23
v_lshlrev_b32 v0, 16, v58
v_and_b32 v23, 0xffff0000, v58
v_mul_f32 v0, v0, v21
v_mul_f32 v23, v23, v21
cv v58,v0,v23
v_lshlrev_b32 v0, 16, v59
v_and_b32 v23, 0xffff0000, v59
v_mul_f32 v0, v0, v21
v_mul_f32 v23, v23, v21
cv v59,v0,v23
v_mul_f32 v80, v80, v21
v_mul_f32 v81, v81, v21
v_mul_f32 v82, v82, v21
v_mul_f32 v83, v83, v21
v_mul_f32 v92, v92, v21
v_mul_f32 v93, v93, v21
v_mul_f32 v94, v94, v21
v_mul_f32 v95, v95, v21
v_mul_f32 v104, v104, v21
v_mul_f32 v105, v105, v21
v_mul_f32 v106, v106, v21
v_mul_f32 v107, v107, v21
v_mul_f32 v116, v116, v21
v_mul_f32 v117, v117, v21
v_mul_f32 v118, v118, v21
v_mul_f32 v119, v119, v21
v_mul_f32 v128, v128, v21
v_mul_f32 v129, v129, v21
v_mul_f32 v130, v130, v21
v_mul_f32 v131, v131, v21
v_mul_f32 v140, v140, v21
v_mul_f32 v141, v141, v21
v_mul_f32 v142, v142, v21
v_mul_f32 v143, v143, v21
ar v23,a128
v_mul_f32 v23, v23, v21
aw a128,v23
ar v23,a129
v_mul_f32 v23, v23, v21
aw a129,v23
ar v23,a130
v_mul_f32 v23, v23, v21
aw a130,v23
ar v23,a131
v_mul_f32 v23, v23, v21
aw a131,v23
ar v23,a140
v_mul_f32 v23, v23, v21
aw a140,v23
ar v23,a141
v_mul_f32 v23, v23, v21
aw a141,v23
ar v23,a142
v_mul_f32 v23, v23, v21
aw a142,v23
ar v23,a143
v_mul_f32 v23, v23, v21
aw a143,v23
ar v23,a152
v_mul_f32 v23, v23, v21
aw a152,v23
ar v23,a153
v_mul_f32 v23, v23, v21
aw a153,v23
ar v23,a154
v_mul_f32 v23, v23, v21
aw a154,v23
ar v23,a155
v_mul_f32 v23, v23, v21
aw a155,v23
ar v23,a164
v_mul_f32 v23, v23, v21
aw a164,v23
ar v23,a165
v_mul_f32 v23, v23, v21
aw a165,v23
ar v23,a166
v_mul_f32 v23, v23, v21
aw a166,v23
ar v23,a167
v_mul_f32 v23, v23, v21
aw a167,v23
ar v23,a176
v_mul_f32 v23, v23, v21
aw a176,v23
ar v23,a177
v_mul_f32 v23, v23, v21
aw a177,v23
ar v23,a178
v_mul_f32 v23, v23, v21
aw a178,v23
ar v23,a179
v_mul_f32 v23, v23, v21
aw a179,v23
ar v23,a188
v_mul_f32 v23, v23, v21
aw a188,v23
ar v23,a189
v_mul_f32 v23, v23, v21
aw a189,v23
ar v23,a190
v_mul_f32 v23, v23, v21
aw a190,v23
ar v23,a191
v_mul_f32 v23, v23, v21
aw a191,v23
ar v23,a200
v_mul_f32 v23, v23, v21
aw a200,v23
ar v23,a201
v_mul_f32 v23, v23, v21
aw a201,v23
ar v23,a202
v_mul_f32 v23, v23, v21
aw a202,v23
ar v23,a203
v_mul_f32 v23, v23, v21
aw a203,v23
ar v23,a212
v_mul_f32 v23, v23, v21
aw a212,v23
ar v23,a213
v_mul_f32 v23, v23, v21
aw a213,v23
ar v23,a214
v_mul_f32 v23, v23, v21
aw a214,v23
ar v23,a215
v_mul_f32 v23, v23, v21
aw a215,v23
ar v23,a224
v_mul_f32 v23, v23, v21
aw a224,v23
ar v23,a225
v_mul_f32 v23, v23, v21
aw a225,v23
ar v23,a226
v_mul_f32 v23, v23, v21
aw a226,v23
ar v23,a227
v_mul_f32 v23, v23, v21
aw a227,v23
ar v23,a236
v_mul_f32 v23, v23, v21
aw a236,v23
ar v23,a237
v_mul_f32 v23, v23, v21
aw a237,v23
ar v23,a238
v_mul_f32 v23, v23, v21
aw a238,v23
ar v23,a239
v_mul_f32 v23, v23, v21
aw a239,v23
v_max3_f32 v0, v48, v49, v50
v_max3_f32 v0, v0, v51, v72
v_max3_f32 v0, v0, v73, v74
v_max_f32 v0, v0, v75
v_mov_b32 v23, v0
s_nop 1
v_permlane32_swap_b32 v0, v23
v_max_f32 v0, v0, v23
v_mov_b32 v23, v0
s_nop 1
v_permlane16_swap_b32 v0, v23
v_max_f32 v0, v0, v23
v_ceil_f32 v0, v0
v_max_f32 v0, 0, v0
v_exp_f32 v21, -v0
v_sub_f32 v36, v36, v0
v_sub_f32 v37, v37, v0
v_sub_f32 v38, v38, v0
v_sub_f32 v39, v39, v0
v_sub_f32 v48, v48, v0
v_sub_f32 v49, v49, v0
v_sub_f32 v50, v50, v0
v_sub_f32 v51, v51, v0
v_sub_f32 v72, v72, v0
v_sub_f32 v73, v73, v0
v_sub_f32 v74, v74, v0
v_sub_f32 v75, v75, v0
v_exp_f32 v48, v48
v_exp_f32 v49, v49
s_nop 0
v_add_f32 v29, v48, v49
cv v48,v48,v49
v_exp_f32 v50, v50
v_exp_f32 v51, v51
v_add_f32 v29, v50, v29
v_add_f32 v29, v51, v29
cv v49,v50,v51
v_exp_f32 v72, v72
v_exp_f32 v73, v73
v_add_f32 v29, v72, v29
v_add_f32 v29, v73, v29
cv v50,v72,v73
v_exp_f32 v74, v74
v_exp_f32 v75, v75
v_add_f32 v29, v74, v29
v_add_f32 v29, v75, v29
cv v51,v74,v75
v_mul_f32 v25, v25, v21
v_lshlrev_b32 v0, 16, v60
v_and_b32 v23, 0xffff0000, v60
v_mul_f32 v0, v0, v21
v_mul_f32 v23, v23, v21
cv v60,v0,v23
v_lshlrev_b32 v0, 16, v61
v_and_b32 v23, 0xffff0000, v61
v_mul_f32 v0, v0, v21
v_mul_f32 v23, v23, v21
cv v61,v0,v23
v_lshlrev_b32 v0, 16, v62
v_and_b32 v23, 0xffff0000, v62
v_mul_f32 v0, v0, v21
v_mul_f32 v23, v23, v21
cv v62,v0,v23
v_lshlrev_b32 v0, 16, v63
v_and_b32 v23, 0xffff0000, v63
v_mul_f32 v0, v0, v21
v_mul_f32 v23, v23, v21
cv v63,v0,v23
v_mul_f32 v84, v84, v21
v_mul_f32 v85, v85, v21
v_mul_f32 v86, v86, v21
v_mul_f32 v87, v87, v21
v_mul_f32 v96, v96, v21
v_mul_f32 v97, v97, v21
v_mul_f32 v98, v98, v21
v_mul_f32 v99, v99, v21
v_mul_f32 v108, v108, v21
v_mul_f32 v109, v109, v21
v_mul_f32 v110, v110, v21
v_mul_f32 v111, v111, v21
v_mul_f32 v120, v120, v21
v_mul_f32 v121, v121, v21
v_mul_f32 v122, v122, v21
v_mul_f32 v123, v123, v21
v_mul_f32 v132, v132, v21
v_mul_f32 v133, v133, v21
v_mul_f32 v134, v134, v21
v_mul_f32 v135, v135, v21
v_mul_f32 v144, v144, v21
v_mul_f32 v145, v145, v21
v_mul_f32 v146, v146, v21
v_mul_f32 v147, v147, v21
ar v23,a132
v_mul_f32 v23, v23, v21
aw a132,v23
ar v23,a133
v_mul_f32 v23, v23, v21
aw a133,v23
ar v23,a134
v_mul_f32 v23, v23, v21
aw a134,v23
ar v23,a135
v_mul_f32 v23, v23, v21
aw a135,v23
ar v23,a144
v_mul_f32 v23, v23, v21
aw a144,v23
ar v23,a145
v_mul_f32 v23, v23, v21
aw a145,v23
ar v23,a146
v_mul_f32 v23, v23, v21
aw a146,v23
ar v23,a147
v_mul_f32 v23, v23, v21
aw a147,v23
ar v23,a156
v_mul_f32 v23, v23, v21
aw a156,v23
ar v23,a157
v_mul_f32 v23, v23, v21
aw a157,v23
ar v23,a158
v_mul_f32 v23, v23, v21
aw a158,v23
ar v23,a159
v_mul_f32 v23, v23, v21
aw a159,v23
ar v23,a168
v_mul_f32 v23, v23, v21
aw a168,v23
ar v23,a169
v_mul_f32 v23, v23, v21
aw a169,v23
ar v23,a170
v_mul_f32 v23, v23, v21
aw a170,v23
ar v23,a171
v_mul_f32 v23, v23, v21
aw a171,v23
ar v23,a180
v_mul_f32 v23, v23, v21
aw a180,v23
ar v23,a181
v_mul_f32 v23, v23, v21
aw a181,v23
ar v23,a182
v_mul_f32 v23, v23, v21
aw a182,v23
ar v23,a183
v_mul_f32 v23, v23, v21
aw a183,v23
ar v23,a192
v_mul_f32 v23, v23, v21
aw a192,v23
ar v23,a193
v_mul_f32 v23, v23, v21
aw a193,v23
ar v23,a194
v_mul_f32 v23, v23, v21
aw a194,v23
ar v23,a195
v_mul_f32 v23, v23, v21
aw a195,v23
ar v23,a204
v_mul_f32 v23, v23, v21
aw a204,v23
ar v23,a205
v_mul_f32 v23, v23, v21
aw a205,v23
ar v23,a206
v_mul_f32 v23, v23, v21
aw a206,v23
ar v23,a207
v_mul_f32 v23, v23, v21
aw a207,v23
ar v23,a216
v_mul_f32 v23, v23, v21
aw a216,v23
ar v23,a217
v_mul_f32 v23, v23, v21
aw a217,v23
ar v23,a218
v_mul_f32 v23, v23, v21
aw a218,v23
ar v23,a219
v_mul_f32 v23, v23, v21
aw a219,v23
ar v23,a228
v_mul_f32 v23, v23, v21
aw a228,v23
ar v23,a229
v_mul_f32 v23, v23, v21
aw a229,v23
ar v23,a230
v_mul_f32 v23, v23, v21
aw a230,v23
ar v23,a231
v_mul_f32 v23, v23, v21
aw a231,v23
ar v23,a240
v_mul_f32 v23, v23, v21
aw a240,v23
ar v23,a241
v_mul_f32 v23, v23, v21
aw a241,v23
ar v23,a242
v_mul_f32 v23, v23, v21
aw a242,v23
ar v23,a243
v_mul_f32 v23, v23, v21
aw a243,v23
v_max3_f32 v0, v52, v53, v54
v_max3_f32 v0, v0, v55, v76
v_max3_f32 v0, v0, v77, v78
v_max_f32 v0, v0, v79
v_mov_b32 v23, v0
s_nop 1
v_permlane32_swap_b32 v0, v23
v_max_f32 v0, v0, v23
v_mov_b32 v23, v0
s_nop 1
v_permlane16_swap_b32 v0, v23
v_max_f32 v0, v0, v23
v_ceil_f32 v0, v0
v_max_f32 v0, 0, v0
v_exp_f32 v21, -v0
v_sub_f32 v40, v40, v0
v_sub_f32 v41, v41, v0
v_sub_f32 v42, v42, v0
v_sub_f32 v43, v43, v0
v_sub_f32 v52, v52, v0
v_sub_f32 v53, v53, v0
v_sub_f32 v54, v54, v0
v_sub_f32 v55, v55, v0
v_sub_f32 v76, v76, v0
v_sub_f32 v77, v77, v0
v_sub_f32 v78, v78, v0
v_sub_f32 v79, v79, v0
v_exp_f32 v52, v52
v_exp_f32 v53, v53
s_nop 0
v_add_f32 v30, v52, v53
cv v52,v52,v53
v_exp_f32 v54, v54
v_exp_f32 v55, v55
v_add_f32 v30, v54, v30
v_add_f32 v30, v55, v30
cv v53,v54,v55
v_exp_f32 v76, v76
v_exp_f32 v77, v77
v_add_f32 v30, v76, v30
v_add_f32 v30, v77, v30
cv v54,v76,v77
v_exp_f32 v78, v78
v_exp_f32 v79, v79
v_add_f32 v30, v78, v30
v_add_f32 v30, v79, v30
cv v55,v78,v79
v_mul_f32 v26, v26, v21
v_lshlrev_b32 v0, 16, v64
v_and_b32 v23, 0xffff0000, v64
v_mul_f32 v0, v0, v21
v_mul_f32 v23, v23, v21
cv v64,v0,v23
v_lshlrev_b32 v0, 16, v65
v_and_b32 v23, 0xffff0000, v65
v_mul_f32 v0, v0, v21
v_mul_f32 v23, v23, v21
cv v65,v0,v23
v_lshlrev_b32 v0, 16, v66
v_and_b32 v23, 0xffff0000, v66
v_mul_f32 v0, v0, v21
v_mul_f32 v23, v23, v21
cv v66,v0,v23
v_lshlrev_b32 v0, 16, v67
v_and_b32 v23, 0xffff0000, v67
v_mul_f32 v0, v0, v21
v_mul_f32 v23, v23, v21
cv v67,v0,v23
v_mul_f32 v88, v88, v21
v_mul_f32 v89, v89, v21
v_mul_f32 v90, v90, v21
v_mul_f32 v91, v91, v21
v_mul_f32 v100, v100, v21
v_mul_f32 v101, v101, v21
v_mul_f32 v102, v102, v21
v_mul_f32 v103, v103, v21
v_mul_f32 v112, v112, v21
v_mul_f32 v113, v113, v21
v_mul_f32 v114, v114, v21
v_mul_f32 v115, v115, v21
v_mul_f32 v124, v124, v21
v_mul_f32 v125, v125, v21
v_mul_f32 v126, v126, v21
v_mul_f32 v127, v127, v21
v_mul_f32 v136, v136, v21
v_mul_f32 v137, v137, v21
v_mul_f32 v138, v138, v21
v_mul_f32 v139, v139, v21
v_mul_f32 v148, v148, v21
v_mul_f32 v149, v149, v21
v_mul_f32 v150, v150, v21
v_mul_f32 v151, v151, v21
ar v23,a136
v_mul_f32 v23, v23, v21
aw a136,v23
ar v23,a137
v_mul_f32 v23, v23, v21
aw a137,v23
ar v23,a138
v_mul_f32 v23, v23, v21
aw a138,v23
ar v23,a139
v_mul_f32 v23, v23, v21
aw a139,v23
ar v23,a148
v_mul_f32 v23, v23, v21
aw a148,v23
ar v23,a149
v_mul_f32 v23, v23, v21
aw a149,v23
ar v23,a150
v_mul_f32 v23, v23, v21
aw a150,v23
ar v23,a151
v_mul_f32 v23, v23, v21
aw a151,v23
ar v23,a160
v_mul_f32 v23, v23, v21
aw a160,v23
ar v23,a161
v_mul_f32 v23, v23, v21
aw a161,v23
ar v23,a162
v_mul_f32 v23, v23, v21
aw a162,v23
ar v23,a163
v_mul_f32 v23, v23, v21
aw a163,v23
ar v23,a172
v_mul_f32 v23, v23, v21
aw a172,v23
ar v23,a173
v_mul_f32 v23, v23, v21
aw a173,v23
ar v23,a174
v_mul_f32 v23, v23, v21
aw a174,v23
ar v23,a175
v_mul_f32 v23, v23, v21
aw a175,v23
ar v23,a184
v_mul_f32 v23, v23, v21
aw a184,v23
ar v23,a185
v_mul_f32 v23, v23, v21
aw a185,v23
ar v23,a186
v_mul_f32 v23, v23, v21
aw a186,v23
ar v23,a187
v_mul_f32 v23, v23, v21
aw a187,v23
ar v23,a196
v_mul_f32 v23, v23, v21
aw a196,v23
ar v23,a197
v_mul_f32 v23, v23, v21
aw a197,v23
ar v23,a198
v_mul_f32 v23, v23, v21
aw a198,v23
ar v23,a199
v_mul_f32 v23, v23, v21
aw a199,v23
ar v23,a208
v_mul_f32 v23, v23, v21
aw a208,v23
ar v23,a209
v_mul_f32 v23, v23, v21
aw a209,v23
ar v23,a210
v_mul_f32 v23, v23, v21
aw a210,v23
ar v23,a211
v_mul_f32 v23, v23, v21
aw a211,v23
ar v23,a220
v_mul_f32 v23, v23, v21
aw a220,v23
ar v23,a221
v_mul_f32 v23, v23, v21
aw a221,v23
ar v23,a222
v_mul_f32 v23, v23, v21
aw a222,v23
ar v23,a223
v_mul_f32 v23, v23, v21
aw a223,v23
ar v23,a232
v_mul_f32 v23, v23, v21
aw a232,v23
ar v23,a233
v_mul_f32 v23, v23, v21
aw a233,v23
ar v23,a234
v_mul_f32 v23, v23, v21
aw a234,v23
ar v23,a235
v_mul_f32 v23, v23, v21
aw a235,v23
ar v23,a244
v_mul_f32 v23, v23, v21
aw a244,v23
ar v23,a245
v_mul_f32 v23, v23, v21
aw a245,v23
ar v23,a246
v_mul_f32 v23, v23, v21
aw a246,v23
ar v23,a247
v_mul_f32 v23, v23, v21
aw a247,v23
ar v21,a96
s_nop 3
s_setpc_b64 s[84:85]
Lslow1_b:
s_nop 15
v_bfe_u32 v0, v1, 4, 4
v_lshrrev_b32 v23, 8, v1
v_lshlrev_b32 v23, 4, v23
v_lshl_add_u32 v0, v0, 9, v23
s_add_u32 s72, s43, 0
buffer_load_dwordx4 a[96:99], v0, s[12:15], s72 offen offset:0
buffer_load_dwordx4 a[100:103], v0, s[12:15], s72 offen offset:64
buffer_load_dwordx4 a[104:107], v0, s[12:15], s72 offen offset:128
buffer_load_dwordx4 a[108:111], v0, s[12:15], s72 offen offset:192
s_waitcnt vmcnt(0)
mz v[56:59],a[96:99],a[0:3],v[32:35]
mf v[56:59],a[100:103],a[12:15]
mf v[56:59],a[104:107],a[24:27]
mf v[56:59],a[108:111],a[36:39]
mz v[60:63],a[96:99],a[4:7],v[36:39]
mf v[60:63],a[100:103],a[16:19]
mf v[60:63],a[104:107],a[28:31]
mf v[60:63],a[108:111],a[40:43]
mz v[64:67],a[96:99],a[8:11],v[40:43]
mf v[64:67],a[100:103],a[20:23]
mf v[64:67],a[104:107],a[32:35]
mf v[64:67],a[108:111],a[44:47]
s_nop 7
buffer_load_dwordx4 a[96:99], v0, s[12:15], s72 offen offset:256
buffer_load_dwordx4 a[100:103], v0, s[12:15], s72 offen offset:320
buffer_load_dwordx4 a[104:107], v0, s[12:15], s72 offen offset:384
buffer_load_dwordx4 a[108:111], v0, s[12:15], s72 offen offset:448
s_waitcnt vmcnt(0)
mf v[56:59],a[96:99],a[48:51]
mf v[56:59],a[100:103],a[60:63]
mf v[56:59],a[104:107],a[72:75]
mf v[56:59],a[108:111],a[84:87]
mf v[60:63],a[96:99],a[52:55]
mf v[60:63],a[100:103],a[64:67]
mf v[60:63],a[104:107],a[76:79]
mf v[60:63],a[108:111],a[88:91]
mf v[64:67],a[96:99],a[56:59]
mf v[64:67],a[100:103],a[68:71]
mf v[64:67],a[104:107],a[80:83]
mf v[64:67],a[108:111],a[92:95]
s_nop 7
s_add_u32 s72, s43, 8192
buffer_load_dwordx4 a[96:99], v0, s[12:15], s72 offen offset:0
buffer_load_dwordx4 a[100:103], v0, s[12:15], s72 offen offset:64
buffer_load_dwordx4 a[104:107], v0, s[12:15], s72 offen offset:128
buffer_load_dwordx4 a[108:111], v0, s[12:15], s72 offen offset:192
s_waitcnt vmcnt(0)
mz v[68:71],a[96:99],a[0:3],v[32:35]
mf v[68:71],a[100:103],a[12:15]
mf v[68:71],a[104:107],a[24:27]
mf v[68:71],a[108:111],a[36:39]
mz v[72:75],a[96:99],a[4:7],v[36:39]
mf v[72:75],a[100:103],a[16:19]
mf v[72:75],a[104:107],a[28:31]
mf v[72:75],a[108:111],a[40:43]
mz v[76:79],a[96:99],a[8:11],v[40:43]
mf v[76:79],a[100:103],a[20:23]
mf v[76:79],a[104:107],a[32:35]
mf v[76:79],a[108:111],a[44:47]
s_nop 7
buffer_load_dwordx4 a[96:99], v0, s[12:15], s72 offen offset:256
buffer_load_dwordx4 a[100:103], v0, s[12:15], s72 offen offset:320
buffer_load_dwordx4 a[104:107], v0, s[12:15], s72 offen offset:384
buffer_load_dwordx4 a[108:111], v0, s[12:15], s72 offen offset:448
s_waitcnt vmcnt(0)
mf v[68:71],a[96:99],a[48:51]
mf v[68:71],a[100:103],a[60:63]
mf v[68:71],a[104:107],a[72:75]
mf v[68:71],a[108:111],a[84:87]
mf v[72:75],a[96:99],a[52:55]
mf v[72:75],a[100:103],a[64:67]
mf v[72:75],a[104:107],a[76:79]
mf v[72:75],a[108:111],a[88:91]
mf v[76:79],a[96:99],a[56:59]
mf v[76:79],a[100:103],a[68:71]
mf v[76:79],a[104:107],a[80:83]
mf v[76:79],a[108:111],a[92:95]
s_nop 7
s_nop 15
aw a96,v21
v_max3_f32 v0, v56, v57, v58
v_max3_f32 v0, v0, v59, v68
v_max3_f32 v0, v0, v69, v70
v_max_f32 v0, v0, v71
v_mov_b32 v23, v0
s_nop 1
v_permlane32_swap_b32 v0, v23
v_max_f32 v0, v0, v23
v_mov_b32 v23, v0
s_nop 1
v_permlane16_swap_b32 v0, v23
v_max_f32 v0, v0, v23
v_ceil_f32 v0, v0
v_max_f32 v0, 0, v0
v_exp_f32 v21, -v0
v_sub_f32 v32, v32, v0
v_sub_f32 v33, v33, v0
v_sub_f32 v34, v34, v0
v_sub_f32 v35, v35, v0
v_sub_f32 v56, v56, v0
v_sub_f32 v57, v57, v0
v_sub_f32 v58, v58, v0
v_sub_f32 v59, v59, v0
v_sub_f32 v68, v68, v0
v_sub_f32 v69, v69, v0
v_sub_f32 v70, v70, v0
v_sub_f32 v71, v71, v0
v_exp_f32 v56, v56
v_exp_f32 v57, v57
s_nop 0
v_add_f32 v28, v56, v57
cv v56,v56,v57
v_exp_f32 v58, v58
v_exp_f32 v59, v59
v_add_f32 v28, v58, v28
v_add_f32 v28, v59, v28
cv v57,v58,v59
v_exp_f32 v68, v68
v_exp_f32 v69, v69
v_add_f32 v28, v68, v28
v_add_f32 v28, v69, v28
cv v58,v68,v69
v_exp_f32 v70, v70
v_exp_f32 v71, v71
v_add_f32 v28, v70, v28
v_add_f32 v28, v71, v28
cv v59,v70,v71
v_mul_f32 v24, v24, v21
v_lshlrev_b32 v0, 16, v44
v_and_b32 v23, 0xffff0000, v44
v_mul_f32 v0, v0, v21
v_mul_f32 v23, v23, v21
cv v44,v0,v23
v_lshlrev_b32 v0, 16, v45
v_and_b32 v23, 0xffff0000, v45
v_mul_f32 v0, v0, v21
v_mul_f32 v23, v23, v21
cv v45,v0,v23
v_lshlrev_b32 v0, 16, v46
v_and_b32 v23, 0xffff0000, v46
v_mul_f32 v0, v0, v21
v_mul_f32 v23, v23, v21
cv v46,v0,v23
v_lshlrev_b32 v0, 16, v47
v_and_b32 v23, 0xffff0000, v47
v_mul_f32 v0, v0, v21
v_mul_f32 v23, v23, v21
cv v47,v0,v23
v_mul_f32 v80, v80, v21
v_mul_f32 v81, v81, v21
v_mul_f32 v82, v82, v21
v_mul_f32 v83, v83, v21
v_mul_f32 v92, v92, v21
v_mul_f32 v93, v93, v21
v_mul_f32 v94, v94, v21
v_mul_f32 v95, v95, v21
v_mul_f32 v104, v104, v21
v_mul_f32 v105, v105, v21
v_mul_f32 v106, v106, v21
v_mul_f32 v107, v107, v21
v_mul_f32 v116, v116, v21
v_mul_f32 v117, v117, v21
v_mul_f32 v118, v118, v21
v_mul_f32 v119, v119, v21
v_mul_f32 v128, v128, v21
v_mul_f32 v129, v129, v21
v_mul_f32 v130, v130, v21
v_mul_f32 v131, v131, v21
v_mul_f32 v140, v140, v21
v_mul_f32 v141, v141, v21
v_mul_f32 v142, v142, v21
v_mul_f32 v143, v143, v21
ar v23,a128
v_mul_f32 v23, v23, v21
aw a128,v23
ar v23,a129
v_mul_f32 v23, v23, v21
aw a129,v23
ar v23,a130
v_mul_f32 v23, v23, v21
aw a130,v23
ar v23,a131
v_mul_f32 v23, v23, v21
aw a131,v23
ar v23,a140
v_mul_f32 v23, v23, v21
aw a140,v23
ar v23,a141
v_mul_f32 v23, v23, v21
aw a141,v23
ar v23,a142
v_mul_f32 v23, v23, v21
aw a142,v23
ar v23,a143
v_mul_f32 v23, v23, v21
aw a143,v23
ar v23,a152
v_mul_f32 v23, v23, v21
aw a152,v23
ar v23,a153
v_mul_f32 v23, v23, v21
aw a153,v23
ar v23,a154
v_mul_f32 v23, v23, v21
aw a154,v23
ar v23,a155
v_mul_f32 v23, v23, v21
aw a155,v23
ar v23,a164
v_mul_f32 v23, v23, v21
aw a164,v23
ar v23,a165
v_mul_f32 v23, v23, v21
aw a165,v23
ar v23,a166
v_mul_f32 v23, v23, v21
aw a166,v23
ar v23,a167
v_mul_f32 v23, v23, v21
aw a167,v23
ar v23,a176
v_mul_f32 v23, v23, v21
aw a176,v23
ar v23,a177
v_mul_f32 v23, v23, v21
aw a177,v23
ar v23,a178
v_mul_f32 v23, v23, v21
aw a178,v23
ar v23,a179
v_mul_f32 v23, v23, v21
aw a179,v23
ar v23,a188
v_mul_f32 v23, v23, v21
aw a188,v23
ar v23,a189
v_mul_f32 v23, v23, v21
aw a189,v23
ar v23,a190
v_mul_f32 v23, v23, v21
aw a190,v23
ar v23,a191
v_mul_f32 v23, v23, v21
aw a191,v23
ar v23,a200
v_mul_f32 v23, v23, v21
aw a200,v23
ar v23,a201
v_mul_f32 v23, v23, v21
aw a201,v23
ar v23,a202
v_mul_f32 v23, v23, v21
aw a202,v23
ar v23,a203
v_mul_f32 v23, v23, v21
aw a203,v23
ar v23,a212
v_mul_f32 v23, v23, v21
aw a212,v23
ar v23,a213
v_mul_f32 v23, v23, v21
aw a213,v23
ar v23,a214
v_mul_f32 v23, v23, v21
aw a214,v23
ar v23,a215
v_mul_f32 v23, v23, v21
aw a215,v23
ar v23,a224
v_mul_f32 v23, v23, v21
aw a224,v23
ar v23,a225
v_mul_f32 v23, v23, v21
aw a225,v23
ar v23,a226
v_mul_f32 v23, v23, v21
aw a226,v23
ar v23,a227
v_mul_f32 v23, v23, v21
aw a227,v23
ar v23,a236
v_mul_f32 v23, v23, v21
aw a236,v23
ar v23,a237
v_mul_f32 v23, v23, v21
aw a237,v23
ar v23,a238
v_mul_f32 v23, v23, v21
aw a238,v23
ar v23,a239
v_mul_f32 v23, v23, v21
aw a239,v23
v_max3_f32 v0, v60, v61, v62
v_max3_f32 v0, v0, v63, v72
v_max3_f32 v0, v0, v73, v74
v_max_f32 v0, v0, v75
v_mov_b32 v23, v0
s_nop 1
v_permlane32_swap_b32 v0, v23
v_max_f32 v0, v0, v23
v_mov_b32 v23, v0
s_nop 1
v_permlane16_swap_b32 v0, v23
v_max_f32 v0, v0, v23
v_ceil_f32 v0, v0
v_max_f32 v0, 0, v0
v_exp_f32 v21, -v0
v_sub_f32 v36, v36, v0
v_sub_f32 v37, v37, v0
v_sub_f32 v38, v38, v0
v_sub_f32 v39, v39, v0
v_sub_f32 v60, v60, v0
v_sub_f32 v61, v61, v0
v_sub_f32 v62, v62, v0
v_sub_f32 v63, v63, v0
v_sub_f32 v72, v72, v0
v_sub_f32 v73, v73, v0
v_sub_f32 v74, v74, v0
v_sub_f32 v75, v75, v0
v_exp_f32 v60, v60
v_exp_f32 v61, v61
s_nop 0
v_add_f32 v29, v60, v61
cv v60,v60,v61
v_exp_f32 v62, v62
v_exp_f32 v63, v63
v_add_f32 v29, v62, v29
v_add_f32 v29, v63, v29
cv v61,v62,v63
v_exp_f32 v72, v72
v_exp_f32 v73, v73
v_add_f32 v29, v72, v29
v_add_f32 v29, v73, v29
cv v62,v72,v73
v_exp_f32 v74, v74
v_exp_f32 v75, v75
v_add_f32 v29, v74, v29
v_add_f32 v29, v75, v29
cv v63,v74,v75
v_mul_f32 v25, v25, v21
v_lshlrev_b32 v0, 16, v48
v_and_b32 v23, 0xffff0000, v48
v_mul_f32 v0, v0, v21
v_mul_f32 v23, v23, v21
cv v48,v0,v23
v_lshlrev_b32 v0, 16, v49
v_and_b32 v23, 0xffff0000, v49
v_mul_f32 v0, v0, v21
v_mul_f32 v23, v23, v21
cv v49,v0,v23
v_lshlrev_b32 v0, 16, v50
v_and_b32 v23, 0xffff0000, v50
v_mul_f32 v0, v0, v21
v_mul_f32 v23, v23, v21
cv v50,v0,v23
v_lshlrev_b32 v0, 16, v51
v_and_b32 v23, 0xffff0000, v51
v_mul_f32 v0, v0, v21
v_mul_f32 v23, v23, v21
cv v51,v0,v23
v_mul_f32 v84, v84, v21
v_mul_f32 v85, v85, v21
v_mul_f32 v86, v86, v21
v_mul_f32 v87, v87, v21
v_mul_f32 v96, v96, v21
v_mul_f32 v97, v97, v21
v_mul_f32 v98, v98, v21
v_mul_f32 v99, v99, v21
v_mul_f32 v108, v108, v21
v_mul_f32 v109, v109, v21
v_mul_f32 v110, v110, v21
v_mul_f32 v111, v111, v21
v_mul_f32 v120, v120, v21
v_mul_f32 v121, v121, v21
v_mul_f32 v122, v122, v21
v_mul_f32 v123, v123, v21
v_mul_f32 v132, v132, v21
v_mul_f32 v133, v133, v21
v_mul_f32 v134, v134, v21
v_mul_f32 v135, v135, v21
v_mul_f32 v144, v144, v21
v_mul_f32 v145, v145, v21
v_mul_f32 v146, v146, v21
v_mul_f32 v147, v147, v21
ar v23,a132
v_mul_f32 v23, v23, v21
aw a132,v23
ar v23,a133
v_mul_f32 v23, v23, v21
aw a133,v23
ar v23,a134
v_mul_f32 v23, v23, v21
aw a134,v23
ar v23,a135
v_mul_f32 v23, v23, v21
aw a135,v23
ar v23,a144
v_mul_f32 v23, v23, v21
aw a144,v23
ar v23,a145
v_mul_f32 v23, v23, v21
aw a145,v23
ar v23,a146
v_mul_f32 v23, v23, v21
aw a146,v23
ar v23,a147
v_mul_f32 v23, v23, v21
aw a147,v23
ar v23,a156
v_mul_f32 v23, v23, v21
aw a156,v23
ar v23,a157
v_mul_f32 v23, v23, v21
aw a157,v23
ar v23,a158
v_mul_f32 v23, v23, v21
aw a158,v23
ar v23,a159
v_mul_f32 v23, v23, v21
aw a159,v23
ar v23,a168
v_mul_f32 v23, v23, v21
aw a168,v23
ar v23,a169
v_mul_f32 v23, v23, v21
aw a169,v23
ar v23,a170
v_mul_f32 v23, v23, v21
aw a170,v23
ar v23,a171
v_mul_f32 v23, v23, v21
aw a171,v23
ar v23,a180
v_mul_f32 v23, v23, v21
aw a180,v23
ar v23,a181
v_mul_f32 v23, v23, v21
aw a181,v23
ar v23,a182
v_mul_f32 v23, v23, v21
aw a182,v23
ar v23,a183
v_mul_f32 v23, v23, v21
aw a183,v23
ar v23,a192
v_mul_f32 v23, v23, v21
aw a192,v23
ar v23,a193
v_mul_f32 v23, v23, v21
aw a193,v23
ar v23,a194
v_mul_f32 v23, v23, v21
aw a194,v23
ar v23,a195
v_mul_f32 v23, v23, v21
aw a195,v23
ar v23,a204
v_mul_f32 v23, v23, v21
aw a204,v23
ar v23,a205
v_mul_f32 v23, v23, v21
aw a205,v23
ar v23,a206
v_mul_f32 v23, v23, v21
aw a206,v23
ar v23,a207
v_mul_f32 v23, v23, v21
aw a207,v23
ar v23,a216
v_mul_f32 v23, v23, v21
aw a216,v23
ar v23,a217
v_mul_f32 v23, v23, v21
aw a217,v23
ar v23,a218
v_mul_f32 v23, v23, v21
aw a218,v23
ar v23,a219
v_mul_f32 v23, v23, v21
aw a219,v23
ar v23,a228
v_mul_f32 v23, v23, v21
aw a228,v23
ar v23,a229
v_mul_f32 v23, v23, v21
aw a229,v23
ar v23,a230
v_mul_f32 v23, v23, v21
aw a230,v23
ar v23,a231
v_mul_f32 v23, v23, v21
aw a231,v23
ar v23,a240
v_mul_f32 v23, v23, v21
aw a240,v23
ar v23,a241
v_mul_f32 v23, v23, v21
aw a241,v23
ar v23,a242
v_mul_f32 v23, v23, v21
aw a242,v23
ar v23,a243
v_mul_f32 v23, v23, v21
aw a243,v23
v_max3_f32 v0, v64, v65, v66
v_max3_f32 v0, v0, v67, v76
v_max3_f32 v0, v0, v77, v78
v_max_f32 v0, v0, v79
v_mov_b32 v23, v0
s_nop 1
v_permlane32_swap_b32 v0, v23
v_max_f32 v0, v0, v23
v_mov_b32 v23, v0
s_nop 1
v_permlane16_swap_b32 v0, v23
v_max_f32 v0, v0, v23
v_ceil_f32 v0, v0
v_max_f32 v0, 0, v0
v_exp_f32 v21, -v0
v_sub_f32 v40, v40, v0
v_sub_f32 v41, v41, v0
v_sub_f32 v42, v42, v0
v_sub_f32 v43, v43, v0
v_sub_f32 v64, v64, v0
v_sub_f32 v65, v65, v0
v_sub_f32 v66, v66, v0
v_sub_f32 v67, v67, v0
v_sub_f32 v76, v76, v0
v_sub_f32 v77, v77, v0
v_sub_f32 v78, v78, v0
v_sub_f32 v79, v79, v0
v_exp_f32 v64, v64
v_exp_f32 v65, v65
s_nop 0
v_add_f32 v30, v64, v65
cv v64,v64,v65
v_exp_f32 v66, v66
v_exp_f32 v67, v67
v_add_f32 v30, v66, v30
v_add_f32 v30, v67, v30
cv v65,v66,v67
v_exp_f32 v76, v76
v_exp_f32 v77, v77
v_add_f32 v30, v76, v30
v_add_f32 v30, v77, v30
cv v66,v76,v77
v_exp_f32 v78, v78
v_exp_f32 v79, v79
v_add_f32 v30, v78, v30
v_add_f32 v30, v79, v30
cv v67,v78,v79
v_mul_f32 v26, v26, v21
v_lshlrev_b32 v0, 16, v52
v_and_b32 v23, 0xffff0000, v52
v_mul_f32 v0, v0, v21
v_mul_f32 v23, v23, v21
cv v52,v0,v23
v_lshlrev_b32 v0, 16, v53
v_and_b32 v23, 0xffff0000, v53
v_mul_f32 v0, v0, v21
v_mul_f32 v23, v23, v21
cv v53,v0,v23
v_lshlrev_b32 v0, 16, v54
v_and_b32 v23, 0xffff0000, v54
v_mul_f32 v0, v0, v21
v_mul_f32 v23, v23, v21
cv v54,v0,v23
v_lshlrev_b32 v0, 16, v55
v_and_b32 v23, 0xffff0000, v55
v_mul_f32 v0, v0, v21
v_mul_f32 v23, v23, v21
cv v55,v0,v23
v_mul_f32 v88, v88, v21
v_mul_f32 v89, v89, v21
v_mul_f32 v90, v90, v21
v_mul_f32 v91, v91, v21
v_mul_f32 v100, v100, v21
v_mul_f32 v101, v101, v21
v_mul_f32 v102, v102, v21
v_mul_f32 v103, v103, v21
v_mul_f32 v112, v112, v21
v_mul_f32 v113, v113, v21
v_mul_f32 v114, v114, v21
v_mul_f32 v115, v115, v21
v_mul_f32 v124, v124, v21
v_mul_f32 v125, v125, v21
v_mul_f32 v126, v126, v21
v_mul_f32 v127, v127, v21
v_mul_f32 v136, v136, v21
v_mul_f32 v137, v137, v21
v_mul_f32 v138, v138, v21
v_mul_f32 v139, v139, v21
v_mul_f32 v148, v148, v21
v_mul_f32 v149, v149, v21
v_mul_f32 v150, v150, v21
v_mul_f32 v151, v151, v21
ar v23,a136
v_mul_f32 v23, v23, v21
aw a136,v23
ar v23,a137
v_mul_f32 v23, v23, v21
aw a137,v23
ar v23,a138
v_mul_f32 v23, v23, v21
aw a138,v23
ar v23,a139
v_mul_f32 v23, v23, v21
aw a139,v23
ar v23,a148
v_mul_f32 v23, v23, v21
aw a148,v23
ar v23,a149
v_mul_f32 v23, v23, v21
aw a149,v23
ar v23,a150
v_mul_f32 v23, v23, v21
aw a150,v23
ar v23,a151
v_mul_f32 v23, v23, v21
aw a151,v23
ar v23,a160
v_mul_f32 v23, v23, v21
aw a160,v23
ar v23,a161
v_mul_f32 v23, v23, v21
aw a161,v23
ar v23,a162
v_mul_f32 v23, v23, v21
aw a162,v23
ar v23,a163
v_mul_f32 v23, v23, v21
aw a163,v23
ar v23,a172
v_mul_f32 v23, v23, v21
aw a172,v23
ar v23,a173
v_mul_f32 v23, v23, v21
aw a173,v23
ar v23,a174
v_mul_f32 v23, v23, v21
aw a174,v23
ar v23,a175
v_mul_f32 v23, v23, v21
aw a175,v23
ar v23,a184
v_mul_f32 v23, v23, v21
aw a184,v23
ar v23,a185
v_mul_f32 v23, v23, v21
aw a185,v23
ar v23,a186
v_mul_f32 v23, v23, v21
aw a186,v23
ar v23,a187
v_mul_f32 v23, v23, v21
aw a187,v23
ar v23,a196
v_mul_f32 v23, v23, v21
aw a196,v23
ar v23,a197
v_mul_f32 v23, v23, v21
aw a197,v23
ar v23,a198
v_mul_f32 v23, v23, v21
aw a198,v23
ar v23,a199
v_mul_f32 v23, v23, v21
aw a199,v23
ar v23,a208
v_mul_f32 v23, v23, v21
aw a208,v23
ar v23,a209
v_mul_f32 v23, v23, v21
aw a209,v23
ar v23,a210
v_mul_f32 v23, v23, v21
aw a210,v23
ar v23,a211
v_mul_f32 v23, v23, v21
aw a211,v23
ar v23,a220
v_mul_f32 v23, v23, v21
aw a220,v23
ar v23,a221
v_mul_f32 v23, v23, v21
aw a221,v23
ar v23,a222
v_mul_f32 v23, v23, v21
aw a222,v23
ar v23,a223
v_mul_f32 v23, v23, v21
aw a223,v23
ar v23,a232
v_mul_f32 v23, v23, v21
aw a232,v23
ar v23,a233
v_mul_f32 v23, v23, v21
aw a233,v23
ar v23,a234
v_mul_f32 v23, v23, v21
aw a234,v23
ar v23,a235
v_mul_f32 v23, v23, v21
aw a235,v23
ar v23,a244
v_mul_f32 v23, v23, v21
aw a244,v23
ar v23,a245
v_mul_f32 v23, v23, v21
aw a245,v23
ar v23,a246
v_mul_f32 v23, v23, v21
aw a246,v23
ar v23,a247
v_mul_f32 v23, v23, v21
aw a247,v23
ar v21,a96
s_nop 3
s_setpc_b64 s[84:85]
Lslowh_b:
s_nop 15
v_bfe_u32 v0, v1, 4, 4
v_lshrrev_b32 v23, 8, v1
v_lshlrev_b32 v23, 4, v23
v_lshl_add_u32 v0, v0, 9, v23
s_add_u32 s72, s43, 0
buffer_load_dwordx4 a[112:115], v0, s[12:15], s72 offen offset:0
buffer_load_dwordx4 a[116:119], v0, s[12:15], s72 offen offset:64
buffer_load_dwordx4 a[120:123], v0, s[12:15], s72 offen offset:128
buffer_load_dwordx4 a[124:127], v0, s[12:15], s72 offen offset:192
s_waitcnt vmcnt(0)
mz v[44:47],a[112:115],a[0:3],v[32:35]
mf v[44:47],a[116:119],a[12:15]
mf v[44:47],a[120:123],a[24:27]
mf v[44:47],a[124:127],a[36:39]
mz v[48:51],a[112:115],a[4:7],v[36:39]
mf v[48:51],a[116:119],a[16:19]
mf v[48:51],a[120:123],a[28:31]
mf v[48:51],a[124:127],a[40:43]
mz v[52:55],a[112:115],a[8:11],v[40:43]
mf v[52:55],a[116:119],a[20:23]
mf v[52:55],a[120:123],a[32:35]
mf v[52:55],a[124:127],a[44:47]
s_nop 7
buffer_load_dwordx4 a[112:115], v0, s[12:15], s72 offen offset:256
buffer_load_dwordx4 a[116:119], v0, s[12:15], s72 offen offset:320
buffer_load_dwordx4 a[120:123], v0, s[12:15], s72 offen offset:384
buffer_load_dwordx4 a[124:127], v0, s[12:15], s72 offen offset:448
s_waitcnt vmcnt(0)
mf v[44:47],a[112:115],a[48:51]
mf v[44:47],a[116:119],a[60:63]
mf v[44:47],a[120:123],a[72:75]
mf v[44:47],a[124:127],a[84:87]
mf v[48:51],a[112:115],a[52:55]
mf v[48:51],a[116:119],a[64:67]
mf v[48:51],a[120:123],a[76:79]
mf v[48:51],a[124:127],a[88:91]
mf v[52:55],a[112:115],a[56:59]
mf v[52:55],a[116:119],a[68:71]
mf v[52:55],a[120:123],a[80:83]
mf v[52:55],a[124:127],a[92:95]
s_nop 7
s_add_u32 s72, s43, 8192
buffer_load_dwordx4 a[112:115], v0, s[12:15], s72 offen offset:0
buffer_load_dwordx4 a[116:119], v0, s[12:15], s72 offen offset:64
buffer_load_dwordx4 a[120:123], v0, s[12:15], s72 offen offset:128
buffer_load_dwordx4 a[124:127], v0, s[12:15], s72 offen offset:192
s_waitcnt vmcnt(0)
mz v[68:71],a[112:115],a[0:3],v[32:35]
mf v[68:71],a[116:119],a[12:15]
mf v[68:71],a[120:123],a[24:27]
mf v[68:71],a[124:127],a[36:39]
mz v[72:75],a[112:115],a[4:7],v[36:39]
mf v[72:75],a[116:119],a[16:19]
mf v[72:75],a[120:123],a[28:31]
mf v[72:75],a[124:127],a[40:43]
mz v[76:79],a[112:115],a[8:11],v[40:43]
mf v[76:79],a[116:119],a[20:23]
mf v[76:79],a[120:123],a[32:35]
mf v[76:79],a[124:127],a[44:47]
s_nop 7
buffer_load_dwordx4 a[112:115], v0, s[12:15], s72 offen offset:256
buffer_load_dwordx4 a[116:119], v0, s[12:15], s72 offen offset:320
buffer_load_dwordx4 a[120:123], v0, s[12:15], s72 offen offset:384
buffer_load_dwordx4 a[124:127], v0, s[12:15], s72 offen offset:448
s_waitcnt vmcnt(0)
mf v[68:71],a[112:115],a[48:51]
mf v[68:71],a[116:119],a[60:63]
mf v[68:71],a[120:123],a[72:75]
mf v[68:71],a[124:127],a[84:87]
mf v[72:75],a[112:115],a[52:55]
mf v[72:75],a[116:119],a[64:67]
mf v[72:75],a[120:123],a[76:79]
mf v[72:75],a[124:127],a[88:91]
mf v[76:79],a[112:115],a[56:59]
mf v[76:79],a[116:119],a[68:71]
mf v[76:79],a[120:123],a[80:83]
mf v[76:79],a[124:127],a[92:95]
s_nop 7
s_nop 15
aw a112,v21
v_max3_f32 v0, v44, v45, v46
v_max3_f32 v0, v0, v47, v68
v_max3_f32 v0, v0, v69, v70
v_max_f32 v0, v0, v71
v_mov_b32 v23, v0
s_nop 1
v_permlane32_swap_b32 v0, v23
v_max_f32 v0, v0, v23
v_mov_b32 v23, v0
s_nop 1
v_permlane16_swap_b32 v0, v23
v_max_f32 v0, v0, v23
v_ceil_f32 v0, v0
v_sub_f32 v32, v32, v0
v_sub_f32 v33, v33, v0
v_sub_f32 v34, v34, v0
v_sub_f32 v35, v35, v0
v_sub_f32 v44, v44, v0
v_sub_f32 v45, v45, v0
v_sub_f32 v46, v46, v0
v_sub_f32 v47, v47, v0
v_sub_f32 v68, v68, v0
v_sub_f32 v69, v69, v0
v_sub_f32 v70, v70, v0
v_sub_f32 v71, v71, v0
v_sub_f32 v56, v56, v0
v_sub_f32 v57, v57, v0
v_sub_f32 v58, v58, v0
v_sub_f32 v59, v59, v0
v_exp_f32 v44, v44
v_exp_f32 v45, v45
s_nop 0
v_add_f32 v24, v44, v45
cv v44,v44,v45
v_exp_f32 v46, v46
v_exp_f32 v47, v47
v_add_f32 v24, v46, v24
v_add_f32 v24, v47, v24
cv v45,v46,v47
v_exp_f32 v68, v68
v_exp_f32 v69, v69
v_add_f32 v24, v68, v24
v_add_f32 v24, v69, v24
cv v46,v68,v69
v_exp_f32 v70, v70
v_exp_f32 v71, v71
v_add_f32 v24, v70, v24
v_add_f32 v24, v71, v24
cv v47,v70,v71
v_max3_f32 v0, v48, v49, v50
v_max3_f32 v0, v0, v51, v72
v_max3_f32 v0, v0, v73, v74
v_max_f32 v0, v0, v75
v_mov_b32 v23, v0
s_nop 1
v_permlane32_swap_b32 v0, v23
v_max_f32 v0, v0, v23
v_mov_b32 v23, v0
s_nop 1
v_permlane16_swap_b32 v0, v23
v_max_f32 v0, v0, v23
v_ceil_f32 v0, v0
v_sub_f32 v36, v36, v0
v_sub_f32 v37, v37, v0
v_sub_f32 v38, v38, v0
v_sub_f32 v39, v39, v0
v_sub_f32 v48, v48, v0
v_sub_f32 v49, v49, v0
v_sub_f32 v50, v50, v0
v_sub_f32 v51, v51, v0
v_sub_f32 v72, v72, v0
v_sub_f32 v73, v73, v0
v_sub_f32 v74, v74, v0
v_sub_f32 v75, v75, v0
v_sub_f32 v60, v60, v0
v_sub_f32 v61, v61, v0
v_sub_f32 v62, v62, v0
v_sub_f32 v63, v63, v0
v_exp_f32 v48, v48
v_exp_f32 v49, v49
s_nop 0
v_add_f32 v25, v48, v49
cv v48,v48,v49
v_exp_f32 v50, v50
v_exp_f32 v51, v51
v_add_f32 v25, v50, v25
v_add_f32 v25, v51, v25
cv v49,v50,v51
v_exp_f32 v72, v72
v_exp_f32 v73, v73
v_add_f32 v25, v72, v25
v_add_f32 v25, v73, v25
cv v50,v72,v73
v_exp_f32 v74, v74
v_exp_f32 v75, v75
v_add_f32 v25, v74, v25
v_add_f32 v25, v75, v25
cv v51,v74,v75
v_max3_f32 v0, v52, v53, v54
v_max3_f32 v0, v0, v55, v76
v_max3_f32 v0, v0, v77, v78
v_max_f32 v0, v0, v79
v_mov_b32 v23, v0
s_nop 1
v_permlane32_swap_b32 v0, v23
v_max_f32 v0, v0, v23
v_mov_b32 v23, v0
s_nop 1
v_permlane16_swap_b32 v0, v23
v_max_f32 v0, v0, v23
v_ceil_f32 v0, v0
v_sub_f32 v40, v40, v0
v_sub_f32 v41, v41, v0
v_sub_f32 v42, v42, v0
v_sub_f32 v43, v43, v0
v_sub_f32 v52, v52, v0
v_sub_f32 v53, v53, v0
v_sub_f32 v54, v54, v0
v_sub_f32 v55, v55, v0
v_sub_f32 v76, v76, v0
v_sub_f32 v77, v77, v0
v_sub_f32 v78, v78, v0
v_sub_f32 v79, v79, v0
v_sub_f32 v64, v64, v0
v_sub_f32 v65, v65, v0
v_sub_f32 v66, v66, v0
v_sub_f32 v67, v67, v0
v_exp_f32 v52, v52
v_exp_f32 v53, v53
s_nop 0
v_add_f32 v26, v52, v53
cv v52,v52,v53
v_exp_f32 v54, v54
v_exp_f32 v55, v55
v_add_f32 v26, v54, v26
v_add_f32 v26, v55, v26
cv v53,v54,v55
v_exp_f32 v76, v76
v_exp_f32 v77, v77
v_add_f32 v26, v76, v26
v_add_f32 v26, v77, v26
cv v54,v76,v77
v_exp_f32 v78, v78
v_exp_f32 v79, v79
v_add_f32 v26, v78, v26
v_add_f32 v26, v79, v26
cv v55,v78,v79
ar v21,a112
s_nop 3
s_setpc_b64 s[84:85]
L_end:
s_endpgm
.section .rodata,"a"
.p2align 6
.amdhsa_kernel concat_heads__mha_block_cached__gqa_block_cached__near_ridge_kernel
  .amdhsa_next_free_vgpr 512
  .amdhsa_next_free_sgpr 102
  .amdhsa_accum_offset 256
  .amdhsa_group_segment_fixed_size 0
  .amdhsa_kernarg_size 104
  .amdhsa_user_sgpr_count 2
  .amdhsa_user_sgpr_kernarg_segment_ptr 1
  .amdhsa_system_sgpr_workgroup_id_x 1
.end_amdhsa_kernel
```
